```python
import torch

def _softmax(x, axis=-1):
    return torch.softmax(x, dim=axis)
def _gelu(x):
    return torch.nn.functional.gelu(x, approximate="tanh")
def _silu(x):
    return torch.nn.functional.silu(x)
def _sigmoid(x):
    return torch.sigmoid(x)
def _layernorm(x, axis=-1, eps=1e-5):
    m = x.mean(dim=axis, keepdim=True)
    v = x.var(dim=axis, keepdim=True, unbiased=False)
    return (x - m) / torch.sqrt(v + eps)
def _scatter_add(tgt, idx, src, axis=0):
    return tgt.clone().index_add_(axis, idx, src)
def _segment_sum(src, seg, n):
    out = torch.zeros((n,) + src.shape[1:], dtype=src.dtype)
    return out.index_add_(0, seg, src)
def _pad(x, pw):
    flat = tuple(v for pair in reversed(pw) for v in pair)
    return torch.nn.functional.pad(x, flat)

kernel_name = 'recurrent_scan__compressed_kv_cla__swiglu_ffn__prompt'

def setup_inputs():

    _w = (lambda a: (lambda t: t.to(torch.bfloat16) if t.is_floating_point() else t)(torch.as_tensor(a)))
    def _A_setup():
        B, H, Sq, Sk, D, M = 1, 16, 2048, 2048, 256, 448
        Dc = 4 * D
        return {
            "x": _w((lambda *s: torch.randn(*s, dtype=torch.bfloat16) * 0.05)(B, Sq, M)),
            "c_kv": _w((lambda *s: torch.randn(*s, dtype=torch.bfloat16) * 0.2)(B, Sk, Dc)),
            "w_q": _w((lambda *s: torch.randn(*s, dtype=torch.bfloat16) * 3.2)(M, H, D) * (M ** -0.5)),
            "w_uk": _w((lambda *s: torch.randn(*s, dtype=torch.bfloat16) * 3.2)(Dc, H, D) * (Dc ** -0.5)),
            "w_uv": _w((lambda *s: torch.randn(*s, dtype=torch.bfloat16) * 0.2)(Dc, H, D) * (Dc ** -0.5)),
            "w_o": _w((lambda *s: torch.randn(*s, dtype=torch.bfloat16) * 0.2)(H, D, M) * ((H * D) ** -0.5)),
        }
    _A_in = _A_setup()

    def _B_setup():
        B, S, D, F = 1, 2048, 448, 1792
        return {
            "x": _w((lambda *s: torch.randn(*s, dtype=torch.bfloat16) * 0.05)(B, S, D)),
            "w_gate": _w((lambda *s: torch.randn(*s, dtype=torch.bfloat16) * 0.1)(D, F)),
            "w_up": _w((lambda *s: torch.randn(*s, dtype=torch.bfloat16) * 0.1)(D, F)),
            "w_down": _w((lambda *s: torch.randn(*s, dtype=torch.bfloat16) * 0.1)(F, D)),
        }
    _B_in = _B_setup()

    return {
        "A_x": _A_in["x"],
        "A_c_kv": _A_in["c_kv"],
        "A_w_q": _A_in["w_q"],
        "A_w_uk": _A_in["w_uk"],
        "A_w_uv": _A_in["w_uv"],
        "A_w_o": _A_in["w_o"],
        "B_x": _B_in["x"],
        "B_w_gate": _B_in["w_gate"],
        "B_w_up": _B_in["w_up"],
        "B_w_down": _B_in["w_down"],
    }

def reference(A_x, A_c_kv, A_w_q, A_w_uk, A_w_uv, A_w_o, B_x, B_w_gate, B_w_up, B_w_down):
    def _A_ref(x, c_kv, w_q, w_uk, w_uv, w_o):
        B, Sq, M = x.shape[0], x.shape[1], x.shape[2]
        Sk = c_kv.shape[1]
        H, D = w_q.shape[1], w_q.shape[2]
        q = torch.einsum("bqm,mhd->bhqd", x, w_q)
        k = torch.einsum("bkc,chd->bhkd", c_kv, w_uk)
        v = torch.einsum("bkc,chd->bhkd", c_kv, w_uv)
        scores = torch.einsum("bhqd,bhkd->bhqk", q, k) * (D ** -0.5)
        off = Sk - Sq
        qi = torch.arange(Sq)[:, None]
        kj = torch.arange(Sk)[None, :]
        cmask = kj <= (qi + off)
        scores = torch.where(cmask[None, None], scores, -1e9)
        p = _softmax(scores, axis=-1)
        ctx = torch.einsum("bhqk,bhkd->bhqd", p, v)
        return torch.einsum("bhqd,hdm->bqm", ctx, w_o)

    def _B_ref(x, w_gate, w_up, w_down):
        g = _silu(x @ w_gate)
        u = x @ w_up
        return (g * u) @ w_down

    x = A_x
    xn = _layernorm(x, axis=-1)
    s = _A_ref(xn, A_c_kv, A_w_q, A_w_uk, A_w_uv, A_w_o)
    g = _silu(_B_ref(xn, B_w_gate, B_w_up, B_w_down))
    return x + s * g
```

```asm
; @launch grid=(256,1,1) block=(256,1,1) lds=163840
.amdgcn_target "amdgcn-amd-amdhsa--gfx950"
.text
    .p2align 8
    .globl recurrent_scan__compressed_kv_cla__swiglu_ffn__prompt_kernel
    .type recurrent_scan__compressed_kv_cla__swiglu_ffn__prompt_kernel,@function
recurrent_scan__compressed_kv_cla__swiglu_ffn__prompt_kernel:
    s_cmp_lt_u32 s2, 256
    s_cbranch_scc1 fz
    s_endpgm
fz:
    s_load_dwordx16 s[40:55], s[0:1], 0
    s_load_dwordx8 s[56:63], s[0:1], 64
    s_load_dwordx2 s[64:65], s[0:1], 96
    s_getpc_b64 s[4:5]
fz_pc_1:
    s_lshr_b32 s6, s2, 3
    v_lshrrev_b32 v28, 6, v0
    v_and_b32 v29, 63, v0
    v_lshl_add_u32 v28, s6, 2, v28
    v_min_u32 v29, 4, v29
    v_mad_u32_u24 v28, v28, 5, v29
    s_sub_u32 s4, s4, fz_pc_1-fz
    s_subb_u32 s5, s5, 0
    v_min_u32 v28, (fz_zend-fz)/128, v28
    v_mov_b32 v29, 0
    v_lshlrev_b32 v28, 7, v28
    v_lshl_add_u64 v[28:29], v[28:29], 0, s[4:5]
    global_load_dword v31, v[28:29], off
    v_lshrrev_b32 v1, 6, v0
    s_and_b32 s68, s2, 15
    v_readfirstlane_b32 s66, v1
    v_and_b32 v1, 63, v0
    s_lshr_b32 s69, s2, 4
    v_lshlrev_b32 v20, 4, v1
    s_lshl_b32 s67, s66, 12
    s_lshl_b32 s86, s69, 4
    s_add_u32 s86, s86, s68
    s_lshl_b32 s86, s86, 2
    s_add_u32 s86, s86, s66
    s_mul_i32 s87, s86, 1792
    v_cmp_gt_u32 vcc, 56, v1
    v_mov_b32 v24, 0x7fffff00
    v_lshrrev_b32 v25, 3, v1
    s_lshl_b32 s88, s66, 5
    v_cndmask_b32 v22, v24, v20, vcc
    v_add_u32 v25, s88, v25
    v_lshlrev_b32 v25, 11, v25
    v_lshrrev_b32 v26, 4, v1
    v_and_b32 v27, 7, v1
    v_xor_b32 v27, v27, v26
    v_lshl_add_u32 v10, v27, 4, v25
    v_xor_b32 v27, 4, v27
    v_lshl_add_u32 v11, v27, 4, v25
    v_add_u32 v12, 30720, v10
    v_add_u32 v11, 15360, v11
    v_add_u32 v13, 30720, v11
    v_lshrrev_b32 v28, 5, v1
    v_lshlrev_b32 v28, 1, v28
    v_and_b32 v27, 3, v1
    v_xor_b32 v28, v28, v27
    v_lshlrev_b32 v4, 4, v28
    v_lshrrev_b32 v25, 3, v1
    v_and_b32 v28, 2, v25
    v_and_b32 v29, 7, v1
    v_xor_b32 v28, v28, v29
    v_lshlrev_b32 v25, 13, v25
    v_lshl_add_u32 v2, v28, 4, v25
    v_xor_b32 v3, 64, v2
    v_add_u32 v3, 64512, v3
    s_cmp_lt_u32 s66, 2
    s_cselect_b32 s86, 2, 1
    s_cselect_b32 s88, 3, 1
    s_cselect_b32 s3, 13, 11
    v_lshrrev_b32 v29, s86, v1
    v_and_b32 v30, s88, v1
    v_lshlrev_b32 v30, 7, v30
    v_lshlrev_b32 v8, s3, v29
    v_add_u32 v8, v8, v30
    s_lshl_b32 s30, s86, 22
    s_mov_b32 s31, 0x20000
    s_lshl_b32 s74, s69, 16
    s_lshl_b32 s86, s68, 9
    s_add_u32 s74, s74, s86
    s_lshl_b32 s86, s69, 1
    s_lshr_b32 s88, s68, 3
    s_add_u32 s86, s86, s88
    s_lshl_b32 s86, s86, 1
    s_add_u32 s86, s86, s66
    s_sub_u32 s86, s86, 2
    s_lshl_b32 s86, s86, 16
    s_and_b32 s88, s68, 0
    s_lshl_b32 s71, s88, 20
    s_lshl_b32 s70, s88, 8
    s_add_u32 s74, s74, s71
    s_add_u32 s86, s86, s70
    s_movk_i32 s88, 256
    s_cmp_lt_u32 s66, 2
    s_cselect_b32 s74, s74, s86
    s_cselect_b32 s75, 1048576, s88
    s_cselect_b32 s86, 32, 64
    s_cselect_b32 s88, 23, 11
    v_cmp_gt_u32 s[36:37], s86, v1
    s_add_u32 s75, s75, s74
    s_bitset0_b32 s75, s88
    v_cndmask_b32 v8, v24, v8, s[36:37]
    s_mov_b32 s72, s71
    s_lshl_b32 s86, s69, 18
    s_add_u32 s70, s70, s86
    s_lshl_b32 s86, s68, 9
    s_and_b32 s88, s66, 1
    s_lshl_b32 s88, s88, 8
    s_add_u32 s86, s86, s88
    s_waitcnt lgkmcnt(0)
    s_cmp_lt_u32 s66, 2
    s_cselect_b32 s28, s46, s42
    s_cselect_b32 s29, s47, s43
    s_cmp_eq_u32 s66, 1
    s_cselect_b32 s28, s48, s28
    s_cselect_b32 s29, s49, s29
    buffer_load_dword v31, v8, s[28:31], s74 offen
    s_mov_b32 s36, s40
    s_mov_b32 s37, s41
    s_mov_b32 s38, 1835008
    s_mov_b32 s39, 0x20000
    s_mov_b32 s20, s42
    s_mov_b32 s21, s43
    s_mov_b32 s22, 4194304
    s_mov_b32 s23, 0x20000
    buffer_load_dwordx4 v[32:35], v22, s[36:39], s87 offen
    buffer_load_dwordx4 v[36:39], v22, s[36:39], s87 offen offset:896
    s_cmp_lt_u32 s66, 2
    s_cselect_b32 s52, s46, s48
    s_cselect_b32 s53, s47, s49
    s_add_u32 s4, s52, s86
    s_addc_u32 s5, s53, 0
    s_sub_u32 s6, 8388608, s86
    s_mov_b32 s7, 0x20000
    s_add_u32 s86, s86, 129024
    s_add_u32 s8, s52, s86
    s_addc_u32 s9, s53, 0
    s_sub_u32 s10, 8388608, s86
    s_mov_b32 s11, 0x20000
    s_sub_u32 s86, s86, 128896
    s_add_u32 s12, s52, s86
    s_addc_u32 s13, s53, 0
    s_sub_u32 s14, 8388608, s86
    s_mov_b32 s15, 0x20000
    s_add_u32 s86, s86, 129024
    s_add_u32 s16, s52, s86
    s_addc_u32 s17, s53, 0
    s_sub_u32 s18, 8388608, s86
    s_mov_b32 s19, 0x20000
    s_add_u32 m0, s67, 131072
    s_nop 0
    buffer_load_dwordx4 v10, s[20:23], s70 offen offset:0  lds
    buffer_load_dwordx4 v11, s[20:23], s70 offen offset:1024  lds
    buffer_load_dwordx4 v12, s[20:23], s70 offen offset:2048  lds
    buffer_load_dwordx4 v13, s[20:23], s70 offen offset:3072  lds
    s_add_u32 m0, s67, 65536
    s_nop 0
    buffer_load_dwordx4 v2, s[4:7], s71 offen offset:0  lds
    buffer_load_dwordx4 v3, s[4:7], s71 offen offset:1024  lds
    buffer_load_dwordx4 v2, s[8:11], s71 offen offset:2048  lds
    buffer_load_dwordx4 v3, s[8:11], s71 offen offset:3072  lds
    s_add_u32 m0, s67, 81920
    s_nop 0
    s_add_u32 s71, s71, 262144
    buffer_load_dwordx4 v2, s[4:7], s71 offen offset:0  lds
    buffer_load_dwordx4 v3, s[4:7], s71 offen offset:1024  lds
    buffer_load_dwordx4 v2, s[8:11], s71 offen offset:2048  lds
    buffer_load_dwordx4 v3, s[8:11], s71 offen offset:3072  lds
    s_add_u32 s71, s71, 262144
    s_add_u32 s70, s70, 128
    s_add_u32 m0, s67, 98304
    s_nop 0
    buffer_load_dwordx4 v2, s[12:15], s72 offen offset:0  lds
    buffer_load_dwordx4 v3, s[12:15], s72 offen offset:1024  lds
    buffer_load_dwordx4 v2, s[16:19], s72 offen offset:2048  lds
    buffer_load_dwordx4 v3, s[16:19], s72 offen offset:3072  lds
    s_add_u32 m0, s67, 114688
    s_nop 0
    s_add_u32 s72, s72, 262144
    buffer_load_dwordx4 v2, s[12:15], s72 offen offset:0  lds
    buffer_load_dwordx4 v3, s[12:15], s72 offen offset:1024  lds
    buffer_load_dwordx4 v2, s[16:19], s72 offen offset:2048  lds
    buffer_load_dwordx4 v3, s[16:19], s72 offen offset:3072  lds
    s_add_u32 s72, s72, 262144
    s_add_u32 m0, s67, 147456
    s_nop 0
    buffer_load_dwordx4 v10, s[20:23], s70 offen offset:0  lds
    buffer_load_dwordx4 v11, s[20:23], s70 offen offset:1024  lds
    buffer_load_dwordx4 v12, s[20:23], s70 offen offset:2048  lds
    buffer_load_dwordx4 v13, s[20:23], s70 offen offset:3072  lds
    s_add_u32 m0, s67, 0
    s_nop 0
    buffer_load_dwordx4 v2, s[4:7], s71 offen offset:0  lds
    buffer_load_dwordx4 v3, s[4:7], s71 offen offset:1024  lds
    buffer_load_dwordx4 v2, s[8:11], s71 offen offset:2048  lds
    buffer_load_dwordx4 v3, s[8:11], s71 offen offset:3072  lds
    s_add_u32 m0, s67, 16384
    s_nop 0
    s_add_u32 s71, s71, 262144
    buffer_load_dwordx4 v2, s[4:7], s71 offen offset:0  lds
    buffer_load_dwordx4 v3, s[4:7], s71 offen offset:1024  lds
    buffer_load_dwordx4 v2, s[8:11], s71 offen offset:2048  lds
    buffer_load_dwordx4 v3, s[8:11], s71 offen offset:3072  lds
    s_add_u32 s71, s71, 262144
    s_add_u32 s70, s70, 128
    s_add_u32 m0, s67, 32768
    s_nop 0
    buffer_load_dwordx4 v2, s[12:15], s72 offen offset:0  lds
    buffer_load_dwordx4 v3, s[12:15], s72 offen offset:1024  lds
    buffer_load_dwordx4 v2, s[16:19], s72 offen offset:2048  lds
    buffer_load_dwordx4 v3, s[16:19], s72 offen offset:3072  lds
    s_add_u32 m0, s67, 49152
    s_nop 0
    s_add_u32 s72, s72, 262144
    buffer_load_dwordx4 v2, s[12:15], s72 offen offset:0  lds
    buffer_load_dwordx4 v3, s[12:15], s72 offen offset:1024  lds
    buffer_load_dwordx4 v2, s[16:19], s72 offen offset:2048  lds
    buffer_load_dwordx4 v3, s[16:19], s72 offen offset:3072  lds
    s_add_u32 s72, s72, 262144
    buffer_load_dword v31, v8, s[28:31], s75 offen
    s_mov_b32 s24, s64
    s_mov_b32 s25, s65
    s_mov_b32 s26, 268435456
    s_mov_b32 s27, 0x20000
    s_mov_b32 s32, s62
    s_mov_b32 s33, s63
    s_mov_b32 s34, 0
    s_mov_b32 s35, 0x20000
    s_lshl_b32 s86, s2, 1
    s_and_b32 s87, s66, 1
    s_add_u32 s86, s86, s87
    s_lshl_b32 s87, s86, 13
    s_cmp_lt_u32 s66, 2
    s_cselect_b32 s87, 2147483648, s87
    v_and_b32 v24, 12, v1
    v_cmp_eq_u32 s[36:37], 0, v24
    v_lshlrev_b32 v8, 7, v1
    s_mov_b32 s74, s86
    s_sub_u32 s75, s69, 6
    v_cndmask_b32 v24, v8, -1, s[36:37]
    s_cmp_lt_u32 s69, 12
    s_cselect_b32 s75, s69, s75
    v_and_b32 v24, 0x7fffff80, v24
    buffer_load_dword v31, v24, s[20:23], s87 offen
    s_mov_b32 s36, s44
    s_mov_b32 s37, s45
    s_mov_b32 s73, 3670016
    s_sub_u32 s87, s86, 224
    s_cselect_b32 s36, s36, s54
    s_cselect_b32 s37, s37, s55
    s_cselect_b32 s74, s74, s87
    s_cselect_b32 s73, s73, 1605632
    s_sub_u32 s87, s86, 322
    s_cselect_b32 s36, s36, s56
    s_cselect_b32 s37, s37, s57
    s_cselect_b32 s74, s74, s87
    s_lshl_b32 s74, s74, 14
    s_lshl_b32 s86, s69, 15
    s_lshl_b32 s87, s68, 9
    s_add_u32 s86, s86, s87
    s_add_u32 s86, s86, 2097152
    s_cmp_lt_u32 s66, 2
    s_cselect_b32 s74, s86, s74
    s_cselect_b32 s28, s28, s36
    s_cselect_b32 s29, s29, s37
    s_cselect_b64 s[36:37], -1, 0
    v_lshrrev_b32 v25, 2, v1
    v_lshlrev_b32 v25, 13, v25
    v_lshl_add_u32 v25, v27, 7, v25
    v_lshl_add_u32 v25, v26, 28, v25
    v_lshlrev_b32 v8, 8, v1
    v_cndmask_b32 v8, v8, v25, s[36:37]
    s_mul_i32 s86, s68, 2129920
    s_lshl_b32 s87, s69, 17
    s_add_u32 s86, s86, s87
    s_add_u32 s86, s86, 4227072
    s_lshl_b32 s87, s66, 12
    s_lshl_b32 s88, s66, 13
    s_cmp_lt_u32 s66, 2
    s_cselect_b32 s87, s87, s88
    s_cselect_b32 s88, 2, 1
    s_lshl_b32 s88, s88, 12
    s_add_u32 s78, s86, s87
    s_add_u32 s82, s78, s88
    s_add_u32 s79, s78, 32768
    s_add_u32 s83, s82, 32768
    s_add_u32 s80, s78, 65536
    s_add_u32 s84, s82, 65536
    s_add_u32 s81, s78, 98304
    s_add_u32 s85, s82, 98304
    v_and_b32 v24, 15, v1
    v_lshrrev_b32 v25, 1, v24
    v_xor_b32 v25, v25, v26
    v_lshlrev_b32 v24, 7, v24
    v_add_u32 v24, 131072, v24
    v_lshl_add_u32 v14, v25, 4, v24
    v_xor_b32 v25, 4, v25
    v_lshl_add_u32 v15, v25, 4, v24
    v_bfe_u32 v24, v1, 2, 2
    v_lshl_add_u32 v24, v26, 3, v24
    v_lshlrev_b32 v24, 7, v24
    v_lshl_add_u32 v24, v27, 3, v24
    v_bfe_u32 v25, v1, 3, 2
    v_lshl_add_u32 v24, v25, 5, v24
    v_add_u32 v24, s67, v24
    v_add_u32 v16, 65536, v24
    v_xor_b32 v17, 32, v16
    v_xor_b32 v18, 64, v16
    v_xor_b32 v19, 0x60, v16
    s_mov_b32 s76, 0
    v_lshrrev_b32 v25, 2, v1
    v_mul_u32_u24 v25, 3584, v25
    v_add_u32 v4, v25, v4
    v_add_u32 v5, 55296, v4
    s_lshl_b32 s86, 1, s68
    v_mov_b32 v23, s86
    s_lshl_b32 s86, s69, 2
    v_lshlrev_b32 v9, 10, v0
    v_add_u32 v9, s86, v9
    s_lshl_b32 s86, s68, 2
    s_add_u32 s86, s86, s66
    s_mul_i32 s89, s69, 114688
    s_lshl_b32 s87, s86, 8
    s_add_u32 s89, s89, s87
    v_xor_b32 v24, s86, v1
    v_and_b32 v24, 7, v24
    v_lshrrev_b32 v25, 3, v1
    v_lshlrev_b32 v25, 10, v25
    v_add_lshl_u32 v24, v24, v25, 4
    v_cndmask_b32 v22, v22, v24, vcc
    s_and_b32 s77, s69, 7
    s_add_u32 s77, s77, 2
    v_accvgpr_write_b32 a192, 0
    v_accvgpr_write_b32 a193, 0
    v_accvgpr_write_b32 a194, 0
    v_accvgpr_write_b32 a195, 0
    s_nop 1
    v_mfma_f32_32x32x16_bf16 v[64:79], a[192:195], a[192:195], 0
    v_mfma_f32_32x32x16_bf16 v[80:95], a[192:195], a[192:195], 0
    v_mfma_f32_32x32x16_bf16 v[96:111], a[192:195], a[192:195], 0
    v_mfma_f32_32x32x16_bf16 v[112:127], a[192:195], a[192:195], 0
    v_mfma_f32_32x32x16_bf16 v[128:143], a[192:195], a[192:195], 0
    v_mfma_f32_32x32x16_bf16 v[144:159], a[192:195], a[192:195], 0
    v_mfma_f32_32x32x16_bf16 v[160:175], a[192:195], a[192:195], 0
    v_mfma_f32_32x32x16_bf16 v[176:191], a[192:195], a[192:195], 0
    v_mfma_f32_32x32x16_bf16 v[192:207], a[192:195], a[192:195], 0
    v_mfma_f32_32x32x16_bf16 v[208:223], a[192:195], a[192:195], 0
    v_mfma_f32_32x32x16_bf16 v[224:239], a[192:195], a[192:195], 0
    v_mfma_f32_32x32x16_bf16 v[240:255], a[192:195], a[192:195], 0
    v_mfma_f32_32x32x16_bf16 a[0:15], a[192:195], a[192:195], 0
    v_mfma_f32_32x32x16_bf16 a[16:31], a[192:195], a[192:195], 0
    s_waitcnt vmcnt(42)
    v_lshlrev_b32 v40, 16, v32
    v_and_b32 v41, 0xffff0000, v32
    v_lshlrev_b32 v48, 16, v36
    v_and_b32 v49, 0xffff0000, v36
    v_lshlrev_b32 v42, 16, v33
    v_and_b32 v43, 0xffff0000, v33
    v_lshlrev_b32 v50, 16, v37
    v_and_b32 v51, 0xffff0000, v37
    v_lshlrev_b32 v44, 16, v34
    v_and_b32 v45, 0xffff0000, v34
    v_lshlrev_b32 v52, 16, v38
    v_and_b32 v53, 0xffff0000, v38
    v_lshlrev_b32 v46, 16, v35
    v_and_b32 v47, 0xffff0000, v35
    v_lshlrev_b32 v54, 16, v39
    v_and_b32 v55, 0xffff0000, v39
    v_add_f32 v24, v40, v41
    v_add_f32 v27, v48, v49
    v_add_f32 v24, v24, v42
    v_add_f32 v27, v27, v50
    v_add_f32 v24, v24, v43
    v_add_f32 v27, v27, v51
    v_add_f32 v24, v24, v44
    v_add_f32 v27, v27, v52
    v_add_f32 v24, v24, v45
    v_add_f32 v27, v27, v53
    v_add_f32 v24, v24, v46
    v_add_f32 v27, v27, v54
    v_add_f32 v24, v24, v47
    v_add_f32 v27, v27, v55
    s_nop 0
    v_add_f32_dpp v24, v24, v24 quad_perm:[1,0,3,2] row_mask:0xf bank_mask:0xf
    v_add_f32_dpp v27, v27, v27 quad_perm:[1,0,3,2] row_mask:0xf bank_mask:0xf
    s_nop 0
    v_add_f32_dpp v24, v24, v24 quad_perm:[2,3,0,1] row_mask:0xf bank_mask:0xf
    v_add_f32_dpp v27, v27, v27 quad_perm:[2,3,0,1] row_mask:0xf bank_mask:0xf
    s_nop 0
    v_add_f32_dpp v24, v24, v24 row_half_mirror row_mask:0xf bank_mask:0xf
    v_add_f32_dpp v27, v27, v27 row_half_mirror row_mask:0xf bank_mask:0xf
    s_nop 0
    v_add_f32_dpp v24, v24, v24 row_mirror row_mask:0xf bank_mask:0xf
    v_add_f32_dpp v27, v27, v27 row_mirror row_mask:0xf bank_mask:0xf
    v_mov_b32 v25, v24
    v_mov_b32 v28, v27
    s_nop 0
    v_permlane16_swap_b32 v24, v25
    v_permlane16_swap_b32 v27, v28
    v_add_f32 v24, v24, v25
    v_add_f32 v27, v27, v28
    v_mov_b32 v25, v24
    v_mov_b32 v28, v27
    s_nop 0
    v_permlane32_swap_b32 v24, v25
    v_permlane32_swap_b32 v27, v28
    v_add_f32 v24, v24, v25
    v_add_f32 v27, v27, v28
    v_mul_f32 v24, 0x3b124925, v24
    v_mul_f32 v27, 0x3b124925, v27
    v_sub_f32 v25, v40, v24
    v_mul_f32 v26, v25, v25
    v_sub_f32 v28, v48, v27
    v_mul_f32 v29, v28, v28
    v_sub_f32 v25, v41, v24
    v_fmac_f32 v26, v25, v25
    v_sub_f32 v28, v49, v27
    v_fmac_f32 v29, v28, v28
    v_sub_f32 v25, v42, v24
    v_fmac_f32 v26, v25, v25
    v_sub_f32 v28, v50, v27
    v_fmac_f32 v29, v28, v28
    v_sub_f32 v25, v43, v24
    v_fmac_f32 v26, v25, v25
    v_sub_f32 v28, v51, v27
    v_fmac_f32 v29, v28, v28
    v_sub_f32 v25, v44, v24
    v_fmac_f32 v26, v25, v25
    v_sub_f32 v28, v52, v27
    v_fmac_f32 v29, v28, v28
    v_sub_f32 v25, v45, v24
    v_fmac_f32 v26, v25, v25
    v_sub_f32 v28, v53, v27
    v_fmac_f32 v29, v28, v28
    v_sub_f32 v25, v46, v24
    v_fmac_f32 v26, v25, v25
    v_sub_f32 v28, v54, v27
    v_fmac_f32 v29, v28, v28
    v_sub_f32 v25, v47, v24
    v_fmac_f32 v26, v25, v25
    v_sub_f32 v28, v55, v27
    v_fmac_f32 v29, v28, v28
    v_cndmask_b32 v26, 0, v26, vcc
    v_cndmask_b32 v29, 0, v29, vcc
    s_nop 0
    v_add_f32_dpp v26, v26, v26 quad_perm:[1,0,3,2] row_mask:0xf bank_mask:0xf
    v_add_f32_dpp v29, v29, v29 quad_perm:[1,0,3,2] row_mask:0xf bank_mask:0xf
    s_nop 0
    v_add_f32_dpp v26, v26, v26 quad_perm:[2,3,0,1] row_mask:0xf bank_mask:0xf
    v_add_f32_dpp v29, v29, v29 quad_perm:[2,3,0,1] row_mask:0xf bank_mask:0xf
    s_nop 0
    v_add_f32_dpp v26, v26, v26 row_half_mirror row_mask:0xf bank_mask:0xf
    v_add_f32_dpp v29, v29, v29 row_half_mirror row_mask:0xf bank_mask:0xf
    s_nop 0
    v_add_f32_dpp v26, v26, v26 row_mirror row_mask:0xf bank_mask:0xf
    v_add_f32_dpp v29, v29, v29 row_mirror row_mask:0xf bank_mask:0xf
    v_mov_b32 v25, v26
    v_mov_b32 v28, v29
    s_nop 0
    v_permlane16_swap_b32 v26, v25
    v_permlane16_swap_b32 v29, v28
    v_add_f32 v26, v26, v25
    v_add_f32 v29, v29, v28
    v_mov_b32 v25, v26
    v_mov_b32 v28, v29
    s_nop 0
    v_permlane32_swap_b32 v26, v25
    v_permlane32_swap_b32 v29, v28
    v_add_f32 v26, v26, v25
    v_add_f32 v29, v29, v28
    v_mul_f32 v26, 0x3b124925, v26
    v_mul_f32 v29, 0x3b124925, v29
    v_cvt_pk_bf16_f32 v24, v24, v24
    v_cvt_pk_bf16_f32 v27, v27, v27
    v_lshlrev_b32 v24, 16, v24
    v_lshlrev_b32 v27, 16, v27
    v_cvt_pk_bf16_f32 v26, v26, v26
    v_cvt_pk_bf16_f32 v29, v29, v29
    v_lshlrev_b32 v26, 16, v26
    v_lshlrev_b32 v29, 16, v29
    v_add_f32 v26, 0x3727c5ac, v26
    v_add_f32 v29, 0x3727c5ac, v29
    v_cvt_pk_bf16_f32 v26, v26, v26
    v_cvt_pk_bf16_f32 v29, v29, v29
    v_lshlrev_b32 v26, 16, v26
    v_lshlrev_b32 v29, 16, v29
    v_sqrt_f32 v26, v26
    v_sqrt_f32 v29, v29
    s_nop 0
    v_cvt_pk_bf16_f32 v26, v26, v26
    v_cvt_pk_bf16_f32 v29, v29, v29
    v_lshlrev_b32 v26, 16, v26
    v_lshlrev_b32 v29, 16, v29
    v_rcp_f32 v26, v26
    v_rcp_f32 v29, v29
    v_sub_f32 v40, v40, v24
    v_sub_f32 v48, v48, v27
    v_sub_f32 v41, v41, v24
    v_sub_f32 v49, v49, v27
    v_sub_f32 v42, v42, v24
    v_sub_f32 v50, v50, v27
    v_sub_f32 v43, v43, v24
    v_sub_f32 v51, v51, v27
    v_sub_f32 v44, v44, v24
    v_sub_f32 v52, v52, v27
    v_sub_f32 v45, v45, v24
    v_sub_f32 v53, v53, v27
    v_sub_f32 v46, v46, v24
    v_sub_f32 v54, v54, v27
    v_sub_f32 v47, v47, v24
    v_sub_f32 v55, v55, v27
    v_mul_f32 v26, 0x3db8aa3b, v26
    v_mul_f32 v29, 0x3db8aa3b, v29
    v_cvt_pk_bf16_f32 v32, v40, v41
    v_cvt_pk_bf16_f32 v36, v48, v49
    v_cvt_pk_bf16_f32 v33, v42, v43
    v_cvt_pk_bf16_f32 v37, v50, v51
    v_cvt_pk_bf16_f32 v34, v44, v45
    v_cvt_pk_bf16_f32 v38, v52, v53
    v_cvt_pk_bf16_f32 v35, v46, v47
    v_cvt_pk_bf16_f32 v39, v54, v55
    v_lshlrev_b32 v40, 16, v32
    v_and_b32 v41, 0xffff0000, v32
    v_lshlrev_b32 v48, 16, v36
    v_and_b32 v49, 0xffff0000, v36
    v_lshlrev_b32 v42, 16, v33
    v_and_b32 v43, 0xffff0000, v33
    v_lshlrev_b32 v50, 16, v37
    v_and_b32 v51, 0xffff0000, v37
    v_lshlrev_b32 v44, 16, v34
    v_and_b32 v45, 0xffff0000, v34
    v_lshlrev_b32 v52, 16, v38
    v_and_b32 v53, 0xffff0000, v38
    v_lshlrev_b32 v46, 16, v35
    v_and_b32 v47, 0xffff0000, v35
    v_lshlrev_b32 v54, 16, v39
    v_and_b32 v55, 0xffff0000, v39
    v_mul_f32 v40, v40, v26
    v_mul_f32 v48, v48, v29
    v_mul_f32 v41, v41, v26
    v_mul_f32 v49, v49, v29
    v_mul_f32 v42, v42, v26
    v_mul_f32 v50, v50, v29
    v_mul_f32 v43, v43, v26
    v_mul_f32 v51, v51, v29
    v_mul_f32 v44, v44, v26
    v_mul_f32 v52, v52, v29
    v_mul_f32 v45, v45, v26
    v_mul_f32 v53, v53, v29
    v_mul_f32 v46, v46, v26
    v_mul_f32 v54, v54, v29
    v_mul_f32 v47, v47, v26
    v_mul_f32 v55, v55, v29
    v_cvt_pk_bf16_f32 v32, v40, v41
    v_cvt_pk_bf16_f32 v36, v48, v49
    v_cvt_pk_bf16_f32 v33, v42, v43
    v_cvt_pk_bf16_f32 v37, v50, v51
    v_cvt_pk_bf16_f32 v34, v44, v45
    v_cvt_pk_bf16_f32 v38, v52, v53
    v_cvt_pk_bf16_f32 v35, v46, v47
    v_cvt_pk_bf16_f32 v39, v54, v55
    buffer_store_dwordx4 v[32:35], v22, s[24:27], s89 offen sc1
    buffer_store_dwordx4 v[36:39], v22, s[24:27], s89 offen offset:128 sc1
    v_lshlrev_b32 v24, 2, v0
    v_mov_b32 v25, 0
    s_lshl_b32 s86, s2, 5
    s_add_u32 s86, s86, 118489088
    s_add_u32 s38, s86, 32
    s_mov_b32 s36, s64
    s_mov_b32 s37, s65
    buffer_store_dword v25, v24, s[36:39], s86 offen sc1
    s_lshl_b32 s86, s2, 10
    s_add_u32 s86, s86, 118554624
    buffer_store_dword v25, v24, s[24:27], s86 offen sc1
    v_mfma_f32_32x32x16_bf16 v[48:63], a[192:195], a[192:195], 0
    v_and_b32 v22, 15, v1
    v_lshlrev_b32 v22, 2, v22
    s_waitcnt vmcnt(34)
    s_barrier
    ds_read_b64_tr_b16 a[160:161], v16 offset:0
    ds_read_b64_tr_b16 a[162:163], v16 offset:512
    ds_read_b64_tr_b16 a[164:165], v16 offset:16384
    ds_read_b64_tr_b16 a[166:167], v16 offset:16896
    ds_read_b128 a[32:35], v14 offset:0
    ds_read_b128 a[36:39], v15 offset:0
    ds_read_b128 a[40:43], v14 offset:2048
    ds_read_b128 a[44:47], v15 offset:2048
    ds_read_b128 a[48:51], v14 offset:4096
    ds_read_b128 a[52:55], v15 offset:4096
    ds_read_b128 a[56:59], v14 offset:6144
    ds_read_b128 a[60:63], v15 offset:6144
    ds_read_b128 a[64:67], v14 offset:8192
    ds_read_b128 a[68:71], v15 offset:8192
    ds_read_b128 a[72:75], v14 offset:10240
    ds_read_b128 a[76:79], v15 offset:10240
    ds_read_b128 a[80:83], v14 offset:12288
    ds_read_b128 a[84:87], v15 offset:12288
    ds_read_b128 a[88:91], v14 offset:14336
    ds_read_b128 a[92:95], v15 offset:14336
    ds_read_b64_tr_b16 a[168:169], v17 offset:0
    ds_read_b64_tr_b16 a[170:171], v17 offset:512
    ds_read_b64_tr_b16 a[172:173], v17 offset:16384
    ds_read_b64_tr_b16 a[174:175], v17 offset:16896
    v_mfma_f32_32x32x16_bf16 v[32:47], a[192:195], a[192:195], 0
    s_waitcnt lgkmcnt(0)
    s_barrier
    s_nop 7
    s_cmp_lt_u32 s66, 2
    s_cbranch_scc1 fz_N0
    .p2align 6
fz_V0:
    v_mfma_f32_16x16x32_bf16 v[32:35], a[32:35], a[160:163], v[32:35]
    v_mfma_f32_16x16x32_bf16 v[32:35], a[36:39], a[164:167], v[32:35]
    v_mfma_f32_16x16x32_bf16 v[36:39], a[40:43], a[160:163], v[36:39]
    ds_read_b64_tr_b16 a[176:177], v18 offset:0
    v_mfma_f32_16x16x32_bf16 v[36:39], a[44:47], a[164:167], v[36:39]
    v_mfma_f32_16x16x32_bf16 v[40:43], a[48:51], a[160:163], v[40:43]
    ds_read_b64_tr_b16 a[178:179], v18 offset:512
    v_mfma_f32_16x16x32_bf16 v[40:43], a[52:55], a[164:167], v[40:43]
    s_cmp_eq_u32 s76, s77
    v_mfma_f32_16x16x32_bf16 v[44:47], a[56:59], a[160:163], v[44:47]
    s_cselect_b32 s34, 64, 0
    ds_read_b64_tr_b16 a[180:181], v18 offset:16384
    v_mfma_f32_16x16x32_bf16 v[44:47], a[60:63], a[164:167], v[44:47]
    buffer_atomic_or v23, v9, s[32:35], 0 offen sc1
    v_mfma_f32_16x16x32_bf16 v[48:51], a[64:67], a[160:163], v[48:51]
    ds_read_b64_tr_b16 a[182:183], v18 offset:16896
    v_mfma_f32_16x16x32_bf16 v[48:51], a[68:71], a[164:167], v[48:51]
    v_mfma_f32_16x16x32_bf16 v[52:55], a[72:75], a[160:163], v[52:55]
    s_cmp_eq_u32 s76, 12
    v_mfma_f32_16x16x32_bf16 v[52:55], a[76:79], a[164:167], v[52:55]
    s_cselect_b32 s34, 64, 0
    v_mfma_f32_16x16x32_bf16 v[56:59], a[80:83], a[160:163], v[56:59]
    buffer_load_dword v21, v22, s[32:35], 0 offen sc1
    v_mfma_f32_16x16x32_bf16 v[56:59], a[84:87], a[164:167], v[56:59]
    v_mfma_f32_16x16x32_bf16 v[60:63], a[88:91], a[160:163], v[60:63]
    v_mfma_f32_16x16x32_bf16 v[60:63], a[92:95], a[164:167], v[60:63]
    v_mfma_f32_16x16x32_bf16 v[64:67], a[32:35], a[168:171], v[64:67]
    s_add_u32 m0, s67, 131072
    v_mfma_f32_16x16x32_bf16 v[64:67], a[36:39], a[172:175], v[64:67]
    buffer_load_dwordx4 v10, s[20:23], s70 offen offset:0  lds
    v_mfma_f32_16x16x32_bf16 v[68:71], a[40:43], a[168:171], v[68:71]
    ds_read_b64_tr_b16 a[184:185], v19 offset:0
    v_mfma_f32_16x16x32_bf16 v[68:71], a[44:47], a[172:175], v[68:71]
    v_mfma_f32_16x16x32_bf16 v[72:75], a[48:51], a[168:171], v[72:75]
    ds_read_b64_tr_b16 a[186:187], v19 offset:512
    v_mfma_f32_16x16x32_bf16 v[72:75], a[52:55], a[172:175], v[72:75]
    buffer_load_dwordx4 v11, s[20:23], s70 offen offset:1024  lds
    v_mfma_f32_16x16x32_bf16 v[76:79], a[56:59], a[168:171], v[76:79]
    ds_read_b64_tr_b16 a[188:189], v19 offset:16384
    v_mfma_f32_16x16x32_bf16 v[76:79], a[60:63], a[172:175], v[76:79]
    v_mfma_f32_16x16x32_bf16 v[80:83], a[64:67], a[168:171], v[80:83]
    ds_read_b64_tr_b16 a[190:191], v19 offset:16896
    v_mfma_f32_16x16x32_bf16 v[80:83], a[68:71], a[172:175], v[80:83]
    buffer_load_dwordx4 v12, s[20:23], s70 offen offset:2048  lds
    v_mfma_f32_16x16x32_bf16 v[84:87], a[72:75], a[168:171], v[84:87]
    v_mfma_f32_16x16x32_bf16 v[84:87], a[76:79], a[172:175], v[84:87]
    v_mfma_f32_16x16x32_bf16 v[88:91], a[80:83], a[168:171], v[88:91]
    v_mfma_f32_16x16x32_bf16 v[88:91], a[84:87], a[172:175], v[88:91]
    buffer_load_dwordx4 v13, s[20:23], s70 offen offset:3072  lds
    v_mfma_f32_16x16x32_bf16 v[92:95], a[88:91], a[168:171], v[92:95]
    s_add_u32 m0, s67, 65536
    v_mfma_f32_16x16x32_bf16 v[92:95], a[92:95], a[172:175], v[92:95]
    s_waitcnt lgkmcnt(6)
    s_waitcnt lgkmcnt(0)
    v_mfma_f32_16x16x32_bf16 v[96:99], a[32:35], a[176:179], v[96:99]
    s_waitcnt vmcnt(30)
    v_mfma_f32_16x16x32_bf16 v[96:99], a[36:39], a[180:183], v[96:99]
    buffer_load_dwordx4 v2, s[4:7], s71 offen offset:0  lds
    v_mfma_f32_16x16x32_bf16 v[100:103], a[40:43], a[176:179], v[100:103]
    ds_read_b64_tr_b16 a[160:161], v16 offset:32768
    v_mfma_f32_16x16x32_bf16 v[100:103], a[44:47], a[180:183], v[100:103]
    v_mfma_f32_16x16x32_bf16 v[104:107], a[48:51], a[176:179], v[104:107]
    s_waitcnt vmcnt(27)
    ds_read_b64_tr_b16 a[162:163], v16 offset:33280
    v_mfma_f32_16x16x32_bf16 v[104:107], a[52:55], a[180:183], v[104:107]
    buffer_load_dwordx4 v3, s[4:7], s71 offen offset:1024  lds
    v_mfma_f32_16x16x32_bf16 v[108:111], a[56:59], a[176:179], v[108:111]
    ds_read_b64_tr_b16 a[164:165], v16 offset:49152
    v_mfma_f32_16x16x32_bf16 v[108:111], a[60:63], a[180:183], v[108:111]
    v_mfma_f32_16x16x32_bf16 v[112:115], a[64:67], a[176:179], v[112:115]
    ds_read_b64_tr_b16 a[166:167], v16 offset:49664
    v_mfma_f32_16x16x32_bf16 v[112:115], a[68:71], a[180:183], v[112:115]
    buffer_load_dwordx4 v2, s[8:11], s71 offen offset:2048  lds
    v_mfma_f32_16x16x32_bf16 v[116:119], a[72:75], a[176:179], v[116:119]
    s_cmp_eq_u32 s76, s75
    v_mfma_f32_16x16x32_bf16 v[116:119], a[76:79], a[180:183], v[116:119]
    s_cselect_b32 s30, s73, 0
    v_mfma_f32_16x16x32_bf16 v[120:123], a[80:83], a[176:179], v[120:123]
    v_mfma_f32_16x16x32_bf16 v[120:123], a[84:87], a[180:183], v[120:123]
    buffer_load_dwordx4 v3, s[8:11], s71 offen offset:3072  lds
    v_mfma_f32_16x16x32_bf16 v[124:127], a[88:91], a[176:179], v[124:127]
    s_add_u32 m0, s67, 81920
    v_mfma_f32_16x16x32_bf16 v[124:127], a[92:95], a[180:183], v[124:127]
    s_add_u32 s71, s71, 262144
    v_mfma_f32_16x16x32_bf16 v[128:131], a[32:35], a[184:187], v[128:131]
    v_mfma_f32_16x16x32_bf16 v[128:131], a[36:39], a[188:191], v[128:131]
    buffer_load_dwordx4 v2, s[4:7], s71 offen offset:0  lds
    v_mfma_f32_16x16x32_bf16 v[132:135], a[40:43], a[184:187], v[132:135]
    ds_read_b64_tr_b16 a[168:169], v17 offset:32768
    v_mfma_f32_16x16x32_bf16 v[132:135], a[44:47], a[188:191], v[132:135]
    v_mfma_f32_16x16x32_bf16 v[136:139], a[48:51], a[184:187], v[136:139]
    ds_read_b64_tr_b16 a[170:171], v17 offset:33280
    v_mfma_f32_16x16x32_bf16 v[136:139], a[52:55], a[188:191], v[136:139]
    buffer_load_dwordx4 v3, s[4:7], s71 offen offset:1024  lds
    v_mfma_f32_16x16x32_bf16 v[140:143], a[56:59], a[184:187], v[140:143]
    ds_read_b64_tr_b16 a[172:173], v17 offset:49152
    v_mfma_f32_16x16x32_bf16 v[140:143], a[60:63], a[188:191], v[140:143]
    v_mfma_f32_16x16x32_bf16 v[144:147], a[64:67], a[184:187], v[144:147]
    ds_read_b64_tr_b16 a[174:175], v17 offset:49664
    v_mfma_f32_16x16x32_bf16 v[144:147], a[68:71], a[188:191], v[144:147]
    buffer_load_dwordx4 v2, s[8:11], s71 offen offset:2048  lds
    v_mfma_f32_16x16x32_bf16 v[148:151], a[72:75], a[184:187], v[148:151]
    s_waitcnt vmcnt(29)
    v_mfma_f32_16x16x32_bf16 v[148:151], a[76:79], a[188:191], v[148:151]
    s_barrier
    v_mfma_f32_16x16x32_bf16 v[152:155], a[80:83], a[184:187], v[152:155]
    v_mfma_f32_16x16x32_bf16 v[152:155], a[84:87], a[188:191], v[152:155]
    buffer_load_dwordx4 v3, s[8:11], s71 offen offset:3072  lds
    ds_read_b128 a[96:99], v14 offset:16384
    v_mfma_f32_16x16x32_bf16 v[156:159], a[88:91], a[184:187], v[156:159]
    s_add_u32 s71, s71, 262144
    buffer_load_dword v31, v8, s[28:31], s74 offen offset:0
    v_mfma_f32_16x16x32_bf16 v[156:159], a[92:95], a[188:191], v[156:159]
    s_waitcnt lgkmcnt(7)
    ds_read_b128 a[100:103], v15 offset:16384
    v_mfma_f32_16x16x32_bf16 v[160:163], a[32:35], a[160:163], v[160:163]
    s_waitcnt lgkmcnt(6)
    buffer_load_dword v31, v8, s[28:31], s74 offen offset:128
    v_mfma_f32_16x16x32_bf16 v[160:163], a[36:39], a[164:167], v[160:163]
    ds_read_b128 a[104:107], v14 offset:18432
    v_mfma_f32_16x16x32_bf16 v[164:167], a[40:43], a[160:163], v[164:167]
    ds_read_b64_tr_b16 a[176:177], v18 offset:32768
    v_mfma_f32_16x16x32_bf16 v[164:167], a[44:47], a[164:167], v[164:167]
    ds_read_b128 a[108:111], v15 offset:18432
    v_mfma_f32_16x16x32_bf16 v[168:171], a[48:51], a[160:163], v[168:171]
    ds_read_b64_tr_b16 a[178:179], v18 offset:33280
    v_mfma_f32_16x16x32_bf16 v[168:171], a[52:55], a[164:167], v[168:171]
    ds_read_b128 a[112:115], v14 offset:20480
    v_mfma_f32_16x16x32_bf16 v[172:175], a[56:59], a[160:163], v[172:175]
    ds_read_b64_tr_b16 a[180:181], v18 offset:49152
    v_mfma_f32_16x16x32_bf16 v[172:175], a[60:63], a[164:167], v[172:175]
    ds_read_b128 a[116:119], v15 offset:20480
    v_mfma_f32_16x16x32_bf16 v[176:179], a[64:67], a[160:163], v[176:179]
    ds_read_b64_tr_b16 a[182:183], v18 offset:49664
    v_mfma_f32_16x16x32_bf16 v[176:179], a[68:71], a[164:167], v[176:179]
    ds_read_b128 a[120:123], v14 offset:22528
    v_mfma_f32_16x16x32_bf16 v[180:183], a[72:75], a[160:163], v[180:183]
    v_mfma_f32_16x16x32_bf16 v[180:183], a[76:79], a[164:167], v[180:183]
    ds_read_b128 a[124:127], v15 offset:22528
    v_mfma_f32_16x16x32_bf16 v[184:187], a[80:83], a[160:163], v[184:187]
    v_mfma_f32_16x16x32_bf16 v[184:187], a[84:87], a[164:167], v[184:187]
    ds_read_b128 a[128:131], v14 offset:24576
    v_mfma_f32_16x16x32_bf16 v[188:191], a[88:91], a[160:163], v[188:191]
    v_mfma_f32_16x16x32_bf16 v[188:191], a[92:95], a[164:167], v[188:191]
    s_waitcnt lgkmcnt(15)
    ds_read_b128 a[132:135], v15 offset:24576
    v_mfma_f32_16x16x32_bf16 v[192:195], a[32:35], a[168:171], v[192:195]
    s_waitcnt lgkmcnt(14)
    s_add_u32 s70, s70, 128
    v_mfma_f32_16x16x32_bf16 v[192:195], a[36:39], a[172:175], v[192:195]
    ds_read_b128 a[136:139], v14 offset:26624
    v_mfma_f32_16x16x32_bf16 v[196:199], a[40:43], a[168:171], v[196:199]
    ds_read_b64_tr_b16 a[184:185], v19 offset:32768
    v_mfma_f32_16x16x32_bf16 v[196:199], a[44:47], a[172:175], v[196:199]
    ds_read_b128 a[140:143], v15 offset:26624
    v_mfma_f32_16x16x32_bf16 v[200:203], a[48:51], a[168:171], v[200:203]
    ds_read_b64_tr_b16 a[186:187], v19 offset:33280
    v_mfma_f32_16x16x32_bf16 v[200:203], a[52:55], a[172:175], v[200:203]
    v_mfma_f32_16x16x32_bf16 v[204:207], a[56:59], a[168:171], v[204:207]
    ds_read_b64_tr_b16 a[188:189], v19 offset:49152
    v_mfma_f32_16x16x32_bf16 v[204:207], a[60:63], a[172:175], v[204:207]
    v_mfma_f32_16x16x32_bf16 v[208:211], a[64:67], a[168:171], v[208:211]
    ds_read_b64_tr_b16 a[190:191], v19 offset:49664
    v_mfma_f32_16x16x32_bf16 v[208:211], a[68:71], a[172:175], v[208:211]
    v_xor_b32 v16, 0x10000, v16
    v_mfma_f32_16x16x32_bf16 v[212:215], a[72:75], a[168:171], v[212:215]
    v_mfma_f32_16x16x32_bf16 v[212:215], a[76:79], a[172:175], v[212:215]
    v_xor_b32 v17, 0x10000, v17
    v_mfma_f32_16x16x32_bf16 v[216:219], a[80:83], a[168:171], v[216:219]
    v_xor_b32 v18, 0x10000, v18
    v_mfma_f32_16x16x32_bf16 v[216:219], a[84:87], a[172:175], v[216:219]
    v_xor_b32 v19, 0x10000, v19
    v_mfma_f32_16x16x32_bf16 v[220:223], a[88:91], a[168:171], v[220:223]
    s_add_u32 m0, s67, 98304
    v_mfma_f32_16x16x32_bf16 v[220:223], a[92:95], a[172:175], v[220:223]
    s_waitcnt lgkmcnt(14)
    s_waitcnt lgkmcnt(0)
    v_mfma_f32_16x16x32_bf16 v[224:227], a[32:35], a[176:179], v[224:227]
    s_waitcnt vmcnt(28)
    v_mfma_f32_16x16x32_bf16 v[224:227], a[36:39], a[180:183], v[224:227]
    buffer_load_dwordx4 v2, s[12:15], s72 offen offset:0  lds
    v_mfma_f32_16x16x32_bf16 v[228:231], a[40:43], a[176:179], v[228:231]
    ds_read_b64_tr_b16 a[160:161], v16 offset:0
    v_mfma_f32_16x16x32_bf16 v[228:231], a[44:47], a[180:183], v[228:231]
    ds_read_b128 a[144:147], v14 offset:28672
    v_mfma_f32_16x16x32_bf16 v[232:235], a[48:51], a[176:179], v[232:235]
    s_waitcnt vmcnt(25)
    ds_read_b64_tr_b16 a[162:163], v16 offset:512
    v_mfma_f32_16x16x32_bf16 v[232:235], a[52:55], a[180:183], v[232:235]
    s_add_u32 s76, s76, 1
    buffer_load_dwordx4 v3, s[12:15], s72 offen offset:1024  lds
    v_mfma_f32_16x16x32_bf16 v[236:239], a[56:59], a[176:179], v[236:239]
    ds_read_b64_tr_b16 a[164:165], v16 offset:16384
    v_mfma_f32_16x16x32_bf16 v[236:239], a[60:63], a[180:183], v[236:239]
    ds_read_b128 a[148:151], v15 offset:28672
    v_mfma_f32_16x16x32_bf16 v[240:243], a[64:67], a[176:179], v[240:243]
    ds_read_b64_tr_b16 a[166:167], v16 offset:16896
    v_mfma_f32_16x16x32_bf16 v[240:243], a[68:71], a[180:183], v[240:243]
    buffer_load_dwordx4 v2, s[16:19], s72 offen offset:2048  lds
    v_mfma_f32_16x16x32_bf16 v[244:247], a[72:75], a[176:179], v[244:247]
    v_mfma_f32_16x16x32_bf16 v[244:247], a[76:79], a[180:183], v[244:247]
    ds_read_b128 a[152:155], v14 offset:30720
    v_mfma_f32_16x16x32_bf16 v[248:251], a[80:83], a[176:179], v[248:251]
    v_mfma_f32_16x16x32_bf16 v[248:251], a[84:87], a[180:183], v[248:251]
    buffer_load_dwordx4 v3, s[16:19], s72 offen offset:3072  lds
    v_mfma_f32_16x16x32_bf16 v[252:255], a[88:91], a[176:179], v[252:255]
    s_add_u32 m0, s67, 114688
    v_mfma_f32_16x16x32_bf16 v[252:255], a[92:95], a[180:183], v[252:255]
    s_add_u32 s72, s72, 262144
    ds_read_b128 a[156:159], v15 offset:30720
    v_mfma_f32_16x16x32_bf16 a[0:3], a[32:35], a[184:187], a[0:3]
    v_mfma_f32_16x16x32_bf16 a[0:3], a[36:39], a[188:191], a[0:3]
    buffer_load_dwordx4 v2, s[12:15], s72 offen offset:0  lds
    v_mfma_f32_16x16x32_bf16 a[4:7], a[40:43], a[184:187], a[4:7]
    ds_read_b64_tr_b16 a[168:169], v17 offset:0
    v_mfma_f32_16x16x32_bf16 a[4:7], a[44:47], a[188:191], a[4:7]
    v_mfma_f32_16x16x32_bf16 a[8:11], a[48:51], a[184:187], a[8:11]
    ds_read_b64_tr_b16 a[170:171], v17 offset:512
    v_mfma_f32_16x16x32_bf16 a[8:11], a[52:55], a[188:191], a[8:11]
    buffer_load_dwordx4 v3, s[12:15], s72 offen offset:1024  lds
    v_mfma_f32_16x16x32_bf16 a[12:15], a[56:59], a[184:187], a[12:15]
    ds_read_b64_tr_b16 a[172:173], v17 offset:16384
    v_mfma_f32_16x16x32_bf16 a[12:15], a[60:63], a[188:191], a[12:15]
    v_mfma_f32_16x16x32_bf16 a[16:19], a[64:67], a[184:187], a[16:19]
    ds_read_b64_tr_b16 a[174:175], v17 offset:16896
    v_mfma_f32_16x16x32_bf16 a[16:19], a[68:71], a[188:191], a[16:19]
    buffer_load_dwordx4 v2, s[16:19], s72 offen offset:2048  lds
    v_mfma_f32_16x16x32_bf16 a[20:23], a[72:75], a[184:187], a[20:23]
    v_mfma_f32_16x16x32_bf16 a[20:23], a[76:79], a[188:191], a[20:23]
    s_waitcnt lgkmcnt(0)
    v_mfma_f32_16x16x32_bf16 a[24:27], a[80:83], a[184:187], a[24:27]
    s_barrier
    v_mfma_f32_16x16x32_bf16 a[24:27], a[84:87], a[188:191], a[24:27]
    buffer_load_dwordx4 v3, s[16:19], s72 offen offset:3072  lds
    v_mfma_f32_16x16x32_bf16 a[28:31], a[88:91], a[184:187], a[28:31]
    s_add_u32 s72, s72, 262144
    v_mfma_f32_16x16x32_bf16 a[28:31], a[92:95], a[188:191], a[28:31]
    v_mfma_f32_16x16x32_bf16 v[32:35], a[96:99], a[160:163], v[32:35]
    v_mfma_f32_16x16x32_bf16 v[32:35], a[100:103], a[164:167], v[32:35]
    v_mfma_f32_16x16x32_bf16 v[36:39], a[104:107], a[160:163], v[36:39]
    ds_read_b64_tr_b16 a[176:177], v18 offset:0
    v_mfma_f32_16x16x32_bf16 v[36:39], a[108:111], a[164:167], v[36:39]
    v_mfma_f32_16x16x32_bf16 v[40:43], a[112:115], a[160:163], v[40:43]
    ds_read_b64_tr_b16 a[178:179], v18 offset:512
    v_mfma_f32_16x16x32_bf16 v[40:43], a[116:119], a[164:167], v[40:43]
    s_cmp_eq_u32 s76, s77
    v_mfma_f32_16x16x32_bf16 v[44:47], a[120:123], a[160:163], v[44:47]
    s_cselect_b32 s34, 64, 0
    ds_read_b64_tr_b16 a[180:181], v18 offset:16384
    v_mfma_f32_16x16x32_bf16 v[44:47], a[124:127], a[164:167], v[44:47]
    buffer_atomic_or v23, v9, s[32:35], 0 offen sc1
    v_mfma_f32_16x16x32_bf16 v[48:51], a[128:131], a[160:163], v[48:51]
    ds_read_b64_tr_b16 a[182:183], v18 offset:16896
    v_mfma_f32_16x16x32_bf16 v[48:51], a[132:135], a[164:167], v[48:51]
    v_mfma_f32_16x16x32_bf16 v[52:55], a[136:139], a[160:163], v[52:55]
    v_mfma_f32_16x16x32_bf16 v[52:55], a[140:143], a[164:167], v[52:55]
    v_mfma_f32_16x16x32_bf16 v[56:59], a[144:147], a[160:163], v[56:59]
    v_mfma_f32_16x16x32_bf16 v[56:59], a[148:151], a[164:167], v[56:59]
    v_mfma_f32_16x16x32_bf16 v[60:63], a[152:155], a[160:163], v[60:63]
    v_mfma_f32_16x16x32_bf16 v[60:63], a[156:159], a[164:167], v[60:63]
    v_mfma_f32_16x16x32_bf16 v[64:67], a[96:99], a[168:171], v[64:67]
    s_add_u32 m0, s67, 147456
    v_mfma_f32_16x16x32_bf16 v[64:67], a[100:103], a[172:175], v[64:67]
    buffer_load_dwordx4 v10, s[20:23], s70 offen offset:0  lds
    v_mfma_f32_16x16x32_bf16 v[68:71], a[104:107], a[168:171], v[68:71]
    ds_read_b64_tr_b16 a[184:185], v19 offset:0
    v_mfma_f32_16x16x32_bf16 v[68:71], a[108:111], a[172:175], v[68:71]
    v_mfma_f32_16x16x32_bf16 v[72:75], a[112:115], a[168:171], v[72:75]
    ds_read_b64_tr_b16 a[186:187], v19 offset:512
    v_mfma_f32_16x16x32_bf16 v[72:75], a[116:119], a[172:175], v[72:75]
    buffer_load_dwordx4 v11, s[20:23], s70 offen offset:1024  lds
    v_mfma_f32_16x16x32_bf16 v[76:79], a[120:123], a[168:171], v[76:79]
    ds_read_b64_tr_b16 a[188:189], v19 offset:16384
    v_mfma_f32_16x16x32_bf16 v[76:79], a[124:127], a[172:175], v[76:79]
    v_mfma_f32_16x16x32_bf16 v[80:83], a[128:131], a[168:171], v[80:83]
    ds_read_b64_tr_b16 a[190:191], v19 offset:16896
    v_mfma_f32_16x16x32_bf16 v[80:83], a[132:135], a[172:175], v[80:83]
    buffer_load_dwordx4 v12, s[20:23], s70 offen offset:2048  lds
    v_mfma_f32_16x16x32_bf16 v[84:87], a[136:139], a[168:171], v[84:87]
    v_mfma_f32_16x16x32_bf16 v[84:87], a[140:143], a[172:175], v[84:87]
    v_mfma_f32_16x16x32_bf16 v[88:91], a[144:147], a[168:171], v[88:91]
    v_mfma_f32_16x16x32_bf16 v[88:91], a[148:151], a[172:175], v[88:91]
    buffer_load_dwordx4 v13, s[20:23], s70 offen offset:3072  lds
    v_mfma_f32_16x16x32_bf16 v[92:95], a[152:155], a[168:171], v[92:95]
    s_add_u32 m0, s67, 0
    v_mfma_f32_16x16x32_bf16 v[92:95], a[156:159], a[172:175], v[92:95]
    s_waitcnt lgkmcnt(6)
    s_waitcnt lgkmcnt(0)
    v_mfma_f32_16x16x32_bf16 v[96:99], a[96:99], a[176:179], v[96:99]
    s_waitcnt vmcnt(33)
    v_mfma_f32_16x16x32_bf16 v[96:99], a[100:103], a[180:183], v[96:99]
    buffer_load_dwordx4 v2, s[4:7], s71 offen offset:0  lds
    v_mfma_f32_16x16x32_bf16 v[100:103], a[104:107], a[176:179], v[100:103]
    ds_read_b64_tr_b16 a[160:161], v16 offset:32768
    v_mfma_f32_16x16x32_bf16 v[100:103], a[108:111], a[180:183], v[100:103]
    v_mfma_f32_16x16x32_bf16 v[104:107], a[112:115], a[176:179], v[104:107]
    s_waitcnt vmcnt(30)
    ds_read_b64_tr_b16 a[162:163], v16 offset:33280
    v_mfma_f32_16x16x32_bf16 v[104:107], a[116:119], a[180:183], v[104:107]
    buffer_load_dwordx4 v3, s[4:7], s71 offen offset:1024  lds
    v_mfma_f32_16x16x32_bf16 v[108:111], a[120:123], a[176:179], v[108:111]
    ds_read_b64_tr_b16 a[164:165], v16 offset:49152
    v_mfma_f32_16x16x32_bf16 v[108:111], a[124:127], a[180:183], v[108:111]
    v_mfma_f32_16x16x32_bf16 v[112:115], a[128:131], a[176:179], v[112:115]
    ds_read_b64_tr_b16 a[166:167], v16 offset:49664
    v_mfma_f32_16x16x32_bf16 v[112:115], a[132:135], a[180:183], v[112:115]
    buffer_load_dwordx4 v2, s[8:11], s71 offen offset:2048  lds
    v_mfma_f32_16x16x32_bf16 v[116:119], a[136:139], a[176:179], v[116:119]
    s_cmp_eq_u32 s76, s75
    v_mfma_f32_16x16x32_bf16 v[116:119], a[140:143], a[180:183], v[116:119]
    s_cselect_b32 s30, s73, 0
    v_mfma_f32_16x16x32_bf16 v[120:123], a[144:147], a[176:179], v[120:123]
    v_mfma_f32_16x16x32_bf16 v[120:123], a[148:151], a[180:183], v[120:123]
    buffer_load_dwordx4 v3, s[8:11], s71 offen offset:3072  lds
    v_mfma_f32_16x16x32_bf16 v[124:127], a[152:155], a[176:179], v[124:127]
    s_add_u32 m0, s67, 16384
    v_mfma_f32_16x16x32_bf16 v[124:127], a[156:159], a[180:183], v[124:127]
    s_add_u32 s71, s71, 262144
    v_mfma_f32_16x16x32_bf16 v[128:131], a[96:99], a[184:187], v[128:131]
    v_mfma_f32_16x16x32_bf16 v[128:131], a[100:103], a[188:191], v[128:131]
    buffer_load_dwordx4 v2, s[4:7], s71 offen offset:0  lds
    v_mfma_f32_16x16x32_bf16 v[132:135], a[104:107], a[184:187], v[132:135]
    ds_read_b64_tr_b16 a[168:169], v17 offset:32768
    v_mfma_f32_16x16x32_bf16 v[132:135], a[108:111], a[188:191], v[132:135]
    v_mfma_f32_16x16x32_bf16 v[136:139], a[112:115], a[184:187], v[136:139]
    ds_read_b64_tr_b16 a[170:171], v17 offset:33280
    v_mfma_f32_16x16x32_bf16 v[136:139], a[116:119], a[188:191], v[136:139]
    buffer_load_dwordx4 v3, s[4:7], s71 offen offset:1024  lds
    v_mfma_f32_16x16x32_bf16 v[140:143], a[120:123], a[184:187], v[140:143]
    ds_read_b64_tr_b16 a[172:173], v17 offset:49152
    v_mfma_f32_16x16x32_bf16 v[140:143], a[124:127], a[188:191], v[140:143]
    v_mfma_f32_16x16x32_bf16 v[144:147], a[128:131], a[184:187], v[144:147]
    ds_read_b64_tr_b16 a[174:175], v17 offset:49664
    v_mfma_f32_16x16x32_bf16 v[144:147], a[132:135], a[188:191], v[144:147]
    buffer_load_dwordx4 v2, s[8:11], s71 offen offset:2048  lds
    v_mfma_f32_16x16x32_bf16 v[148:151], a[136:139], a[184:187], v[148:151]
    s_waitcnt vmcnt(30)
    v_mfma_f32_16x16x32_bf16 v[148:151], a[140:143], a[188:191], v[148:151]
    s_barrier
    v_mfma_f32_16x16x32_bf16 v[152:155], a[144:147], a[184:187], v[152:155]
    v_mfma_f32_16x16x32_bf16 v[152:155], a[148:151], a[188:191], v[152:155]
    buffer_load_dwordx4 v3, s[8:11], s71 offen offset:3072  lds
    ds_read_b128 a[32:35], v14 offset:0
    v_mfma_f32_16x16x32_bf16 v[156:159], a[152:155], a[184:187], v[156:159]
    s_add_u32 s71, s71, 262144
    buffer_load_dword v31, v8, s[28:31], s74 offen offset:0
    v_mfma_f32_16x16x32_bf16 v[156:159], a[156:159], a[188:191], v[156:159]
    s_waitcnt lgkmcnt(7)
    ds_read_b128 a[36:39], v15 offset:0
    v_mfma_f32_16x16x32_bf16 v[160:163], a[96:99], a[160:163], v[160:163]
    s_waitcnt lgkmcnt(6)
    buffer_load_dword v31, v8, s[28:31], s74 offen offset:128
    v_mfma_f32_16x16x32_bf16 v[160:163], a[100:103], a[164:167], v[160:163]
    ds_read_b128 a[40:43], v14 offset:2048
    v_mfma_f32_16x16x32_bf16 v[164:167], a[104:107], a[160:163], v[164:167]
    ds_read_b64_tr_b16 a[176:177], v18 offset:32768
    v_mfma_f32_16x16x32_bf16 v[164:167], a[108:111], a[164:167], v[164:167]
    ds_read_b128 a[44:47], v15 offset:2048
    v_mfma_f32_16x16x32_bf16 v[168:171], a[112:115], a[160:163], v[168:171]
    ds_read_b64_tr_b16 a[178:179], v18 offset:33280
    v_mfma_f32_16x16x32_bf16 v[168:171], a[116:119], a[164:167], v[168:171]
    ds_read_b128 a[48:51], v14 offset:4096
    v_mfma_f32_16x16x32_bf16 v[172:175], a[120:123], a[160:163], v[172:175]
    ds_read_b64_tr_b16 a[180:181], v18 offset:49152
    v_mfma_f32_16x16x32_bf16 v[172:175], a[124:127], a[164:167], v[172:175]
    ds_read_b128 a[52:55], v15 offset:4096
    v_mfma_f32_16x16x32_bf16 v[176:179], a[128:131], a[160:163], v[176:179]
    ds_read_b64_tr_b16 a[182:183], v18 offset:49664
    v_mfma_f32_16x16x32_bf16 v[176:179], a[132:135], a[164:167], v[176:179]
    ds_read_b128 a[56:59], v14 offset:6144
    v_mfma_f32_16x16x32_bf16 v[180:183], a[136:139], a[160:163], v[180:183]
    v_mfma_f32_16x16x32_bf16 v[180:183], a[140:143], a[164:167], v[180:183]
    ds_read_b128 a[60:63], v15 offset:6144
    v_mfma_f32_16x16x32_bf16 v[184:187], a[144:147], a[160:163], v[184:187]
    v_mfma_f32_16x16x32_bf16 v[184:187], a[148:151], a[164:167], v[184:187]
    ds_read_b128 a[64:67], v14 offset:8192
    v_mfma_f32_16x16x32_bf16 v[188:191], a[152:155], a[160:163], v[188:191]
    v_mfma_f32_16x16x32_bf16 v[188:191], a[156:159], a[164:167], v[188:191]
    s_waitcnt lgkmcnt(15)
    ds_read_b128 a[68:71], v15 offset:8192
    v_mfma_f32_16x16x32_bf16 v[192:195], a[96:99], a[168:171], v[192:195]
    s_waitcnt lgkmcnt(14)
    s_add_u32 s70, s70, 128
    v_mfma_f32_16x16x32_bf16 v[192:195], a[100:103], a[172:175], v[192:195]
    ds_read_b128 a[72:75], v14 offset:10240
    v_mfma_f32_16x16x32_bf16 v[196:199], a[104:107], a[168:171], v[196:199]
    ds_read_b64_tr_b16 a[184:185], v19 offset:32768
    v_mfma_f32_16x16x32_bf16 v[196:199], a[108:111], a[172:175], v[196:199]
    ds_read_b128 a[76:79], v15 offset:10240
    v_mfma_f32_16x16x32_bf16 v[200:203], a[112:115], a[168:171], v[200:203]
    ds_read_b64_tr_b16 a[186:187], v19 offset:33280
    v_mfma_f32_16x16x32_bf16 v[200:203], a[116:119], a[172:175], v[200:203]
    v_mfma_f32_16x16x32_bf16 v[204:207], a[120:123], a[168:171], v[204:207]
    ds_read_b64_tr_b16 a[188:189], v19 offset:49152
    v_mfma_f32_16x16x32_bf16 v[204:207], a[124:127], a[172:175], v[204:207]
    v_mfma_f32_16x16x32_bf16 v[208:211], a[128:131], a[168:171], v[208:211]
    ds_read_b64_tr_b16 a[190:191], v19 offset:49664
    v_mfma_f32_16x16x32_bf16 v[208:211], a[132:135], a[172:175], v[208:211]
    v_xor_b32 v16, 0x10000, v16
    v_mfma_f32_16x16x32_bf16 v[212:215], a[136:139], a[168:171], v[212:215]
    v_mfma_f32_16x16x32_bf16 v[212:215], a[140:143], a[172:175], v[212:215]
    v_xor_b32 v17, 0x10000, v17
    v_mfma_f32_16x16x32_bf16 v[216:219], a[144:147], a[168:171], v[216:219]
    v_xor_b32 v18, 0x10000, v18
    v_mfma_f32_16x16x32_bf16 v[216:219], a[148:151], a[172:175], v[216:219]
    v_xor_b32 v19, 0x10000, v19
    v_mfma_f32_16x16x32_bf16 v[220:223], a[152:155], a[168:171], v[220:223]
    s_add_u32 m0, s67, 32768
    v_mfma_f32_16x16x32_bf16 v[220:223], a[156:159], a[172:175], v[220:223]
    s_waitcnt lgkmcnt(14)
    s_waitcnt lgkmcnt(0)
    v_mfma_f32_16x16x32_bf16 v[224:227], a[96:99], a[176:179], v[224:227]
    s_waitcnt vmcnt(29)
    v_mfma_f32_16x16x32_bf16 v[224:227], a[100:103], a[180:183], v[224:227]
    buffer_load_dwordx4 v2, s[12:15], s72 offen offset:0  lds
    v_mfma_f32_16x16x32_bf16 v[228:231], a[104:107], a[176:179], v[228:231]
    ds_read_b64_tr_b16 a[160:161], v16 offset:0
    v_mfma_f32_16x16x32_bf16 v[228:231], a[108:111], a[180:183], v[228:231]
    ds_read_b128 a[80:83], v14 offset:12288
    v_mfma_f32_16x16x32_bf16 v[232:235], a[112:115], a[176:179], v[232:235]
    s_waitcnt vmcnt(26)
    ds_read_b64_tr_b16 a[162:163], v16 offset:512
    v_mfma_f32_16x16x32_bf16 v[232:235], a[116:119], a[180:183], v[232:235]
    s_add_u32 s76, s76, 1
    buffer_load_dwordx4 v3, s[12:15], s72 offen offset:1024  lds
    v_mfma_f32_16x16x32_bf16 v[236:239], a[120:123], a[176:179], v[236:239]
    ds_read_b64_tr_b16 a[164:165], v16 offset:16384
    v_mfma_f32_16x16x32_bf16 v[236:239], a[124:127], a[180:183], v[236:239]
    ds_read_b128 a[84:87], v15 offset:12288
    v_mfma_f32_16x16x32_bf16 v[240:243], a[128:131], a[176:179], v[240:243]
    ds_read_b64_tr_b16 a[166:167], v16 offset:16896
    v_mfma_f32_16x16x32_bf16 v[240:243], a[132:135], a[180:183], v[240:243]
    buffer_load_dwordx4 v2, s[16:19], s72 offen offset:2048  lds
    v_mfma_f32_16x16x32_bf16 v[244:247], a[136:139], a[176:179], v[244:247]
    v_mfma_f32_16x16x32_bf16 v[244:247], a[140:143], a[180:183], v[244:247]
    ds_read_b128 a[88:91], v14 offset:14336
    v_mfma_f32_16x16x32_bf16 v[248:251], a[144:147], a[176:179], v[248:251]
    v_mfma_f32_16x16x32_bf16 v[248:251], a[148:151], a[180:183], v[248:251]
    buffer_load_dwordx4 v3, s[16:19], s72 offen offset:3072  lds
    v_mfma_f32_16x16x32_bf16 v[252:255], a[152:155], a[176:179], v[252:255]
    s_add_u32 m0, s67, 49152
    v_mfma_f32_16x16x32_bf16 v[252:255], a[156:159], a[180:183], v[252:255]
    s_add_u32 s72, s72, 262144
    ds_read_b128 a[92:95], v15 offset:14336
    v_mfma_f32_16x16x32_bf16 a[0:3], a[96:99], a[184:187], a[0:3]
    v_mfma_f32_16x16x32_bf16 a[0:3], a[100:103], a[188:191], a[0:3]
    buffer_load_dwordx4 v2, s[12:15], s72 offen offset:0  lds
    v_mfma_f32_16x16x32_bf16 a[4:7], a[104:107], a[184:187], a[4:7]
    ds_read_b64_tr_b16 a[168:169], v17 offset:0
    v_mfma_f32_16x16x32_bf16 a[4:7], a[108:111], a[188:191], a[4:7]
    v_mfma_f32_16x16x32_bf16 a[8:11], a[112:115], a[184:187], a[8:11]
    ds_read_b64_tr_b16 a[170:171], v17 offset:512
    v_mfma_f32_16x16x32_bf16 a[8:11], a[116:119], a[188:191], a[8:11]
    buffer_load_dwordx4 v3, s[12:15], s72 offen offset:1024  lds
    v_mfma_f32_16x16x32_bf16 a[12:15], a[120:123], a[184:187], a[12:15]
    ds_read_b64_tr_b16 a[172:173], v17 offset:16384
    v_mfma_f32_16x16x32_bf16 a[12:15], a[124:127], a[188:191], a[12:15]
    v_mfma_f32_16x16x32_bf16 a[16:19], a[128:131], a[184:187], a[16:19]
    ds_read_b64_tr_b16 a[174:175], v17 offset:16896
    v_mfma_f32_16x16x32_bf16 a[16:19], a[132:135], a[188:191], a[16:19]
    buffer_load_dwordx4 v2, s[16:19], s72 offen offset:2048  lds
    v_mfma_f32_16x16x32_bf16 a[20:23], a[136:139], a[184:187], a[20:23]
    v_mfma_f32_16x16x32_bf16 a[20:23], a[140:143], a[188:191], a[20:23]
    s_waitcnt lgkmcnt(0)
    v_mfma_f32_16x16x32_bf16 a[24:27], a[144:147], a[184:187], a[24:27]
    s_barrier
    v_mfma_f32_16x16x32_bf16 a[24:27], a[148:151], a[188:191], a[24:27]
    buffer_load_dwordx4 v3, s[16:19], s72 offen offset:3072  lds
    v_mfma_f32_16x16x32_bf16 a[28:31], a[152:155], a[184:187], a[28:31]
    s_add_u32 s72, s72, 262144
    v_mfma_f32_16x16x32_bf16 a[28:31], a[156:159], a[188:191], a[28:31]
    s_cmp_lg_u32 s76, 14
    s_cbranch_scc1 fz_V0
fz_lastV:
    v_cmp_ne_u32 vcc, 0xffff, v21
    s_mov_b32 s20, s64
    s_mov_b32 s21, s65
    s_mul_i32 s70, s69, 114688
    v_add_u32 v10, s67, v20
    s_cbranch_vccz fz_goV
    s_mov_b32 s87, 100000
    s_mov_b32 s34, 64
fz_spinV:
    s_sub_u32 s87, s87, 1
    s_cbranch_scc1 fz_goV
    buffer_load_dword v21, v22, s[32:35], 0 offen sc1
    s_waitcnt vmcnt(0)
    v_cmp_ne_u32 vcc, 0xffff, v21
    s_cbranch_vccnz fz_spinV
fz_goV:
    s_getpc_b64 s[36:37]
fz_pc_2:
    s_lshr_b32 s38, s2, 3
    v_lshrrev_b32 v28, 6, v0
    v_and_b32 v29, 63, v0
    v_lshl_add_u32 v28, s38, 2, v28
    v_min_u32 v29, 4, v29
    v_mad_u32_u24 v28, v28, 5, v29
    s_sub_u32 s36, s36, fz_pc_2-fz
    s_subb_u32 s37, s37, 0
    v_min_u32 v28, (fz_zend-fz)/128, v28
    v_mov_b32 v29, 0
    v_lshlrev_b32 v28, 7, v28
    v_lshl_add_u64 v[28:29], v[28:29], 0, s[36:37]
    global_load_dword v31, v[28:29], off
    v_mfma_f32_16x16x32_bf16 v[32:35], a[32:35], a[160:163], v[32:35]
    v_bfe_u32 v24, v1, 2, 2
    v_bfe_u32 v25, v1, 4, 1
    v_mfma_f32_16x16x32_bf16 v[32:35], a[36:39], a[164:167], v[32:35]
    v_lshl_add_u32 v24, v25, 3, v24
    v_lshlrev_b32 v24, 6, v24
    v_mfma_f32_16x16x32_bf16 v[36:39], a[40:43], a[160:163], v[36:39]
    ds_read_b64_tr_b16 a[176:177], v18 offset:0
    v_and_b32 v26, 3, v1
    v_mfma_f32_16x16x32_bf16 v[36:39], a[44:47], a[164:167], v[36:39]
    s_lshl_b32 s86, s68, 8
    v_lshl_add_u32 v24, v26, 3, v24
    v_lshrrev_b32 v26, 5, v1
    v_mfma_f32_16x16x32_bf16 v[40:43], a[48:51], a[160:163], v[40:43]
    s_lshl_b32 s87, s66, 6
    ds_read_b64_tr_b16 a[178:179], v18 offset:512
    v_lshl_add_u32 v24, v26, 11, v24
    v_mfma_f32_16x16x32_bf16 v[40:43], a[52:55], a[164:167], v[40:43]
    s_add_u32 s86, s86, s87
    v_add_u32 v24, s67, v24
    v_lshl_add_u32 v11, v25, 5, v24
    v_mfma_f32_16x16x32_bf16 v[44:47], a[56:59], a[160:163], v[44:47]
    s_sub_u32 s87, 1605632, s86
    ds_read_b64_tr_b16 a[180:181], v18 offset:16384
    v_xor_b32 v12, 32, v11
    v_mfma_f32_16x16x32_bf16 v[44:47], a[60:63], a[164:167], v[44:47]
    s_add_u32 s88, s87, 1024
    v_add_u32 v13, 65536, v11
    v_add_u32 v8, 65536, v12
    v_mfma_f32_16x16x32_bf16 v[48:51], a[64:67], a[160:163], v[48:51]
    s_cmp_lt_u32 s68, 14
    s_cselect_b32 s6, s87, 0
    s_cselect_b32 s10, s88, 0
    ds_read_b64_tr_b16 a[182:183], v18 offset:16896
    v_mfma_f32_16x16x32_bf16 v[48:51], a[68:71], a[164:167], v[48:51]
    s_add_u32 s4, s54, s86
    s_addc_u32 s5, s55, 0
    v_mfma_f32_16x16x32_bf16 v[52:55], a[72:75], a[160:163], v[52:55]
    s_add_u32 s8, s56, s86
    s_addc_u32 s9, s57, 0
    v_mfma_f32_16x16x32_bf16 v[52:55], a[76:79], a[164:167], v[52:55]
    s_sub_u32 s8, s8, 1024
    s_subb_u32 s9, s9, 0
    v_mfma_f32_16x16x32_bf16 v[56:59], a[80:83], a[160:163], v[56:59]
    s_mov_b32 s71, 0
    v_mfma_f32_16x16x32_bf16 v[56:59], a[84:87], a[164:167], v[56:59]
    s_lshl_b32 s86, s86, 1
    v_mfma_f32_16x16x32_bf16 v[60:63], a[88:91], a[160:163], v[60:63]
    s_add_u32 s12, s44, s86
    s_addc_u32 s13, s45, 0
    v_mfma_f32_16x16x32_bf16 v[60:63], a[92:95], a[164:167], v[60:63]
    s_sub_u32 s14, 3670016, s86
    v_mfma_f32_16x16x32_bf16 v[64:67], a[32:35], a[168:171], v[64:67]
    s_add_u32 m0, s67, 131072
    v_mfma_f32_16x16x32_bf16 v[64:67], a[36:39], a[172:175], v[64:67]
    s_add_u32 s86, s86, 129024
    buffer_load_dwordx4 v10, s[20:23], s70 offen offset:0 sc1 lds
    v_mfma_f32_16x16x32_bf16 v[68:71], a[40:43], a[168:171], v[68:71]
    s_add_u32 s16, s44, s86
    s_addc_u32 s17, s45, 0
    ds_read_b64_tr_b16 a[184:185], v19 offset:0
    v_mfma_f32_16x16x32_bf16 v[68:71], a[44:47], a[172:175], v[68:71]
    s_sub_u32 s18, 3670016, s86
    v_mfma_f32_16x16x32_bf16 v[72:75], a[48:51], a[168:171], v[72:75]
    s_mov_b32 s72, 0
    ds_read_b64_tr_b16 a[186:187], v19 offset:512
    v_mfma_f32_16x16x32_bf16 v[72:75], a[52:55], a[172:175], v[72:75]
    buffer_load_dwordx4 v10, s[20:23], s70 offen offset:1024 sc1 lds
    v_mfma_f32_16x16x32_bf16 v[76:79], a[56:59], a[168:171], v[76:79]
    ds_read_b64_tr_b16 a[188:189], v19 offset:16384
    v_mfma_f32_16x16x32_bf16 v[76:79], a[60:63], a[172:175], v[76:79]
    v_mfma_f32_16x16x32_bf16 v[80:83], a[64:67], a[168:171], v[80:83]
    ds_read_b64_tr_b16 a[190:191], v19 offset:16896
    v_mfma_f32_16x16x32_bf16 v[80:83], a[68:71], a[172:175], v[80:83]
    buffer_load_dwordx4 v10, s[20:23], s70 offen offset:2048 sc1 lds
    v_mfma_f32_16x16x32_bf16 v[84:87], a[72:75], a[168:171], v[84:87]
    v_mfma_f32_16x16x32_bf16 v[84:87], a[76:79], a[172:175], v[84:87]
    v_mfma_f32_16x16x32_bf16 v[88:91], a[80:83], a[168:171], v[88:91]
    v_mfma_f32_16x16x32_bf16 v[88:91], a[84:87], a[172:175], v[88:91]
    buffer_load_dwordx4 v10, s[20:23], s70 offen offset:3072 sc1 lds
    v_mfma_f32_16x16x32_bf16 v[92:95], a[88:91], a[168:171], v[92:95]
    s_add_u32 m0, s67, 65536
    v_mfma_f32_16x16x32_bf16 v[92:95], a[92:95], a[172:175], v[92:95]
    s_waitcnt lgkmcnt(6)
    s_waitcnt lgkmcnt(0)
    v_mfma_f32_16x16x32_bf16 v[96:99], a[32:35], a[176:179], v[96:99]
    s_waitcnt vmcnt(32)
    v_mfma_f32_16x16x32_bf16 v[96:99], a[36:39], a[180:183], v[96:99]
    buffer_load_dwordx4 v4, s[4:7], s71 offen offset:0  lds
    v_mfma_f32_16x16x32_bf16 v[100:103], a[40:43], a[176:179], v[100:103]
    ds_read_b64_tr_b16 a[160:161], v16 offset:32768
    v_mfma_f32_16x16x32_bf16 v[100:103], a[44:47], a[180:183], v[100:103]
    v_mfma_f32_16x16x32_bf16 v[104:107], a[48:51], a[176:179], v[104:107]
    s_waitcnt vmcnt(29)
    ds_read_b64_tr_b16 a[162:163], v16 offset:33280
    v_mfma_f32_16x16x32_bf16 v[104:107], a[52:55], a[180:183], v[104:107]
    buffer_load_dwordx4 v4, s[8:11], s71 offen offset:1024  lds
    v_mfma_f32_16x16x32_bf16 v[108:111], a[56:59], a[176:179], v[108:111]
    ds_read_b64_tr_b16 a[164:165], v16 offset:49152
    v_mfma_f32_16x16x32_bf16 v[108:111], a[60:63], a[180:183], v[108:111]
    v_mfma_f32_16x16x32_bf16 v[112:115], a[64:67], a[176:179], v[112:115]
    ds_read_b64_tr_b16 a[166:167], v16 offset:49664
    v_mfma_f32_16x16x32_bf16 v[112:115], a[68:71], a[180:183], v[112:115]
    buffer_load_dwordx4 v5, s[4:7], s71 offen offset:2048  lds
    v_mfma_f32_16x16x32_bf16 v[116:119], a[72:75], a[176:179], v[116:119]
    v_mfma_f32_16x16x32_bf16 v[116:119], a[76:79], a[180:183], v[116:119]
    v_mfma_f32_16x16x32_bf16 v[120:123], a[80:83], a[176:179], v[120:123]
    v_mfma_f32_16x16x32_bf16 v[120:123], a[84:87], a[180:183], v[120:123]
    buffer_load_dwordx4 v5, s[8:11], s71 offen offset:3072  lds
    v_mfma_f32_16x16x32_bf16 v[124:127], a[88:91], a[176:179], v[124:127]
    s_add_u32 m0, s67, 81920
    v_mfma_f32_16x16x32_bf16 v[124:127], a[92:95], a[180:183], v[124:127]
    s_add_u32 s71, s71, 114688
    v_mfma_f32_16x16x32_bf16 v[128:131], a[32:35], a[184:187], v[128:131]
    v_mfma_f32_16x16x32_bf16 v[128:131], a[36:39], a[188:191], v[128:131]
    buffer_load_dwordx4 v4, s[4:7], s71 offen offset:0  lds
    v_mfma_f32_16x16x32_bf16 v[132:135], a[40:43], a[184:187], v[132:135]
    ds_read_b64_tr_b16 a[168:169], v17 offset:32768
    v_mfma_f32_16x16x32_bf16 v[132:135], a[44:47], a[188:191], v[132:135]
    v_mfma_f32_16x16x32_bf16 v[136:139], a[48:51], a[184:187], v[136:139]
    ds_read_b64_tr_b16 a[170:171], v17 offset:33280
    v_mfma_f32_16x16x32_bf16 v[136:139], a[52:55], a[188:191], v[136:139]
    buffer_load_dwordx4 v4, s[8:11], s71 offen offset:1024  lds
    v_mfma_f32_16x16x32_bf16 v[140:143], a[56:59], a[184:187], v[140:143]
    ds_read_b64_tr_b16 a[172:173], v17 offset:49152
    v_mfma_f32_16x16x32_bf16 v[140:143], a[60:63], a[188:191], v[140:143]
    v_mfma_f32_16x16x32_bf16 v[144:147], a[64:67], a[184:187], v[144:147]
    ds_read_b64_tr_b16 a[174:175], v17 offset:49664
    v_mfma_f32_16x16x32_bf16 v[144:147], a[68:71], a[188:191], v[144:147]
    buffer_load_dwordx4 v5, s[4:7], s71 offen offset:2048  lds
    v_mfma_f32_16x16x32_bf16 v[148:151], a[72:75], a[184:187], v[148:151]
    s_waitcnt vmcnt(30)
    v_mfma_f32_16x16x32_bf16 v[148:151], a[76:79], a[188:191], v[148:151]
    s_barrier
    v_mfma_f32_16x16x32_bf16 v[152:155], a[80:83], a[184:187], v[152:155]
    v_mfma_f32_16x16x32_bf16 v[152:155], a[84:87], a[188:191], v[152:155]
    buffer_load_dwordx4 v5, s[8:11], s71 offen offset:3072  lds
    ds_read_b128 a[96:99], v14 offset:16384
    v_mfma_f32_16x16x32_bf16 v[156:159], a[88:91], a[184:187], v[156:159]
    s_add_u32 s71, s71, 114688
    v_mfma_f32_16x16x32_bf16 v[156:159], a[92:95], a[188:191], v[156:159]
    s_waitcnt lgkmcnt(7)
    ds_read_b128 a[100:103], v15 offset:16384
    v_mfma_f32_16x16x32_bf16 v[160:163], a[32:35], a[160:163], v[160:163]
    s_waitcnt lgkmcnt(6)
    v_mfma_f32_16x16x32_bf16 v[160:163], a[36:39], a[164:167], v[160:163]
    ds_read_b128 a[104:107], v14 offset:18432
    v_mfma_f32_16x16x32_bf16 v[164:167], a[40:43], a[160:163], v[164:167]
    ds_read_b64_tr_b16 a[176:177], v18 offset:32768
    v_mfma_f32_16x16x32_bf16 v[164:167], a[44:47], a[164:167], v[164:167]
    ds_read_b128 a[108:111], v15 offset:18432
    v_mfma_f32_16x16x32_bf16 v[168:171], a[48:51], a[160:163], v[168:171]
    ds_read_b64_tr_b16 a[178:179], v18 offset:33280
    v_mfma_f32_16x16x32_bf16 v[168:171], a[52:55], a[164:167], v[168:171]
    ds_read_b128 a[112:115], v14 offset:20480
    v_mfma_f32_16x16x32_bf16 v[172:175], a[56:59], a[160:163], v[172:175]
    ds_read_b64_tr_b16 a[180:181], v18 offset:49152
    v_mfma_f32_16x16x32_bf16 v[172:175], a[60:63], a[164:167], v[172:175]
    ds_read_b128 a[116:119], v15 offset:20480
    v_mfma_f32_16x16x32_bf16 v[176:179], a[64:67], a[160:163], v[176:179]
    ds_read_b64_tr_b16 a[182:183], v18 offset:49664
    v_mfma_f32_16x16x32_bf16 v[176:179], a[68:71], a[164:167], v[176:179]
    ds_read_b128 a[120:123], v14 offset:22528
    v_mfma_f32_16x16x32_bf16 v[180:183], a[72:75], a[160:163], v[180:183]
    v_mfma_f32_16x16x32_bf16 v[180:183], a[76:79], a[164:167], v[180:183]
    ds_read_b128 a[124:127], v15 offset:22528
    v_mfma_f32_16x16x32_bf16 v[184:187], a[80:83], a[160:163], v[184:187]
    v_mfma_f32_16x16x32_bf16 v[184:187], a[84:87], a[164:167], v[184:187]
    ds_read_b128 a[128:131], v14 offset:24576
    v_mfma_f32_16x16x32_bf16 v[188:191], a[88:91], a[160:163], v[188:191]
    v_mfma_f32_16x16x32_bf16 v[188:191], a[92:95], a[164:167], v[188:191]
    s_waitcnt lgkmcnt(15)
    ds_read_b128 a[132:135], v15 offset:24576
    v_mfma_f32_16x16x32_bf16 v[192:195], a[32:35], a[168:171], v[192:195]
    s_waitcnt lgkmcnt(14)
    s_add_u32 s70, s70, 16384
    v_mfma_f32_16x16x32_bf16 v[192:195], a[36:39], a[172:175], v[192:195]
    ds_read_b128 a[136:139], v14 offset:26624
    v_mfma_f32_16x16x32_bf16 v[196:199], a[40:43], a[168:171], v[196:199]
    ds_read_b64_tr_b16 a[184:185], v19 offset:32768
    v_mfma_f32_16x16x32_bf16 v[196:199], a[44:47], a[172:175], v[196:199]
    ds_read_b128 a[140:143], v15 offset:26624
    v_mfma_f32_16x16x32_bf16 v[200:203], a[48:51], a[168:171], v[200:203]
    ds_read_b64_tr_b16 a[186:187], v19 offset:33280
    v_mfma_f32_16x16x32_bf16 v[200:203], a[52:55], a[172:175], v[200:203]
    v_mfma_f32_16x16x32_bf16 v[204:207], a[56:59], a[168:171], v[204:207]
    ds_read_b64_tr_b16 a[188:189], v19 offset:49152
    v_mfma_f32_16x16x32_bf16 v[204:207], a[60:63], a[172:175], v[204:207]
    v_mfma_f32_16x16x32_bf16 v[208:211], a[64:67], a[168:171], v[208:211]
    ds_read_b64_tr_b16 a[190:191], v19 offset:49664
    v_mfma_f32_16x16x32_bf16 v[208:211], a[68:71], a[172:175], v[208:211]
    v_xor_b32 v16, 0x10000, v16
    v_mfma_f32_16x16x32_bf16 v[212:215], a[72:75], a[168:171], v[212:215]
    v_mfma_f32_16x16x32_bf16 v[212:215], a[76:79], a[172:175], v[212:215]
    v_xor_b32 v17, 0x10000, v17
    v_mfma_f32_16x16x32_bf16 v[216:219], a[80:83], a[168:171], v[216:219]
    v_xor_b32 v18, 0x10000, v18
    v_mfma_f32_16x16x32_bf16 v[216:219], a[84:87], a[172:175], v[216:219]
    v_xor_b32 v19, 0x10000, v19
    v_mfma_f32_16x16x32_bf16 v[220:223], a[88:91], a[168:171], v[220:223]
    s_add_u32 m0, s67, 98304
    v_mfma_f32_16x16x32_bf16 v[220:223], a[92:95], a[172:175], v[220:223]
    s_waitcnt lgkmcnt(14)
    s_waitcnt lgkmcnt(0)
    v_mfma_f32_16x16x32_bf16 v[224:227], a[32:35], a[176:179], v[224:227]
    s_waitcnt vmcnt(27)
    v_mfma_f32_16x16x32_bf16 v[224:227], a[36:39], a[180:183], v[224:227]
    buffer_load_dwordx4 v2, s[12:15], s72 offen offset:0  lds
    v_mfma_f32_16x16x32_bf16 v[228:231], a[40:43], a[176:179], v[228:231]
    ds_read_b64_tr_b16 a[160:161], v16 offset:0
    v_mfma_f32_16x16x32_bf16 v[228:231], a[44:47], a[180:183], v[228:231]
    ds_read_b128 a[144:147], v14 offset:28672
    v_mfma_f32_16x16x32_bf16 v[232:235], a[48:51], a[176:179], v[232:235]
    s_waitcnt vmcnt(24)
    ds_read_b64_tr_b16 a[162:163], v16 offset:512
    v_mfma_f32_16x16x32_bf16 v[232:235], a[52:55], a[180:183], v[232:235]
    s_add_u32 s76, s76, 1
    buffer_load_dwordx4 v3, s[12:15], s72 offen offset:1024  lds
    v_mfma_f32_16x16x32_bf16 v[236:239], a[56:59], a[176:179], v[236:239]
    ds_read_b64_tr_b16 a[164:165], v16 offset:16384
    v_mfma_f32_16x16x32_bf16 v[236:239], a[60:63], a[180:183], v[236:239]
    ds_read_b128 a[148:151], v15 offset:28672
    v_mfma_f32_16x16x32_bf16 v[240:243], a[64:67], a[176:179], v[240:243]
    ds_read_b64_tr_b16 a[166:167], v16 offset:16896
    v_mfma_f32_16x16x32_bf16 v[240:243], a[68:71], a[180:183], v[240:243]
    buffer_load_dwordx4 v2, s[16:19], s72 offen offset:2048  lds
    v_mfma_f32_16x16x32_bf16 v[244:247], a[72:75], a[176:179], v[244:247]
    v_mfma_f32_16x16x32_bf16 v[244:247], a[76:79], a[180:183], v[244:247]
    ds_read_b128 a[152:155], v14 offset:30720
    v_mfma_f32_16x16x32_bf16 v[248:251], a[80:83], a[176:179], v[248:251]
    v_mfma_f32_16x16x32_bf16 v[248:251], a[84:87], a[180:183], v[248:251]
    buffer_load_dwordx4 v3, s[16:19], s72 offen offset:3072  lds
    v_mfma_f32_16x16x32_bf16 v[252:255], a[88:91], a[176:179], v[252:255]
    s_add_u32 m0, s67, 114688
    v_mfma_f32_16x16x32_bf16 v[252:255], a[92:95], a[180:183], v[252:255]
    s_add_u32 s72, s72, 262144
    ds_read_b128 a[156:159], v15 offset:30720
    v_mfma_f32_16x16x32_bf16 a[0:3], a[32:35], a[184:187], a[0:3]
    v_mfma_f32_16x16x32_bf16 a[0:3], a[36:39], a[188:191], a[0:3]
    buffer_load_dwordx4 v2, s[12:15], s72 offen offset:0  lds
    v_mfma_f32_16x16x32_bf16 a[4:7], a[40:43], a[184:187], a[4:7]
    ds_read_b64_tr_b16 a[168:169], v17 offset:0
    v_mfma_f32_16x16x32_bf16 a[4:7], a[44:47], a[188:191], a[4:7]
    v_mfma_f32_16x16x32_bf16 a[8:11], a[48:51], a[184:187], a[8:11]
    ds_read_b64_tr_b16 a[170:171], v17 offset:512
    v_mfma_f32_16x16x32_bf16 a[8:11], a[52:55], a[188:191], a[8:11]
    buffer_load_dwordx4 v3, s[12:15], s72 offen offset:1024  lds
    v_mfma_f32_16x16x32_bf16 a[12:15], a[56:59], a[184:187], a[12:15]
    ds_read_b64_tr_b16 a[172:173], v17 offset:16384
    v_mfma_f32_16x16x32_bf16 a[12:15], a[60:63], a[188:191], a[12:15]
    v_mfma_f32_16x16x32_bf16 a[16:19], a[64:67], a[184:187], a[16:19]
    ds_read_b64_tr_b16 a[174:175], v17 offset:16896
    v_mfma_f32_16x16x32_bf16 a[16:19], a[68:71], a[188:191], a[16:19]
    buffer_load_dwordx4 v2, s[16:19], s72 offen offset:2048  lds
    v_mfma_f32_16x16x32_bf16 a[20:23], a[72:75], a[184:187], a[20:23]
    v_mfma_f32_16x16x32_bf16 a[20:23], a[76:79], a[188:191], a[20:23]
    s_waitcnt lgkmcnt(0)
    v_mfma_f32_16x16x32_bf16 a[24:27], a[80:83], a[184:187], a[24:27]
    s_barrier
    v_mfma_f32_16x16x32_bf16 a[24:27], a[84:87], a[188:191], a[24:27]
    buffer_load_dwordx4 v3, s[16:19], s72 offen offset:3072  lds
    v_mfma_f32_16x16x32_bf16 a[28:31], a[88:91], a[184:187], a[28:31]
    s_add_u32 s72, s72, 262144
    v_mfma_f32_16x16x32_bf16 a[28:31], a[92:95], a[188:191], a[28:31]
    v_mfma_f32_16x16x32_bf16 v[32:35], a[96:99], a[160:163], v[32:35]
    v_mfma_f32_16x16x32_bf16 v[32:35], a[100:103], a[164:167], v[32:35]
    v_mfma_f32_16x16x32_bf16 v[36:39], a[104:107], a[160:163], v[36:39]
    ds_read_b64_tr_b16 a[176:177], v18 offset:0
    v_mfma_f32_16x16x32_bf16 v[36:39], a[108:111], a[164:167], v[36:39]
    v_mfma_f32_16x16x32_bf16 v[40:43], a[112:115], a[160:163], v[40:43]
    ds_read_b64_tr_b16 a[178:179], v18 offset:512
    v_mfma_f32_16x16x32_bf16 v[40:43], a[116:119], a[164:167], v[40:43]
    v_mfma_f32_16x16x32_bf16 v[44:47], a[120:123], a[160:163], v[44:47]
    ds_read_b64_tr_b16 a[180:181], v18 offset:16384
    v_mfma_f32_16x16x32_bf16 v[44:47], a[124:127], a[164:167], v[44:47]
    v_mfma_f32_16x16x32_bf16 v[48:51], a[128:131], a[160:163], v[48:51]
    ds_read_b64_tr_b16 a[182:183], v18 offset:16896
    v_cvt_pk_bf16_f32 v39, v38, v39
    v_mfma_f32_16x16x32_bf16 v[48:51], a[132:135], a[164:167], v[48:51]
    v_cvt_pk_bf16_f32 v38, v36, v37
    v_cvt_pk_bf16_f32 v36, v32, v33
    v_mfma_f32_16x16x32_bf16 v[52:55], a[136:139], a[160:163], v[52:55]
    v_cvt_pk_bf16_f32 v37, v34, v35
    v_mfma_f32_16x16x32_bf16 v[52:55], a[140:143], a[164:167], v[52:55]
    v_mfma_f32_16x16x32_bf16 v[56:59], a[144:147], a[160:163], v[56:59]
    v_cvt_pk_bf16_f32 v47, v46, v47
    v_cvt_pk_bf16_f32 v46, v44, v45
    v_mfma_f32_16x16x32_bf16 v[56:59], a[148:151], a[164:167], v[56:59]
    v_cvt_pk_bf16_f32 v44, v40, v41
    v_cvt_pk_bf16_f32 v45, v42, v43
    v_mfma_f32_16x16x32_bf16 v[60:63], a[152:155], a[160:163], v[60:63]
    v_mfma_f32_16x16x32_bf16 v[60:63], a[156:159], a[164:167], v[60:63]
    v_mfma_f32_16x16x32_bf16 v[64:67], a[96:99], a[168:171], v[64:67]
    s_add_u32 m0, s67, 147456
    v_cvt_pk_bf16_f32 v55, v54, v55
    v_cvt_pk_bf16_f32 v54, v52, v53
    v_mfma_f32_16x16x32_bf16 v[64:67], a[100:103], a[172:175], v[64:67]
    buffer_load_dwordx4 v10, s[20:23], s70 offen offset:0 sc1 lds
    v_cvt_pk_bf16_f32 v52, v48, v49
    v_mfma_f32_16x16x32_bf16 v[68:71], a[104:107], a[168:171], v[68:71]
    ds_read_b64_tr_b16 a[184:185], v19 offset:0
    v_cvt_pk_bf16_f32 v53, v50, v51
    v_mfma_f32_16x16x32_bf16 v[68:71], a[108:111], a[172:175], v[68:71]
    v_mfma_f32_16x16x32_bf16 v[72:75], a[112:115], a[168:171], v[72:75]
    ds_read_b64_tr_b16 a[186:187], v19 offset:512
    v_cvt_pk_bf16_f32 v63, v62, v63
    v_mfma_f32_16x16x32_bf16 v[72:75], a[116:119], a[172:175], v[72:75]
    buffer_load_dwordx4 v10, s[20:23], s70 offen offset:1024 sc1 lds
    v_cvt_pk_bf16_f32 v62, v60, v61
    v_mfma_f32_16x16x32_bf16 v[76:79], a[120:123], a[168:171], v[76:79]
    ds_read_b64_tr_b16 a[188:189], v19 offset:16384
    v_cvt_pk_bf16_f32 v60, v56, v57
    v_mfma_f32_16x16x32_bf16 v[76:79], a[124:127], a[172:175], v[76:79]
    v_cvt_pk_bf16_f32 v61, v58, v59
    v_mfma_f32_16x16x32_bf16 v[80:83], a[128:131], a[168:171], v[80:83]
    ds_read_b64_tr_b16 a[190:191], v19 offset:16896
    v_cvt_pk_bf16_f32 v64, v64, v65
    v_mfma_f32_16x16x32_bf16 v[80:83], a[132:135], a[172:175], v[80:83]
    buffer_load_dwordx4 v10, s[20:23], s70 offen offset:2048 sc1 lds
    v_cvt_pk_bf16_f32 v65, v66, v67
    v_mfma_f32_16x16x32_bf16 v[84:87], a[136:139], a[168:171], v[84:87]
    v_cvt_pk_bf16_f32 v66, v68, v69
    v_cvt_pk_bf16_f32 v67, v70, v71
    v_mfma_f32_16x16x32_bf16 v[84:87], a[140:143], a[172:175], v[84:87]
    v_accvgpr_write_b32 a192, v64
    v_accvgpr_write_b32 a193, v65
    v_mfma_f32_16x16x32_bf16 v[88:91], a[144:147], a[168:171], v[88:91]
    v_accvgpr_write_b32 a194, v66
    v_accvgpr_write_b32 a195, v67
    v_mfma_f32_16x16x32_bf16 v[88:91], a[148:151], a[172:175], v[88:91]
    buffer_load_dwordx4 v10, s[20:23], s70 offen offset:3072 sc1 lds
    v_cvt_pk_bf16_f32 v72, v72, v73
    v_mfma_f32_16x16x32_bf16 v[92:95], a[152:155], a[168:171], v[92:95]
    s_add_u32 m0, s67, 0
    v_cvt_pk_bf16_f32 v73, v74, v75
    v_cvt_pk_bf16_f32 v74, v76, v77
    v_mfma_f32_16x16x32_bf16 v[92:95], a[156:159], a[172:175], v[92:95]
    s_waitcnt lgkmcnt(6)
    s_waitcnt lgkmcnt(0)
    v_cvt_pk_bf16_f32 v75, v78, v79
    v_mfma_f32_16x16x32_bf16 v[96:99], a[96:99], a[176:179], v[96:99]
    s_waitcnt vmcnt(29)
    v_accvgpr_write_b32 a196, v72
    v_accvgpr_write_b32 a197, v73
    v_mfma_f32_16x16x32_bf16 v[96:99], a[100:103], a[180:183], v[96:99]
    buffer_load_dwordx4 v4, s[4:7], s71 offen offset:0  lds
    v_accvgpr_write_b32 a198, v74
    v_mfma_f32_16x16x32_bf16 v[100:103], a[104:107], a[176:179], v[100:103]
    ds_read_b64_tr_b16 a[160:161], v16 offset:32768
    v_accvgpr_write_b32 a199, v75
    v_mfma_f32_16x16x32_bf16 v[100:103], a[108:111], a[180:183], v[100:103]
    v_cvt_pk_bf16_f32 v80, v80, v81
    v_cvt_pk_bf16_f32 v81, v82, v83
    v_mfma_f32_16x16x32_bf16 v[104:107], a[112:115], a[176:179], v[104:107]
    s_waitcnt vmcnt(26)
    ds_read_b64_tr_b16 a[162:163], v16 offset:33280
    v_cvt_pk_bf16_f32 v82, v84, v85
    v_mfma_f32_16x16x32_bf16 v[104:107], a[116:119], a[180:183], v[104:107]
    buffer_load_dwordx4 v4, s[8:11], s71 offen offset:1024  lds
    v_cvt_pk_bf16_f32 v83, v86, v87
    v_mfma_f32_16x16x32_bf16 v[108:111], a[120:123], a[176:179], v[108:111]
    ds_read_b64_tr_b16 a[164:165], v16 offset:49152
    v_accvgpr_write_b32 a200, v80
    v_mfma_f32_16x16x32_bf16 v[108:111], a[124:127], a[180:183], v[108:111]
    v_accvgpr_write_b32 a201, v81
    v_accvgpr_write_b32 a202, v82
    v_mfma_f32_16x16x32_bf16 v[112:115], a[128:131], a[176:179], v[112:115]
    ds_read_b64_tr_b16 a[166:167], v16 offset:49664
    v_accvgpr_write_b32 a203, v83
    v_mfma_f32_16x16x32_bf16 v[112:115], a[132:135], a[180:183], v[112:115]
    buffer_load_dwordx4 v5, s[4:7], s71 offen offset:2048  lds
    v_cvt_pk_bf16_f32 v88, v88, v89
    v_mfma_f32_16x16x32_bf16 v[116:119], a[136:139], a[176:179], v[116:119]
    buffer_store_dwordx4 v[36:39], v20, s[24:27], s78 offen offset:0 sc1
    v_cvt_pk_bf16_f32 v89, v90, v91
    v_mfma_f32_16x16x32_bf16 v[116:119], a[140:143], a[180:183], v[116:119]
    v_cvt_pk_bf16_f32 v90, v92, v93
    v_cvt_pk_bf16_f32 v91, v94, v95
    v_mfma_f32_16x16x32_bf16 v[120:123], a[144:147], a[176:179], v[120:123]
    v_accvgpr_write_b32 a204, v88
    v_accvgpr_write_b32 a205, v89
    v_mfma_f32_16x16x32_bf16 v[120:123], a[148:151], a[180:183], v[120:123]
    buffer_load_dwordx4 v5, s[8:11], s71 offen offset:3072  lds
    v_accvgpr_write_b32 a206, v90
    v_mfma_f32_16x16x32_bf16 v[124:127], a[152:155], a[176:179], v[124:127]
    s_add_u32 m0, s67, 16384
    v_accvgpr_write_b32 a207, v91
    v_cvt_pk_bf16_f32 v96, v96, v97
    v_mfma_f32_16x16x32_bf16 v[124:127], a[156:159], a[180:183], v[124:127]
    s_add_u32 s71, s71, 114688
    v_cvt_pk_bf16_f32 v97, v98, v99
    v_cvt_pk_bf16_f32 v98, v100, v101
    v_mfma_f32_16x16x32_bf16 v[128:131], a[96:99], a[184:187], v[128:131]
    buffer_store_dwordx4 v[44:47], v20, s[24:27], s79 offen offset:0 sc1
    v_cvt_pk_bf16_f32 v99, v102, v103
    v_mfma_f32_16x16x32_bf16 v[128:131], a[100:103], a[188:191], v[128:131]
    buffer_load_dwordx4 v4, s[4:7], s71 offen offset:0  lds
    v_accvgpr_write_b32 a224, v96
    v_mfma_f32_16x16x32_bf16 v[132:135], a[104:107], a[184:187], v[132:135]
    ds_read_b64_tr_b16 a[168:169], v17 offset:32768
    v_accvgpr_write_b32 a225, v97
    v_mfma_f32_16x16x32_bf16 v[132:135], a[108:111], a[188:191], v[132:135]
    v_accvgpr_write_b32 a226, v98
    v_accvgpr_write_b32 a227, v99
    v_mfma_f32_16x16x32_bf16 v[136:139], a[112:115], a[184:187], v[136:139]
    ds_read_b64_tr_b16 a[170:171], v17 offset:33280
    v_cvt_pk_bf16_f32 v104, v104, v105
    v_mfma_f32_16x16x32_bf16 v[136:139], a[116:119], a[188:191], v[136:139]
    buffer_load_dwordx4 v4, s[8:11], s71 offen offset:1024  lds
    v_cvt_pk_bf16_f32 v105, v106, v107
    v_mfma_f32_16x16x32_bf16 v[140:143], a[120:123], a[184:187], v[140:143]
    buffer_store_dwordx4 v[52:55], v20, s[24:27], s80 offen offset:0 sc1
    ds_read_b64_tr_b16 a[172:173], v17 offset:49152
    v_mfma_f32_16x16x32_bf16 v[140:143], a[124:127], a[188:191], v[140:143]
    v_cvt_pk_bf16_f32 v106, v108, v109
    v_cvt_pk_bf16_f32 v107, v110, v111
    v_mfma_f32_16x16x32_bf16 v[144:147], a[128:131], a[184:187], v[144:147]
    ds_read_b64_tr_b16 a[174:175], v17 offset:49664
    v_cvt_pk_bf16_f32 v135, v134, v135
    v_mfma_f32_16x16x32_bf16 v[144:147], a[132:135], a[188:191], v[144:147]
    buffer_load_dwordx4 v5, s[4:7], s71 offen offset:2048  lds
    v_cvt_pk_bf16_f32 v134, v132, v133
    v_mfma_f32_16x16x32_bf16 v[148:151], a[136:139], a[184:187], v[148:151]
    s_waitcnt vmcnt(30)
    v_cvt_pk_bf16_f32 v132, v128, v129
    v_cvt_pk_bf16_f32 v133, v130, v131
    v_mfma_f32_16x16x32_bf16 v[148:151], a[140:143], a[188:191], v[148:151]
    s_barrier
    v_accvgpr_write_b32 a228, v104
    v_accvgpr_write_b32 a229, v105
    v_mfma_f32_16x16x32_bf16 v[152:155], a[144:147], a[184:187], v[152:155]
    v_cvt_pk_bf16_f32 v143, v142, v143
    v_cvt_pk_bf16_f32 v142, v140, v141
    v_mfma_f32_16x16x32_bf16 v[152:155], a[148:151], a[188:191], v[152:155]
    buffer_load_dwordx4 v5, s[8:11], s71 offen offset:3072  lds
    ds_read_b128 a[32:35], v14 offset:0
    v_mfma_f32_16x16x32_bf16 v[156:159], a[152:155], a[184:187], v[156:159]
    s_add_u32 s71, s71, 114688
    v_cvt_pk_bf16_f32 v140, v136, v137
    v_cvt_pk_bf16_f32 v141, v138, v139
    v_mfma_f32_16x16x32_bf16 v[156:159], a[156:159], a[188:191], v[156:159]
    s_waitcnt lgkmcnt(7)
    ds_read_b128 a[36:39], v15 offset:0
    v_accvgpr_write_b32 a230, v106
    v_mfma_f32_16x16x32_bf16 v[160:163], a[96:99], a[160:163], v[160:163]
    s_waitcnt lgkmcnt(6)
    v_cvt_pk_bf16_f32 v151, v150, v151
    v_cvt_pk_bf16_f32 v150, v148, v149
    v_mfma_f32_16x16x32_bf16 v[160:163], a[100:103], a[164:167], v[160:163]
    ds_read_b128 a[40:43], v14 offset:2048
    v_cvt_pk_bf16_f32 v148, v144, v145
    v_mfma_f32_16x16x32_bf16 v[164:167], a[104:107], a[160:163], v[164:167]
    buffer_store_dwordx4 v[60:63], v20, s[24:27], s81 offen offset:0 sc1
    ds_read_b64_tr_b16 a[176:177], v18 offset:32768
    v_mfma_f32_16x16x32_bf16 v[164:167], a[108:111], a[164:167], v[164:167]
    ds_read_b128 a[44:47], v15 offset:2048
    v_cvt_pk_bf16_f32 v149, v146, v147
    v_mfma_f32_16x16x32_bf16 v[168:171], a[112:115], a[160:163], v[168:171]
    ds_read_b64_tr_b16 a[178:179], v18 offset:33280
    v_cvt_pk_bf16_f32 v159, v158, v159
    v_mfma_f32_16x16x32_bf16 v[168:171], a[116:119], a[164:167], v[168:171]
    ds_read_b128 a[48:51], v14 offset:4096
    v_cvt_pk_bf16_f32 v158, v156, v157
    v_mfma_f32_16x16x32_bf16 v[172:175], a[120:123], a[160:163], v[172:175]
    ds_read_b64_tr_b16 a[180:181], v18 offset:49152
    v_cvt_pk_bf16_f32 v156, v152, v153
    v_mfma_f32_16x16x32_bf16 v[172:175], a[124:127], a[164:167], v[172:175]
    ds_read_b128 a[52:55], v15 offset:4096
    v_cvt_pk_bf16_f32 v157, v154, v155
    v_mfma_f32_16x16x32_bf16 v[176:179], a[128:131], a[160:163], v[176:179]
    ds_read_b64_tr_b16 a[182:183], v18 offset:49664
    v_accvgpr_write_b32 a231, v107
    v_mfma_f32_16x16x32_bf16 v[176:179], a[132:135], a[164:167], v[176:179]
    ds_read_b128 a[56:59], v14 offset:6144
    v_cvt_pk_bf16_f32 v112, v112, v113
    v_mfma_f32_16x16x32_bf16 v[180:183], a[136:139], a[160:163], v[180:183]
    v_cvt_pk_bf16_f32 v113, v114, v115
    v_cvt_pk_bf16_f32 v114, v116, v117
    v_mfma_f32_16x16x32_bf16 v[180:183], a[140:143], a[164:167], v[180:183]
    ds_read_b128 a[60:63], v15 offset:6144
    v_cvt_pk_bf16_f32 v115, v118, v119
    v_mfma_f32_16x16x32_bf16 v[184:187], a[144:147], a[160:163], v[184:187]
    v_accvgpr_write_b32 a232, v112
    v_accvgpr_write_b32 a233, v113
    v_mfma_f32_16x16x32_bf16 v[184:187], a[148:151], a[164:167], v[184:187]
    ds_read_b128 a[64:67], v14 offset:8192
    v_accvgpr_write_b32 a234, v114
    v_mfma_f32_16x16x32_bf16 v[188:191], a[152:155], a[160:163], v[188:191]
    buffer_store_dwordx4 v[132:135], v20, s[24:27], s78 offen offset:3072 sc1
    v_accvgpr_write_b32 a235, v115
    v_mfma_f32_16x16x32_bf16 v[188:191], a[156:159], a[164:167], v[188:191]
    s_waitcnt lgkmcnt(15)
    ds_read_b128 a[68:71], v15 offset:8192
    v_cvt_pk_bf16_f32 v120, v120, v121
    v_mfma_f32_16x16x32_bf16 v[192:195], a[96:99], a[168:171], v[192:195]
    s_waitcnt lgkmcnt(14)
    s_add_u32 s70, s70, 16384
    v_cvt_pk_bf16_f32 v121, v122, v123
    v_mfma_f32_16x16x32_bf16 v[192:195], a[100:103], a[172:175], v[192:195]
    ds_read_b128 a[72:75], v14 offset:10240
    v_cvt_pk_bf16_f32 v122, v124, v125
    v_mfma_f32_16x16x32_bf16 v[196:199], a[104:107], a[168:171], v[196:199]
    ds_read_b64_tr_b16 a[184:185], v19 offset:32768
    v_cvt_pk_bf16_f32 v123, v126, v127
    v_mfma_f32_16x16x32_bf16 v[196:199], a[108:111], a[172:175], v[196:199]
    ds_read_b128 a[76:79], v15 offset:10240
    v_accvgpr_write_b32 a236, v120
    v_mfma_f32_16x16x32_bf16 v[200:203], a[112:115], a[168:171], v[200:203]
    buffer_store_dwordx4 v[140:143], v20, s[24:27], s79 offen offset:3072 sc1
    ds_read_b64_tr_b16 a[186:187], v19 offset:33280
    v_mfma_f32_16x16x32_bf16 v[200:203], a[116:119], a[172:175], v[200:203]
    v_accvgpr_write_b32 a237, v121
    v_accvgpr_write_b32 a238, v122
    v_mfma_f32_16x16x32_bf16 v[204:207], a[120:123], a[168:171], v[204:207]
    ds_read_b64_tr_b16 a[188:189], v19 offset:49152
    v_accvgpr_write_b32 a239, v123
    v_mfma_f32_16x16x32_bf16 v[204:207], a[124:127], a[172:175], v[204:207]
    v_cvt_pk_bf16_f32 v167, v166, v167
    v_cvt_pk_bf16_f32 v166, v164, v165
    v_mfma_f32_16x16x32_bf16 v[208:211], a[128:131], a[168:171], v[208:211]
    ds_read_b64_tr_b16 a[190:191], v19 offset:49664
    v_cvt_pk_bf16_f32 v164, v160, v161
    v_mfma_f32_16x16x32_bf16 v[208:211], a[132:135], a[172:175], v[208:211]
    v_xor_b32 v16, 0x10000, v16
    v_cvt_pk_bf16_f32 v165, v162, v163
    v_mfma_f32_16x16x32_bf16 v[212:215], a[136:139], a[168:171], v[212:215]
    buffer_store_dwordx4 v[148:151], v20, s[24:27], s80 offen offset:3072 sc1
    v_cvt_pk_bf16_f32 v175, v174, v175
    v_mfma_f32_16x16x32_bf16 v[212:215], a[140:143], a[172:175], v[212:215]
    v_xor_b32 v17, 0x10000, v17
    v_cvt_pk_bf16_f32 v174, v172, v173
    v_mfma_f32_16x16x32_bf16 v[216:219], a[144:147], a[168:171], v[216:219]
    v_xor_b32 v18, 0x10000, v18
    v_cvt_pk_bf16_f32 v172, v168, v169
    v_mfma_f32_16x16x32_bf16 v[216:219], a[148:151], a[172:175], v[216:219]
    v_xor_b32 v19, 0x10000, v19
    v_cvt_pk_bf16_f32 v173, v170, v171
    v_mfma_f32_16x16x32_bf16 v[220:223], a[152:155], a[168:171], v[220:223]
    s_add_u32 m0, s67, 32768
    buffer_store_dwordx4 v[156:159], v20, s[24:27], s81 offen offset:3072 sc1
    v_cvt_pk_bf16_f32 v183, v182, v183
    v_mfma_f32_16x16x32_bf16 v[220:223], a[156:159], a[172:175], v[220:223]
    s_waitcnt lgkmcnt(14)
    s_waitcnt lgkmcnt(0)
    v_cvt_pk_bf16_f32 v182, v180, v181
    v_mfma_f32_16x16x32_bf16 v[224:227], a[96:99], a[176:179], v[224:227]
    s_waitcnt vmcnt(32)
    v_cvt_pk_bf16_f32 v180, v176, v177
    v_cvt_pk_bf16_f32 v181, v178, v179
    v_mfma_f32_16x16x32_bf16 v[224:227], a[100:103], a[180:183], v[224:227]
    buffer_load_dwordx4 v2, s[12:15], s72 offen offset:0  lds
    v_cvt_pk_bf16_f32 v191, v190, v191
    v_mfma_f32_16x16x32_bf16 v[228:231], a[104:107], a[176:179], v[228:231]
    ds_read_b64_tr_b16 a[160:161], v13 offset:0
    v_cvt_pk_bf16_f32 v190, v188, v189
    v_mfma_f32_16x16x32_bf16 v[228:231], a[108:111], a[180:183], v[228:231]
    ds_read_b128 a[80:83], v14 offset:12288
    v_cvt_pk_bf16_f32 v188, v184, v185
    v_mfma_f32_16x16x32_bf16 v[232:235], a[112:115], a[176:179], v[232:235]
    s_waitcnt vmcnt(29)
    ds_read_b64_tr_b16 a[162:163], v13 offset:256
    v_cvt_pk_bf16_f32 v189, v186, v187
    v_mfma_f32_16x16x32_bf16 v[232:235], a[116:119], a[180:183], v[232:235]
    s_add_u32 s76, s76, 1
    buffer_load_dwordx4 v3, s[12:15], s72 offen offset:1024  lds
    v_cvt_pk_bf16_f32 v192, v192, v193
    v_mfma_f32_16x16x32_bf16 v[236:239], a[120:123], a[176:179], v[236:239]
    ds_read_b64_tr_b16 a[164:165], v13 offset:16384
    v_cvt_pk_bf16_f32 v193, v194, v195
    v_mfma_f32_16x16x32_bf16 v[236:239], a[124:127], a[180:183], v[236:239]
    ds_read_b128 a[84:87], v15 offset:12288
    v_cvt_pk_bf16_f32 v194, v196, v197
    v_mfma_f32_16x16x32_bf16 v[240:243], a[128:131], a[176:179], v[240:243]
    ds_read_b64_tr_b16 a[166:167], v13 offset:16640
    v_cvt_pk_bf16_f32 v195, v198, v199
    v_mfma_f32_16x16x32_bf16 v[240:243], a[132:135], a[180:183], v[240:243]
    buffer_load_dwordx4 v2, s[16:19], s72 offen offset:2048  lds
    v_accvgpr_write_b32 a208, v192
    v_mfma_f32_16x16x32_bf16 v[244:247], a[136:139], a[176:179], v[244:247]
    v_accvgpr_write_b32 a209, v193
    v_accvgpr_write_b32 a210, v194
    v_mfma_f32_16x16x32_bf16 v[244:247], a[140:143], a[180:183], v[244:247]
    ds_read_b128 a[88:91], v14 offset:14336
    v_accvgpr_write_b32 a211, v195
    v_mfma_f32_16x16x32_bf16 v[248:251], a[144:147], a[176:179], v[248:251]
    v_cvt_pk_bf16_f32 v200, v200, v201
    v_cvt_pk_bf16_f32 v201, v202, v203
    v_mfma_f32_16x16x32_bf16 v[248:251], a[148:151], a[180:183], v[248:251]
    buffer_load_dwordx4 v3, s[16:19], s72 offen offset:3072  lds
    v_cvt_pk_bf16_f32 v202, v204, v205
    v_mfma_f32_16x16x32_bf16 v[252:255], a[152:155], a[176:179], v[252:255]
    s_add_u32 m0, s67, 49152
    v_cvt_pk_bf16_f32 v203, v206, v207
    v_accvgpr_write_b32 a212, v200
    v_mfma_f32_16x16x32_bf16 v[252:255], a[156:159], a[180:183], v[252:255]
    s_add_u32 s72, s72, 262144
    ds_read_b128 a[92:95], v15 offset:14336
    v_accvgpr_write_b32 a213, v201
    v_mfma_f32_16x16x32_bf16 a[0:3], a[96:99], a[184:187], a[0:3]
    v_accvgpr_write_b32 a214, v202
    v_accvgpr_write_b32 a215, v203
    v_mfma_f32_16x16x32_bf16 a[0:3], a[100:103], a[188:191], a[0:3]
    buffer_load_dwordx4 v2, s[12:15], s72 offen offset:0  lds
    v_cvt_pk_bf16_f32 v208, v208, v209
    v_mfma_f32_16x16x32_bf16 a[4:7], a[104:107], a[184:187], a[4:7]
    ds_read_b64_tr_b16 a[168:169], v8 offset:0
    v_cvt_pk_bf16_f32 v209, v210, v211
    v_mfma_f32_16x16x32_bf16 a[4:7], a[108:111], a[188:191], a[4:7]
    v_cvt_pk_bf16_f32 v210, v212, v213
    v_cvt_pk_bf16_f32 v211, v214, v215
    v_mfma_f32_16x16x32_bf16 a[8:11], a[112:115], a[184:187], a[8:11]
    ds_read_b64_tr_b16 a[170:171], v8 offset:256
    v_accvgpr_write_b32 a216, v208
    v_mfma_f32_16x16x32_bf16 a[8:11], a[116:119], a[188:191], a[8:11]
    buffer_load_dwordx4 v3, s[12:15], s72 offen offset:1024  lds
    v_accvgpr_write_b32 a217, v209
    v_mfma_f32_16x16x32_bf16 a[12:15], a[120:123], a[184:187], a[12:15]
    ds_read_b64_tr_b16 a[172:173], v8 offset:16384
    v_accvgpr_write_b32 a218, v210
    v_mfma_f32_16x16x32_bf16 a[12:15], a[124:127], a[188:191], a[12:15]
    v_accvgpr_write_b32 a219, v211
    v_cvt_pk_bf16_f32 v216, v216, v217
    v_mfma_f32_16x16x32_bf16 a[16:19], a[128:131], a[184:187], a[16:19]
    ds_read_b64_tr_b16 a[174:175], v8 offset:16640
    v_cvt_pk_bf16_f32 v217, v218, v219
    v_mfma_f32_16x16x32_bf16 a[16:19], a[132:135], a[188:191], a[16:19]
    buffer_load_dwordx4 v2, s[16:19], s72 offen offset:2048  lds
    v_cvt_pk_bf16_f32 v218, v220, v221
    v_mfma_f32_16x16x32_bf16 a[20:23], a[136:139], a[184:187], a[20:23]
    v_cvt_pk_bf16_f32 v219, v222, v223
    v_accvgpr_write_b32 a220, v216
    v_mfma_f32_16x16x32_bf16 a[20:23], a[140:143], a[188:191], a[20:23]
    s_waitcnt lgkmcnt(0)
    v_accvgpr_write_b32 a221, v217
    v_accvgpr_write_b32 a222, v218
    v_mfma_f32_16x16x32_bf16 a[24:27], a[144:147], a[184:187], a[24:27]
    s_barrier
    v_accvgpr_write_b32 a223, v219
    v_cvt_pk_bf16_f32 v224, v224, v225
    v_mfma_f32_16x16x32_bf16 a[24:27], a[148:151], a[188:191], a[24:27]
    buffer_load_dwordx4 v3, s[16:19], s72 offen offset:3072  lds
    v_cvt_pk_bf16_f32 v225, v226, v227
    v_mfma_f32_16x16x32_bf16 a[28:31], a[152:155], a[184:187], a[28:31]
    s_add_u32 s72, s72, 262144
    v_cvt_pk_bf16_f32 v226, v228, v229
    v_cvt_pk_bf16_f32 v227, v230, v231
    v_mfma_f32_16x16x32_bf16 a[28:31], a[156:159], a[188:191], a[28:31]
    v_accvgpr_write_b32 a240, v224
    v_accvgpr_write_b32 a241, v225
    v_mfma_f32_16x16x32_bf16 v[32:35], a[160:163], a[32:35], 0
    v_accvgpr_write_b32 a242, v226
    v_accvgpr_write_b32 a243, v227
    v_mfma_f32_16x16x32_bf16 v[32:35], a[164:167], a[36:39], v[32:35]
    v_cvt_pk_bf16_f32 v232, v232, v233
    v_cvt_pk_bf16_f32 v233, v234, v235
    v_mfma_f32_16x16x32_bf16 v[36:39], a[160:163], a[40:43], 0
    ds_read_b64_tr_b16 a[176:177], v13 offset:1024
    v_cvt_pk_bf16_f32 v234, v236, v237
    v_mfma_f32_16x16x32_bf16 v[36:39], a[164:167], a[44:47], v[36:39]
    v_cvt_pk_bf16_f32 v235, v238, v239
    v_accvgpr_write_b32 a244, v232
    v_mfma_f32_16x16x32_bf16 v[40:43], a[160:163], a[48:51], 0
    ds_read_b64_tr_b16 a[178:179], v13 offset:1280
    v_accvgpr_write_b32 a245, v233
    v_mfma_f32_16x16x32_bf16 v[40:43], a[164:167], a[52:55], v[40:43]
    v_accvgpr_write_b32 a246, v234
    v_accvgpr_write_b32 a247, v235
    v_mfma_f32_16x16x32_bf16 v[44:47], a[160:163], a[56:59], 0
    ds_read_b64_tr_b16 a[180:181], v13 offset:17408
    v_cvt_pk_bf16_f32 v240, v240, v241
    v_mfma_f32_16x16x32_bf16 v[44:47], a[164:167], a[60:63], v[44:47]
    v_cvt_pk_bf16_f32 v241, v242, v243
    v_cvt_pk_bf16_f32 v242, v244, v245
    v_mfma_f32_16x16x32_bf16 v[48:51], a[160:163], a[64:67], 0
    ds_read_b64_tr_b16 a[182:183], v13 offset:17664
    v_cvt_pk_bf16_f32 v243, v246, v247
    v_mfma_f32_16x16x32_bf16 v[48:51], a[164:167], a[68:71], v[48:51]
    v_accvgpr_write_b32 a248, v240
    v_accvgpr_write_b32 a249, v241
    v_mfma_f32_16x16x32_bf16 v[52:55], a[160:163], a[72:75], 0
    v_accvgpr_write_b32 a250, v242
    v_accvgpr_write_b32 a251, v243
    v_mfma_f32_16x16x32_bf16 v[52:55], a[164:167], a[76:79], v[52:55]
    v_cvt_pk_bf16_f32 v248, v248, v249
    v_cvt_pk_bf16_f32 v249, v250, v251
    v_mfma_f32_16x16x32_bf16 v[56:59], a[160:163], a[80:83], 0
    v_cvt_pk_bf16_f32 v250, v252, v253
    v_cvt_pk_bf16_f32 v251, v254, v255
    v_mfma_f32_16x16x32_bf16 v[56:59], a[164:167], a[84:87], v[56:59]
    v_accvgpr_write_b32 a252, v248
    v_accvgpr_write_b32 a253, v249
    v_mfma_f32_16x16x32_bf16 v[60:63], a[160:163], a[88:91], 0
    v_accvgpr_write_b32 a254, v250
    v_accvgpr_write_b32 a255, v251
    v_mfma_f32_16x16x32_bf16 v[60:63], a[164:167], a[92:95], v[60:63]
    v_accvgpr_read_b32 v24, a0
    v_accvgpr_read_b32 v25, a1
    v_mfma_f32_16x16x32_bf16 v[64:67], a[168:171], a[32:35], 0
    s_add_u32 m0, s67, 131072
    v_accvgpr_read_b32 v26, a2
    v_accvgpr_read_b32 v27, a3
    v_mfma_f32_16x16x32_bf16 v[64:67], a[172:175], a[36:39], v[64:67]
    buffer_load_dwordx4 v10, s[20:23], s70 offen offset:0 sc1 lds
    v_accvgpr_read_b32 v28, a4
    v_mfma_f32_16x16x32_bf16 v[68:71], a[168:171], a[40:43], 0
    ds_read_b64_tr_b16 a[184:185], v8 offset:1024
    v_accvgpr_read_b32 v29, a5
    v_mfma_f32_16x16x32_bf16 v[68:71], a[172:175], a[44:47], v[68:71]
    v_accvgpr_read_b32 v30, a6
    v_accvgpr_read_b32 v31, a7
    v_mfma_f32_16x16x32_bf16 v[72:75], a[168:171], a[48:51], 0
    ds_read_b64_tr_b16 a[186:187], v8 offset:1280
    v_cvt_pk_bf16_f32 v240, v24, v25
    v_mfma_f32_16x16x32_bf16 v[72:75], a[172:175], a[52:55], v[72:75]
    buffer_load_dwordx4 v10, s[20:23], s70 offen offset:1024 sc1 lds
    v_cvt_pk_bf16_f32 v241, v26, v27
    v_mfma_f32_16x16x32_bf16 v[76:79], a[168:171], a[56:59], 0
    ds_read_b64_tr_b16 a[188:189], v8 offset:17408
    v_cvt_pk_bf16_f32 v242, v28, v29
    v_mfma_f32_16x16x32_bf16 v[76:79], a[172:175], a[60:63], v[76:79]
    v_cvt_pk_bf16_f32 v243, v30, v31
    v_accvgpr_read_b32 v24, a8
    v_mfma_f32_16x16x32_bf16 v[80:83], a[168:171], a[64:67], 0
    ds_read_b64_tr_b16 a[190:191], v8 offset:17664
    v_accvgpr_read_b32 v25, a9
    v_mfma_f32_16x16x32_bf16 v[80:83], a[172:175], a[68:71], v[80:83]
    buffer_load_dwordx4 v10, s[20:23], s70 offen offset:2048 sc1 lds
    v_accvgpr_read_b32 v26, a10
    v_mfma_f32_16x16x32_bf16 v[84:87], a[168:171], a[72:75], 0
    v_accvgpr_read_b32 v27, a11
    v_accvgpr_read_b32 v28, a12
    v_mfma_f32_16x16x32_bf16 v[84:87], a[172:175], a[76:79], v[84:87]
    v_accvgpr_read_b32 v29, a13
    v_accvgpr_read_b32 v30, a14
    v_mfma_f32_16x16x32_bf16 v[88:91], a[168:171], a[80:83], 0
    v_accvgpr_read_b32 v31, a15
    v_cvt_pk_bf16_f32 v244, v24, v25
    v_mfma_f32_16x16x32_bf16 v[88:91], a[172:175], a[84:87], v[88:91]
    buffer_load_dwordx4 v10, s[20:23], s70 offen offset:3072 sc1 lds
    v_cvt_pk_bf16_f32 v245, v26, v27
    v_mfma_f32_16x16x32_bf16 v[92:95], a[168:171], a[88:91], 0
    s_add_u32 m0, s67, 65536
    v_cvt_pk_bf16_f32 v246, v28, v29
    v_cvt_pk_bf16_f32 v247, v30, v31
    v_mfma_f32_16x16x32_bf16 v[92:95], a[172:175], a[92:95], v[92:95]
    s_waitcnt lgkmcnt(6)
    s_waitcnt lgkmcnt(0)
    v_accvgpr_read_b32 v24, a16
    v_mfma_f32_16x16x32_bf16 v[96:99], a[176:179], a[32:35], 0
    s_waitcnt vmcnt(36)
    v_accvgpr_read_b32 v25, a17
    v_accvgpr_read_b32 v26, a18
    v_mfma_f32_16x16x32_bf16 v[96:99], a[180:183], a[36:39], v[96:99]
    buffer_load_dwordx4 v4, s[4:7], s71 offen offset:0  lds
    v_accvgpr_read_b32 v27, a19
    v_mfma_f32_16x16x32_bf16 v[100:103], a[176:179], a[40:43], 0
    ds_read_b64_tr_b16 a[160:161], v16 offset:32768
    v_accvgpr_read_b32 v28, a20
    v_mfma_f32_16x16x32_bf16 v[100:103], a[180:183], a[44:47], v[100:103]
    v_accvgpr_read_b32 v29, a21
    v_accvgpr_read_b32 v30, a22
    v_mfma_f32_16x16x32_bf16 v[104:107], a[176:179], a[48:51], 0
    s_waitcnt vmcnt(33)
    ds_read_b64_tr_b16 a[162:163], v16 offset:33280
    v_accvgpr_read_b32 v31, a23
    v_mfma_f32_16x16x32_bf16 v[104:107], a[180:183], a[52:55], v[104:107]
    buffer_load_dwordx4 v4, s[8:11], s71 offen offset:1024  lds
    v_cvt_pk_bf16_f32 v248, v24, v25
    v_mfma_f32_16x16x32_bf16 v[108:111], a[176:179], a[56:59], 0
    ds_read_b64_tr_b16 a[164:165], v16 offset:49152
    v_cvt_pk_bf16_f32 v249, v26, v27
    v_mfma_f32_16x16x32_bf16 v[108:111], a[180:183], a[60:63], v[108:111]
    v_cvt_pk_bf16_f32 v250, v28, v29
    v_cvt_pk_bf16_f32 v251, v30, v31
    v_mfma_f32_16x16x32_bf16 v[112:115], a[176:179], a[64:67], 0
    ds_read_b64_tr_b16 a[166:167], v16 offset:49664
    v_accvgpr_read_b32 v24, a24
    v_mfma_f32_16x16x32_bf16 v[112:115], a[180:183], a[68:71], v[112:115]
    buffer_load_dwordx4 v5, s[4:7], s71 offen offset:2048  lds
    v_accvgpr_read_b32 v25, a25
    v_mfma_f32_16x16x32_bf16 v[116:119], a[176:179], a[72:75], 0
    buffer_store_dwordx4 v[164:167], v20, s[24:27], s82 offen offset:0 sc1
    v_accvgpr_read_b32 v26, a26
    v_mfma_f32_16x16x32_bf16 v[116:119], a[180:183], a[76:79], v[116:119]
    v_accvgpr_read_b32 v27, a27
    v_accvgpr_read_b32 v28, a28
    v_mfma_f32_16x16x32_bf16 v[120:123], a[176:179], a[80:83], 0
    v_accvgpr_read_b32 v29, a29
    v_accvgpr_read_b32 v30, a30
    v_mfma_f32_16x16x32_bf16 v[120:123], a[180:183], a[84:87], v[120:123]
    buffer_load_dwordx4 v5, s[8:11], s71 offen offset:3072  lds
    v_accvgpr_read_b32 v31, a31
    v_mfma_f32_16x16x32_bf16 v[124:127], a[176:179], a[88:91], 0
    s_add_u32 m0, s67, 81920
    v_cvt_pk_bf16_f32 v252, v24, v25
    v_cvt_pk_bf16_f32 v253, v26, v27
    v_mfma_f32_16x16x32_bf16 v[124:127], a[180:183], a[92:95], v[124:127]
    s_add_u32 s71, s71, 114688
    v_cvt_pk_bf16_f32 v254, v28, v29
    v_cvt_pk_bf16_f32 v255, v30, v31
    v_mfma_f32_16x16x32_bf16 v[128:131], a[184:187], a[32:35], 0
    buffer_store_dwordx4 v[172:175], v20, s[24:27], s83 offen offset:0 sc1
    v_mfma_f32_16x16x32_bf16 v[128:131], a[188:191], a[36:39], v[128:131]
    buffer_load_dwordx4 v4, s[4:7], s71 offen offset:0  lds
    v_mfma_f32_16x16x32_bf16 v[132:135], a[184:187], a[40:43], 0
    ds_read_b64_tr_b16 a[168:169], v17 offset:32768
    v_mfma_f32_16x16x32_bf16 v[132:135], a[188:191], a[44:47], v[132:135]
    v_mfma_f32_16x16x32_bf16 v[136:139], a[184:187], a[48:51], 0
    ds_read_b64_tr_b16 a[170:171], v17 offset:33280
    v_mfma_f32_16x16x32_bf16 v[136:139], a[188:191], a[52:55], v[136:139]
    buffer_load_dwordx4 v4, s[8:11], s71 offen offset:1024  lds
    v_mfma_f32_16x16x32_bf16 v[140:143], a[184:187], a[56:59], 0
    buffer_store_dwordx4 v[180:183], v20, s[24:27], s84 offen offset:0 sc1
    ds_read_b64_tr_b16 a[172:173], v17 offset:49152
    v_mfma_f32_16x16x32_bf16 v[140:143], a[188:191], a[60:63], v[140:143]
    v_mfma_f32_16x16x32_bf16 v[144:147], a[184:187], a[64:67], 0
    ds_read_b64_tr_b16 a[174:175], v17 offset:49664
    v_mfma_f32_16x16x32_bf16 v[144:147], a[188:191], a[68:71], v[144:147]
    buffer_load_dwordx4 v5, s[4:7], s71 offen offset:2048  lds
    v_mfma_f32_16x16x32_bf16 v[148:151], a[184:187], a[72:75], 0
    s_waitcnt vmcnt(38)
    v_mfma_f32_16x16x32_bf16 v[148:151], a[188:191], a[76:79], v[148:151]
    s_barrier
    v_mfma_f32_16x16x32_bf16 v[152:155], a[184:187], a[80:83], 0
    v_mfma_f32_16x16x32_bf16 v[152:155], a[188:191], a[84:87], v[152:155]
    buffer_load_dwordx4 v5, s[8:11], s71 offen offset:3072  lds
    ds_read_b128 a[96:99], v14 offset:16384
    v_mfma_f32_16x16x32_bf16 v[156:159], a[184:187], a[88:91], 0
    s_add_u32 s71, s71, 114688
    v_mfma_f32_16x16x32_bf16 v[156:159], a[188:191], a[92:95], v[156:159]
    s_waitcnt lgkmcnt(7)
    ds_read_b128 a[100:103], v15 offset:16384
    v_mfma_f32_16x16x32_bf16 v[160:163], a[160:163], a[32:35], 0
    s_waitcnt lgkmcnt(6)
    v_mfma_f32_16x16x32_bf16 v[160:163], a[164:167], a[36:39], v[160:163]
    ds_read_b128 a[104:107], v14 offset:18432
    v_mfma_f32_16x16x32_bf16 v[164:167], a[160:163], a[40:43], 0
    buffer_store_dwordx4 v[188:191], v20, s[24:27], s85 offen offset:0 sc1
    ds_read_b64_tr_b16 a[176:177], v18 offset:32768
    v_mfma_f32_16x16x32_bf16 v[164:167], a[164:167], a[44:47], v[164:167]
    ds_read_b128 a[108:111], v15 offset:18432
    v_mfma_f32_16x16x32_bf16 v[168:171], a[160:163], a[48:51], 0
    ds_read_b64_tr_b16 a[178:179], v18 offset:33280
    v_mfma_f32_16x16x32_bf16 v[168:171], a[164:167], a[52:55], v[168:171]
    ds_read_b128 a[112:115], v14 offset:20480
    v_mfma_f32_16x16x32_bf16 v[172:175], a[160:163], a[56:59], 0
    ds_read_b64_tr_b16 a[180:181], v18 offset:49152
    v_mfma_f32_16x16x32_bf16 v[172:175], a[164:167], a[60:63], v[172:175]
    ds_read_b128 a[116:119], v15 offset:20480
    v_mfma_f32_16x16x32_bf16 v[176:179], a[160:163], a[64:67], 0
    ds_read_b64_tr_b16 a[182:183], v18 offset:49664
    v_mfma_f32_16x16x32_bf16 v[176:179], a[164:167], a[68:71], v[176:179]
    ds_read_b128 a[120:123], v14 offset:22528
    v_mfma_f32_16x16x32_bf16 v[180:183], a[160:163], a[72:75], 0
    v_mfma_f32_16x16x32_bf16 v[180:183], a[164:167], a[76:79], v[180:183]
    ds_read_b128 a[124:127], v15 offset:22528
    v_mfma_f32_16x16x32_bf16 v[184:187], a[160:163], a[80:83], 0
    v_mfma_f32_16x16x32_bf16 v[184:187], a[164:167], a[84:87], v[184:187]
    ds_read_b128 a[128:131], v14 offset:24576
    v_mfma_f32_16x16x32_bf16 v[188:191], a[160:163], a[88:91], 0
    buffer_store_dwordx4 v[240:243], v20, s[24:27], s82 offen offset:3072 sc1
    v_mfma_f32_16x16x32_bf16 v[188:191], a[164:167], a[92:95], v[188:191]
    s_waitcnt lgkmcnt(15)
    ds_read_b128 a[132:135], v15 offset:24576
    v_mfma_f32_16x16x32_bf16 v[192:195], a[168:171], a[32:35], 0
    s_waitcnt lgkmcnt(14)
    s_add_u32 s70, s70, 16384
    v_mfma_f32_16x16x32_bf16 v[192:195], a[172:175], a[36:39], v[192:195]
    ds_read_b128 a[136:139], v14 offset:26624
    v_mfma_f32_16x16x32_bf16 v[196:199], a[168:171], a[40:43], 0
    ds_read_b64_tr_b16 a[184:185], v19 offset:32768
    v_mfma_f32_16x16x32_bf16 v[196:199], a[172:175], a[44:47], v[196:199]
    ds_read_b128 a[140:143], v15 offset:26624
    v_mfma_f32_16x16x32_bf16 v[200:203], a[168:171], a[48:51], 0
    buffer_store_dwordx4 v[244:247], v20, s[24:27], s83 offen offset:3072 sc1
    ds_read_b64_tr_b16 a[186:187], v19 offset:33280
    v_mfma_f32_16x16x32_bf16 v[200:203], a[172:175], a[52:55], v[200:203]
    v_mfma_f32_16x16x32_bf16 v[204:207], a[168:171], a[56:59], 0
    ds_read_b64_tr_b16 a[188:189], v19 offset:49152
    v_mfma_f32_16x16x32_bf16 v[204:207], a[172:175], a[60:63], v[204:207]
    v_mfma_f32_16x16x32_bf16 v[208:211], a[168:171], a[64:67], 0
    ds_read_b64_tr_b16 a[190:191], v19 offset:49664
    v_mfma_f32_16x16x32_bf16 v[208:211], a[172:175], a[68:71], v[208:211]
    v_xor_b32 v16, 0x10000, v16
    v_mfma_f32_16x16x32_bf16 v[212:215], a[168:171], a[72:75], 0
    buffer_store_dwordx4 v[248:251], v20, s[24:27], s84 offen offset:3072 sc1
    v_mfma_f32_16x16x32_bf16 v[212:215], a[172:175], a[76:79], v[212:215]
    v_xor_b32 v17, 0x10000, v17
    v_mfma_f32_16x16x32_bf16 v[216:219], a[168:171], a[80:83], 0
    v_xor_b32 v18, 0x10000, v18
    v_mfma_f32_16x16x32_bf16 v[216:219], a[172:175], a[84:87], v[216:219]
    v_xor_b32 v19, 0x10000, v19
    v_mfma_f32_16x16x32_bf16 v[220:223], a[168:171], a[88:91], 0
    s_add_u32 m0, s67, 98304
    buffer_store_dwordx4 v[252:255], v20, s[24:27], s85 offen offset:3072 sc1
    v_mfma_f32_16x16x32_bf16 v[220:223], a[172:175], a[92:95], v[220:223]
    s_waitcnt lgkmcnt(14)
    s_waitcnt lgkmcnt(0)
    v_mfma_f32_16x16x32_bf16 v[224:227], a[176:179], a[32:35], 0
    s_waitcnt vmcnt(39)
    v_mfma_f32_16x16x32_bf16 v[224:227], a[180:183], a[36:39], v[224:227]
    buffer_load_dwordx4 v2, s[12:15], s72 offen offset:0  lds
    v_mfma_f32_16x16x32_bf16 v[228:231], a[176:179], a[40:43], 0
    ds_read_b64_tr_b16 a[160:161], v11 offset:0
    v_mfma_f32_16x16x32_bf16 v[228:231], a[180:183], a[44:47], v[228:231]
    ds_read_b128 a[144:147], v14 offset:28672
    v_mfma_f32_16x16x32_bf16 v[232:235], a[176:179], a[48:51], 0
    s_waitcnt vmcnt(34)
    ds_read_b64_tr_b16 a[162:163], v11 offset:256
    v_mfma_f32_16x16x32_bf16 v[232:235], a[180:183], a[52:55], v[232:235]
    s_add_u32 s76, s76, 1
    buffer_load_dwordx4 v3, s[12:15], s72 offen offset:1024  lds
    v_mfma_f32_16x16x32_bf16 v[236:239], a[176:179], a[56:59], 0
    ds_read_b64_tr_b16 a[164:165], v11 offset:16384
    v_mfma_f32_16x16x32_bf16 v[236:239], a[180:183], a[60:63], v[236:239]
    ds_read_b128 a[148:151], v15 offset:28672
    v_mfma_f32_16x16x32_bf16 v[240:243], a[176:179], a[64:67], 0
    ds_read_b64_tr_b16 a[166:167], v11 offset:16640
    v_mfma_f32_16x16x32_bf16 v[240:243], a[180:183], a[68:71], v[240:243]
    buffer_load_dwordx4 v2, s[16:19], s72 offen offset:2048  lds
    v_mfma_f32_16x16x32_bf16 v[244:247], a[176:179], a[72:75], 0
    v_mfma_f32_16x16x32_bf16 v[244:247], a[180:183], a[76:79], v[244:247]
    ds_read_b128 a[152:155], v14 offset:30720
    v_mfma_f32_16x16x32_bf16 v[248:251], a[176:179], a[80:83], 0
    v_mfma_f32_16x16x32_bf16 v[248:251], a[180:183], a[84:87], v[248:251]
    buffer_load_dwordx4 v3, s[16:19], s72 offen offset:3072  lds
    v_mfma_f32_16x16x32_bf16 v[252:255], a[176:179], a[88:91], 0
    s_add_u32 m0, s67, 114688
    v_mfma_f32_16x16x32_bf16 v[252:255], a[180:183], a[92:95], v[252:255]
    s_add_u32 s72, s72, 262144
    ds_read_b128 a[156:159], v15 offset:30720
    v_mfma_f32_16x16x32_bf16 a[0:3], a[184:187], a[32:35], 0
    v_mfma_f32_16x16x32_bf16 a[0:3], a[188:191], a[36:39], a[0:3]
    buffer_load_dwordx4 v2, s[12:15], s72 offen offset:0  lds
    v_mfma_f32_16x16x32_bf16 a[4:7], a[184:187], a[40:43], 0
    ds_read_b64_tr_b16 a[168:169], v12 offset:0
    v_mfma_f32_16x16x32_bf16 a[4:7], a[188:191], a[44:47], a[4:7]
    v_mfma_f32_16x16x32_bf16 a[8:11], a[184:187], a[48:51], 0
    ds_read_b64_tr_b16 a[170:171], v12 offset:256
    v_mfma_f32_16x16x32_bf16 a[8:11], a[188:191], a[52:55], a[8:11]
    buffer_load_dwordx4 v3, s[12:15], s72 offen offset:1024  lds
    v_mfma_f32_16x16x32_bf16 a[12:15], a[184:187], a[56:59], 0
    ds_read_b64_tr_b16 a[172:173], v12 offset:16384
    v_mfma_f32_16x16x32_bf16 a[12:15], a[188:191], a[60:63], a[12:15]
    v_mfma_f32_16x16x32_bf16 a[16:19], a[184:187], a[64:67], 0
    ds_read_b64_tr_b16 a[174:175], v12 offset:16640
    v_mfma_f32_16x16x32_bf16 a[16:19], a[188:191], a[68:71], a[16:19]
    buffer_load_dwordx4 v2, s[16:19], s72 offen offset:2048  lds
    v_mfma_f32_16x16x32_bf16 a[20:23], a[184:187], a[72:75], 0
    v_mfma_f32_16x16x32_bf16 a[20:23], a[188:191], a[76:79], a[20:23]
    s_waitcnt lgkmcnt(0)
    v_mfma_f32_16x16x32_bf16 a[24:27], a[184:187], a[80:83], 0
    s_barrier
    v_mfma_f32_16x16x32_bf16 a[24:27], a[188:191], a[84:87], a[24:27]
    buffer_load_dwordx4 v3, s[16:19], s72 offen offset:3072  lds
    v_mfma_f32_16x16x32_bf16 a[28:31], a[184:187], a[88:91], 0
    s_add_u32 s72, s72, 262144
    v_mfma_f32_16x16x32_bf16 a[28:31], a[188:191], a[92:95], a[28:31]
    s_branch fz_T2
fz_endV:
    .p2align 6
fz_N0:
    v_mfma_f32_16x16x32_bf16 v[32:35], a[160:163], a[32:35], v[32:35]
    v_mfma_f32_16x16x32_bf16 v[32:35], a[164:167], a[36:39], v[32:35]
    v_mfma_f32_16x16x32_bf16 v[36:39], a[160:163], a[40:43], v[36:39]
    ds_read_b64_tr_b16 a[176:177], v18 offset:0
    v_mfma_f32_16x16x32_bf16 v[36:39], a[164:167], a[44:47], v[36:39]
    v_mfma_f32_16x16x32_bf16 v[40:43], a[160:163], a[48:51], v[40:43]
    ds_read_b64_tr_b16 a[178:179], v18 offset:512
    v_mfma_f32_16x16x32_bf16 v[40:43], a[164:167], a[52:55], v[40:43]
    s_cmp_eq_u32 s76, s77
    v_mfma_f32_16x16x32_bf16 v[44:47], a[160:163], a[56:59], v[44:47]
    s_cselect_b32 s34, 64, 0
    ds_read_b64_tr_b16 a[180:181], v18 offset:16384
    v_mfma_f32_16x16x32_bf16 v[44:47], a[164:167], a[60:63], v[44:47]
    buffer_atomic_or v23, v9, s[32:35], 0 offen sc1
    v_mfma_f32_16x16x32_bf16 v[48:51], a[160:163], a[64:67], v[48:51]
    ds_read_b64_tr_b16 a[182:183], v18 offset:16896
    v_mfma_f32_16x16x32_bf16 v[48:51], a[164:167], a[68:71], v[48:51]
    v_mfma_f32_16x16x32_bf16 v[52:55], a[160:163], a[72:75], v[52:55]
    s_cmp_eq_u32 s76, 12
    v_mfma_f32_16x16x32_bf16 v[52:55], a[164:167], a[76:79], v[52:55]
    s_cselect_b32 s34, 64, 0
    v_mfma_f32_16x16x32_bf16 v[56:59], a[160:163], a[80:83], v[56:59]
    buffer_load_dword v21, v22, s[32:35], 0 offen sc1
    v_mfma_f32_16x16x32_bf16 v[56:59], a[164:167], a[84:87], v[56:59]
    v_mfma_f32_16x16x32_bf16 v[60:63], a[160:163], a[88:91], v[60:63]
    v_mfma_f32_16x16x32_bf16 v[60:63], a[164:167], a[92:95], v[60:63]
    v_mfma_f32_16x16x32_bf16 v[64:67], a[168:171], a[32:35], v[64:67]
    s_add_u32 m0, s67, 131072
    v_mfma_f32_16x16x32_bf16 v[64:67], a[172:175], a[36:39], v[64:67]
    buffer_load_dwordx4 v10, s[20:23], s70 offen offset:0  lds
    v_mfma_f32_16x16x32_bf16 v[68:71], a[168:171], a[40:43], v[68:71]
    ds_read_b64_tr_b16 a[184:185], v19 offset:0
    v_mfma_f32_16x16x32_bf16 v[68:71], a[172:175], a[44:47], v[68:71]
    v_mfma_f32_16x16x32_bf16 v[72:75], a[168:171], a[48:51], v[72:75]
    ds_read_b64_tr_b16 a[186:187], v19 offset:512
    v_mfma_f32_16x16x32_bf16 v[72:75], a[172:175], a[52:55], v[72:75]
    buffer_load_dwordx4 v11, s[20:23], s70 offen offset:1024  lds
    v_mfma_f32_16x16x32_bf16 v[76:79], a[168:171], a[56:59], v[76:79]
    ds_read_b64_tr_b16 a[188:189], v19 offset:16384
    v_mfma_f32_16x16x32_bf16 v[76:79], a[172:175], a[60:63], v[76:79]
    v_mfma_f32_16x16x32_bf16 v[80:83], a[168:171], a[64:67], v[80:83]
    ds_read_b64_tr_b16 a[190:191], v19 offset:16896
    v_mfma_f32_16x16x32_bf16 v[80:83], a[172:175], a[68:71], v[80:83]
    buffer_load_dwordx4 v12, s[20:23], s70 offen offset:2048  lds
    v_mfma_f32_16x16x32_bf16 v[84:87], a[168:171], a[72:75], v[84:87]
    v_mfma_f32_16x16x32_bf16 v[84:87], a[172:175], a[76:79], v[84:87]
    v_mfma_f32_16x16x32_bf16 v[88:91], a[168:171], a[80:83], v[88:91]
    v_mfma_f32_16x16x32_bf16 v[88:91], a[172:175], a[84:87], v[88:91]
    buffer_load_dwordx4 v13, s[20:23], s70 offen offset:3072  lds
    v_mfma_f32_16x16x32_bf16 v[92:95], a[168:171], a[88:91], v[92:95]
    s_add_u32 m0, s67, 65536
    v_mfma_f32_16x16x32_bf16 v[92:95], a[172:175], a[92:95], v[92:95]
    s_waitcnt lgkmcnt(6)
    s_waitcnt lgkmcnt(0)
    v_mfma_f32_16x16x32_bf16 v[96:99], a[176:179], a[32:35], v[96:99]
    s_waitcnt vmcnt(30)
    v_mfma_f32_16x16x32_bf16 v[96:99], a[180:183], a[36:39], v[96:99]
    buffer_load_dwordx4 v2, s[4:7], s71 offen offset:0  lds
    v_mfma_f32_16x16x32_bf16 v[100:103], a[176:179], a[40:43], v[100:103]
    ds_read_b64_tr_b16 a[160:161], v16 offset:32768
    v_mfma_f32_16x16x32_bf16 v[100:103], a[180:183], a[44:47], v[100:103]
    v_mfma_f32_16x16x32_bf16 v[104:107], a[176:179], a[48:51], v[104:107]
    s_waitcnt vmcnt(27)
    ds_read_b64_tr_b16 a[162:163], v16 offset:33280
    v_mfma_f32_16x16x32_bf16 v[104:107], a[180:183], a[52:55], v[104:107]
    buffer_load_dwordx4 v3, s[4:7], s71 offen offset:1024  lds
    v_mfma_f32_16x16x32_bf16 v[108:111], a[176:179], a[56:59], v[108:111]
    ds_read_b64_tr_b16 a[164:165], v16 offset:49152
    v_mfma_f32_16x16x32_bf16 v[108:111], a[180:183], a[60:63], v[108:111]
    v_mfma_f32_16x16x32_bf16 v[112:115], a[176:179], a[64:67], v[112:115]
    ds_read_b64_tr_b16 a[166:167], v16 offset:49664
    v_mfma_f32_16x16x32_bf16 v[112:115], a[180:183], a[68:71], v[112:115]
    buffer_load_dwordx4 v2, s[8:11], s71 offen offset:2048  lds
    v_mfma_f32_16x16x32_bf16 v[116:119], a[176:179], a[72:75], v[116:119]
    v_mfma_f32_16x16x32_bf16 v[116:119], a[180:183], a[76:79], v[116:119]
    v_mfma_f32_16x16x32_bf16 v[120:123], a[176:179], a[80:83], v[120:123]
    v_mfma_f32_16x16x32_bf16 v[120:123], a[180:183], a[84:87], v[120:123]
    buffer_load_dwordx4 v3, s[8:11], s71 offen offset:3072  lds
    v_mfma_f32_16x16x32_bf16 v[124:127], a[176:179], a[88:91], v[124:127]
    s_add_u32 m0, s67, 81920
    v_mfma_f32_16x16x32_bf16 v[124:127], a[180:183], a[92:95], v[124:127]
    s_add_u32 s71, s71, 262144
    v_mfma_f32_16x16x32_bf16 v[128:131], a[184:187], a[32:35], v[128:131]
    v_mfma_f32_16x16x32_bf16 v[128:131], a[188:191], a[36:39], v[128:131]
    buffer_load_dwordx4 v2, s[4:7], s71 offen offset:0  lds
    v_mfma_f32_16x16x32_bf16 v[132:135], a[184:187], a[40:43], v[132:135]
    ds_read_b64_tr_b16 a[168:169], v17 offset:32768
    v_mfma_f32_16x16x32_bf16 v[132:135], a[188:191], a[44:47], v[132:135]
    v_mfma_f32_16x16x32_bf16 v[136:139], a[184:187], a[48:51], v[136:139]
    ds_read_b64_tr_b16 a[170:171], v17 offset:33280
    v_mfma_f32_16x16x32_bf16 v[136:139], a[188:191], a[52:55], v[136:139]
    buffer_load_dwordx4 v3, s[4:7], s71 offen offset:1024  lds
    v_mfma_f32_16x16x32_bf16 v[140:143], a[184:187], a[56:59], v[140:143]
    ds_read_b64_tr_b16 a[172:173], v17 offset:49152
    v_mfma_f32_16x16x32_bf16 v[140:143], a[188:191], a[60:63], v[140:143]
    v_mfma_f32_16x16x32_bf16 v[144:147], a[184:187], a[64:67], v[144:147]
    ds_read_b64_tr_b16 a[174:175], v17 offset:49664
    v_mfma_f32_16x16x32_bf16 v[144:147], a[188:191], a[68:71], v[144:147]
    buffer_load_dwordx4 v2, s[8:11], s71 offen offset:2048  lds
    v_mfma_f32_16x16x32_bf16 v[148:151], a[184:187], a[72:75], v[148:151]
    s_waitcnt vmcnt(29)
    v_mfma_f32_16x16x32_bf16 v[148:151], a[188:191], a[76:79], v[148:151]
    s_barrier
    v_mfma_f32_16x16x32_bf16 v[152:155], a[184:187], a[80:83], v[152:155]
    v_mfma_f32_16x16x32_bf16 v[152:155], a[188:191], a[84:87], v[152:155]
    buffer_load_dwordx4 v3, s[8:11], s71 offen offset:3072  lds
    ds_read_b128 a[96:99], v14 offset:16384
    v_mfma_f32_16x16x32_bf16 v[156:159], a[184:187], a[88:91], v[156:159]
    s_add_u32 s71, s71, 262144
    buffer_load_dword v31, v8, s[28:31], s74 offen offset:0
    v_mfma_f32_16x16x32_bf16 v[156:159], a[188:191], a[92:95], v[156:159]
    s_waitcnt lgkmcnt(7)
    ds_read_b128 a[100:103], v15 offset:16384
    v_mfma_f32_16x16x32_bf16 v[160:163], a[160:163], a[32:35], v[160:163]
    s_waitcnt lgkmcnt(6)
    v_mfma_f32_16x16x32_bf16 v[160:163], a[164:167], a[36:39], v[160:163]
    ds_read_b128 a[104:107], v14 offset:18432
    v_mfma_f32_16x16x32_bf16 v[164:167], a[160:163], a[40:43], v[164:167]
    ds_read_b64_tr_b16 a[176:177], v18 offset:32768
    v_mfma_f32_16x16x32_bf16 v[164:167], a[164:167], a[44:47], v[164:167]
    ds_read_b128 a[108:111], v15 offset:18432
    v_mfma_f32_16x16x32_bf16 v[168:171], a[160:163], a[48:51], v[168:171]
    ds_read_b64_tr_b16 a[178:179], v18 offset:33280
    v_mfma_f32_16x16x32_bf16 v[168:171], a[164:167], a[52:55], v[168:171]
    ds_read_b128 a[112:115], v14 offset:20480
    v_mfma_f32_16x16x32_bf16 v[172:175], a[160:163], a[56:59], v[172:175]
    ds_read_b64_tr_b16 a[180:181], v18 offset:49152
    v_mfma_f32_16x16x32_bf16 v[172:175], a[164:167], a[60:63], v[172:175]
    ds_read_b128 a[116:119], v15 offset:20480
    v_mfma_f32_16x16x32_bf16 v[176:179], a[160:163], a[64:67], v[176:179]
    ds_read_b64_tr_b16 a[182:183], v18 offset:49664
    v_mfma_f32_16x16x32_bf16 v[176:179], a[164:167], a[68:71], v[176:179]
    ds_read_b128 a[120:123], v14 offset:22528
    v_mfma_f32_16x16x32_bf16 v[180:183], a[160:163], a[72:75], v[180:183]
    v_mfma_f32_16x16x32_bf16 v[180:183], a[164:167], a[76:79], v[180:183]
    ds_read_b128 a[124:127], v15 offset:22528
    v_mfma_f32_16x16x32_bf16 v[184:187], a[160:163], a[80:83], v[184:187]
    v_mfma_f32_16x16x32_bf16 v[184:187], a[164:167], a[84:87], v[184:187]
    ds_read_b128 a[128:131], v14 offset:24576
    v_mfma_f32_16x16x32_bf16 v[188:191], a[160:163], a[88:91], v[188:191]
    v_mfma_f32_16x16x32_bf16 v[188:191], a[164:167], a[92:95], v[188:191]
    s_waitcnt lgkmcnt(15)
    ds_read_b128 a[132:135], v15 offset:24576
    v_mfma_f32_16x16x32_bf16 v[192:195], a[168:171], a[32:35], v[192:195]
    s_waitcnt lgkmcnt(14)
    s_add_u32 s70, s70, 128
    v_mfma_f32_16x16x32_bf16 v[192:195], a[172:175], a[36:39], v[192:195]
    ds_read_b128 a[136:139], v14 offset:26624
    v_mfma_f32_16x16x32_bf16 v[196:199], a[168:171], a[40:43], v[196:199]
    ds_read_b64_tr_b16 a[184:185], v19 offset:32768
    v_mfma_f32_16x16x32_bf16 v[196:199], a[172:175], a[44:47], v[196:199]
    ds_read_b128 a[140:143], v15 offset:26624
    v_mfma_f32_16x16x32_bf16 v[200:203], a[168:171], a[48:51], v[200:203]
    ds_read_b64_tr_b16 a[186:187], v19 offset:33280
    v_mfma_f32_16x16x32_bf16 v[200:203], a[172:175], a[52:55], v[200:203]
    v_mfma_f32_16x16x32_bf16 v[204:207], a[168:171], a[56:59], v[204:207]
    s_add_u32 s74, s74, 524288
    ds_read_b64_tr_b16 a[188:189], v19 offset:49152
    v_mfma_f32_16x16x32_bf16 v[204:207], a[172:175], a[60:63], v[204:207]
    v_mfma_f32_16x16x32_bf16 v[208:211], a[168:171], a[64:67], v[208:211]
    ds_read_b64_tr_b16 a[190:191], v19 offset:49664
    v_mfma_f32_16x16x32_bf16 v[208:211], a[172:175], a[68:71], v[208:211]
    v_xor_b32 v16, 0x10000, v16
    v_mfma_f32_16x16x32_bf16 v[212:215], a[168:171], a[72:75], v[212:215]
    v_mfma_f32_16x16x32_bf16 v[212:215], a[172:175], a[76:79], v[212:215]
    v_xor_b32 v17, 0x10000, v17
    v_mfma_f32_16x16x32_bf16 v[216:219], a[168:171], a[80:83], v[216:219]
    v_xor_b32 v18, 0x10000, v18
    v_mfma_f32_16x16x32_bf16 v[216:219], a[172:175], a[84:87], v[216:219]
    v_xor_b32 v19, 0x10000, v19
    v_mfma_f32_16x16x32_bf16 v[220:223], a[168:171], a[88:91], v[220:223]
    s_add_u32 m0, s67, 98304
    v_mfma_f32_16x16x32_bf16 v[220:223], a[172:175], a[92:95], v[220:223]
    s_waitcnt lgkmcnt(14)
    s_waitcnt lgkmcnt(0)
    v_mfma_f32_16x16x32_bf16 v[224:227], a[176:179], a[32:35], v[224:227]
    s_waitcnt vmcnt(27)
    v_mfma_f32_16x16x32_bf16 v[224:227], a[180:183], a[36:39], v[224:227]
    buffer_load_dwordx4 v2, s[12:15], s72 offen offset:0  lds
    v_mfma_f32_16x16x32_bf16 v[228:231], a[176:179], a[40:43], v[228:231]
    ds_read_b64_tr_b16 a[160:161], v16 offset:0
    v_mfma_f32_16x16x32_bf16 v[228:231], a[180:183], a[44:47], v[228:231]
    ds_read_b128 a[144:147], v14 offset:28672
    v_mfma_f32_16x16x32_bf16 v[232:235], a[176:179], a[48:51], v[232:235]
    s_waitcnt vmcnt(24)
    ds_read_b64_tr_b16 a[162:163], v16 offset:512
    v_mfma_f32_16x16x32_bf16 v[232:235], a[180:183], a[52:55], v[232:235]
    s_add_u32 s76, s76, 1
    buffer_load_dwordx4 v3, s[12:15], s72 offen offset:1024  lds
    v_mfma_f32_16x16x32_bf16 v[236:239], a[176:179], a[56:59], v[236:239]
    ds_read_b64_tr_b16 a[164:165], v16 offset:16384
    v_mfma_f32_16x16x32_bf16 v[236:239], a[180:183], a[60:63], v[236:239]
    ds_read_b128 a[148:151], v15 offset:28672
    v_mfma_f32_16x16x32_bf16 v[240:243], a[176:179], a[64:67], v[240:243]
    ds_read_b64_tr_b16 a[166:167], v16 offset:16896
    v_mfma_f32_16x16x32_bf16 v[240:243], a[180:183], a[68:71], v[240:243]
    buffer_load_dwordx4 v2, s[16:19], s72 offen offset:2048  lds
    v_mfma_f32_16x16x32_bf16 v[244:247], a[176:179], a[72:75], v[244:247]
    v_mfma_f32_16x16x32_bf16 v[244:247], a[180:183], a[76:79], v[244:247]
    ds_read_b128 a[152:155], v14 offset:30720
    v_mfma_f32_16x16x32_bf16 v[248:251], a[176:179], a[80:83], v[248:251]
    v_mfma_f32_16x16x32_bf16 v[248:251], a[180:183], a[84:87], v[248:251]
    buffer_load_dwordx4 v3, s[16:19], s72 offen offset:3072  lds
    v_mfma_f32_16x16x32_bf16 v[252:255], a[176:179], a[88:91], v[252:255]
    s_add_u32 m0, s67, 114688
    v_mfma_f32_16x16x32_bf16 v[252:255], a[180:183], a[92:95], v[252:255]
    s_add_u32 s72, s72, 262144
    ds_read_b128 a[156:159], v15 offset:30720
    v_mfma_f32_16x16x32_bf16 a[0:3], a[184:187], a[32:35], a[0:3]
    v_mfma_f32_16x16x32_bf16 a[0:3], a[188:191], a[36:39], a[0:3]
    buffer_load_dwordx4 v2, s[12:15], s72 offen offset:0  lds
    v_mfma_f32_16x16x32_bf16 a[4:7], a[184:187], a[40:43], a[4:7]
    ds_read_b64_tr_b16 a[168:169], v17 offset:0
    v_mfma_f32_16x16x32_bf16 a[4:7], a[188:191], a[44:47], a[4:7]
    v_mfma_f32_16x16x32_bf16 a[8:11], a[184:187], a[48:51], a[8:11]
    ds_read_b64_tr_b16 a[170:171], v17 offset:512
    v_mfma_f32_16x16x32_bf16 a[8:11], a[188:191], a[52:55], a[8:11]
    buffer_load_dwordx4 v3, s[12:15], s72 offen offset:1024  lds
    v_mfma_f32_16x16x32_bf16 a[12:15], a[184:187], a[56:59], a[12:15]
    ds_read_b64_tr_b16 a[172:173], v17 offset:16384
    v_mfma_f32_16x16x32_bf16 a[12:15], a[188:191], a[60:63], a[12:15]
    v_mfma_f32_16x16x32_bf16 a[16:19], a[184:187], a[64:67], a[16:19]
    ds_read_b64_tr_b16 a[174:175], v17 offset:16896
    v_mfma_f32_16x16x32_bf16 a[16:19], a[188:191], a[68:71], a[16:19]
    buffer_load_dwordx4 v2, s[16:19], s72 offen offset:2048  lds
    v_mfma_f32_16x16x32_bf16 a[20:23], a[184:187], a[72:75], a[20:23]
    v_mfma_f32_16x16x32_bf16 a[20:23], a[188:191], a[76:79], a[20:23]
    s_waitcnt lgkmcnt(0)
    v_mfma_f32_16x16x32_bf16 a[24:27], a[184:187], a[80:83], a[24:27]
    s_barrier
    v_mfma_f32_16x16x32_bf16 a[24:27], a[188:191], a[84:87], a[24:27]
    buffer_load_dwordx4 v3, s[16:19], s72 offen offset:3072  lds
    v_mfma_f32_16x16x32_bf16 a[28:31], a[184:187], a[88:91], a[28:31]
    s_add_u32 s72, s72, 262144
    v_mfma_f32_16x16x32_bf16 a[28:31], a[188:191], a[92:95], a[28:31]
    v_mfma_f32_16x16x32_bf16 v[32:35], a[160:163], a[96:99], v[32:35]
    v_mfma_f32_16x16x32_bf16 v[32:35], a[164:167], a[100:103], v[32:35]
    v_mfma_f32_16x16x32_bf16 v[36:39], a[160:163], a[104:107], v[36:39]
    ds_read_b64_tr_b16 a[176:177], v18 offset:0
    v_mfma_f32_16x16x32_bf16 v[36:39], a[164:167], a[108:111], v[36:39]
    v_mfma_f32_16x16x32_bf16 v[40:43], a[160:163], a[112:115], v[40:43]
    ds_read_b64_tr_b16 a[178:179], v18 offset:512
    v_mfma_f32_16x16x32_bf16 v[40:43], a[164:167], a[116:119], v[40:43]
    s_cmp_eq_u32 s76, s77
    v_mfma_f32_16x16x32_bf16 v[44:47], a[160:163], a[120:123], v[44:47]
    s_cselect_b32 s34, 64, 0
    ds_read_b64_tr_b16 a[180:181], v18 offset:16384
    v_mfma_f32_16x16x32_bf16 v[44:47], a[164:167], a[124:127], v[44:47]
    buffer_atomic_or v23, v9, s[32:35], 0 offen sc1
    v_mfma_f32_16x16x32_bf16 v[48:51], a[160:163], a[128:131], v[48:51]
    ds_read_b64_tr_b16 a[182:183], v18 offset:16896
    v_mfma_f32_16x16x32_bf16 v[48:51], a[164:167], a[132:135], v[48:51]
    v_mfma_f32_16x16x32_bf16 v[52:55], a[160:163], a[136:139], v[52:55]
    v_mfma_f32_16x16x32_bf16 v[52:55], a[164:167], a[140:143], v[52:55]
    v_mfma_f32_16x16x32_bf16 v[56:59], a[160:163], a[144:147], v[56:59]
    v_mfma_f32_16x16x32_bf16 v[56:59], a[164:167], a[148:151], v[56:59]
    v_mfma_f32_16x16x32_bf16 v[60:63], a[160:163], a[152:155], v[60:63]
    v_mfma_f32_16x16x32_bf16 v[60:63], a[164:167], a[156:159], v[60:63]
    v_mfma_f32_16x16x32_bf16 v[64:67], a[168:171], a[96:99], v[64:67]
    s_add_u32 m0, s67, 147456
    v_mfma_f32_16x16x32_bf16 v[64:67], a[172:175], a[100:103], v[64:67]
    buffer_load_dwordx4 v10, s[20:23], s70 offen offset:0  lds
    v_mfma_f32_16x16x32_bf16 v[68:71], a[168:171], a[104:107], v[68:71]
    ds_read_b64_tr_b16 a[184:185], v19 offset:0
    v_mfma_f32_16x16x32_bf16 v[68:71], a[172:175], a[108:111], v[68:71]
    v_mfma_f32_16x16x32_bf16 v[72:75], a[168:171], a[112:115], v[72:75]
    ds_read_b64_tr_b16 a[186:187], v19 offset:512
    v_mfma_f32_16x16x32_bf16 v[72:75], a[172:175], a[116:119], v[72:75]
    buffer_load_dwordx4 v11, s[20:23], s70 offen offset:1024  lds
    v_mfma_f32_16x16x32_bf16 v[76:79], a[168:171], a[120:123], v[76:79]
    ds_read_b64_tr_b16 a[188:189], v19 offset:16384
    v_mfma_f32_16x16x32_bf16 v[76:79], a[172:175], a[124:127], v[76:79]
    v_mfma_f32_16x16x32_bf16 v[80:83], a[168:171], a[128:131], v[80:83]
    ds_read_b64_tr_b16 a[190:191], v19 offset:16896
    v_mfma_f32_16x16x32_bf16 v[80:83], a[172:175], a[132:135], v[80:83]
    buffer_load_dwordx4 v12, s[20:23], s70 offen offset:2048  lds
    v_mfma_f32_16x16x32_bf16 v[84:87], a[168:171], a[136:139], v[84:87]
    v_mfma_f32_16x16x32_bf16 v[84:87], a[172:175], a[140:143], v[84:87]
    v_mfma_f32_16x16x32_bf16 v[88:91], a[168:171], a[144:147], v[88:91]
    v_mfma_f32_16x16x32_bf16 v[88:91], a[172:175], a[148:151], v[88:91]
    buffer_load_dwordx4 v13, s[20:23], s70 offen offset:3072  lds
    v_mfma_f32_16x16x32_bf16 v[92:95], a[168:171], a[152:155], v[92:95]
    s_add_u32 m0, s67, 0
    v_mfma_f32_16x16x32_bf16 v[92:95], a[172:175], a[156:159], v[92:95]
    s_waitcnt lgkmcnt(6)
    s_waitcnt lgkmcnt(0)
    v_mfma_f32_16x16x32_bf16 v[96:99], a[176:179], a[96:99], v[96:99]
    s_waitcnt vmcnt(32)
    v_mfma_f32_16x16x32_bf16 v[96:99], a[180:183], a[100:103], v[96:99]
    buffer_load_dwordx4 v2, s[4:7], s71 offen offset:0  lds
    v_mfma_f32_16x16x32_bf16 v[100:103], a[176:179], a[104:107], v[100:103]
    ds_read_b64_tr_b16 a[160:161], v16 offset:32768
    v_mfma_f32_16x16x32_bf16 v[100:103], a[180:183], a[108:111], v[100:103]
    v_mfma_f32_16x16x32_bf16 v[104:107], a[176:179], a[112:115], v[104:107]
    s_waitcnt vmcnt(29)
    ds_read_b64_tr_b16 a[162:163], v16 offset:33280
    v_mfma_f32_16x16x32_bf16 v[104:107], a[180:183], a[116:119], v[104:107]
    buffer_load_dwordx4 v3, s[4:7], s71 offen offset:1024  lds
    v_mfma_f32_16x16x32_bf16 v[108:111], a[176:179], a[120:123], v[108:111]
    ds_read_b64_tr_b16 a[164:165], v16 offset:49152
    v_mfma_f32_16x16x32_bf16 v[108:111], a[180:183], a[124:127], v[108:111]
    v_mfma_f32_16x16x32_bf16 v[112:115], a[176:179], a[128:131], v[112:115]
    ds_read_b64_tr_b16 a[166:167], v16 offset:49664
    v_mfma_f32_16x16x32_bf16 v[112:115], a[180:183], a[132:135], v[112:115]
    buffer_load_dwordx4 v2, s[8:11], s71 offen offset:2048  lds
    v_mfma_f32_16x16x32_bf16 v[116:119], a[176:179], a[136:139], v[116:119]
    v_mfma_f32_16x16x32_bf16 v[116:119], a[180:183], a[140:143], v[116:119]
    v_mfma_f32_16x16x32_bf16 v[120:123], a[176:179], a[144:147], v[120:123]
    v_mfma_f32_16x16x32_bf16 v[120:123], a[180:183], a[148:151], v[120:123]
    buffer_load_dwordx4 v3, s[8:11], s71 offen offset:3072  lds
    v_mfma_f32_16x16x32_bf16 v[124:127], a[176:179], a[152:155], v[124:127]
    s_add_u32 m0, s67, 16384
    v_mfma_f32_16x16x32_bf16 v[124:127], a[180:183], a[156:159], v[124:127]
    s_add_u32 s71, s71, 262144
    v_mfma_f32_16x16x32_bf16 v[128:131], a[184:187], a[96:99], v[128:131]
    v_mfma_f32_16x16x32_bf16 v[128:131], a[188:191], a[100:103], v[128:131]
    buffer_load_dwordx4 v2, s[4:7], s71 offen offset:0  lds
    v_mfma_f32_16x16x32_bf16 v[132:135], a[184:187], a[104:107], v[132:135]
    ds_read_b64_tr_b16 a[168:169], v17 offset:32768
    v_mfma_f32_16x16x32_bf16 v[132:135], a[188:191], a[108:111], v[132:135]
    v_mfma_f32_16x16x32_bf16 v[136:139], a[184:187], a[112:115], v[136:139]
    ds_read_b64_tr_b16 a[170:171], v17 offset:33280
    v_mfma_f32_16x16x32_bf16 v[136:139], a[188:191], a[116:119], v[136:139]
    buffer_load_dwordx4 v3, s[4:7], s71 offen offset:1024  lds
    v_mfma_f32_16x16x32_bf16 v[140:143], a[184:187], a[120:123], v[140:143]
    ds_read_b64_tr_b16 a[172:173], v17 offset:49152
    v_mfma_f32_16x16x32_bf16 v[140:143], a[188:191], a[124:127], v[140:143]
    v_mfma_f32_16x16x32_bf16 v[144:147], a[184:187], a[128:131], v[144:147]
    ds_read_b64_tr_b16 a[174:175], v17 offset:49664
    v_mfma_f32_16x16x32_bf16 v[144:147], a[188:191], a[132:135], v[144:147]
    buffer_load_dwordx4 v2, s[8:11], s71 offen offset:2048  lds
    v_mfma_f32_16x16x32_bf16 v[148:151], a[184:187], a[136:139], v[148:151]
    s_waitcnt vmcnt(29)
    v_mfma_f32_16x16x32_bf16 v[148:151], a[188:191], a[140:143], v[148:151]
    s_barrier
    v_mfma_f32_16x16x32_bf16 v[152:155], a[184:187], a[144:147], v[152:155]
    v_mfma_f32_16x16x32_bf16 v[152:155], a[188:191], a[148:151], v[152:155]
    buffer_load_dwordx4 v3, s[8:11], s71 offen offset:3072  lds
    ds_read_b128 a[32:35], v14 offset:0
    v_mfma_f32_16x16x32_bf16 v[156:159], a[184:187], a[152:155], v[156:159]
    s_add_u32 s71, s71, 262144
    buffer_load_dword v31, v8, s[28:31], s74 offen offset:0
    v_mfma_f32_16x16x32_bf16 v[156:159], a[188:191], a[156:159], v[156:159]
    s_waitcnt lgkmcnt(7)
    ds_read_b128 a[36:39], v15 offset:0
    v_mfma_f32_16x16x32_bf16 v[160:163], a[160:163], a[96:99], v[160:163]
    s_waitcnt lgkmcnt(6)
    v_mfma_f32_16x16x32_bf16 v[160:163], a[164:167], a[100:103], v[160:163]
    ds_read_b128 a[40:43], v14 offset:2048
    v_mfma_f32_16x16x32_bf16 v[164:167], a[160:163], a[104:107], v[164:167]
    ds_read_b64_tr_b16 a[176:177], v18 offset:32768
    v_mfma_f32_16x16x32_bf16 v[164:167], a[164:167], a[108:111], v[164:167]
    ds_read_b128 a[44:47], v15 offset:2048
    v_mfma_f32_16x16x32_bf16 v[168:171], a[160:163], a[112:115], v[168:171]
    ds_read_b64_tr_b16 a[178:179], v18 offset:33280
    v_mfma_f32_16x16x32_bf16 v[168:171], a[164:167], a[116:119], v[168:171]
    ds_read_b128 a[48:51], v14 offset:4096
    v_mfma_f32_16x16x32_bf16 v[172:175], a[160:163], a[120:123], v[172:175]
    ds_read_b64_tr_b16 a[180:181], v18 offset:49152
    v_mfma_f32_16x16x32_bf16 v[172:175], a[164:167], a[124:127], v[172:175]
    ds_read_b128 a[52:55], v15 offset:4096
    v_mfma_f32_16x16x32_bf16 v[176:179], a[160:163], a[128:131], v[176:179]
    ds_read_b64_tr_b16 a[182:183], v18 offset:49664
    v_mfma_f32_16x16x32_bf16 v[176:179], a[164:167], a[132:135], v[176:179]
    ds_read_b128 a[56:59], v14 offset:6144
    v_mfma_f32_16x16x32_bf16 v[180:183], a[160:163], a[136:139], v[180:183]
    v_mfma_f32_16x16x32_bf16 v[180:183], a[164:167], a[140:143], v[180:183]
    ds_read_b128 a[60:63], v15 offset:6144
    v_mfma_f32_16x16x32_bf16 v[184:187], a[160:163], a[144:147], v[184:187]
    v_mfma_f32_16x16x32_bf16 v[184:187], a[164:167], a[148:151], v[184:187]
    ds_read_b128 a[64:67], v14 offset:8192
    v_mfma_f32_16x16x32_bf16 v[188:191], a[160:163], a[152:155], v[188:191]
    v_mfma_f32_16x16x32_bf16 v[188:191], a[164:167], a[156:159], v[188:191]
    s_waitcnt lgkmcnt(15)
    ds_read_b128 a[68:71], v15 offset:8192
    v_mfma_f32_16x16x32_bf16 v[192:195], a[168:171], a[96:99], v[192:195]
    s_waitcnt lgkmcnt(14)
    s_add_u32 s70, s70, 128
    v_mfma_f32_16x16x32_bf16 v[192:195], a[172:175], a[100:103], v[192:195]
    ds_read_b128 a[72:75], v14 offset:10240
    v_mfma_f32_16x16x32_bf16 v[196:199], a[168:171], a[104:107], v[196:199]
    ds_read_b64_tr_b16 a[184:185], v19 offset:32768
    v_mfma_f32_16x16x32_bf16 v[196:199], a[172:175], a[108:111], v[196:199]
    ds_read_b128 a[76:79], v15 offset:10240
    v_mfma_f32_16x16x32_bf16 v[200:203], a[168:171], a[112:115], v[200:203]
    ds_read_b64_tr_b16 a[186:187], v19 offset:33280
    v_mfma_f32_16x16x32_bf16 v[200:203], a[172:175], a[116:119], v[200:203]
    v_mfma_f32_16x16x32_bf16 v[204:207], a[168:171], a[120:123], v[204:207]
    s_add_u32 s74, s74, 524288
    ds_read_b64_tr_b16 a[188:189], v19 offset:49152
    v_mfma_f32_16x16x32_bf16 v[204:207], a[172:175], a[124:127], v[204:207]
    v_mfma_f32_16x16x32_bf16 v[208:211], a[168:171], a[128:131], v[208:211]
    ds_read_b64_tr_b16 a[190:191], v19 offset:49664
    v_mfma_f32_16x16x32_bf16 v[208:211], a[172:175], a[132:135], v[208:211]
    v_xor_b32 v16, 0x10000, v16
    v_mfma_f32_16x16x32_bf16 v[212:215], a[168:171], a[136:139], v[212:215]
    v_mfma_f32_16x16x32_bf16 v[212:215], a[172:175], a[140:143], v[212:215]
    v_xor_b32 v17, 0x10000, v17
    v_mfma_f32_16x16x32_bf16 v[216:219], a[168:171], a[144:147], v[216:219]
    v_xor_b32 v18, 0x10000, v18
    v_mfma_f32_16x16x32_bf16 v[216:219], a[172:175], a[148:151], v[216:219]
    v_xor_b32 v19, 0x10000, v19
    v_mfma_f32_16x16x32_bf16 v[220:223], a[168:171], a[152:155], v[220:223]
    s_add_u32 m0, s67, 32768
    v_mfma_f32_16x16x32_bf16 v[220:223], a[172:175], a[156:159], v[220:223]
    s_waitcnt lgkmcnt(14)
    s_waitcnt lgkmcnt(0)
    v_mfma_f32_16x16x32_bf16 v[224:227], a[176:179], a[96:99], v[224:227]
    s_waitcnt vmcnt(27)
    v_mfma_f32_16x16x32_bf16 v[224:227], a[180:183], a[100:103], v[224:227]
    buffer_load_dwordx4 v2, s[12:15], s72 offen offset:0  lds
    v_mfma_f32_16x16x32_bf16 v[228:231], a[176:179], a[104:107], v[228:231]
    ds_read_b64_tr_b16 a[160:161], v16 offset:0
    v_mfma_f32_16x16x32_bf16 v[228:231], a[180:183], a[108:111], v[228:231]
    ds_read_b128 a[80:83], v14 offset:12288
    v_mfma_f32_16x16x32_bf16 v[232:235], a[176:179], a[112:115], v[232:235]
    s_waitcnt vmcnt(24)
    ds_read_b64_tr_b16 a[162:163], v16 offset:512
    v_mfma_f32_16x16x32_bf16 v[232:235], a[180:183], a[116:119], v[232:235]
    s_add_u32 s76, s76, 1
    buffer_load_dwordx4 v3, s[12:15], s72 offen offset:1024  lds
    v_mfma_f32_16x16x32_bf16 v[236:239], a[176:179], a[120:123], v[236:239]
    ds_read_b64_tr_b16 a[164:165], v16 offset:16384
    v_mfma_f32_16x16x32_bf16 v[236:239], a[180:183], a[124:127], v[236:239]
    ds_read_b128 a[84:87], v15 offset:12288
    v_mfma_f32_16x16x32_bf16 v[240:243], a[176:179], a[128:131], v[240:243]
    ds_read_b64_tr_b16 a[166:167], v16 offset:16896
    v_mfma_f32_16x16x32_bf16 v[240:243], a[180:183], a[132:135], v[240:243]
    buffer_load_dwordx4 v2, s[16:19], s72 offen offset:2048  lds
    v_mfma_f32_16x16x32_bf16 v[244:247], a[176:179], a[136:139], v[244:247]
    v_mfma_f32_16x16x32_bf16 v[244:247], a[180:183], a[140:143], v[244:247]
    ds_read_b128 a[88:91], v14 offset:14336
    v_mfma_f32_16x16x32_bf16 v[248:251], a[176:179], a[144:147], v[248:251]
    v_mfma_f32_16x16x32_bf16 v[248:251], a[180:183], a[148:151], v[248:251]
    buffer_load_dwordx4 v3, s[16:19], s72 offen offset:3072  lds
    v_mfma_f32_16x16x32_bf16 v[252:255], a[176:179], a[152:155], v[252:255]
    s_add_u32 m0, s67, 49152
    v_mfma_f32_16x16x32_bf16 v[252:255], a[180:183], a[156:159], v[252:255]
    s_add_u32 s72, s72, 262144
    ds_read_b128 a[92:95], v15 offset:14336
    v_mfma_f32_16x16x32_bf16 a[0:3], a[184:187], a[96:99], a[0:3]
    v_mfma_f32_16x16x32_bf16 a[0:3], a[188:191], a[100:103], a[0:3]
    buffer_load_dwordx4 v2, s[12:15], s72 offen offset:0  lds
    v_mfma_f32_16x16x32_bf16 a[4:7], a[184:187], a[104:107], a[4:7]
    ds_read_b64_tr_b16 a[168:169], v17 offset:0
    v_mfma_f32_16x16x32_bf16 a[4:7], a[188:191], a[108:111], a[4:7]
    v_mfma_f32_16x16x32_bf16 a[8:11], a[184:187], a[112:115], a[8:11]
    ds_read_b64_tr_b16 a[170:171], v17 offset:512
    v_mfma_f32_16x16x32_bf16 a[8:11], a[188:191], a[116:119], a[8:11]
    buffer_load_dwordx4 v3, s[12:15], s72 offen offset:1024  lds
    v_mfma_f32_16x16x32_bf16 a[12:15], a[184:187], a[120:123], a[12:15]
    ds_read_b64_tr_b16 a[172:173], v17 offset:16384
    v_mfma_f32_16x16x32_bf16 a[12:15], a[188:191], a[124:127], a[12:15]
    v_mfma_f32_16x16x32_bf16 a[16:19], a[184:187], a[128:131], a[16:19]
    ds_read_b64_tr_b16 a[174:175], v17 offset:16896
    v_mfma_f32_16x16x32_bf16 a[16:19], a[188:191], a[132:135], a[16:19]
    buffer_load_dwordx4 v2, s[16:19], s72 offen offset:2048  lds
    v_mfma_f32_16x16x32_bf16 a[20:23], a[184:187], a[136:139], a[20:23]
    v_mfma_f32_16x16x32_bf16 a[20:23], a[188:191], a[140:143], a[20:23]
    s_waitcnt lgkmcnt(0)
    v_mfma_f32_16x16x32_bf16 a[24:27], a[184:187], a[144:147], a[24:27]
    s_barrier
    v_mfma_f32_16x16x32_bf16 a[24:27], a[188:191], a[148:151], a[24:27]
    buffer_load_dwordx4 v3, s[16:19], s72 offen offset:3072  lds
    v_mfma_f32_16x16x32_bf16 a[28:31], a[184:187], a[152:155], a[28:31]
    s_add_u32 s72, s72, 262144
    v_mfma_f32_16x16x32_bf16 a[28:31], a[188:191], a[156:159], a[28:31]
    s_cmp_lg_u32 s76, 14
    s_cbranch_scc1 fz_N0
fz_lastN:
    v_cmp_ne_u32 vcc, 0xffff, v21
    s_mov_b32 s20, s64
    s_mov_b32 s21, s65
    s_mul_i32 s70, s69, 114688
    v_add_u32 v10, s67, v20
    s_cbranch_vccz fz_goN
    s_mov_b32 s87, 100000
    s_mov_b32 s34, 64
fz_spinN:
    s_sub_u32 s87, s87, 1
    s_cbranch_scc1 fz_goN
    buffer_load_dword v21, v22, s[32:35], 0 offen sc1
    s_waitcnt vmcnt(0)
    v_cmp_ne_u32 vcc, 0xffff, v21
    s_cbranch_vccnz fz_spinN
fz_goN:
    s_getpc_b64 s[36:37]
fz_pc_3:
    s_lshr_b32 s38, s2, 3
    v_lshrrev_b32 v28, 6, v0
    v_and_b32 v29, 63, v0
    v_lshl_add_u32 v28, s38, 2, v28
    v_min_u32 v29, 4, v29
    v_mad_u32_u24 v28, v28, 5, v29
    s_sub_u32 s36, s36, fz_pc_3-fz
    s_subb_u32 s37, s37, 0
    v_min_u32 v28, (fz_zend-fz)/128, v28
    v_mov_b32 v29, 0
    v_lshlrev_b32 v28, 7, v28
    v_lshl_add_u64 v[28:29], v[28:29], 0, s[36:37]
    global_load_dword v31, v[28:29], off
    v_mfma_f32_16x16x32_bf16 v[32:35], a[160:163], a[32:35], v[32:35]
    v_bfe_u32 v24, v1, 2, 2
    v_bfe_u32 v25, v1, 4, 1
    v_mfma_f32_16x16x32_bf16 v[32:35], a[164:167], a[36:39], v[32:35]
    v_lshl_add_u32 v24, v25, 3, v24
    v_lshlrev_b32 v24, 6, v24
    v_mfma_f32_16x16x32_bf16 v[36:39], a[160:163], a[40:43], v[36:39]
    ds_read_b64_tr_b16 a[176:177], v18 offset:0
    v_and_b32 v26, 3, v1
    v_mfma_f32_16x16x32_bf16 v[36:39], a[164:167], a[44:47], v[36:39]
    s_lshl_b32 s86, s68, 8
    v_lshl_add_u32 v24, v26, 3, v24
    v_lshrrev_b32 v26, 5, v1
    v_mfma_f32_16x16x32_bf16 v[40:43], a[160:163], a[48:51], v[40:43]
    s_lshl_b32 s87, s66, 6
    ds_read_b64_tr_b16 a[178:179], v18 offset:512
    v_lshl_add_u32 v24, v26, 11, v24
    v_mfma_f32_16x16x32_bf16 v[40:43], a[164:167], a[52:55], v[40:43]
    s_add_u32 s86, s86, s87
    v_add_u32 v24, s67, v24
    v_lshl_add_u32 v11, v25, 5, v24
    v_mfma_f32_16x16x32_bf16 v[44:47], a[160:163], a[56:59], v[44:47]
    s_sub_u32 s87, 1605632, s86
    ds_read_b64_tr_b16 a[180:181], v18 offset:16384
    v_xor_b32 v12, 32, v11
    v_mfma_f32_16x16x32_bf16 v[44:47], a[164:167], a[60:63], v[44:47]
    s_add_u32 s88, s87, 1024
    v_add_u32 v13, 65536, v11
    v_add_u32 v8, 65536, v12
    v_mfma_f32_16x16x32_bf16 v[48:51], a[160:163], a[64:67], v[48:51]
    s_cmp_lt_u32 s68, 14
    s_cselect_b32 s6, s87, 0
    s_cselect_b32 s10, s88, 0
    ds_read_b64_tr_b16 a[182:183], v18 offset:16896
    v_mfma_f32_16x16x32_bf16 v[48:51], a[164:167], a[68:71], v[48:51]
    s_add_u32 s4, s54, s86
    s_addc_u32 s5, s55, 0
    v_mfma_f32_16x16x32_bf16 v[52:55], a[160:163], a[72:75], v[52:55]
    s_add_u32 s8, s56, s86
    s_addc_u32 s9, s57, 0
    v_mfma_f32_16x16x32_bf16 v[52:55], a[164:167], a[76:79], v[52:55]
    s_sub_u32 s8, s8, 1024
    s_subb_u32 s9, s9, 0
    v_mfma_f32_16x16x32_bf16 v[56:59], a[160:163], a[80:83], v[56:59]
    s_mov_b32 s71, 0
    v_mfma_f32_16x16x32_bf16 v[56:59], a[164:167], a[84:87], v[56:59]
    s_lshl_b32 s86, s86, 1
    v_mfma_f32_16x16x32_bf16 v[60:63], a[160:163], a[88:91], v[60:63]
    s_add_u32 s12, s44, s86
    s_addc_u32 s13, s45, 0
    v_mfma_f32_16x16x32_bf16 v[60:63], a[164:167], a[92:95], v[60:63]
    s_sub_u32 s14, 3670016, s86
    v_mfma_f32_16x16x32_bf16 v[64:67], a[168:171], a[32:35], v[64:67]
    s_add_u32 m0, s67, 131072
    v_mfma_f32_16x16x32_bf16 v[64:67], a[172:175], a[36:39], v[64:67]
    s_add_u32 s86, s86, 129024
    buffer_load_dwordx4 v10, s[20:23], s70 offen offset:0 sc1 lds
    v_mfma_f32_16x16x32_bf16 v[68:71], a[168:171], a[40:43], v[68:71]
    s_add_u32 s16, s44, s86
    s_addc_u32 s17, s45, 0
    ds_read_b64_tr_b16 a[184:185], v19 offset:0
    v_mfma_f32_16x16x32_bf16 v[68:71], a[172:175], a[44:47], v[68:71]
    s_sub_u32 s18, 3670016, s86
    v_mfma_f32_16x16x32_bf16 v[72:75], a[168:171], a[48:51], v[72:75]
    s_mov_b32 s72, 0
    ds_read_b64_tr_b16 a[186:187], v19 offset:512
    v_mfma_f32_16x16x32_bf16 v[72:75], a[172:175], a[52:55], v[72:75]
    buffer_load_dwordx4 v10, s[20:23], s70 offen offset:1024 sc1 lds
    v_mfma_f32_16x16x32_bf16 v[76:79], a[168:171], a[56:59], v[76:79]
    ds_read_b64_tr_b16 a[188:189], v19 offset:16384
    v_mfma_f32_16x16x32_bf16 v[76:79], a[172:175], a[60:63], v[76:79]
    v_mfma_f32_16x16x32_bf16 v[80:83], a[168:171], a[64:67], v[80:83]
    ds_read_b64_tr_b16 a[190:191], v19 offset:16896
    v_mfma_f32_16x16x32_bf16 v[80:83], a[172:175], a[68:71], v[80:83]
    buffer_load_dwordx4 v10, s[20:23], s70 offen offset:2048 sc1 lds
    v_mfma_f32_16x16x32_bf16 v[84:87], a[168:171], a[72:75], v[84:87]
    v_mfma_f32_16x16x32_bf16 v[84:87], a[172:175], a[76:79], v[84:87]
    v_mfma_f32_16x16x32_bf16 v[88:91], a[168:171], a[80:83], v[88:91]
    v_mfma_f32_16x16x32_bf16 v[88:91], a[172:175], a[84:87], v[88:91]
    buffer_load_dwordx4 v10, s[20:23], s70 offen offset:3072 sc1 lds
    v_mfma_f32_16x16x32_bf16 v[92:95], a[168:171], a[88:91], v[92:95]
    s_add_u32 m0, s67, 65536
    v_mfma_f32_16x16x32_bf16 v[92:95], a[172:175], a[92:95], v[92:95]
    s_waitcnt lgkmcnt(6)
    s_waitcnt lgkmcnt(0)
    v_mfma_f32_16x16x32_bf16 v[96:99], a[176:179], a[32:35], v[96:99]
    s_waitcnt vmcnt(31)
    v_mfma_f32_16x16x32_bf16 v[96:99], a[180:183], a[36:39], v[96:99]
    buffer_load_dwordx4 v4, s[4:7], s71 offen offset:0  lds
    v_mfma_f32_16x16x32_bf16 v[100:103], a[176:179], a[40:43], v[100:103]
    ds_read_b64_tr_b16 a[160:161], v16 offset:32768
    v_mfma_f32_16x16x32_bf16 v[100:103], a[180:183], a[44:47], v[100:103]
    v_mfma_f32_16x16x32_bf16 v[104:107], a[176:179], a[48:51], v[104:107]
    s_waitcnt vmcnt(28)
    ds_read_b64_tr_b16 a[162:163], v16 offset:33280
    v_mfma_f32_16x16x32_bf16 v[104:107], a[180:183], a[52:55], v[104:107]
    buffer_load_dwordx4 v4, s[8:11], s71 offen offset:1024  lds
    v_mfma_f32_16x16x32_bf16 v[108:111], a[176:179], a[56:59], v[108:111]
    ds_read_b64_tr_b16 a[164:165], v16 offset:49152
    v_mfma_f32_16x16x32_bf16 v[108:111], a[180:183], a[60:63], v[108:111]
    v_mfma_f32_16x16x32_bf16 v[112:115], a[176:179], a[64:67], v[112:115]
    ds_read_b64_tr_b16 a[166:167], v16 offset:49664
    v_mfma_f32_16x16x32_bf16 v[112:115], a[180:183], a[68:71], v[112:115]
    buffer_load_dwordx4 v5, s[4:7], s71 offen offset:2048  lds
    v_mfma_f32_16x16x32_bf16 v[116:119], a[176:179], a[72:75], v[116:119]
    v_mfma_f32_16x16x32_bf16 v[116:119], a[180:183], a[76:79], v[116:119]
    v_mfma_f32_16x16x32_bf16 v[120:123], a[176:179], a[80:83], v[120:123]
    v_mfma_f32_16x16x32_bf16 v[120:123], a[180:183], a[84:87], v[120:123]
    buffer_load_dwordx4 v5, s[8:11], s71 offen offset:3072  lds
    v_mfma_f32_16x16x32_bf16 v[124:127], a[176:179], a[88:91], v[124:127]
    s_add_u32 m0, s67, 81920
    v_mfma_f32_16x16x32_bf16 v[124:127], a[180:183], a[92:95], v[124:127]
    s_add_u32 s71, s71, 114688
    v_mfma_f32_16x16x32_bf16 v[128:131], a[184:187], a[32:35], v[128:131]
    v_mfma_f32_16x16x32_bf16 v[128:131], a[188:191], a[36:39], v[128:131]
    buffer_load_dwordx4 v4, s[4:7], s71 offen offset:0  lds
    v_mfma_f32_16x16x32_bf16 v[132:135], a[184:187], a[40:43], v[132:135]
    ds_read_b64_tr_b16 a[168:169], v17 offset:32768
    v_mfma_f32_16x16x32_bf16 v[132:135], a[188:191], a[44:47], v[132:135]
    v_mfma_f32_16x16x32_bf16 v[136:139], a[184:187], a[48:51], v[136:139]
    ds_read_b64_tr_b16 a[170:171], v17 offset:33280
    v_mfma_f32_16x16x32_bf16 v[136:139], a[188:191], a[52:55], v[136:139]
    buffer_load_dwordx4 v4, s[8:11], s71 offen offset:1024  lds
    v_mfma_f32_16x16x32_bf16 v[140:143], a[184:187], a[56:59], v[140:143]
    ds_read_b64_tr_b16 a[172:173], v17 offset:49152
    v_mfma_f32_16x16x32_bf16 v[140:143], a[188:191], a[60:63], v[140:143]
    v_mfma_f32_16x16x32_bf16 v[144:147], a[184:187], a[64:67], v[144:147]
    ds_read_b64_tr_b16 a[174:175], v17 offset:49664
    v_mfma_f32_16x16x32_bf16 v[144:147], a[188:191], a[68:71], v[144:147]
    buffer_load_dwordx4 v5, s[4:7], s71 offen offset:2048  lds
    v_mfma_f32_16x16x32_bf16 v[148:151], a[184:187], a[72:75], v[148:151]
    s_waitcnt vmcnt(29)
    v_mfma_f32_16x16x32_bf16 v[148:151], a[188:191], a[76:79], v[148:151]
    s_barrier
    v_mfma_f32_16x16x32_bf16 v[152:155], a[184:187], a[80:83], v[152:155]
    v_mfma_f32_16x16x32_bf16 v[152:155], a[188:191], a[84:87], v[152:155]
    buffer_load_dwordx4 v5, s[8:11], s71 offen offset:3072  lds
    ds_read_b128 a[96:99], v14 offset:16384
    v_mfma_f32_16x16x32_bf16 v[156:159], a[184:187], a[88:91], v[156:159]
    s_add_u32 s71, s71, 114688
    v_mfma_f32_16x16x32_bf16 v[156:159], a[188:191], a[92:95], v[156:159]
    s_waitcnt lgkmcnt(7)
    ds_read_b128 a[100:103], v15 offset:16384
    v_mfma_f32_16x16x32_bf16 v[160:163], a[160:163], a[32:35], v[160:163]
    s_waitcnt lgkmcnt(6)
    v_mfma_f32_16x16x32_bf16 v[160:163], a[164:167], a[36:39], v[160:163]
    ds_read_b128 a[104:107], v14 offset:18432
    v_mfma_f32_16x16x32_bf16 v[164:167], a[160:163], a[40:43], v[164:167]
    ds_read_b64_tr_b16 a[176:177], v18 offset:32768
    v_mfma_f32_16x16x32_bf16 v[164:167], a[164:167], a[44:47], v[164:167]
    ds_read_b128 a[108:111], v15 offset:18432
    v_mfma_f32_16x16x32_bf16 v[168:171], a[160:163], a[48:51], v[168:171]
    ds_read_b64_tr_b16 a[178:179], v18 offset:33280
    v_mfma_f32_16x16x32_bf16 v[168:171], a[164:167], a[52:55], v[168:171]
    ds_read_b128 a[112:115], v14 offset:20480
    v_mfma_f32_16x16x32_bf16 v[172:175], a[160:163], a[56:59], v[172:175]
    ds_read_b64_tr_b16 a[180:181], v18 offset:49152
    v_mfma_f32_16x16x32_bf16 v[172:175], a[164:167], a[60:63], v[172:175]
    ds_read_b128 a[116:119], v15 offset:20480
    v_mfma_f32_16x16x32_bf16 v[176:179], a[160:163], a[64:67], v[176:179]
    ds_read_b64_tr_b16 a[182:183], v18 offset:49664
    v_mfma_f32_16x16x32_bf16 v[176:179], a[164:167], a[68:71], v[176:179]
    ds_read_b128 a[120:123], v14 offset:22528
    v_mfma_f32_16x16x32_bf16 v[180:183], a[160:163], a[72:75], v[180:183]
    v_mfma_f32_16x16x32_bf16 v[180:183], a[164:167], a[76:79], v[180:183]
    ds_read_b128 a[124:127], v15 offset:22528
    v_mfma_f32_16x16x32_bf16 v[184:187], a[160:163], a[80:83], v[184:187]
    v_mfma_f32_16x16x32_bf16 v[184:187], a[164:167], a[84:87], v[184:187]
    ds_read_b128 a[128:131], v14 offset:24576
    v_mfma_f32_16x16x32_bf16 v[188:191], a[160:163], a[88:91], v[188:191]
    v_mfma_f32_16x16x32_bf16 v[188:191], a[164:167], a[92:95], v[188:191]
    s_waitcnt lgkmcnt(15)
    ds_read_b128 a[132:135], v15 offset:24576
    v_mfma_f32_16x16x32_bf16 v[192:195], a[168:171], a[32:35], v[192:195]
    s_waitcnt lgkmcnt(14)
    s_add_u32 s70, s70, 16384
    v_mfma_f32_16x16x32_bf16 v[192:195], a[172:175], a[36:39], v[192:195]
    ds_read_b128 a[136:139], v14 offset:26624
    v_mfma_f32_16x16x32_bf16 v[196:199], a[168:171], a[40:43], v[196:199]
    ds_read_b64_tr_b16 a[184:185], v19 offset:32768
    v_mfma_f32_16x16x32_bf16 v[196:199], a[172:175], a[44:47], v[196:199]
    ds_read_b128 a[140:143], v15 offset:26624
    v_mfma_f32_16x16x32_bf16 v[200:203], a[168:171], a[48:51], v[200:203]
    ds_read_b64_tr_b16 a[186:187], v19 offset:33280
    v_mfma_f32_16x16x32_bf16 v[200:203], a[172:175], a[52:55], v[200:203]
    v_mfma_f32_16x16x32_bf16 v[204:207], a[168:171], a[56:59], v[204:207]
    ds_read_b64_tr_b16 a[188:189], v19 offset:49152
    v_mfma_f32_16x16x32_bf16 v[204:207], a[172:175], a[60:63], v[204:207]
    v_mfma_f32_16x16x32_bf16 v[208:211], a[168:171], a[64:67], v[208:211]
    ds_read_b64_tr_b16 a[190:191], v19 offset:49664
    v_mfma_f32_16x16x32_bf16 v[208:211], a[172:175], a[68:71], v[208:211]
    v_xor_b32 v16, 0x10000, v16
    v_mfma_f32_16x16x32_bf16 v[212:215], a[168:171], a[72:75], v[212:215]
    v_mfma_f32_16x16x32_bf16 v[212:215], a[172:175], a[76:79], v[212:215]
    v_xor_b32 v17, 0x10000, v17
    v_mfma_f32_16x16x32_bf16 v[216:219], a[168:171], a[80:83], v[216:219]
    v_xor_b32 v18, 0x10000, v18
    v_mfma_f32_16x16x32_bf16 v[216:219], a[172:175], a[84:87], v[216:219]
    v_xor_b32 v19, 0x10000, v19
    v_mfma_f32_16x16x32_bf16 v[220:223], a[168:171], a[88:91], v[220:223]
    s_add_u32 m0, s67, 98304
    v_mfma_f32_16x16x32_bf16 v[220:223], a[172:175], a[92:95], v[220:223]
    s_waitcnt lgkmcnt(14)
    s_waitcnt lgkmcnt(0)
    v_mfma_f32_16x16x32_bf16 v[224:227], a[176:179], a[32:35], v[224:227]
    s_waitcnt vmcnt(26)
    v_mfma_f32_16x16x32_bf16 v[224:227], a[180:183], a[36:39], v[224:227]
    buffer_load_dwordx4 v2, s[12:15], s72 offen offset:0  lds
    v_mfma_f32_16x16x32_bf16 v[228:231], a[176:179], a[40:43], v[228:231]
    ds_read_b64_tr_b16 a[160:161], v16 offset:0
    v_mfma_f32_16x16x32_bf16 v[228:231], a[180:183], a[44:47], v[228:231]
    ds_read_b128 a[144:147], v14 offset:28672
    v_mfma_f32_16x16x32_bf16 v[232:235], a[176:179], a[48:51], v[232:235]
    s_waitcnt vmcnt(23)
    ds_read_b64_tr_b16 a[162:163], v16 offset:512
    v_mfma_f32_16x16x32_bf16 v[232:235], a[180:183], a[52:55], v[232:235]
    s_add_u32 s76, s76, 1
    buffer_load_dwordx4 v3, s[12:15], s72 offen offset:1024  lds
    v_mfma_f32_16x16x32_bf16 v[236:239], a[176:179], a[56:59], v[236:239]
    ds_read_b64_tr_b16 a[164:165], v16 offset:16384
    v_mfma_f32_16x16x32_bf16 v[236:239], a[180:183], a[60:63], v[236:239]
    ds_read_b128 a[148:151], v15 offset:28672
    v_mfma_f32_16x16x32_bf16 v[240:243], a[176:179], a[64:67], v[240:243]
    ds_read_b64_tr_b16 a[166:167], v16 offset:16896
    v_mfma_f32_16x16x32_bf16 v[240:243], a[180:183], a[68:71], v[240:243]
    buffer_load_dwordx4 v2, s[16:19], s72 offen offset:2048  lds
    v_mfma_f32_16x16x32_bf16 v[244:247], a[176:179], a[72:75], v[244:247]
    v_mfma_f32_16x16x32_bf16 v[244:247], a[180:183], a[76:79], v[244:247]
    ds_read_b128 a[152:155], v14 offset:30720
    v_mfma_f32_16x16x32_bf16 v[248:251], a[176:179], a[80:83], v[248:251]
    v_mfma_f32_16x16x32_bf16 v[248:251], a[180:183], a[84:87], v[248:251]
    buffer_load_dwordx4 v3, s[16:19], s72 offen offset:3072  lds
    v_mfma_f32_16x16x32_bf16 v[252:255], a[176:179], a[88:91], v[252:255]
    s_add_u32 m0, s67, 114688
    v_mfma_f32_16x16x32_bf16 v[252:255], a[180:183], a[92:95], v[252:255]
    s_add_u32 s72, s72, 262144
    ds_read_b128 a[156:159], v15 offset:30720
    v_mfma_f32_16x16x32_bf16 a[0:3], a[184:187], a[32:35], a[0:3]
    v_mfma_f32_16x16x32_bf16 a[0:3], a[188:191], a[36:39], a[0:3]
    buffer_load_dwordx4 v2, s[12:15], s72 offen offset:0  lds
    v_mfma_f32_16x16x32_bf16 a[4:7], a[184:187], a[40:43], a[4:7]
    ds_read_b64_tr_b16 a[168:169], v17 offset:0
    v_mfma_f32_16x16x32_bf16 a[4:7], a[188:191], a[44:47], a[4:7]
    v_mfma_f32_16x16x32_bf16 a[8:11], a[184:187], a[48:51], a[8:11]
    ds_read_b64_tr_b16 a[170:171], v17 offset:512
    v_mfma_f32_16x16x32_bf16 a[8:11], a[188:191], a[52:55], a[8:11]
    buffer_load_dwordx4 v3, s[12:15], s72 offen offset:1024  lds
    v_mfma_f32_16x16x32_bf16 a[12:15], a[184:187], a[56:59], a[12:15]
    ds_read_b64_tr_b16 a[172:173], v17 offset:16384
    v_mfma_f32_16x16x32_bf16 a[12:15], a[188:191], a[60:63], a[12:15]
    v_mfma_f32_16x16x32_bf16 a[16:19], a[184:187], a[64:67], a[16:19]
    ds_read_b64_tr_b16 a[174:175], v17 offset:16896
    v_mfma_f32_16x16x32_bf16 a[16:19], a[188:191], a[68:71], a[16:19]
    buffer_load_dwordx4 v2, s[16:19], s72 offen offset:2048  lds
    v_mfma_f32_16x16x32_bf16 a[20:23], a[184:187], a[72:75], a[20:23]
    v_mfma_f32_16x16x32_bf16 a[20:23], a[188:191], a[76:79], a[20:23]
    s_waitcnt lgkmcnt(0)
    v_mfma_f32_16x16x32_bf16 a[24:27], a[184:187], a[80:83], a[24:27]
    s_barrier
    v_mfma_f32_16x16x32_bf16 a[24:27], a[188:191], a[84:87], a[24:27]
    buffer_load_dwordx4 v3, s[16:19], s72 offen offset:3072  lds
    v_mfma_f32_16x16x32_bf16 a[28:31], a[184:187], a[88:91], a[28:31]
    s_add_u32 s72, s72, 262144
    v_mfma_f32_16x16x32_bf16 a[28:31], a[188:191], a[92:95], a[28:31]
    v_mfma_f32_16x16x32_bf16 v[32:35], a[160:163], a[96:99], v[32:35]
    v_mfma_f32_16x16x32_bf16 v[32:35], a[164:167], a[100:103], v[32:35]
    v_mfma_f32_16x16x32_bf16 v[36:39], a[160:163], a[104:107], v[36:39]
    ds_read_b64_tr_b16 a[176:177], v18 offset:0
    v_mfma_f32_16x16x32_bf16 v[36:39], a[164:167], a[108:111], v[36:39]
    v_mfma_f32_16x16x32_bf16 v[40:43], a[160:163], a[112:115], v[40:43]
    ds_read_b64_tr_b16 a[178:179], v18 offset:512
    v_mfma_f32_16x16x32_bf16 v[40:43], a[164:167], a[116:119], v[40:43]
    v_mfma_f32_16x16x32_bf16 v[44:47], a[160:163], a[120:123], v[44:47]
    ds_read_b64_tr_b16 a[180:181], v18 offset:16384
    v_mfma_f32_16x16x32_bf16 v[44:47], a[164:167], a[124:127], v[44:47]
    v_mfma_f32_16x16x32_bf16 v[48:51], a[160:163], a[128:131], v[48:51]
    ds_read_b64_tr_b16 a[182:183], v18 offset:16896
    v_mfma_f32_16x16x32_bf16 v[48:51], a[164:167], a[132:135], v[48:51]
    v_mfma_f32_16x16x32_bf16 v[52:55], a[160:163], a[136:139], v[52:55]
    v_mfma_f32_16x16x32_bf16 v[52:55], a[164:167], a[140:143], v[52:55]
    v_mfma_f32_16x16x32_bf16 v[56:59], a[160:163], a[144:147], v[56:59]
    v_mfma_f32_16x16x32_bf16 v[56:59], a[164:167], a[148:151], v[56:59]
    v_mfma_f32_16x16x32_bf16 v[60:63], a[160:163], a[152:155], v[60:63]
    v_mfma_f32_16x16x32_bf16 v[60:63], a[164:167], a[156:159], v[60:63]
    v_mfma_f32_16x16x32_bf16 v[64:67], a[168:171], a[96:99], v[64:67]
    s_add_u32 m0, s67, 147456
    v_mfma_f32_16x16x32_bf16 v[64:67], a[172:175], a[100:103], v[64:67]
    buffer_load_dwordx4 v10, s[20:23], s70 offen offset:0 sc1 lds
    v_mfma_f32_16x16x32_bf16 v[68:71], a[168:171], a[104:107], v[68:71]
    ds_read_b64_tr_b16 a[184:185], v19 offset:0
    v_mfma_f32_16x16x32_bf16 v[68:71], a[172:175], a[108:111], v[68:71]
    v_mfma_f32_16x16x32_bf16 v[72:75], a[168:171], a[112:115], v[72:75]
    ds_read_b64_tr_b16 a[186:187], v19 offset:512
    v_mfma_f32_16x16x32_bf16 v[72:75], a[172:175], a[116:119], v[72:75]
    buffer_load_dwordx4 v10, s[20:23], s70 offen offset:1024 sc1 lds
    v_cvt_pk_bf16_f32 v32, v32, v33
    v_mfma_f32_16x16x32_bf16 v[76:79], a[168:171], a[120:123], v[76:79]
    ds_read_b64_tr_b16 a[188:189], v19 offset:16384
    v_cvt_pk_bf16_f32 v33, v34, v35
    v_mfma_f32_16x16x32_bf16 v[76:79], a[172:175], a[124:127], v[76:79]
    v_cvt_pk_bf16_f32 v34, v64, v65
    v_cvt_pk_bf16_f32 v35, v66, v67
    v_mfma_f32_16x16x32_bf16 v[80:83], a[168:171], a[128:131], v[80:83]
    ds_read_b64_tr_b16 a[190:191], v19 offset:16896
    v_cvt_pk_bf16_f32 v36, v36, v37
    v_mfma_f32_16x16x32_bf16 v[80:83], a[172:175], a[132:135], v[80:83]
    buffer_load_dwordx4 v10, s[20:23], s70 offen offset:2048 sc1 lds
    v_cvt_pk_bf16_f32 v37, v38, v39
    v_mfma_f32_16x16x32_bf16 v[84:87], a[168:171], a[136:139], v[84:87]
    v_cvt_pk_bf16_f32 v38, v68, v69
    v_cvt_pk_bf16_f32 v39, v70, v71
    v_mfma_f32_16x16x32_bf16 v[84:87], a[172:175], a[140:143], v[84:87]
    v_cvt_pk_bf16_f32 v40, v40, v41
    v_cvt_pk_bf16_f32 v41, v42, v43
    v_mfma_f32_16x16x32_bf16 v[88:91], a[168:171], a[144:147], v[88:91]
    v_cvt_pk_bf16_f32 v42, v72, v73
    v_cvt_pk_bf16_f32 v43, v74, v75
    v_mfma_f32_16x16x32_bf16 v[88:91], a[172:175], a[148:151], v[88:91]
    buffer_load_dwordx4 v10, s[20:23], s70 offen offset:3072 sc1 lds
    v_cvt_pk_bf16_f32 v44, v44, v45
    v_mfma_f32_16x16x32_bf16 v[92:95], a[168:171], a[152:155], v[92:95]
    s_add_u32 m0, s67, 0
    v_cvt_pk_bf16_f32 v45, v46, v47
    v_cvt_pk_bf16_f32 v46, v76, v77
    v_mfma_f32_16x16x32_bf16 v[92:95], a[172:175], a[156:159], v[92:95]
    s_waitcnt lgkmcnt(6)
    s_waitcnt lgkmcnt(0)
    v_cvt_pk_bf16_f32 v47, v78, v79
    v_mfma_f32_16x16x32_bf16 v[96:99], a[176:179], a[96:99], v[96:99]
    s_waitcnt vmcnt(29)
    v_cvt_pk_bf16_f32 v48, v48, v49
    v_cvt_pk_bf16_f32 v49, v50, v51
    v_mfma_f32_16x16x32_bf16 v[96:99], a[180:183], a[100:103], v[96:99]
    buffer_load_dwordx4 v4, s[4:7], s71 offen offset:0  lds
    v_cvt_pk_bf16_f32 v50, v80, v81
    v_mfma_f32_16x16x32_bf16 v[100:103], a[176:179], a[104:107], v[100:103]
    ds_read_b64_tr_b16 a[160:161], v16 offset:32768
    v_cvt_pk_bf16_f32 v51, v82, v83
    v_mfma_f32_16x16x32_bf16 v[100:103], a[180:183], a[108:111], v[100:103]
    v_cvt_pk_bf16_f32 v52, v52, v53
    v_cvt_pk_bf16_f32 v53, v54, v55
    v_mfma_f32_16x16x32_bf16 v[104:107], a[176:179], a[112:115], v[104:107]
    s_waitcnt vmcnt(26)
    ds_read_b64_tr_b16 a[162:163], v16 offset:33280
    v_cvt_pk_bf16_f32 v54, v84, v85
    v_mfma_f32_16x16x32_bf16 v[104:107], a[180:183], a[116:119], v[104:107]
    buffer_load_dwordx4 v4, s[8:11], s71 offen offset:1024  lds
    v_cvt_pk_bf16_f32 v55, v86, v87
    v_mfma_f32_16x16x32_bf16 v[108:111], a[176:179], a[120:123], v[108:111]
    ds_read_b64_tr_b16 a[164:165], v16 offset:49152
    v_cvt_pk_bf16_f32 v56, v56, v57
    v_mfma_f32_16x16x32_bf16 v[108:111], a[180:183], a[124:127], v[108:111]
    v_cvt_pk_bf16_f32 v57, v58, v59
    v_cvt_pk_bf16_f32 v58, v88, v89
    v_mfma_f32_16x16x32_bf16 v[112:115], a[176:179], a[128:131], v[112:115]
    ds_read_b64_tr_b16 a[166:167], v16 offset:49664
    v_cvt_pk_bf16_f32 v59, v90, v91
    v_mfma_f32_16x16x32_bf16 v[112:115], a[180:183], a[132:135], v[112:115]
    buffer_load_dwordx4 v5, s[4:7], s71 offen offset:2048  lds
    v_cvt_pk_bf16_f32 v60, v60, v61
    v_mfma_f32_16x16x32_bf16 v[116:119], a[176:179], a[136:139], v[116:119]
    buffer_store_dwordx4 v[32:35], v20, s[24:27], s78 offen offset:0 sc1
    v_cvt_pk_bf16_f32 v61, v62, v63
    v_mfma_f32_16x16x32_bf16 v[116:119], a[180:183], a[140:143], v[116:119]
    v_cvt_pk_bf16_f32 v62, v92, v93
    v_cvt_pk_bf16_f32 v63, v94, v95
    v_mfma_f32_16x16x32_bf16 v[120:123], a[176:179], a[144:147], v[120:123]
    v_mfma_f32_16x16x32_bf16 v[120:123], a[180:183], a[148:151], v[120:123]
    buffer_load_dwordx4 v5, s[8:11], s71 offen offset:3072  lds
    v_mfma_f32_16x16x32_bf16 v[124:127], a[176:179], a[152:155], v[124:127]
    s_add_u32 m0, s67, 16384
    v_mfma_f32_16x16x32_bf16 v[124:127], a[180:183], a[156:159], v[124:127]
    s_add_u32 s71, s71, 114688
    v_mfma_f32_16x16x32_bf16 v[128:131], a[184:187], a[96:99], v[128:131]
    buffer_store_dwordx4 v[36:39], v20, s[24:27], s82 offen offset:0 sc1
    v_mfma_f32_16x16x32_bf16 v[128:131], a[188:191], a[100:103], v[128:131]
    buffer_load_dwordx4 v4, s[4:7], s71 offen offset:0  lds
    v_mfma_f32_16x16x32_bf16 v[132:135], a[184:187], a[104:107], v[132:135]
    ds_read_b64_tr_b16 a[168:169], v17 offset:32768
    v_mfma_f32_16x16x32_bf16 v[132:135], a[188:191], a[108:111], v[132:135]
    v_mfma_f32_16x16x32_bf16 v[136:139], a[184:187], a[112:115], v[136:139]
    ds_read_b64_tr_b16 a[170:171], v17 offset:33280
    v_mfma_f32_16x16x32_bf16 v[136:139], a[188:191], a[116:119], v[136:139]
    buffer_load_dwordx4 v4, s[8:11], s71 offen offset:1024  lds
    v_cvt_pk_bf16_f32 v96, v96, v97
    v_mfma_f32_16x16x32_bf16 v[140:143], a[184:187], a[120:123], v[140:143]
    buffer_store_dwordx4 v[40:43], v20, s[24:27], s79 offen offset:0 sc1
    ds_read_b64_tr_b16 a[172:173], v17 offset:49152
    v_mfma_f32_16x16x32_bf16 v[140:143], a[188:191], a[124:127], v[140:143]
    v_cvt_pk_bf16_f32 v97, v98, v99
    v_cvt_pk_bf16_f32 v98, v128, v129
    v_mfma_f32_16x16x32_bf16 v[144:147], a[184:187], a[128:131], v[144:147]
    ds_read_b64_tr_b16 a[174:175], v17 offset:49664
    v_cvt_pk_bf16_f32 v99, v130, v131
    v_mfma_f32_16x16x32_bf16 v[144:147], a[188:191], a[132:135], v[144:147]
    buffer_load_dwordx4 v5, s[4:7], s71 offen offset:2048  lds
    v_accvgpr_write_b32 a192, v96
    v_mfma_f32_16x16x32_bf16 v[148:151], a[184:187], a[136:139], v[148:151]
    s_waitcnt vmcnt(30)
    v_accvgpr_write_b32 a193, v97
    v_accvgpr_write_b32 a194, v98
    v_mfma_f32_16x16x32_bf16 v[148:151], a[188:191], a[140:143], v[148:151]
    s_barrier
    v_accvgpr_write_b32 a195, v99
    v_cvt_pk_bf16_f32 v100, v100, v101
    v_mfma_f32_16x16x32_bf16 v[152:155], a[184:187], a[144:147], v[152:155]
    v_cvt_pk_bf16_f32 v101, v102, v103
    v_cvt_pk_bf16_f32 v102, v132, v133
    v_mfma_f32_16x16x32_bf16 v[152:155], a[188:191], a[148:151], v[152:155]
    buffer_load_dwordx4 v5, s[8:11], s71 offen offset:3072  lds
    ds_read_b128 a[32:35], v14 offset:0
    v_mfma_f32_16x16x32_bf16 v[156:159], a[184:187], a[152:155], v[156:159]
    s_add_u32 s71, s71, 114688
    v_cvt_pk_bf16_f32 v103, v134, v135
    v_accvgpr_write_b32 a208, v100
    v_mfma_f32_16x16x32_bf16 v[156:159], a[188:191], a[156:159], v[156:159]
    s_waitcnt lgkmcnt(7)
    ds_read_b128 a[36:39], v15 offset:0
    v_accvgpr_write_b32 a209, v101
    v_mfma_f32_16x16x32_bf16 v[160:163], a[160:163], a[96:99], v[160:163]
    s_waitcnt lgkmcnt(6)
    v_accvgpr_write_b32 a210, v102
    v_accvgpr_write_b32 a211, v103
    v_mfma_f32_16x16x32_bf16 v[160:163], a[164:167], a[100:103], v[160:163]
    ds_read_b128 a[40:43], v14 offset:2048
    v_cvt_pk_bf16_f32 v104, v104, v105
    v_mfma_f32_16x16x32_bf16 v[164:167], a[160:163], a[104:107], v[164:167]
    buffer_store_dwordx4 v[44:47], v20, s[24:27], s83 offen offset:0 sc1
    ds_read_b64_tr_b16 a[176:177], v18 offset:32768
    v_mfma_f32_16x16x32_bf16 v[164:167], a[164:167], a[108:111], v[164:167]
    ds_read_b128 a[44:47], v15 offset:2048
    v_cvt_pk_bf16_f32 v105, v106, v107
    v_mfma_f32_16x16x32_bf16 v[168:171], a[160:163], a[112:115], v[168:171]
    ds_read_b64_tr_b16 a[178:179], v18 offset:33280
    v_cvt_pk_bf16_f32 v106, v136, v137
    v_mfma_f32_16x16x32_bf16 v[168:171], a[164:167], a[116:119], v[168:171]
    ds_read_b128 a[48:51], v14 offset:4096
    v_cvt_pk_bf16_f32 v107, v138, v139
    v_mfma_f32_16x16x32_bf16 v[172:175], a[160:163], a[120:123], v[172:175]
    ds_read_b64_tr_b16 a[180:181], v18 offset:49152
    v_accvgpr_write_b32 a196, v104
    v_mfma_f32_16x16x32_bf16 v[172:175], a[164:167], a[124:127], v[172:175]
    ds_read_b128 a[52:55], v15 offset:4096
    v_accvgpr_write_b32 a197, v105
    v_mfma_f32_16x16x32_bf16 v[176:179], a[160:163], a[128:131], v[176:179]
    ds_read_b64_tr_b16 a[182:183], v18 offset:49664
    v_accvgpr_write_b32 a198, v106
    v_mfma_f32_16x16x32_bf16 v[176:179], a[164:167], a[132:135], v[176:179]
    ds_read_b128 a[56:59], v14 offset:6144
    v_accvgpr_write_b32 a199, v107
    v_mfma_f32_16x16x32_bf16 v[180:183], a[160:163], a[136:139], v[180:183]
    v_cvt_pk_bf16_f32 v108, v108, v109
    v_cvt_pk_bf16_f32 v109, v110, v111
    v_mfma_f32_16x16x32_bf16 v[180:183], a[164:167], a[140:143], v[180:183]
    ds_read_b128 a[60:63], v15 offset:6144
    v_cvt_pk_bf16_f32 v110, v140, v141
    v_mfma_f32_16x16x32_bf16 v[184:187], a[160:163], a[144:147], v[184:187]
    v_cvt_pk_bf16_f32 v111, v142, v143
    v_accvgpr_write_b32 a212, v108
    v_mfma_f32_16x16x32_bf16 v[184:187], a[164:167], a[148:151], v[184:187]
    ds_read_b128 a[64:67], v14 offset:8192
    v_accvgpr_write_b32 a213, v109
    v_mfma_f32_16x16x32_bf16 v[188:191], a[160:163], a[152:155], v[188:191]
    buffer_store_dwordx4 v[48:51], v20, s[24:27], s80 offen offset:0 sc1
    v_accvgpr_write_b32 a214, v110
    v_mfma_f32_16x16x32_bf16 v[188:191], a[164:167], a[156:159], v[188:191]
    s_waitcnt lgkmcnt(15)
    ds_read_b128 a[68:71], v15 offset:8192
    v_accvgpr_write_b32 a215, v111
    v_mfma_f32_16x16x32_bf16 v[192:195], a[168:171], a[96:99], v[192:195]
    s_waitcnt lgkmcnt(14)
    s_add_u32 s70, s70, 16384
    v_cvt_pk_bf16_f32 v112, v112, v113
    v_mfma_f32_16x16x32_bf16 v[192:195], a[172:175], a[100:103], v[192:195]
    ds_read_b128 a[72:75], v14 offset:10240
    v_cvt_pk_bf16_f32 v113, v114, v115
    v_mfma_f32_16x16x32_bf16 v[196:199], a[168:171], a[104:107], v[196:199]
    ds_read_b64_tr_b16 a[184:185], v19 offset:32768
    v_cvt_pk_bf16_f32 v114, v144, v145
    v_mfma_f32_16x16x32_bf16 v[196:199], a[172:175], a[108:111], v[196:199]
    ds_read_b128 a[76:79], v15 offset:10240
    v_cvt_pk_bf16_f32 v115, v146, v147
    v_mfma_f32_16x16x32_bf16 v[200:203], a[168:171], a[112:115], v[200:203]
    buffer_store_dwordx4 v[52:55], v20, s[24:27], s84 offen offset:0 sc1
    ds_read_b64_tr_b16 a[186:187], v19 offset:33280
    v_mfma_f32_16x16x32_bf16 v[200:203], a[172:175], a[116:119], v[200:203]
    v_accvgpr_write_b32 a200, v112
    v_accvgpr_write_b32 a201, v113
    v_mfma_f32_16x16x32_bf16 v[204:207], a[168:171], a[120:123], v[204:207]
    ds_read_b64_tr_b16 a[188:189], v19 offset:49152
    v_accvgpr_write_b32 a202, v114
    v_mfma_f32_16x16x32_bf16 v[204:207], a[172:175], a[124:127], v[204:207]
    v_accvgpr_write_b32 a203, v115
    v_cvt_pk_bf16_f32 v116, v116, v117
    v_mfma_f32_16x16x32_bf16 v[208:211], a[168:171], a[128:131], v[208:211]
    ds_read_b64_tr_b16 a[190:191], v19 offset:49664
    v_cvt_pk_bf16_f32 v117, v118, v119
    v_mfma_f32_16x16x32_bf16 v[208:211], a[172:175], a[132:135], v[208:211]
    v_xor_b32 v16, 0x10000, v16
    v_cvt_pk_bf16_f32 v118, v148, v149
    v_mfma_f32_16x16x32_bf16 v[212:215], a[168:171], a[136:139], v[212:215]
    buffer_store_dwordx4 v[56:59], v20, s[24:27], s81 offen offset:0 sc1
    v_cvt_pk_bf16_f32 v119, v150, v151
    v_mfma_f32_16x16x32_bf16 v[212:215], a[172:175], a[140:143], v[212:215]
    v_xor_b32 v17, 0x10000, v17
    v_accvgpr_write_b32 a216, v116
    v_mfma_f32_16x16x32_bf16 v[216:219], a[168:171], a[144:147], v[216:219]
    v_xor_b32 v18, 0x10000, v18
    v_accvgpr_write_b32 a217, v117
    v_mfma_f32_16x16x32_bf16 v[216:219], a[172:175], a[148:151], v[216:219]
    v_xor_b32 v19, 0x10000, v19
    v_accvgpr_write_b32 a218, v118
    v_mfma_f32_16x16x32_bf16 v[220:223], a[168:171], a[152:155], v[220:223]
    s_add_u32 m0, s67, 32768
    buffer_store_dwordx4 v[60:63], v20, s[24:27], s85 offen offset:0 sc1
    v_accvgpr_write_b32 a219, v119
    v_mfma_f32_16x16x32_bf16 v[220:223], a[172:175], a[156:159], v[220:223]
    s_waitcnt lgkmcnt(14)
    s_waitcnt lgkmcnt(0)
    v_cvt_pk_bf16_f32 v120, v120, v121
    v_mfma_f32_16x16x32_bf16 v[224:227], a[176:179], a[96:99], v[224:227]
    s_waitcnt vmcnt(32)
    v_cvt_pk_bf16_f32 v121, v122, v123
    v_cvt_pk_bf16_f32 v122, v152, v153
    v_mfma_f32_16x16x32_bf16 v[224:227], a[180:183], a[100:103], v[224:227]
    buffer_load_dwordx4 v2, s[12:15], s72 offen offset:0  lds
    v_cvt_pk_bf16_f32 v123, v154, v155
    v_mfma_f32_16x16x32_bf16 v[228:231], a[176:179], a[104:107], v[228:231]
    ds_read_b64_tr_b16 a[160:161], v13 offset:0
    v_accvgpr_write_b32 a204, v120
    v_mfma_f32_16x16x32_bf16 v[228:231], a[180:183], a[108:111], v[228:231]
    ds_read_b128 a[80:83], v14 offset:12288
    v_accvgpr_write_b32 a205, v121
    v_mfma_f32_16x16x32_bf16 v[232:235], a[176:179], a[112:115], v[232:235]
    s_waitcnt vmcnt(29)
    ds_read_b64_tr_b16 a[162:163], v13 offset:256
    v_accvgpr_write_b32 a206, v122
    v_mfma_f32_16x16x32_bf16 v[232:235], a[180:183], a[116:119], v[232:235]
    s_add_u32 s76, s76, 1
    buffer_load_dwordx4 v3, s[12:15], s72 offen offset:1024  lds
    v_accvgpr_write_b32 a207, v123
    v_mfma_f32_16x16x32_bf16 v[236:239], a[176:179], a[120:123], v[236:239]
    ds_read_b64_tr_b16 a[164:165], v13 offset:16384
    v_cvt_pk_bf16_f32 v124, v124, v125
    v_mfma_f32_16x16x32_bf16 v[236:239], a[180:183], a[124:127], v[236:239]
    ds_read_b128 a[84:87], v15 offset:12288
    v_cvt_pk_bf16_f32 v125, v126, v127
    v_mfma_f32_16x16x32_bf16 v[240:243], a[176:179], a[128:131], v[240:243]
    ds_read_b64_tr_b16 a[166:167], v13 offset:16640
    v_cvt_pk_bf16_f32 v126, v156, v157
    v_mfma_f32_16x16x32_bf16 v[240:243], a[180:183], a[132:135], v[240:243]
    buffer_load_dwordx4 v2, s[16:19], s72 offen offset:2048  lds
    v_cvt_pk_bf16_f32 v127, v158, v159
    v_mfma_f32_16x16x32_bf16 v[244:247], a[176:179], a[136:139], v[244:247]
    v_accvgpr_write_b32 a220, v124
    v_accvgpr_write_b32 a221, v125
    v_mfma_f32_16x16x32_bf16 v[244:247], a[180:183], a[140:143], v[244:247]
    ds_read_b128 a[88:91], v14 offset:14336
    v_accvgpr_write_b32 a222, v126
    v_mfma_f32_16x16x32_bf16 v[248:251], a[176:179], a[144:147], v[248:251]
    v_accvgpr_write_b32 a223, v127
    v_cvt_pk_bf16_f32 v160, v160, v161
    v_mfma_f32_16x16x32_bf16 v[248:251], a[180:183], a[148:151], v[248:251]
    buffer_load_dwordx4 v3, s[16:19], s72 offen offset:3072  lds
    v_cvt_pk_bf16_f32 v161, v162, v163
    v_mfma_f32_16x16x32_bf16 v[252:255], a[176:179], a[152:155], v[252:255]
    s_add_u32 m0, s67, 49152
    v_cvt_pk_bf16_f32 v162, v192, v193
    v_cvt_pk_bf16_f32 v163, v194, v195
    v_mfma_f32_16x16x32_bf16 v[252:255], a[180:183], a[156:159], v[252:255]
    s_add_u32 s72, s72, 262144
    ds_read_b128 a[92:95], v15 offset:14336
    v_accvgpr_write_b32 a224, v160
    v_mfma_f32_16x16x32_bf16 a[0:3], a[184:187], a[96:99], a[0:3]
    v_accvgpr_write_b32 a225, v161
    v_accvgpr_write_b32 a226, v162
    v_mfma_f32_16x16x32_bf16 a[0:3], a[188:191], a[100:103], a[0:3]
    buffer_load_dwordx4 v2, s[12:15], s72 offen offset:0  lds
    v_accvgpr_write_b32 a227, v163
    v_mfma_f32_16x16x32_bf16 a[4:7], a[184:187], a[104:107], a[4:7]
    ds_read_b64_tr_b16 a[168:169], v8 offset:0
    v_cvt_pk_bf16_f32 v164, v164, v165
    v_mfma_f32_16x16x32_bf16 a[4:7], a[188:191], a[108:111], a[4:7]
    v_cvt_pk_bf16_f32 v165, v166, v167
    v_cvt_pk_bf16_f32 v166, v196, v197
    v_mfma_f32_16x16x32_bf16 a[8:11], a[184:187], a[112:115], a[8:11]
    ds_read_b64_tr_b16 a[170:171], v8 offset:256
    v_cvt_pk_bf16_f32 v167, v198, v199
    v_mfma_f32_16x16x32_bf16 a[8:11], a[188:191], a[116:119], a[8:11]
    buffer_load_dwordx4 v3, s[12:15], s72 offen offset:1024  lds
    v_accvgpr_write_b32 a240, v164
    v_mfma_f32_16x16x32_bf16 a[12:15], a[184:187], a[120:123], a[12:15]
    ds_read_b64_tr_b16 a[172:173], v8 offset:16384
    v_accvgpr_write_b32 a241, v165
    v_mfma_f32_16x16x32_bf16 a[12:15], a[188:191], a[124:127], a[12:15]
    v_accvgpr_write_b32 a242, v166
    v_accvgpr_write_b32 a243, v167
    v_mfma_f32_16x16x32_bf16 a[16:19], a[184:187], a[128:131], a[16:19]
    ds_read_b64_tr_b16 a[174:175], v8 offset:16640
    v_cvt_pk_bf16_f32 v168, v168, v169
    v_mfma_f32_16x16x32_bf16 a[16:19], a[188:191], a[132:135], a[16:19]
    buffer_load_dwordx4 v2, s[16:19], s72 offen offset:2048  lds
    v_cvt_pk_bf16_f32 v169, v170, v171
    v_mfma_f32_16x16x32_bf16 a[20:23], a[184:187], a[136:139], a[20:23]
    v_cvt_pk_bf16_f32 v170, v200, v201
    v_cvt_pk_bf16_f32 v171, v202, v203
    v_mfma_f32_16x16x32_bf16 a[20:23], a[188:191], a[140:143], a[20:23]
    s_waitcnt lgkmcnt(0)
    v_accvgpr_write_b32 a228, v168
    v_accvgpr_write_b32 a229, v169
    v_mfma_f32_16x16x32_bf16 a[24:27], a[184:187], a[144:147], a[24:27]
    s_barrier
    v_accvgpr_write_b32 a230, v170
    v_accvgpr_write_b32 a231, v171
    v_mfma_f32_16x16x32_bf16 a[24:27], a[188:191], a[148:151], a[24:27]
    buffer_load_dwordx4 v3, s[16:19], s72 offen offset:3072  lds
    v_cvt_pk_bf16_f32 v172, v172, v173
    v_mfma_f32_16x16x32_bf16 a[28:31], a[184:187], a[152:155], a[28:31]
    s_add_u32 s72, s72, 262144
    v_cvt_pk_bf16_f32 v173, v174, v175
    v_cvt_pk_bf16_f32 v174, v204, v205
    v_mfma_f32_16x16x32_bf16 a[28:31], a[188:191], a[156:159], a[28:31]
    v_cvt_pk_bf16_f32 v175, v206, v207
    v_accvgpr_write_b32 a244, v172
    v_mfma_f32_16x16x32_bf16 v[32:35], a[160:163], a[32:35], 0
    v_accvgpr_write_b32 a245, v173
    v_accvgpr_write_b32 a246, v174
    v_mfma_f32_16x16x32_bf16 v[32:35], a[164:167], a[36:39], v[32:35]
    v_accvgpr_write_b32 a247, v175
    v_cvt_pk_bf16_f32 v176, v176, v177
    v_mfma_f32_16x16x32_bf16 v[36:39], a[160:163], a[40:43], 0
    ds_read_b64_tr_b16 a[176:177], v13 offset:1024
    v_cvt_pk_bf16_f32 v177, v178, v179
    v_mfma_f32_16x16x32_bf16 v[36:39], a[164:167], a[44:47], v[36:39]
    v_cvt_pk_bf16_f32 v178, v208, v209
    v_cvt_pk_bf16_f32 v179, v210, v211
    v_mfma_f32_16x16x32_bf16 v[40:43], a[160:163], a[48:51], 0
    ds_read_b64_tr_b16 a[178:179], v13 offset:1280
    v_accvgpr_write_b32 a232, v176
    v_mfma_f32_16x16x32_bf16 v[40:43], a[164:167], a[52:55], v[40:43]
    v_accvgpr_write_b32 a233, v177
    v_accvgpr_write_b32 a234, v178
    v_mfma_f32_16x16x32_bf16 v[44:47], a[160:163], a[56:59], 0
    ds_read_b64_tr_b16 a[180:181], v13 offset:17408
    v_accvgpr_write_b32 a235, v179
    v_mfma_f32_16x16x32_bf16 v[44:47], a[164:167], a[60:63], v[44:47]
    v_cvt_pk_bf16_f32 v180, v180, v181
    v_cvt_pk_bf16_f32 v181, v182, v183
    v_mfma_f32_16x16x32_bf16 v[48:51], a[160:163], a[64:67], 0
    ds_read_b64_tr_b16 a[182:183], v13 offset:17664
    v_cvt_pk_bf16_f32 v182, v212, v213
    v_mfma_f32_16x16x32_bf16 v[48:51], a[164:167], a[68:71], v[48:51]
    v_cvt_pk_bf16_f32 v183, v214, v215
    v_accvgpr_write_b32 a248, v180
    v_mfma_f32_16x16x32_bf16 v[52:55], a[160:163], a[72:75], 0
    v_accvgpr_write_b32 a249, v181
    v_accvgpr_write_b32 a250, v182
    v_mfma_f32_16x16x32_bf16 v[52:55], a[164:167], a[76:79], v[52:55]
    v_accvgpr_write_b32 a251, v183
    v_cvt_pk_bf16_f32 v184, v184, v185
    v_mfma_f32_16x16x32_bf16 v[56:59], a[160:163], a[80:83], 0
    v_cvt_pk_bf16_f32 v185, v186, v187
    v_cvt_pk_bf16_f32 v186, v216, v217
    v_mfma_f32_16x16x32_bf16 v[56:59], a[164:167], a[84:87], v[56:59]
    v_cvt_pk_bf16_f32 v187, v218, v219
    v_accvgpr_write_b32 a236, v184
    v_mfma_f32_16x16x32_bf16 v[60:63], a[160:163], a[88:91], 0
    v_accvgpr_write_b32 a237, v185
    v_accvgpr_write_b32 a238, v186
    v_mfma_f32_16x16x32_bf16 v[60:63], a[164:167], a[92:95], v[60:63]
    v_accvgpr_write_b32 a239, v187
    v_cvt_pk_bf16_f32 v188, v188, v189
    v_mfma_f32_16x16x32_bf16 v[64:67], a[168:171], a[32:35], 0
    s_add_u32 m0, s67, 131072
    v_cvt_pk_bf16_f32 v189, v190, v191
    v_cvt_pk_bf16_f32 v190, v220, v221
    v_mfma_f32_16x16x32_bf16 v[64:67], a[172:175], a[36:39], v[64:67]
    buffer_load_dwordx4 v10, s[20:23], s70 offen offset:0 sc1 lds
    v_cvt_pk_bf16_f32 v191, v222, v223
    v_mfma_f32_16x16x32_bf16 v[68:71], a[168:171], a[40:43], 0
    ds_read_b64_tr_b16 a[184:185], v8 offset:1024
    v_accvgpr_write_b32 a252, v188
    v_mfma_f32_16x16x32_bf16 v[68:71], a[172:175], a[44:47], v[68:71]
    v_accvgpr_write_b32 a253, v189
    v_accvgpr_write_b32 a254, v190
    v_mfma_f32_16x16x32_bf16 v[72:75], a[168:171], a[48:51], 0
    ds_read_b64_tr_b16 a[186:187], v8 offset:1280
    v_accvgpr_write_b32 a255, v191
    v_mfma_f32_16x16x32_bf16 v[72:75], a[172:175], a[52:55], v[72:75]
    buffer_load_dwordx4 v10, s[20:23], s70 offen offset:1024 sc1 lds
    v_accvgpr_read_b32 v24, a0
    v_mfma_f32_16x16x32_bf16 v[76:79], a[168:171], a[56:59], 0
    ds_read_b64_tr_b16 a[188:189], v8 offset:17408
    v_accvgpr_read_b32 v25, a1
    v_mfma_f32_16x16x32_bf16 v[76:79], a[172:175], a[60:63], v[76:79]
    v_accvgpr_read_b32 v26, a2
    v_accvgpr_read_b32 v27, a3
    v_mfma_f32_16x16x32_bf16 v[80:83], a[168:171], a[64:67], 0
    ds_read_b64_tr_b16 a[190:191], v8 offset:17664
    v_cvt_pk_bf16_f32 v224, v224, v225
    v_mfma_f32_16x16x32_bf16 v[80:83], a[172:175], a[68:71], v[80:83]
    buffer_load_dwordx4 v10, s[20:23], s70 offen offset:2048 sc1 lds
    v_cvt_pk_bf16_f32 v225, v226, v227
    v_mfma_f32_16x16x32_bf16 v[84:87], a[168:171], a[72:75], 0
    v_cvt_pk_bf16_f32 v226, v24, v25
    v_cvt_pk_bf16_f32 v227, v26, v27
    v_mfma_f32_16x16x32_bf16 v[84:87], a[172:175], a[76:79], v[84:87]
    v_accvgpr_read_b32 v28, a4
    v_accvgpr_read_b32 v29, a5
    v_mfma_f32_16x16x32_bf16 v[88:91], a[168:171], a[80:83], 0
    v_accvgpr_read_b32 v30, a6
    v_accvgpr_read_b32 v31, a7
    v_mfma_f32_16x16x32_bf16 v[88:91], a[172:175], a[84:87], v[88:91]
    buffer_load_dwordx4 v10, s[20:23], s70 offen offset:3072 sc1 lds
    v_cvt_pk_bf16_f32 v228, v228, v229
    v_mfma_f32_16x16x32_bf16 v[92:95], a[168:171], a[88:91], 0
    s_add_u32 m0, s67, 65536
    v_cvt_pk_bf16_f32 v229, v230, v231
    v_cvt_pk_bf16_f32 v230, v28, v29
    v_mfma_f32_16x16x32_bf16 v[92:95], a[172:175], a[92:95], v[92:95]
    s_waitcnt lgkmcnt(6)
    s_waitcnt lgkmcnt(0)
    v_cvt_pk_bf16_f32 v231, v30, v31
    v_mfma_f32_16x16x32_bf16 v[96:99], a[176:179], a[32:35], 0
    s_waitcnt vmcnt(36)
    v_accvgpr_read_b32 v24, a8
    v_accvgpr_read_b32 v25, a9
    v_mfma_f32_16x16x32_bf16 v[96:99], a[180:183], a[36:39], v[96:99]
    buffer_load_dwordx4 v4, s[4:7], s71 offen offset:0  lds
    v_accvgpr_read_b32 v26, a10
    v_mfma_f32_16x16x32_bf16 v[100:103], a[176:179], a[40:43], 0
    ds_read_b64_tr_b16 a[160:161], v16 offset:32768
    v_accvgpr_read_b32 v27, a11
    v_mfma_f32_16x16x32_bf16 v[100:103], a[180:183], a[44:47], v[100:103]
    v_cvt_pk_bf16_f32 v232, v232, v233
    v_cvt_pk_bf16_f32 v233, v234, v235
    v_mfma_f32_16x16x32_bf16 v[104:107], a[176:179], a[48:51], 0
    s_waitcnt vmcnt(33)
    ds_read_b64_tr_b16 a[162:163], v16 offset:33280
    v_cvt_pk_bf16_f32 v234, v24, v25
    v_mfma_f32_16x16x32_bf16 v[104:107], a[180:183], a[52:55], v[104:107]
    buffer_load_dwordx4 v4, s[8:11], s71 offen offset:1024  lds
    v_cvt_pk_bf16_f32 v235, v26, v27
    v_mfma_f32_16x16x32_bf16 v[108:111], a[176:179], a[56:59], 0
    ds_read_b64_tr_b16 a[164:165], v16 offset:49152
    v_accvgpr_read_b32 v28, a12
    v_mfma_f32_16x16x32_bf16 v[108:111], a[180:183], a[60:63], v[108:111]
    v_accvgpr_read_b32 v29, a13
    v_accvgpr_read_b32 v30, a14
    v_mfma_f32_16x16x32_bf16 v[112:115], a[176:179], a[64:67], 0
    ds_read_b64_tr_b16 a[166:167], v16 offset:49664
    v_accvgpr_read_b32 v31, a15
    v_mfma_f32_16x16x32_bf16 v[112:115], a[180:183], a[68:71], v[112:115]
    buffer_load_dwordx4 v5, s[4:7], s71 offen offset:2048  lds
    v_cvt_pk_bf16_f32 v236, v236, v237
    v_mfma_f32_16x16x32_bf16 v[116:119], a[176:179], a[72:75], 0
    buffer_store_dwordx4 v[224:227], v20, s[24:27], s78 offen offset:3072 sc1
    v_cvt_pk_bf16_f32 v237, v238, v239
    v_mfma_f32_16x16x32_bf16 v[116:119], a[180:183], a[76:79], v[116:119]
    v_cvt_pk_bf16_f32 v238, v28, v29
    v_cvt_pk_bf16_f32 v239, v30, v31
    v_mfma_f32_16x16x32_bf16 v[120:123], a[176:179], a[80:83], 0
    v_accvgpr_read_b32 v24, a16
    v_accvgpr_read_b32 v25, a17
    v_mfma_f32_16x16x32_bf16 v[120:123], a[180:183], a[84:87], v[120:123]
    buffer_load_dwordx4 v5, s[8:11], s71 offen offset:3072  lds
    v_accvgpr_read_b32 v26, a18
    v_mfma_f32_16x16x32_bf16 v[124:127], a[176:179], a[88:91], 0
    s_add_u32 m0, s67, 81920
    v_accvgpr_read_b32 v27, a19
    v_cvt_pk_bf16_f32 v240, v240, v241
    v_mfma_f32_16x16x32_bf16 v[124:127], a[180:183], a[92:95], v[124:127]
    s_add_u32 s71, s71, 114688
    v_cvt_pk_bf16_f32 v241, v242, v243
    v_cvt_pk_bf16_f32 v242, v24, v25
    v_mfma_f32_16x16x32_bf16 v[128:131], a[184:187], a[32:35], 0
    buffer_store_dwordx4 v[228:231], v20, s[24:27], s82 offen offset:3072 sc1
    v_cvt_pk_bf16_f32 v243, v26, v27
    v_mfma_f32_16x16x32_bf16 v[128:131], a[188:191], a[36:39], v[128:131]
    buffer_load_dwordx4 v4, s[4:7], s71 offen offset:0  lds
    v_accvgpr_read_b32 v28, a20
    v_mfma_f32_16x16x32_bf16 v[132:135], a[184:187], a[40:43], 0
    ds_read_b64_tr_b16 a[168:169], v17 offset:32768
    v_accvgpr_read_b32 v29, a21
    v_mfma_f32_16x16x32_bf16 v[132:135], a[188:191], a[44:47], v[132:135]
    v_accvgpr_read_b32 v30, a22
    v_accvgpr_read_b32 v31, a23
    v_mfma_f32_16x16x32_bf16 v[136:139], a[184:187], a[48:51], 0
    ds_read_b64_tr_b16 a[170:171], v17 offset:33280
    v_cvt_pk_bf16_f32 v244, v244, v245
    v_mfma_f32_16x16x32_bf16 v[136:139], a[188:191], a[52:55], v[136:139]
    buffer_load_dwordx4 v4, s[8:11], s71 offen offset:1024  lds
    v_cvt_pk_bf16_f32 v245, v246, v247
    v_mfma_f32_16x16x32_bf16 v[140:143], a[184:187], a[56:59], 0
    buffer_store_dwordx4 v[232:235], v20, s[24:27], s79 offen offset:3072 sc1
    ds_read_b64_tr_b16 a[172:173], v17 offset:49152
    v_mfma_f32_16x16x32_bf16 v[140:143], a[188:191], a[60:63], v[140:143]
    v_cvt_pk_bf16_f32 v246, v28, v29
    v_cvt_pk_bf16_f32 v247, v30, v31
    v_mfma_f32_16x16x32_bf16 v[144:147], a[184:187], a[64:67], 0
    ds_read_b64_tr_b16 a[174:175], v17 offset:49664
    v_accvgpr_read_b32 v24, a24
    v_mfma_f32_16x16x32_bf16 v[144:147], a[188:191], a[68:71], v[144:147]
    buffer_load_dwordx4 v5, s[4:7], s71 offen offset:2048  lds
    v_accvgpr_read_b32 v25, a25
    v_mfma_f32_16x16x32_bf16 v[148:151], a[184:187], a[72:75], 0
    s_waitcnt vmcnt(38)
    v_accvgpr_read_b32 v26, a26
    v_accvgpr_read_b32 v27, a27
    v_mfma_f32_16x16x32_bf16 v[148:151], a[188:191], a[76:79], v[148:151]
    s_barrier
    v_cvt_pk_bf16_f32 v248, v248, v249
    v_cvt_pk_bf16_f32 v249, v250, v251
    v_mfma_f32_16x16x32_bf16 v[152:155], a[184:187], a[80:83], 0
    v_cvt_pk_bf16_f32 v250, v24, v25
    v_cvt_pk_bf16_f32 v251, v26, v27
    v_mfma_f32_16x16x32_bf16 v[152:155], a[188:191], a[84:87], v[152:155]
    buffer_load_dwordx4 v5, s[8:11], s71 offen offset:3072  lds
    ds_read_b128 a[96:99], v14 offset:16384
    v_mfma_f32_16x16x32_bf16 v[156:159], a[184:187], a[88:91], 0
    s_add_u32 s71, s71, 114688
    v_accvgpr_read_b32 v28, a28
    v_accvgpr_read_b32 v29, a29
    v_mfma_f32_16x16x32_bf16 v[156:159], a[188:191], a[92:95], v[156:159]
    s_waitcnt lgkmcnt(7)
    ds_read_b128 a[100:103], v15 offset:16384
    v_accvgpr_read_b32 v30, a30
    v_mfma_f32_16x16x32_bf16 v[160:163], a[160:163], a[32:35], 0
    s_waitcnt lgkmcnt(6)
    v_accvgpr_read_b32 v31, a31
    v_cvt_pk_bf16_f32 v252, v252, v253
    v_mfma_f32_16x16x32_bf16 v[160:163], a[164:167], a[36:39], v[160:163]
    ds_read_b128 a[104:107], v14 offset:18432
    v_cvt_pk_bf16_f32 v253, v254, v255
    v_mfma_f32_16x16x32_bf16 v[164:167], a[160:163], a[40:43], 0
    buffer_store_dwordx4 v[236:239], v20, s[24:27], s83 offen offset:3072 sc1
    ds_read_b64_tr_b16 a[176:177], v18 offset:32768
    v_mfma_f32_16x16x32_bf16 v[164:167], a[164:167], a[44:47], v[164:167]
    ds_read_b128 a[108:111], v15 offset:18432
    v_cvt_pk_bf16_f32 v254, v28, v29
    v_mfma_f32_16x16x32_bf16 v[168:171], a[160:163], a[48:51], 0
    ds_read_b64_tr_b16 a[178:179], v18 offset:33280
    v_cvt_pk_bf16_f32 v255, v30, v31
    v_mfma_f32_16x16x32_bf16 v[168:171], a[164:167], a[52:55], v[168:171]
    ds_read_b128 a[112:115], v14 offset:20480
    v_mfma_f32_16x16x32_bf16 v[172:175], a[160:163], a[56:59], 0
    ds_read_b64_tr_b16 a[180:181], v18 offset:49152
    v_mfma_f32_16x16x32_bf16 v[172:175], a[164:167], a[60:63], v[172:175]
    ds_read_b128 a[116:119], v15 offset:20480
    v_mfma_f32_16x16x32_bf16 v[176:179], a[160:163], a[64:67], 0
    ds_read_b64_tr_b16 a[182:183], v18 offset:49664
    v_mfma_f32_16x16x32_bf16 v[176:179], a[164:167], a[68:71], v[176:179]
    ds_read_b128 a[120:123], v14 offset:22528
    v_mfma_f32_16x16x32_bf16 v[180:183], a[160:163], a[72:75], 0
    v_mfma_f32_16x16x32_bf16 v[180:183], a[164:167], a[76:79], v[180:183]
    ds_read_b128 a[124:127], v15 offset:22528
    v_mfma_f32_16x16x32_bf16 v[184:187], a[160:163], a[80:83], 0
    v_mfma_f32_16x16x32_bf16 v[184:187], a[164:167], a[84:87], v[184:187]
    ds_read_b128 a[128:131], v14 offset:24576
    v_mfma_f32_16x16x32_bf16 v[188:191], a[160:163], a[88:91], 0
    buffer_store_dwordx4 v[240:243], v20, s[24:27], s80 offen offset:3072 sc1
    v_mfma_f32_16x16x32_bf16 v[188:191], a[164:167], a[92:95], v[188:191]
    s_waitcnt lgkmcnt(15)
    ds_read_b128 a[132:135], v15 offset:24576
    v_mfma_f32_16x16x32_bf16 v[192:195], a[168:171], a[32:35], 0
    s_waitcnt lgkmcnt(14)
    s_add_u32 s70, s70, 16384
    v_mfma_f32_16x16x32_bf16 v[192:195], a[172:175], a[36:39], v[192:195]
    ds_read_b128 a[136:139], v14 offset:26624
    v_mfma_f32_16x16x32_bf16 v[196:199], a[168:171], a[40:43], 0
    ds_read_b64_tr_b16 a[184:185], v19 offset:32768
    v_mfma_f32_16x16x32_bf16 v[196:199], a[172:175], a[44:47], v[196:199]
    ds_read_b128 a[140:143], v15 offset:26624
    v_mfma_f32_16x16x32_bf16 v[200:203], a[168:171], a[48:51], 0
    buffer_store_dwordx4 v[244:247], v20, s[24:27], s84 offen offset:3072 sc1
    ds_read_b64_tr_b16 a[186:187], v19 offset:33280
    v_mfma_f32_16x16x32_bf16 v[200:203], a[172:175], a[52:55], v[200:203]
    v_mfma_f32_16x16x32_bf16 v[204:207], a[168:171], a[56:59], 0
    ds_read_b64_tr_b16 a[188:189], v19 offset:49152
    v_mfma_f32_16x16x32_bf16 v[204:207], a[172:175], a[60:63], v[204:207]
    v_mfma_f32_16x16x32_bf16 v[208:211], a[168:171], a[64:67], 0
    ds_read_b64_tr_b16 a[190:191], v19 offset:49664
    v_mfma_f32_16x16x32_bf16 v[208:211], a[172:175], a[68:71], v[208:211]
    v_xor_b32 v16, 0x10000, v16
    v_mfma_f32_16x16x32_bf16 v[212:215], a[168:171], a[72:75], 0
    buffer_store_dwordx4 v[248:251], v20, s[24:27], s81 offen offset:3072 sc1
    v_mfma_f32_16x16x32_bf16 v[212:215], a[172:175], a[76:79], v[212:215]
    v_xor_b32 v17, 0x10000, v17
    v_mfma_f32_16x16x32_bf16 v[216:219], a[168:171], a[80:83], 0
    v_xor_b32 v18, 0x10000, v18
    v_mfma_f32_16x16x32_bf16 v[216:219], a[172:175], a[84:87], v[216:219]
    v_xor_b32 v19, 0x10000, v19
    v_mfma_f32_16x16x32_bf16 v[220:223], a[168:171], a[88:91], 0
    s_add_u32 m0, s67, 98304
    buffer_store_dwordx4 v[252:255], v20, s[24:27], s85 offen offset:3072 sc1
    v_mfma_f32_16x16x32_bf16 v[220:223], a[172:175], a[92:95], v[220:223]
    s_waitcnt lgkmcnt(14)
    s_waitcnt lgkmcnt(0)
    v_mfma_f32_16x16x32_bf16 v[224:227], a[176:179], a[32:35], 0
    s_waitcnt vmcnt(39)
    v_mfma_f32_16x16x32_bf16 v[224:227], a[180:183], a[36:39], v[224:227]
    buffer_load_dwordx4 v2, s[12:15], s72 offen offset:0  lds
    v_mfma_f32_16x16x32_bf16 v[228:231], a[176:179], a[40:43], 0
    ds_read_b64_tr_b16 a[160:161], v11 offset:0
    v_mfma_f32_16x16x32_bf16 v[228:231], a[180:183], a[44:47], v[228:231]
    ds_read_b128 a[144:147], v14 offset:28672
    v_mfma_f32_16x16x32_bf16 v[232:235], a[176:179], a[48:51], 0
    s_waitcnt vmcnt(34)
    ds_read_b64_tr_b16 a[162:163], v11 offset:256
    v_mfma_f32_16x16x32_bf16 v[232:235], a[180:183], a[52:55], v[232:235]
    s_add_u32 s76, s76, 1
    buffer_load_dwordx4 v3, s[12:15], s72 offen offset:1024  lds
    v_mfma_f32_16x16x32_bf16 v[236:239], a[176:179], a[56:59], 0
    ds_read_b64_tr_b16 a[164:165], v11 offset:16384
    v_mfma_f32_16x16x32_bf16 v[236:239], a[180:183], a[60:63], v[236:239]
    ds_read_b128 a[148:151], v15 offset:28672
    v_mfma_f32_16x16x32_bf16 v[240:243], a[176:179], a[64:67], 0
    ds_read_b64_tr_b16 a[166:167], v11 offset:16640
    v_mfma_f32_16x16x32_bf16 v[240:243], a[180:183], a[68:71], v[240:243]
    buffer_load_dwordx4 v2, s[16:19], s72 offen offset:2048  lds
    v_mfma_f32_16x16x32_bf16 v[244:247], a[176:179], a[72:75], 0
    v_mfma_f32_16x16x32_bf16 v[244:247], a[180:183], a[76:79], v[244:247]
    ds_read_b128 a[152:155], v14 offset:30720
    v_mfma_f32_16x16x32_bf16 v[248:251], a[176:179], a[80:83], 0
    v_mfma_f32_16x16x32_bf16 v[248:251], a[180:183], a[84:87], v[248:251]
    buffer_load_dwordx4 v3, s[16:19], s72 offen offset:3072  lds
    v_mfma_f32_16x16x32_bf16 v[252:255], a[176:179], a[88:91], 0
    s_add_u32 m0, s67, 114688
    v_mfma_f32_16x16x32_bf16 v[252:255], a[180:183], a[92:95], v[252:255]
    s_add_u32 s72, s72, 262144
    ds_read_b128 a[156:159], v15 offset:30720
    v_mfma_f32_16x16x32_bf16 a[0:3], a[184:187], a[32:35], 0
    v_mfma_f32_16x16x32_bf16 a[0:3], a[188:191], a[36:39], a[0:3]
    buffer_load_dwordx4 v2, s[12:15], s72 offen offset:0  lds
    v_mfma_f32_16x16x32_bf16 a[4:7], a[184:187], a[40:43], 0
    ds_read_b64_tr_b16 a[168:169], v12 offset:0
    v_mfma_f32_16x16x32_bf16 a[4:7], a[188:191], a[44:47], a[4:7]
    v_mfma_f32_16x16x32_bf16 a[8:11], a[184:187], a[48:51], 0
    ds_read_b64_tr_b16 a[170:171], v12 offset:256
    v_mfma_f32_16x16x32_bf16 a[8:11], a[188:191], a[52:55], a[8:11]
    buffer_load_dwordx4 v3, s[12:15], s72 offen offset:1024  lds
    v_mfma_f32_16x16x32_bf16 a[12:15], a[184:187], a[56:59], 0
    ds_read_b64_tr_b16 a[172:173], v12 offset:16384
    v_mfma_f32_16x16x32_bf16 a[12:15], a[188:191], a[60:63], a[12:15]
    v_mfma_f32_16x16x32_bf16 a[16:19], a[184:187], a[64:67], 0
    ds_read_b64_tr_b16 a[174:175], v12 offset:16640
    v_mfma_f32_16x16x32_bf16 a[16:19], a[188:191], a[68:71], a[16:19]
    buffer_load_dwordx4 v2, s[16:19], s72 offen offset:2048  lds
    v_mfma_f32_16x16x32_bf16 a[20:23], a[184:187], a[72:75], 0
    v_mfma_f32_16x16x32_bf16 a[20:23], a[188:191], a[76:79], a[20:23]
    s_waitcnt lgkmcnt(0)
    v_mfma_f32_16x16x32_bf16 a[24:27], a[184:187], a[80:83], 0
    s_barrier
    v_mfma_f32_16x16x32_bf16 a[24:27], a[188:191], a[84:87], a[24:27]
    buffer_load_dwordx4 v3, s[16:19], s72 offen offset:3072  lds
    v_mfma_f32_16x16x32_bf16 a[28:31], a[184:187], a[88:91], 0
    s_add_u32 s72, s72, 262144
    v_mfma_f32_16x16x32_bf16 a[28:31], a[188:191], a[92:95], a[28:31]
fz_endN:
fz_T2:
    v_mfma_f32_16x16x32_bf16 v[32:35], a[160:163], a[96:99], v[32:35]
    v_mfma_f32_16x16x32_bf16 v[32:35], a[164:167], a[100:103], v[32:35]
    v_mfma_f32_16x16x32_bf16 v[36:39], a[160:163], a[104:107], v[36:39]
    ds_read_b64_tr_b16 a[176:177], v11 offset:1024
    v_mfma_f32_16x16x32_bf16 v[36:39], a[164:167], a[108:111], v[36:39]
    v_mfma_f32_16x16x32_bf16 v[40:43], a[160:163], a[112:115], v[40:43]
    ds_read_b64_tr_b16 a[178:179], v11 offset:1280
    v_mfma_f32_16x16x32_bf16 v[40:43], a[164:167], a[116:119], v[40:43]
    v_mfma_f32_16x16x32_bf16 v[44:47], a[160:163], a[120:123], v[44:47]
    ds_read_b64_tr_b16 a[180:181], v11 offset:17408
    v_mfma_f32_16x16x32_bf16 v[44:47], a[164:167], a[124:127], v[44:47]
    v_mfma_f32_16x16x32_bf16 v[48:51], a[160:163], a[128:131], v[48:51]
    ds_read_b64_tr_b16 a[182:183], v11 offset:17664
    v_mfma_f32_16x16x32_bf16 v[48:51], a[164:167], a[132:135], v[48:51]
    v_mfma_f32_16x16x32_bf16 v[52:55], a[160:163], a[136:139], v[52:55]
    v_mfma_f32_16x16x32_bf16 v[52:55], a[164:167], a[140:143], v[52:55]
    v_mfma_f32_16x16x32_bf16 v[56:59], a[160:163], a[144:147], v[56:59]
    v_mfma_f32_16x16x32_bf16 v[56:59], a[164:167], a[148:151], v[56:59]
    v_mfma_f32_16x16x32_bf16 v[60:63], a[160:163], a[152:155], v[60:63]
    v_mfma_f32_16x16x32_bf16 v[60:63], a[164:167], a[156:159], v[60:63]
    v_mfma_f32_16x16x32_bf16 v[64:67], a[168:171], a[96:99], v[64:67]
    s_add_u32 m0, s67, 147456
    v_mfma_f32_16x16x32_bf16 v[64:67], a[172:175], a[100:103], v[64:67]
    buffer_load_dwordx4 v10, s[20:23], s70 offen offset:0 sc1 lds
    v_mfma_f32_16x16x32_bf16 v[68:71], a[168:171], a[104:107], v[68:71]
    ds_read_b64_tr_b16 a[184:185], v12 offset:1024
    v_mfma_f32_16x16x32_bf16 v[68:71], a[172:175], a[108:111], v[68:71]
    v_mfma_f32_16x16x32_bf16 v[72:75], a[168:171], a[112:115], v[72:75]
    ds_read_b64_tr_b16 a[186:187], v12 offset:1280
    v_mfma_f32_16x16x32_bf16 v[72:75], a[172:175], a[116:119], v[72:75]
    buffer_load_dwordx4 v10, s[20:23], s70 offen offset:1024 sc1 lds
    v_mfma_f32_16x16x32_bf16 v[76:79], a[168:171], a[120:123], v[76:79]
    ds_read_b64_tr_b16 a[188:189], v12 offset:17408
    v_mfma_f32_16x16x32_bf16 v[76:79], a[172:175], a[124:127], v[76:79]
    v_mfma_f32_16x16x32_bf16 v[80:83], a[168:171], a[128:131], v[80:83]
    ds_read_b64_tr_b16 a[190:191], v12 offset:17664
    v_mfma_f32_16x16x32_bf16 v[80:83], a[172:175], a[132:135], v[80:83]
    buffer_load_dwordx4 v10, s[20:23], s70 offen offset:2048 sc1 lds
    v_mfma_f32_16x16x32_bf16 v[84:87], a[168:171], a[136:139], v[84:87]
    v_mfma_f32_16x16x32_bf16 v[84:87], a[172:175], a[140:143], v[84:87]
    buffer_store_dwordx4 a[192:195], v20, s[24:27], s78 offen offset:1024 sc1
    v_mfma_f32_16x16x32_bf16 v[88:91], a[168:171], a[144:147], v[88:91]
    v_mfma_f32_16x16x32_bf16 v[88:91], a[172:175], a[148:151], v[88:91]
    buffer_load_dwordx4 v10, s[20:23], s70 offen offset:3072 sc1 lds
    v_mfma_f32_16x16x32_bf16 v[92:95], a[168:171], a[152:155], v[92:95]
    s_add_u32 m0, s67, 0
    v_mfma_f32_16x16x32_bf16 v[92:95], a[172:175], a[156:159], v[92:95]
    s_waitcnt lgkmcnt(6)
    s_waitcnt lgkmcnt(0)
    v_mfma_f32_16x16x32_bf16 v[96:99], a[176:179], a[96:99], v[96:99]
    s_waitcnt vmcnt(37)
    v_mfma_f32_16x16x32_bf16 v[96:99], a[180:183], a[100:103], v[96:99]
    buffer_load_dwordx4 v4, s[4:7], s71 offen offset:0  lds
    v_mfma_f32_16x16x32_bf16 v[100:103], a[176:179], a[104:107], v[100:103]
    ds_read_b64_tr_b16 a[160:161], v16 offset:32768
    v_mfma_f32_16x16x32_bf16 v[100:103], a[180:183], a[108:111], v[100:103]
    v_mfma_f32_16x16x32_bf16 v[104:107], a[176:179], a[112:115], v[104:107]
    s_waitcnt vmcnt(34)
    ds_read_b64_tr_b16 a[162:163], v16 offset:33280
    v_mfma_f32_16x16x32_bf16 v[104:107], a[180:183], a[116:119], v[104:107]
    buffer_load_dwordx4 v4, s[8:11], s71 offen offset:1024  lds
    v_mfma_f32_16x16x32_bf16 v[108:111], a[176:179], a[120:123], v[108:111]
    ds_read_b64_tr_b16 a[164:165], v16 offset:49152
    v_mfma_f32_16x16x32_bf16 v[108:111], a[180:183], a[124:127], v[108:111]
    v_mfma_f32_16x16x32_bf16 v[112:115], a[176:179], a[128:131], v[112:115]
    ds_read_b64_tr_b16 a[166:167], v16 offset:49664
    v_mfma_f32_16x16x32_bf16 v[112:115], a[180:183], a[132:135], v[112:115]
    buffer_load_dwordx4 v5, s[4:7], s71 offen offset:2048  lds
    v_mfma_f32_16x16x32_bf16 v[116:119], a[176:179], a[136:139], v[116:119]
    v_mfma_f32_16x16x32_bf16 v[116:119], a[180:183], a[140:143], v[116:119]
    v_mfma_f32_16x16x32_bf16 v[120:123], a[176:179], a[144:147], v[120:123]
    v_mfma_f32_16x16x32_bf16 v[120:123], a[180:183], a[148:151], v[120:123]
    buffer_load_dwordx4 v5, s[8:11], s71 offen offset:3072  lds
    v_mfma_f32_16x16x32_bf16 v[124:127], a[176:179], a[152:155], v[124:127]
    s_add_u32 m0, s67, 16384
    v_mfma_f32_16x16x32_bf16 v[124:127], a[180:183], a[156:159], v[124:127]
    s_add_u32 s71, s71, 114688
    v_mfma_f32_16x16x32_bf16 v[128:131], a[184:187], a[96:99], v[128:131]
    v_mfma_f32_16x16x32_bf16 v[128:131], a[188:191], a[100:103], v[128:131]
    buffer_load_dwordx4 v4, s[4:7], s71 offen offset:0  lds
    v_mfma_f32_16x16x32_bf16 v[132:135], a[184:187], a[104:107], v[132:135]
    ds_read_b64_tr_b16 a[168:169], v17 offset:32768
    v_mfma_f32_16x16x32_bf16 v[132:135], a[188:191], a[108:111], v[132:135]
    v_mfma_f32_16x16x32_bf16 v[136:139], a[184:187], a[112:115], v[136:139]
    ds_read_b64_tr_b16 a[170:171], v17 offset:33280
    v_mfma_f32_16x16x32_bf16 v[136:139], a[188:191], a[116:119], v[136:139]
    buffer_load_dwordx4 v4, s[8:11], s71 offen offset:1024  lds
    v_mfma_f32_16x16x32_bf16 v[140:143], a[184:187], a[120:123], v[140:143]
    ds_read_b64_tr_b16 a[172:173], v17 offset:49152
    v_mfma_f32_16x16x32_bf16 v[140:143], a[188:191], a[124:127], v[140:143]
    v_mfma_f32_16x16x32_bf16 v[144:147], a[184:187], a[128:131], v[144:147]
    ds_read_b64_tr_b16 a[174:175], v17 offset:49664
    v_mfma_f32_16x16x32_bf16 v[144:147], a[188:191], a[132:135], v[144:147]
    buffer_load_dwordx4 v5, s[4:7], s71 offen offset:2048  lds
    v_mfma_f32_16x16x32_bf16 v[148:151], a[184:187], a[136:139], v[148:151]
    s_waitcnt vmcnt(36)
    v_mfma_f32_16x16x32_bf16 v[148:151], a[188:191], a[140:143], v[148:151]
    s_barrier
    v_mfma_f32_16x16x32_bf16 v[152:155], a[184:187], a[144:147], v[152:155]
    v_mfma_f32_16x16x32_bf16 v[152:155], a[188:191], a[148:151], v[152:155]
    buffer_load_dwordx4 v5, s[8:11], s71 offen offset:3072  lds
    ds_read_b128 a[32:35], v14 offset:0
    v_mfma_f32_16x16x32_bf16 v[156:159], a[184:187], a[152:155], v[156:159]
    s_add_u32 s71, s71, 114688
    v_mfma_f32_16x16x32_bf16 v[156:159], a[188:191], a[156:159], v[156:159]
    s_waitcnt lgkmcnt(7)
    ds_read_b128 a[36:39], v15 offset:0
    v_mfma_f32_16x16x32_bf16 v[160:163], a[160:163], a[96:99], v[160:163]
    s_waitcnt lgkmcnt(6)
    v_mfma_f32_16x16x32_bf16 v[160:163], a[164:167], a[100:103], v[160:163]
    ds_read_b128 a[40:43], v14 offset:2048
    v_mfma_f32_16x16x32_bf16 v[164:167], a[160:163], a[104:107], v[164:167]
    ds_read_b64_tr_b16 a[176:177], v18 offset:32768
    v_mfma_f32_16x16x32_bf16 v[164:167], a[164:167], a[108:111], v[164:167]
    ds_read_b128 a[44:47], v15 offset:2048
    v_mfma_f32_16x16x32_bf16 v[168:171], a[160:163], a[112:115], v[168:171]
    ds_read_b64_tr_b16 a[178:179], v18 offset:33280
    v_mfma_f32_16x16x32_bf16 v[168:171], a[164:167], a[116:119], v[168:171]
    ds_read_b128 a[48:51], v14 offset:4096
    v_mfma_f32_16x16x32_bf16 v[172:175], a[160:163], a[120:123], v[172:175]
    ds_read_b64_tr_b16 a[180:181], v18 offset:49152
    v_mfma_f32_16x16x32_bf16 v[172:175], a[164:167], a[124:127], v[172:175]
    ds_read_b128 a[52:55], v15 offset:4096
    v_mfma_f32_16x16x32_bf16 v[176:179], a[160:163], a[128:131], v[176:179]
    ds_read_b64_tr_b16 a[182:183], v18 offset:49664
    v_mfma_f32_16x16x32_bf16 v[176:179], a[164:167], a[132:135], v[176:179]
    ds_read_b128 a[56:59], v14 offset:6144
    v_mfma_f32_16x16x32_bf16 v[180:183], a[160:163], a[136:139], v[180:183]
    v_mfma_f32_16x16x32_bf16 v[180:183], a[164:167], a[140:143], v[180:183]
    ds_read_b128 a[60:63], v15 offset:6144
    v_mfma_f32_16x16x32_bf16 v[184:187], a[160:163], a[144:147], v[184:187]
    v_mfma_f32_16x16x32_bf16 v[184:187], a[164:167], a[148:151], v[184:187]
    ds_read_b128 a[64:67], v14 offset:8192
    v_mfma_f32_16x16x32_bf16 v[188:191], a[160:163], a[152:155], v[188:191]
    v_mfma_f32_16x16x32_bf16 v[188:191], a[164:167], a[156:159], v[188:191]
    s_waitcnt lgkmcnt(15)
    ds_read_b128 a[68:71], v15 offset:8192
    v_mfma_f32_16x16x32_bf16 v[192:195], a[168:171], a[96:99], v[192:195]
    s_waitcnt lgkmcnt(14)
    s_add_u32 s70, s70, 16384
    v_mfma_f32_16x16x32_bf16 v[192:195], a[172:175], a[100:103], v[192:195]
    buffer_store_dwordx4 a[208:211], v20, s[24:27], s82 offen offset:1024 sc1
    ds_read_b128 a[72:75], v14 offset:10240
    v_mfma_f32_16x16x32_bf16 v[196:199], a[168:171], a[104:107], v[196:199]
    ds_read_b64_tr_b16 a[184:185], v19 offset:32768
    v_mfma_f32_16x16x32_bf16 v[196:199], a[172:175], a[108:111], v[196:199]
    ds_read_b128 a[76:79], v15 offset:10240
    v_mfma_f32_16x16x32_bf16 v[200:203], a[168:171], a[112:115], v[200:203]
    ds_read_b64_tr_b16 a[186:187], v19 offset:33280
    v_mfma_f32_16x16x32_bf16 v[200:203], a[172:175], a[116:119], v[200:203]
    v_mfma_f32_16x16x32_bf16 v[204:207], a[168:171], a[120:123], v[204:207]
    ds_read_b64_tr_b16 a[188:189], v19 offset:49152
    v_mfma_f32_16x16x32_bf16 v[204:207], a[172:175], a[124:127], v[204:207]
    buffer_store_dwordx4 a[196:199], v20, s[24:27], s79 offen offset:1024 sc1
    v_mfma_f32_16x16x32_bf16 v[208:211], a[168:171], a[128:131], v[208:211]
    ds_read_b64_tr_b16 a[190:191], v19 offset:49664
    v_mfma_f32_16x16x32_bf16 v[208:211], a[172:175], a[132:135], v[208:211]
    v_xor_b32 v16, 0x10000, v16
    v_mfma_f32_16x16x32_bf16 v[212:215], a[168:171], a[136:139], v[212:215]
    v_mfma_f32_16x16x32_bf16 v[212:215], a[172:175], a[140:143], v[212:215]
    v_xor_b32 v17, 0x10000, v17
    v_mfma_f32_16x16x32_bf16 v[216:219], a[168:171], a[144:147], v[216:219]
    v_xor_b32 v18, 0x10000, v18
    v_mfma_f32_16x16x32_bf16 v[216:219], a[172:175], a[148:151], v[216:219]
    buffer_store_dwordx4 a[212:215], v20, s[24:27], s83 offen offset:1024 sc1
    v_xor_b32 v19, 0x10000, v19
    v_mfma_f32_16x16x32_bf16 v[220:223], a[168:171], a[152:155], v[220:223]
    s_add_u32 m0, s67, 32768
    v_mfma_f32_16x16x32_bf16 v[220:223], a[172:175], a[156:159], v[220:223]
    s_waitcnt lgkmcnt(14)
    s_waitcnt lgkmcnt(0)
    v_mfma_f32_16x16x32_bf16 v[224:227], a[176:179], a[96:99], v[224:227]
    s_waitcnt vmcnt(35)
    v_mfma_f32_16x16x32_bf16 v[224:227], a[180:183], a[100:103], v[224:227]
    buffer_load_dwordx4 v2, s[12:15], s72 offen offset:0  lds
    v_mfma_f32_16x16x32_bf16 v[228:231], a[176:179], a[104:107], v[228:231]
    ds_read_b64_tr_b16 a[160:161], v13 offset:0
    v_mfma_f32_16x16x32_bf16 v[228:231], a[180:183], a[108:111], v[228:231]
    ds_read_b128 a[80:83], v14 offset:12288
    v_mfma_f32_16x16x32_bf16 v[232:235], a[176:179], a[112:115], v[232:235]
    s_waitcnt vmcnt(30)
    ds_read_b64_tr_b16 a[162:163], v13 offset:256
    v_mfma_f32_16x16x32_bf16 v[232:235], a[180:183], a[116:119], v[232:235]
    s_add_u32 s76, s76, 1
    buffer_load_dwordx4 v3, s[12:15], s72 offen offset:1024  lds
    v_mfma_f32_16x16x32_bf16 v[236:239], a[176:179], a[120:123], v[236:239]
    ds_read_b64_tr_b16 a[164:165], v13 offset:16384
    v_mfma_f32_16x16x32_bf16 v[236:239], a[180:183], a[124:127], v[236:239]
    ds_read_b128 a[84:87], v15 offset:12288
    v_mfma_f32_16x16x32_bf16 v[240:243], a[176:179], a[128:131], v[240:243]
    ds_read_b64_tr_b16 a[166:167], v13 offset:16640
    v_mfma_f32_16x16x32_bf16 v[240:243], a[180:183], a[132:135], v[240:243]
    buffer_load_dwordx4 v2, s[16:19], s72 offen offset:2048  lds
    v_mfma_f32_16x16x32_bf16 v[244:247], a[176:179], a[136:139], v[244:247]
    v_mfma_f32_16x16x32_bf16 v[244:247], a[180:183], a[140:143], v[244:247]
    ds_read_b128 a[88:91], v14 offset:14336
    v_mfma_f32_16x16x32_bf16 v[248:251], a[176:179], a[144:147], v[248:251]
    v_mfma_f32_16x16x32_bf16 v[248:251], a[180:183], a[148:151], v[248:251]
    buffer_load_dwordx4 v3, s[16:19], s72 offen offset:3072  lds
    v_mfma_f32_16x16x32_bf16 v[252:255], a[176:179], a[152:155], v[252:255]
    s_add_u32 m0, s67, 49152
    v_mfma_f32_16x16x32_bf16 v[252:255], a[180:183], a[156:159], v[252:255]
    s_add_u32 s72, s72, 262144
    ds_read_b128 a[92:95], v15 offset:14336
    v_mfma_f32_16x16x32_bf16 a[0:3], a[184:187], a[96:99], a[0:3]
    v_mfma_f32_16x16x32_bf16 a[0:3], a[188:191], a[100:103], a[0:3]
    buffer_load_dwordx4 v2, s[12:15], s72 offen offset:0  lds
    v_mfma_f32_16x16x32_bf16 a[4:7], a[184:187], a[104:107], a[4:7]
    ds_read_b64_tr_b16 a[168:169], v8 offset:0
    v_mfma_f32_16x16x32_bf16 a[4:7], a[188:191], a[108:111], a[4:7]
    v_mfma_f32_16x16x32_bf16 a[8:11], a[184:187], a[112:115], a[8:11]
    ds_read_b64_tr_b16 a[170:171], v8 offset:256
    v_mfma_f32_16x16x32_bf16 a[8:11], a[188:191], a[116:119], a[8:11]
    buffer_load_dwordx4 v3, s[12:15], s72 offen offset:1024  lds
    v_mfma_f32_16x16x32_bf16 a[12:15], a[184:187], a[120:123], a[12:15]
    ds_read_b64_tr_b16 a[172:173], v8 offset:16384
    v_mfma_f32_16x16x32_bf16 a[12:15], a[188:191], a[124:127], a[12:15]
    v_mfma_f32_16x16x32_bf16 a[16:19], a[184:187], a[128:131], a[16:19]
    ds_read_b64_tr_b16 a[174:175], v8 offset:16640
    v_mfma_f32_16x16x32_bf16 a[16:19], a[188:191], a[132:135], a[16:19]
    buffer_load_dwordx4 v2, s[16:19], s72 offen offset:2048  lds
    v_mfma_f32_16x16x32_bf16 a[20:23], a[184:187], a[136:139], a[20:23]
    v_mfma_f32_16x16x32_bf16 a[20:23], a[188:191], a[140:143], a[20:23]
    s_waitcnt lgkmcnt(0)
    v_mfma_f32_16x16x32_bf16 a[24:27], a[184:187], a[144:147], a[24:27]
    s_barrier
    v_mfma_f32_16x16x32_bf16 a[24:27], a[188:191], a[148:151], a[24:27]
    buffer_load_dwordx4 v3, s[16:19], s72 offen offset:3072  lds
    v_mfma_f32_16x16x32_bf16 a[28:31], a[184:187], a[152:155], a[28:31]
    s_add_u32 s72, s72, 262144
    v_mfma_f32_16x16x32_bf16 a[28:31], a[188:191], a[156:159], a[28:31]
    v_mfma_f32_16x16x32_bf16 v[32:35], a[160:163], a[32:35], v[32:35]
    v_mfma_f32_16x16x32_bf16 v[32:35], a[164:167], a[36:39], v[32:35]
    v_mfma_f32_16x16x32_bf16 v[36:39], a[160:163], a[40:43], v[36:39]
    ds_read_b64_tr_b16 a[176:177], v13 offset:1024
    v_mfma_f32_16x16x32_bf16 v[36:39], a[164:167], a[44:47], v[36:39]
    v_mfma_f32_16x16x32_bf16 v[40:43], a[160:163], a[48:51], v[40:43]
    ds_read_b64_tr_b16 a[178:179], v13 offset:1280
    v_mfma_f32_16x16x32_bf16 v[40:43], a[164:167], a[52:55], v[40:43]
    v_mfma_f32_16x16x32_bf16 v[44:47], a[160:163], a[56:59], v[44:47]
    ds_read_b64_tr_b16 a[180:181], v13 offset:17408
    v_mfma_f32_16x16x32_bf16 v[44:47], a[164:167], a[60:63], v[44:47]
    v_mfma_f32_16x16x32_bf16 v[48:51], a[160:163], a[64:67], v[48:51]
    ds_read_b64_tr_b16 a[182:183], v13 offset:17664
    v_mfma_f32_16x16x32_bf16 v[48:51], a[164:167], a[68:71], v[48:51]
    v_mfma_f32_16x16x32_bf16 v[52:55], a[160:163], a[72:75], v[52:55]
    v_mfma_f32_16x16x32_bf16 v[52:55], a[164:167], a[76:79], v[52:55]
    v_mfma_f32_16x16x32_bf16 v[56:59], a[160:163], a[80:83], v[56:59]
    v_mfma_f32_16x16x32_bf16 v[56:59], a[164:167], a[84:87], v[56:59]
    v_mfma_f32_16x16x32_bf16 v[60:63], a[160:163], a[88:91], v[60:63]
    v_mfma_f32_16x16x32_bf16 v[60:63], a[164:167], a[92:95], v[60:63]
    v_mfma_f32_16x16x32_bf16 v[64:67], a[168:171], a[32:35], v[64:67]
    s_add_u32 m0, s67, 131072
    v_mfma_f32_16x16x32_bf16 v[64:67], a[172:175], a[36:39], v[64:67]
    buffer_load_dwordx4 v10, s[20:23], s70 offen offset:0 sc1 lds
    v_mfma_f32_16x16x32_bf16 v[68:71], a[168:171], a[40:43], v[68:71]
    ds_read_b64_tr_b16 a[184:185], v8 offset:1024
    v_mfma_f32_16x16x32_bf16 v[68:71], a[172:175], a[44:47], v[68:71]
    v_mfma_f32_16x16x32_bf16 v[72:75], a[168:171], a[48:51], v[72:75]
    ds_read_b64_tr_b16 a[186:187], v8 offset:1280
    v_mfma_f32_16x16x32_bf16 v[72:75], a[172:175], a[52:55], v[72:75]
    buffer_load_dwordx4 v10, s[20:23], s70 offen offset:1024 sc1 lds
    v_mfma_f32_16x16x32_bf16 v[76:79], a[168:171], a[56:59], v[76:79]
    ds_read_b64_tr_b16 a[188:189], v8 offset:17408
    v_mfma_f32_16x16x32_bf16 v[76:79], a[172:175], a[60:63], v[76:79]
    v_mfma_f32_16x16x32_bf16 v[80:83], a[168:171], a[64:67], v[80:83]
    ds_read_b64_tr_b16 a[190:191], v8 offset:17664
    v_mfma_f32_16x16x32_bf16 v[80:83], a[172:175], a[68:71], v[80:83]
    buffer_load_dwordx4 v10, s[20:23], s70 offen offset:2048 sc1 lds
    v_mfma_f32_16x16x32_bf16 v[84:87], a[168:171], a[72:75], v[84:87]
    v_mfma_f32_16x16x32_bf16 v[84:87], a[172:175], a[76:79], v[84:87]
    buffer_store_dwordx4 a[200:203], v20, s[24:27], s80 offen offset:1024 sc1
    v_mfma_f32_16x16x32_bf16 v[88:91], a[168:171], a[80:83], v[88:91]
    v_mfma_f32_16x16x32_bf16 v[88:91], a[172:175], a[84:87], v[88:91]
    buffer_load_dwordx4 v10, s[20:23], s70 offen offset:3072 sc1 lds
    v_mfma_f32_16x16x32_bf16 v[92:95], a[168:171], a[88:91], v[92:95]
    s_add_u32 m0, s67, 65536
    v_mfma_f32_16x16x32_bf16 v[92:95], a[172:175], a[92:95], v[92:95]
    s_waitcnt lgkmcnt(6)
    s_waitcnt lgkmcnt(0)
    v_mfma_f32_16x16x32_bf16 v[96:99], a[176:179], a[32:35], v[96:99]
    s_waitcnt vmcnt(33)
    v_mfma_f32_16x16x32_bf16 v[96:99], a[180:183], a[36:39], v[96:99]
    buffer_load_dwordx4 v4, s[4:7], s71 offen offset:0  lds
    v_mfma_f32_16x16x32_bf16 v[100:103], a[176:179], a[40:43], v[100:103]
    ds_read_b64_tr_b16 a[160:161], v16 offset:32768
    v_mfma_f32_16x16x32_bf16 v[100:103], a[180:183], a[44:47], v[100:103]
    v_mfma_f32_16x16x32_bf16 v[104:107], a[176:179], a[48:51], v[104:107]
    s_waitcnt vmcnt(30)
    ds_read_b64_tr_b16 a[162:163], v16 offset:33280
    v_mfma_f32_16x16x32_bf16 v[104:107], a[180:183], a[52:55], v[104:107]
    buffer_load_dwordx4 v4, s[8:11], s71 offen offset:1024  lds
    v_mfma_f32_16x16x32_bf16 v[108:111], a[176:179], a[56:59], v[108:111]
    ds_read_b64_tr_b16 a[164:165], v16 offset:49152
    v_mfma_f32_16x16x32_bf16 v[108:111], a[180:183], a[60:63], v[108:111]
    v_mfma_f32_16x16x32_bf16 v[112:115], a[176:179], a[64:67], v[112:115]
    ds_read_b64_tr_b16 a[166:167], v16 offset:49664
    v_mfma_f32_16x16x32_bf16 v[112:115], a[180:183], a[68:71], v[112:115]
    buffer_load_dwordx4 v5, s[4:7], s71 offen offset:2048  lds
    v_mfma_f32_16x16x32_bf16 v[116:119], a[176:179], a[72:75], v[116:119]
    v_mfma_f32_16x16x32_bf16 v[116:119], a[180:183], a[76:79], v[116:119]
    v_mfma_f32_16x16x32_bf16 v[120:123], a[176:179], a[80:83], v[120:123]
    v_mfma_f32_16x16x32_bf16 v[120:123], a[180:183], a[84:87], v[120:123]
    buffer_load_dwordx4 v5, s[8:11], s71 offen offset:3072  lds
    v_mfma_f32_16x16x32_bf16 v[124:127], a[176:179], a[88:91], v[124:127]
    s_add_u32 m0, s67, 81920
    v_mfma_f32_16x16x32_bf16 v[124:127], a[180:183], a[92:95], v[124:127]
    s_add_u32 s71, s71, 114688
    v_mfma_f32_16x16x32_bf16 v[128:131], a[184:187], a[32:35], v[128:131]
    v_mfma_f32_16x16x32_bf16 v[128:131], a[188:191], a[36:39], v[128:131]
    buffer_load_dwordx4 v4, s[4:7], s71 offen offset:0  lds
    v_mfma_f32_16x16x32_bf16 v[132:135], a[184:187], a[40:43], v[132:135]
    ds_read_b64_tr_b16 a[168:169], v17 offset:32768
    v_mfma_f32_16x16x32_bf16 v[132:135], a[188:191], a[44:47], v[132:135]
    v_mfma_f32_16x16x32_bf16 v[136:139], a[184:187], a[48:51], v[136:139]
    ds_read_b64_tr_b16 a[170:171], v17 offset:33280
    v_mfma_f32_16x16x32_bf16 v[136:139], a[188:191], a[52:55], v[136:139]
    buffer_load_dwordx4 v4, s[8:11], s71 offen offset:1024  lds
    v_mfma_f32_16x16x32_bf16 v[140:143], a[184:187], a[56:59], v[140:143]
    ds_read_b64_tr_b16 a[172:173], v17 offset:49152
    v_mfma_f32_16x16x32_bf16 v[140:143], a[188:191], a[60:63], v[140:143]
    v_mfma_f32_16x16x32_bf16 v[144:147], a[184:187], a[64:67], v[144:147]
    ds_read_b64_tr_b16 a[174:175], v17 offset:49664
    v_mfma_f32_16x16x32_bf16 v[144:147], a[188:191], a[68:71], v[144:147]
    buffer_load_dwordx4 v5, s[4:7], s71 offen offset:2048  lds
    v_mfma_f32_16x16x32_bf16 v[148:151], a[184:187], a[72:75], v[148:151]
    s_waitcnt vmcnt(31)
    v_mfma_f32_16x16x32_bf16 v[148:151], a[188:191], a[76:79], v[148:151]
    s_barrier
    v_mfma_f32_16x16x32_bf16 v[152:155], a[184:187], a[80:83], v[152:155]
    v_mfma_f32_16x16x32_bf16 v[152:155], a[188:191], a[84:87], v[152:155]
    buffer_load_dwordx4 v5, s[8:11], s71 offen offset:3072  lds
    ds_read_b128 a[96:99], v14 offset:16384
    v_mfma_f32_16x16x32_bf16 v[156:159], a[184:187], a[88:91], v[156:159]
    s_add_u32 s71, s71, 114688
    v_mfma_f32_16x16x32_bf16 v[156:159], a[188:191], a[92:95], v[156:159]
    s_waitcnt lgkmcnt(7)
    ds_read_b128 a[100:103], v15 offset:16384
    v_mfma_f32_16x16x32_bf16 v[160:163], a[160:163], a[32:35], v[160:163]
    s_waitcnt lgkmcnt(6)
    v_mfma_f32_16x16x32_bf16 v[160:163], a[164:167], a[36:39], v[160:163]
    ds_read_b128 a[104:107], v14 offset:18432
    v_mfma_f32_16x16x32_bf16 v[164:167], a[160:163], a[40:43], v[164:167]
    ds_read_b64_tr_b16 a[176:177], v18 offset:32768
    v_mfma_f32_16x16x32_bf16 v[164:167], a[164:167], a[44:47], v[164:167]
    ds_read_b128 a[108:111], v15 offset:18432
    v_mfma_f32_16x16x32_bf16 v[168:171], a[160:163], a[48:51], v[168:171]
    ds_read_b64_tr_b16 a[178:179], v18 offset:33280
    v_mfma_f32_16x16x32_bf16 v[168:171], a[164:167], a[52:55], v[168:171]
    ds_read_b128 a[112:115], v14 offset:20480
    v_mfma_f32_16x16x32_bf16 v[172:175], a[160:163], a[56:59], v[172:175]
    ds_read_b64_tr_b16 a[180:181], v18 offset:49152
    v_mfma_f32_16x16x32_bf16 v[172:175], a[164:167], a[60:63], v[172:175]
    ds_read_b128 a[116:119], v15 offset:20480
    v_mfma_f32_16x16x32_bf16 v[176:179], a[160:163], a[64:67], v[176:179]
    ds_read_b64_tr_b16 a[182:183], v18 offset:49664
    v_mfma_f32_16x16x32_bf16 v[176:179], a[164:167], a[68:71], v[176:179]
    ds_read_b128 a[120:123], v14 offset:22528
    v_mfma_f32_16x16x32_bf16 v[180:183], a[160:163], a[72:75], v[180:183]
    v_mfma_f32_16x16x32_bf16 v[180:183], a[164:167], a[76:79], v[180:183]
    ds_read_b128 a[124:127], v15 offset:22528
    v_mfma_f32_16x16x32_bf16 v[184:187], a[160:163], a[80:83], v[184:187]
    v_mfma_f32_16x16x32_bf16 v[184:187], a[164:167], a[84:87], v[184:187]
    ds_read_b128 a[128:131], v14 offset:24576
    v_mfma_f32_16x16x32_bf16 v[188:191], a[160:163], a[88:91], v[188:191]
    v_mfma_f32_16x16x32_bf16 v[188:191], a[164:167], a[92:95], v[188:191]
    s_waitcnt lgkmcnt(15)
    ds_read_b128 a[132:135], v15 offset:24576
    v_mfma_f32_16x16x32_bf16 v[192:195], a[168:171], a[32:35], v[192:195]
    s_waitcnt lgkmcnt(14)
    s_add_u32 s70, s70, 16384
    v_mfma_f32_16x16x32_bf16 v[192:195], a[172:175], a[36:39], v[192:195]
    buffer_store_dwordx4 a[216:219], v20, s[24:27], s84 offen offset:1024 sc1
    ds_read_b128 a[136:139], v14 offset:26624
    v_mfma_f32_16x16x32_bf16 v[196:199], a[168:171], a[40:43], v[196:199]
    ds_read_b64_tr_b16 a[184:185], v19 offset:32768
    v_mfma_f32_16x16x32_bf16 v[196:199], a[172:175], a[44:47], v[196:199]
    ds_read_b128 a[140:143], v15 offset:26624
    v_mfma_f32_16x16x32_bf16 v[200:203], a[168:171], a[48:51], v[200:203]
    ds_read_b64_tr_b16 a[186:187], v19 offset:33280
    v_mfma_f32_16x16x32_bf16 v[200:203], a[172:175], a[52:55], v[200:203]
    v_mfma_f32_16x16x32_bf16 v[204:207], a[168:171], a[56:59], v[204:207]
    ds_read_b64_tr_b16 a[188:189], v19 offset:49152
    v_mfma_f32_16x16x32_bf16 v[204:207], a[172:175], a[60:63], v[204:207]
    buffer_store_dwordx4 a[204:207], v20, s[24:27], s81 offen offset:1024 sc1
    v_mfma_f32_16x16x32_bf16 v[208:211], a[168:171], a[64:67], v[208:211]
    ds_read_b64_tr_b16 a[190:191], v19 offset:49664
    v_mfma_f32_16x16x32_bf16 v[208:211], a[172:175], a[68:71], v[208:211]
    v_xor_b32 v16, 0x10000, v16
    v_mfma_f32_16x16x32_bf16 v[212:215], a[168:171], a[72:75], v[212:215]
    v_mfma_f32_16x16x32_bf16 v[212:215], a[172:175], a[76:79], v[212:215]
    v_xor_b32 v17, 0x10000, v17
    v_mfma_f32_16x16x32_bf16 v[216:219], a[168:171], a[80:83], v[216:219]
    v_xor_b32 v18, 0x10000, v18
    v_mfma_f32_16x16x32_bf16 v[216:219], a[172:175], a[84:87], v[216:219]
    buffer_store_dwordx4 a[220:223], v20, s[24:27], s85 offen offset:1024 sc1
    v_xor_b32 v19, 0x10000, v19
    v_mfma_f32_16x16x32_bf16 v[220:223], a[168:171], a[88:91], v[220:223]
    s_add_u32 m0, s67, 98304
    v_mfma_f32_16x16x32_bf16 v[220:223], a[172:175], a[92:95], v[220:223]
    s_waitcnt lgkmcnt(14)
    s_waitcnt lgkmcnt(0)
    v_mfma_f32_16x16x32_bf16 v[224:227], a[176:179], a[32:35], v[224:227]
    s_waitcnt vmcnt(31)
    v_mfma_f32_16x16x32_bf16 v[224:227], a[180:183], a[36:39], v[224:227]
    buffer_load_dwordx4 v2, s[12:15], s72 offen offset:0  lds
    v_mfma_f32_16x16x32_bf16 v[228:231], a[176:179], a[40:43], v[228:231]
    ds_read_b64_tr_b16 a[160:161], v11 offset:0
    v_mfma_f32_16x16x32_bf16 v[228:231], a[180:183], a[44:47], v[228:231]
    ds_read_b128 a[144:147], v14 offset:28672
    v_mfma_f32_16x16x32_bf16 v[232:235], a[176:179], a[48:51], v[232:235]
    s_waitcnt vmcnt(28)
    ds_read_b64_tr_b16 a[162:163], v11 offset:256
    v_mfma_f32_16x16x32_bf16 v[232:235], a[180:183], a[52:55], v[232:235]
    s_add_u32 s76, s76, 1
    buffer_load_dwordx4 v3, s[12:15], s72 offen offset:1024  lds
    v_mfma_f32_16x16x32_bf16 v[236:239], a[176:179], a[56:59], v[236:239]
    ds_read_b64_tr_b16 a[164:165], v11 offset:16384
    v_mfma_f32_16x16x32_bf16 v[236:239], a[180:183], a[60:63], v[236:239]
    ds_read_b128 a[148:151], v15 offset:28672
    v_mfma_f32_16x16x32_bf16 v[240:243], a[176:179], a[64:67], v[240:243]
    ds_read_b64_tr_b16 a[166:167], v11 offset:16640
    v_mfma_f32_16x16x32_bf16 v[240:243], a[180:183], a[68:71], v[240:243]
    buffer_load_dwordx4 v2, s[16:19], s72 offen offset:2048  lds
    v_mfma_f32_16x16x32_bf16 v[244:247], a[176:179], a[72:75], v[244:247]
    v_mfma_f32_16x16x32_bf16 v[244:247], a[180:183], a[76:79], v[244:247]
    ds_read_b128 a[152:155], v14 offset:30720
    v_mfma_f32_16x16x32_bf16 v[248:251], a[176:179], a[80:83], v[248:251]
    v_mfma_f32_16x16x32_bf16 v[248:251], a[180:183], a[84:87], v[248:251]
    buffer_load_dwordx4 v3, s[16:19], s72 offen offset:3072  lds
    v_mfma_f32_16x16x32_bf16 v[252:255], a[176:179], a[88:91], v[252:255]
    s_add_u32 m0, s67, 114688
    v_mfma_f32_16x16x32_bf16 v[252:255], a[180:183], a[92:95], v[252:255]
    s_add_u32 s72, s72, 262144
    ds_read_b128 a[156:159], v15 offset:30720
    v_mfma_f32_16x16x32_bf16 a[0:3], a[184:187], a[32:35], a[0:3]
    v_mfma_f32_16x16x32_bf16 a[0:3], a[188:191], a[36:39], a[0:3]
    buffer_load_dwordx4 v2, s[12:15], s72 offen offset:0  lds
    v_mfma_f32_16x16x32_bf16 a[4:7], a[184:187], a[40:43], a[4:7]
    ds_read_b64_tr_b16 a[168:169], v12 offset:0
    v_mfma_f32_16x16x32_bf16 a[4:7], a[188:191], a[44:47], a[4:7]
    v_mfma_f32_16x16x32_bf16 a[8:11], a[184:187], a[48:51], a[8:11]
    ds_read_b64_tr_b16 a[170:171], v12 offset:256
    v_mfma_f32_16x16x32_bf16 a[8:11], a[188:191], a[52:55], a[8:11]
    buffer_load_dwordx4 v3, s[12:15], s72 offen offset:1024  lds
    v_mfma_f32_16x16x32_bf16 a[12:15], a[184:187], a[56:59], a[12:15]
    ds_read_b64_tr_b16 a[172:173], v12 offset:16384
    v_mfma_f32_16x16x32_bf16 a[12:15], a[188:191], a[60:63], a[12:15]
    v_mfma_f32_16x16x32_bf16 a[16:19], a[184:187], a[64:67], a[16:19]
    ds_read_b64_tr_b16 a[174:175], v12 offset:16640
    v_mfma_f32_16x16x32_bf16 a[16:19], a[188:191], a[68:71], a[16:19]
    buffer_load_dwordx4 v2, s[16:19], s72 offen offset:2048  lds
    v_mfma_f32_16x16x32_bf16 a[20:23], a[184:187], a[72:75], a[20:23]
    v_mfma_f32_16x16x32_bf16 a[20:23], a[188:191], a[76:79], a[20:23]
    s_waitcnt lgkmcnt(0)
    v_mfma_f32_16x16x32_bf16 a[24:27], a[184:187], a[80:83], a[24:27]
    s_barrier
    v_mfma_f32_16x16x32_bf16 a[24:27], a[188:191], a[84:87], a[24:27]
    buffer_load_dwordx4 v3, s[16:19], s72 offen offset:3072  lds
    v_mfma_f32_16x16x32_bf16 a[28:31], a[184:187], a[88:91], a[28:31]
    s_add_u32 s72, s72, 262144
    v_mfma_f32_16x16x32_bf16 a[28:31], a[188:191], a[92:95], a[28:31]
    v_mfma_f32_16x16x32_bf16 v[32:35], a[160:163], a[96:99], v[32:35]
    v_mfma_f32_16x16x32_bf16 v[32:35], a[164:167], a[100:103], v[32:35]
    v_mfma_f32_16x16x32_bf16 v[36:39], a[160:163], a[104:107], v[36:39]
    ds_read_b64_tr_b16 a[176:177], v11 offset:1024
    v_mfma_f32_16x16x32_bf16 v[36:39], a[164:167], a[108:111], v[36:39]
    v_mfma_f32_16x16x32_bf16 v[40:43], a[160:163], a[112:115], v[40:43]
    ds_read_b64_tr_b16 a[178:179], v11 offset:1280
    v_mfma_f32_16x16x32_bf16 v[40:43], a[164:167], a[116:119], v[40:43]
    v_mfma_f32_16x16x32_bf16 v[44:47], a[160:163], a[120:123], v[44:47]
    ds_read_b64_tr_b16 a[180:181], v11 offset:17408
    v_mfma_f32_16x16x32_bf16 v[44:47], a[164:167], a[124:127], v[44:47]
    v_mfma_f32_16x16x32_bf16 v[48:51], a[160:163], a[128:131], v[48:51]
    ds_read_b64_tr_b16 a[182:183], v11 offset:17664
    v_mfma_f32_16x16x32_bf16 v[48:51], a[164:167], a[132:135], v[48:51]
    v_mfma_f32_16x16x32_bf16 v[52:55], a[160:163], a[136:139], v[52:55]
    v_mfma_f32_16x16x32_bf16 v[52:55], a[164:167], a[140:143], v[52:55]
    v_mfma_f32_16x16x32_bf16 v[56:59], a[160:163], a[144:147], v[56:59]
    v_mfma_f32_16x16x32_bf16 v[56:59], a[164:167], a[148:151], v[56:59]
    v_mfma_f32_16x16x32_bf16 v[60:63], a[160:163], a[152:155], v[60:63]
    v_mfma_f32_16x16x32_bf16 v[60:63], a[164:167], a[156:159], v[60:63]
    v_mfma_f32_16x16x32_bf16 v[64:67], a[168:171], a[96:99], v[64:67]
    s_add_u32 m0, s67, 147456
    v_mfma_f32_16x16x32_bf16 v[64:67], a[172:175], a[100:103], v[64:67]
    buffer_load_dwordx4 v10, s[20:23], s70 offen offset:0 sc1 lds
    v_mfma_f32_16x16x32_bf16 v[68:71], a[168:171], a[104:107], v[68:71]
    ds_read_b64_tr_b16 a[184:185], v12 offset:1024
    v_mfma_f32_16x16x32_bf16 v[68:71], a[172:175], a[108:111], v[68:71]
    v_mfma_f32_16x16x32_bf16 v[72:75], a[168:171], a[112:115], v[72:75]
    ds_read_b64_tr_b16 a[186:187], v12 offset:1280
    v_mfma_f32_16x16x32_bf16 v[72:75], a[172:175], a[116:119], v[72:75]
    buffer_load_dwordx4 v10, s[20:23], s70 offen offset:1024 sc1 lds
    v_mfma_f32_16x16x32_bf16 v[76:79], a[168:171], a[120:123], v[76:79]
    ds_read_b64_tr_b16 a[188:189], v12 offset:17408
    v_mfma_f32_16x16x32_bf16 v[76:79], a[172:175], a[124:127], v[76:79]
    v_mfma_f32_16x16x32_bf16 v[80:83], a[168:171], a[128:131], v[80:83]
    ds_read_b64_tr_b16 a[190:191], v12 offset:17664
    v_mfma_f32_16x16x32_bf16 v[80:83], a[172:175], a[132:135], v[80:83]
    buffer_load_dwordx4 v10, s[20:23], s70 offen offset:2048 sc1 lds
    v_mfma_f32_16x16x32_bf16 v[84:87], a[168:171], a[136:139], v[84:87]
    v_mfma_f32_16x16x32_bf16 v[84:87], a[172:175], a[140:143], v[84:87]
    buffer_store_dwordx4 a[224:227], v20, s[24:27], s78 offen offset:2048 sc1
    v_mfma_f32_16x16x32_bf16 v[88:91], a[168:171], a[144:147], v[88:91]
    v_mfma_f32_16x16x32_bf16 v[88:91], a[172:175], a[148:151], v[88:91]
    buffer_load_dwordx4 v10, s[20:23], s70 offen offset:3072 sc1 lds
    v_mfma_f32_16x16x32_bf16 v[92:95], a[168:171], a[152:155], v[92:95]
    s_add_u32 m0, s67, 0
    v_mfma_f32_16x16x32_bf16 v[92:95], a[172:175], a[156:159], v[92:95]
    s_waitcnt lgkmcnt(6)
    s_waitcnt lgkmcnt(0)
    v_mfma_f32_16x16x32_bf16 v[96:99], a[176:179], a[96:99], v[96:99]
    s_waitcnt vmcnt(33)
    v_mfma_f32_16x16x32_bf16 v[96:99], a[180:183], a[100:103], v[96:99]
    buffer_load_dwordx4 v4, s[4:7], s71 offen offset:0  lds
    v_mfma_f32_16x16x32_bf16 v[100:103], a[176:179], a[104:107], v[100:103]
    ds_read_b64_tr_b16 a[160:161], v16 offset:32768
    v_mfma_f32_16x16x32_bf16 v[100:103], a[180:183], a[108:111], v[100:103]
    v_mfma_f32_16x16x32_bf16 v[104:107], a[176:179], a[112:115], v[104:107]
    s_waitcnt vmcnt(30)
    ds_read_b64_tr_b16 a[162:163], v16 offset:33280
    v_mfma_f32_16x16x32_bf16 v[104:107], a[180:183], a[116:119], v[104:107]
    buffer_load_dwordx4 v4, s[8:11], s71 offen offset:1024  lds
    v_mfma_f32_16x16x32_bf16 v[108:111], a[176:179], a[120:123], v[108:111]
    ds_read_b64_tr_b16 a[164:165], v16 offset:49152
    v_mfma_f32_16x16x32_bf16 v[108:111], a[180:183], a[124:127], v[108:111]
    v_mfma_f32_16x16x32_bf16 v[112:115], a[176:179], a[128:131], v[112:115]
    ds_read_b64_tr_b16 a[166:167], v16 offset:49664
    v_mfma_f32_16x16x32_bf16 v[112:115], a[180:183], a[132:135], v[112:115]
    buffer_load_dwordx4 v5, s[4:7], s71 offen offset:2048  lds
    v_mfma_f32_16x16x32_bf16 v[116:119], a[176:179], a[136:139], v[116:119]
    v_mfma_f32_16x16x32_bf16 v[116:119], a[180:183], a[140:143], v[116:119]
    v_mfma_f32_16x16x32_bf16 v[120:123], a[176:179], a[144:147], v[120:123]
    v_mfma_f32_16x16x32_bf16 v[120:123], a[180:183], a[148:151], v[120:123]
    buffer_load_dwordx4 v5, s[8:11], s71 offen offset:3072  lds
    v_mfma_f32_16x16x32_bf16 v[124:127], a[176:179], a[152:155], v[124:127]
    s_add_u32 m0, s67, 16384
    v_mfma_f32_16x16x32_bf16 v[124:127], a[180:183], a[156:159], v[124:127]
    s_add_u32 s71, s71, 114688
    v_mfma_f32_16x16x32_bf16 v[128:131], a[184:187], a[96:99], v[128:131]
    v_mfma_f32_16x16x32_bf16 v[128:131], a[188:191], a[100:103], v[128:131]
    buffer_load_dwordx4 v4, s[4:7], s71 offen offset:0  lds
    v_mfma_f32_16x16x32_bf16 v[132:135], a[184:187], a[104:107], v[132:135]
    ds_read_b64_tr_b16 a[168:169], v17 offset:32768
    v_mfma_f32_16x16x32_bf16 v[132:135], a[188:191], a[108:111], v[132:135]
    v_mfma_f32_16x16x32_bf16 v[136:139], a[184:187], a[112:115], v[136:139]
    ds_read_b64_tr_b16 a[170:171], v17 offset:33280
    v_mfma_f32_16x16x32_bf16 v[136:139], a[188:191], a[116:119], v[136:139]
    buffer_load_dwordx4 v4, s[8:11], s71 offen offset:1024  lds
    v_mfma_f32_16x16x32_bf16 v[140:143], a[184:187], a[120:123], v[140:143]
    ds_read_b64_tr_b16 a[172:173], v17 offset:49152
    v_mfma_f32_16x16x32_bf16 v[140:143], a[188:191], a[124:127], v[140:143]
    v_mfma_f32_16x16x32_bf16 v[144:147], a[184:187], a[128:131], v[144:147]
    ds_read_b64_tr_b16 a[174:175], v17 offset:49664
    v_mfma_f32_16x16x32_bf16 v[144:147], a[188:191], a[132:135], v[144:147]
    buffer_load_dwordx4 v5, s[4:7], s71 offen offset:2048  lds
    v_mfma_f32_16x16x32_bf16 v[148:151], a[184:187], a[136:139], v[148:151]
    s_waitcnt vmcnt(31)
    v_mfma_f32_16x16x32_bf16 v[148:151], a[188:191], a[140:143], v[148:151]
    s_barrier
    v_mfma_f32_16x16x32_bf16 v[152:155], a[184:187], a[144:147], v[152:155]
    v_mfma_f32_16x16x32_bf16 v[152:155], a[188:191], a[148:151], v[152:155]
    buffer_load_dwordx4 v5, s[8:11], s71 offen offset:3072  lds
    ds_read_b128 a[32:35], v14 offset:0
    v_mfma_f32_16x16x32_bf16 v[156:159], a[184:187], a[152:155], v[156:159]
    s_add_u32 s71, s71, 114688
    v_mfma_f32_16x16x32_bf16 v[156:159], a[188:191], a[156:159], v[156:159]
    s_waitcnt lgkmcnt(7)
    ds_read_b128 a[36:39], v15 offset:0
    v_mfma_f32_16x16x32_bf16 v[160:163], a[160:163], a[96:99], v[160:163]
    s_waitcnt lgkmcnt(6)
    v_mfma_f32_16x16x32_bf16 v[160:163], a[164:167], a[100:103], v[160:163]
    ds_read_b128 a[40:43], v14 offset:2048
    v_mfma_f32_16x16x32_bf16 v[164:167], a[160:163], a[104:107], v[164:167]
    ds_read_b64_tr_b16 a[176:177], v18 offset:32768
    v_mfma_f32_16x16x32_bf16 v[164:167], a[164:167], a[108:111], v[164:167]
    ds_read_b128 a[44:47], v15 offset:2048
    v_mfma_f32_16x16x32_bf16 v[168:171], a[160:163], a[112:115], v[168:171]
    ds_read_b64_tr_b16 a[178:179], v18 offset:33280
    v_mfma_f32_16x16x32_bf16 v[168:171], a[164:167], a[116:119], v[168:171]
    ds_read_b128 a[48:51], v14 offset:4096
    v_mfma_f32_16x16x32_bf16 v[172:175], a[160:163], a[120:123], v[172:175]
    ds_read_b64_tr_b16 a[180:181], v18 offset:49152
    v_mfma_f32_16x16x32_bf16 v[172:175], a[164:167], a[124:127], v[172:175]
    ds_read_b128 a[52:55], v15 offset:4096
    v_mfma_f32_16x16x32_bf16 v[176:179], a[160:163], a[128:131], v[176:179]
    ds_read_b64_tr_b16 a[182:183], v18 offset:49664
    v_mfma_f32_16x16x32_bf16 v[176:179], a[164:167], a[132:135], v[176:179]
    ds_read_b128 a[56:59], v14 offset:6144
    v_mfma_f32_16x16x32_bf16 v[180:183], a[160:163], a[136:139], v[180:183]
    v_mfma_f32_16x16x32_bf16 v[180:183], a[164:167], a[140:143], v[180:183]
    ds_read_b128 a[60:63], v15 offset:6144
    v_mfma_f32_16x16x32_bf16 v[184:187], a[160:163], a[144:147], v[184:187]
    v_mfma_f32_16x16x32_bf16 v[184:187], a[164:167], a[148:151], v[184:187]
    ds_read_b128 a[64:67], v14 offset:8192
    v_mfma_f32_16x16x32_bf16 v[188:191], a[160:163], a[152:155], v[188:191]
    v_mfma_f32_16x16x32_bf16 v[188:191], a[164:167], a[156:159], v[188:191]
    s_waitcnt lgkmcnt(15)
    ds_read_b128 a[68:71], v15 offset:8192
    v_mfma_f32_16x16x32_bf16 v[192:195], a[168:171], a[96:99], v[192:195]
    s_waitcnt lgkmcnt(14)
    s_add_u32 s70, s70, 16384
    v_mfma_f32_16x16x32_bf16 v[192:195], a[172:175], a[100:103], v[192:195]
    buffer_store_dwordx4 a[240:243], v20, s[24:27], s82 offen offset:2048 sc1
    ds_read_b128 a[72:75], v14 offset:10240
    v_mfma_f32_16x16x32_bf16 v[196:199], a[168:171], a[104:107], v[196:199]
    ds_read_b64_tr_b16 a[184:185], v19 offset:32768
    v_mfma_f32_16x16x32_bf16 v[196:199], a[172:175], a[108:111], v[196:199]
    ds_read_b128 a[76:79], v15 offset:10240
    v_mfma_f32_16x16x32_bf16 v[200:203], a[168:171], a[112:115], v[200:203]
    ds_read_b64_tr_b16 a[186:187], v19 offset:33280
    v_mfma_f32_16x16x32_bf16 v[200:203], a[172:175], a[116:119], v[200:203]
    v_mfma_f32_16x16x32_bf16 v[204:207], a[168:171], a[120:123], v[204:207]
    ds_read_b64_tr_b16 a[188:189], v19 offset:49152
    v_mfma_f32_16x16x32_bf16 v[204:207], a[172:175], a[124:127], v[204:207]
    buffer_store_dwordx4 a[228:231], v20, s[24:27], s79 offen offset:2048 sc1
    v_mfma_f32_16x16x32_bf16 v[208:211], a[168:171], a[128:131], v[208:211]
    ds_read_b64_tr_b16 a[190:191], v19 offset:49664
    v_mfma_f32_16x16x32_bf16 v[208:211], a[172:175], a[132:135], v[208:211]
    v_xor_b32 v16, 0x10000, v16
    v_mfma_f32_16x16x32_bf16 v[212:215], a[168:171], a[136:139], v[212:215]
    v_mfma_f32_16x16x32_bf16 v[212:215], a[172:175], a[140:143], v[212:215]
    v_xor_b32 v17, 0x10000, v17
    v_mfma_f32_16x16x32_bf16 v[216:219], a[168:171], a[144:147], v[216:219]
    v_xor_b32 v18, 0x10000, v18
    v_mfma_f32_16x16x32_bf16 v[216:219], a[172:175], a[148:151], v[216:219]
    buffer_store_dwordx4 a[244:247], v20, s[24:27], s83 offen offset:2048 sc1
    v_xor_b32 v19, 0x10000, v19
    v_mfma_f32_16x16x32_bf16 v[220:223], a[168:171], a[152:155], v[220:223]
    s_add_u32 m0, s67, 32768
    v_mfma_f32_16x16x32_bf16 v[220:223], a[172:175], a[156:159], v[220:223]
    s_waitcnt lgkmcnt(14)
    s_waitcnt lgkmcnt(0)
    v_mfma_f32_16x16x32_bf16 v[224:227], a[176:179], a[96:99], v[224:227]
    s_waitcnt vmcnt(31)
    v_mfma_f32_16x16x32_bf16 v[224:227], a[180:183], a[100:103], v[224:227]
    buffer_load_dwordx4 v2, s[12:15], s72 offen offset:0  lds
    v_mfma_f32_16x16x32_bf16 v[228:231], a[176:179], a[104:107], v[228:231]
    ds_read_b64_tr_b16 a[160:161], v13 offset:0
    v_mfma_f32_16x16x32_bf16 v[228:231], a[180:183], a[108:111], v[228:231]
    ds_read_b128 a[80:83], v14 offset:12288
    v_mfma_f32_16x16x32_bf16 v[232:235], a[176:179], a[112:115], v[232:235]
    s_waitcnt vmcnt(28)
    ds_read_b64_tr_b16 a[162:163], v13 offset:256
    v_mfma_f32_16x16x32_bf16 v[232:235], a[180:183], a[116:119], v[232:235]
    s_add_u32 s76, s76, 1
    buffer_load_dwordx4 v3, s[12:15], s72 offen offset:1024  lds
    v_mfma_f32_16x16x32_bf16 v[236:239], a[176:179], a[120:123], v[236:239]
    ds_read_b64_tr_b16 a[164:165], v13 offset:16384
    v_mfma_f32_16x16x32_bf16 v[236:239], a[180:183], a[124:127], v[236:239]
    ds_read_b128 a[84:87], v15 offset:12288
    v_mfma_f32_16x16x32_bf16 v[240:243], a[176:179], a[128:131], v[240:243]
    ds_read_b64_tr_b16 a[166:167], v13 offset:16640
    v_mfma_f32_16x16x32_bf16 v[240:243], a[180:183], a[132:135], v[240:243]
    buffer_load_dwordx4 v2, s[16:19], s72 offen offset:2048  lds
    v_mfma_f32_16x16x32_bf16 v[244:247], a[176:179], a[136:139], v[244:247]
    v_mfma_f32_16x16x32_bf16 v[244:247], a[180:183], a[140:143], v[244:247]
    ds_read_b128 a[88:91], v14 offset:14336
    v_mfma_f32_16x16x32_bf16 v[248:251], a[176:179], a[144:147], v[248:251]
    v_mfma_f32_16x16x32_bf16 v[248:251], a[180:183], a[148:151], v[248:251]
    buffer_load_dwordx4 v3, s[16:19], s72 offen offset:3072  lds
    v_mfma_f32_16x16x32_bf16 v[252:255], a[176:179], a[152:155], v[252:255]
    s_add_u32 m0, s67, 49152
    v_mfma_f32_16x16x32_bf16 v[252:255], a[180:183], a[156:159], v[252:255]
    s_add_u32 s72, s72, 262144
    ds_read_b128 a[92:95], v15 offset:14336
    v_mfma_f32_16x16x32_bf16 a[0:3], a[184:187], a[96:99], a[0:3]
    v_mfma_f32_16x16x32_bf16 a[0:3], a[188:191], a[100:103], a[0:3]
    buffer_load_dwordx4 v2, s[12:15], s72 offen offset:0  lds
    v_mfma_f32_16x16x32_bf16 a[4:7], a[184:187], a[104:107], a[4:7]
    ds_read_b64_tr_b16 a[168:169], v8 offset:0
    v_mfma_f32_16x16x32_bf16 a[4:7], a[188:191], a[108:111], a[4:7]
    v_mfma_f32_16x16x32_bf16 a[8:11], a[184:187], a[112:115], a[8:11]
    ds_read_b64_tr_b16 a[170:171], v8 offset:256
    v_mfma_f32_16x16x32_bf16 a[8:11], a[188:191], a[116:119], a[8:11]
    buffer_load_dwordx4 v3, s[12:15], s72 offen offset:1024  lds
    v_mfma_f32_16x16x32_bf16 a[12:15], a[184:187], a[120:123], a[12:15]
    ds_read_b64_tr_b16 a[172:173], v8 offset:16384
    v_mfma_f32_16x16x32_bf16 a[12:15], a[188:191], a[124:127], a[12:15]
    v_mfma_f32_16x16x32_bf16 a[16:19], a[184:187], a[128:131], a[16:19]
    ds_read_b64_tr_b16 a[174:175], v8 offset:16640
    v_mfma_f32_16x16x32_bf16 a[16:19], a[188:191], a[132:135], a[16:19]
    buffer_load_dwordx4 v2, s[16:19], s72 offen offset:2048  lds
    v_mfma_f32_16x16x32_bf16 a[20:23], a[184:187], a[136:139], a[20:23]
    v_mfma_f32_16x16x32_bf16 a[20:23], a[188:191], a[140:143], a[20:23]
    s_waitcnt lgkmcnt(0)
    v_mfma_f32_16x16x32_bf16 a[24:27], a[184:187], a[144:147], a[24:27]
    s_barrier
    v_mfma_f32_16x16x32_bf16 a[24:27], a[188:191], a[148:151], a[24:27]
    buffer_load_dwordx4 v3, s[16:19], s72 offen offset:3072  lds
    v_mfma_f32_16x16x32_bf16 a[28:31], a[184:187], a[152:155], a[28:31]
    s_add_u32 s72, s72, 262144
    v_mfma_f32_16x16x32_bf16 a[28:31], a[188:191], a[156:159], a[28:31]
    v_mfma_f32_16x16x32_bf16 v[32:35], a[160:163], a[32:35], v[32:35]
    v_mfma_f32_16x16x32_bf16 v[32:35], a[164:167], a[36:39], v[32:35]
    v_mfma_f32_16x16x32_bf16 v[36:39], a[160:163], a[40:43], v[36:39]
    ds_read_b64_tr_b16 a[176:177], v13 offset:1024
    v_mfma_f32_16x16x32_bf16 v[36:39], a[164:167], a[44:47], v[36:39]
    v_mfma_f32_16x16x32_bf16 v[40:43], a[160:163], a[48:51], v[40:43]
    ds_read_b64_tr_b16 a[178:179], v13 offset:1280
    v_mfma_f32_16x16x32_bf16 v[40:43], a[164:167], a[52:55], v[40:43]
    v_mfma_f32_16x16x32_bf16 v[44:47], a[160:163], a[56:59], v[44:47]
    ds_read_b64_tr_b16 a[180:181], v13 offset:17408
    v_mfma_f32_16x16x32_bf16 v[44:47], a[164:167], a[60:63], v[44:47]
    v_mfma_f32_16x16x32_bf16 v[48:51], a[160:163], a[64:67], v[48:51]
    ds_read_b64_tr_b16 a[182:183], v13 offset:17664
    v_mfma_f32_16x16x32_bf16 v[48:51], a[164:167], a[68:71], v[48:51]
    v_mfma_f32_16x16x32_bf16 v[52:55], a[160:163], a[72:75], v[52:55]
    v_mfma_f32_16x16x32_bf16 v[52:55], a[164:167], a[76:79], v[52:55]
    v_mfma_f32_16x16x32_bf16 v[56:59], a[160:163], a[80:83], v[56:59]
    v_mfma_f32_16x16x32_bf16 v[56:59], a[164:167], a[84:87], v[56:59]
    v_mfma_f32_16x16x32_bf16 v[60:63], a[160:163], a[88:91], v[60:63]
    v_mfma_f32_16x16x32_bf16 v[60:63], a[164:167], a[92:95], v[60:63]
    v_mfma_f32_16x16x32_bf16 v[64:67], a[168:171], a[32:35], v[64:67]
    s_add_u32 m0, s67, 131072
    v_mfma_f32_16x16x32_bf16 v[64:67], a[172:175], a[36:39], v[64:67]
    buffer_load_dwordx4 v10, s[20:23], s70 offen offset:0 sc1 lds
    v_mfma_f32_16x16x32_bf16 v[68:71], a[168:171], a[40:43], v[68:71]
    ds_read_b64_tr_b16 a[184:185], v8 offset:1024
    v_mfma_f32_16x16x32_bf16 v[68:71], a[172:175], a[44:47], v[68:71]
    v_mfma_f32_16x16x32_bf16 v[72:75], a[168:171], a[48:51], v[72:75]
    ds_read_b64_tr_b16 a[186:187], v8 offset:1280
    v_mfma_f32_16x16x32_bf16 v[72:75], a[172:175], a[52:55], v[72:75]
    buffer_load_dwordx4 v10, s[20:23], s70 offen offset:1024 sc1 lds
    v_mfma_f32_16x16x32_bf16 v[76:79], a[168:171], a[56:59], v[76:79]
    ds_read_b64_tr_b16 a[188:189], v8 offset:17408
    v_mfma_f32_16x16x32_bf16 v[76:79], a[172:175], a[60:63], v[76:79]
    v_mfma_f32_16x16x32_bf16 v[80:83], a[168:171], a[64:67], v[80:83]
    ds_read_b64_tr_b16 a[190:191], v8 offset:17664
    v_mfma_f32_16x16x32_bf16 v[80:83], a[172:175], a[68:71], v[80:83]
    buffer_load_dwordx4 v10, s[20:23], s70 offen offset:2048 sc1 lds
    v_mfma_f32_16x16x32_bf16 v[84:87], a[168:171], a[72:75], v[84:87]
    v_mfma_f32_16x16x32_bf16 v[84:87], a[172:175], a[76:79], v[84:87]
    buffer_store_dwordx4 a[232:235], v20, s[24:27], s80 offen offset:2048 sc1
    v_mfma_f32_16x16x32_bf16 v[88:91], a[168:171], a[80:83], v[88:91]
    v_mfma_f32_16x16x32_bf16 v[88:91], a[172:175], a[84:87], v[88:91]
    buffer_load_dwordx4 v10, s[20:23], s70 offen offset:3072 sc1 lds
    v_mfma_f32_16x16x32_bf16 v[92:95], a[168:171], a[88:91], v[92:95]
    s_add_u32 m0, s67, 65536
    v_mfma_f32_16x16x32_bf16 v[92:95], a[172:175], a[92:95], v[92:95]
    s_waitcnt lgkmcnt(6)
    s_waitcnt lgkmcnt(0)
    v_mfma_f32_16x16x32_bf16 v[96:99], a[176:179], a[32:35], v[96:99]
    s_waitcnt vmcnt(33)
    v_mfma_f32_16x16x32_bf16 v[96:99], a[180:183], a[36:39], v[96:99]
    buffer_load_dwordx4 v4, s[4:7], s71 offen offset:0  lds
    v_mfma_f32_16x16x32_bf16 v[100:103], a[176:179], a[40:43], v[100:103]
    ds_read_b64_tr_b16 a[160:161], v16 offset:32768
    v_mfma_f32_16x16x32_bf16 v[100:103], a[180:183], a[44:47], v[100:103]
    v_mfma_f32_16x16x32_bf16 v[104:107], a[176:179], a[48:51], v[104:107]
    s_waitcnt vmcnt(30)
    ds_read_b64_tr_b16 a[162:163], v16 offset:33280
    v_mfma_f32_16x16x32_bf16 v[104:107], a[180:183], a[52:55], v[104:107]
    buffer_load_dwordx4 v4, s[8:11], s71 offen offset:1024  lds
    v_mfma_f32_16x16x32_bf16 v[108:111], a[176:179], a[56:59], v[108:111]
    ds_read_b64_tr_b16 a[164:165], v16 offset:49152
    v_mfma_f32_16x16x32_bf16 v[108:111], a[180:183], a[60:63], v[108:111]
    v_mfma_f32_16x16x32_bf16 v[112:115], a[176:179], a[64:67], v[112:115]
    ds_read_b64_tr_b16 a[166:167], v16 offset:49664
    v_mfma_f32_16x16x32_bf16 v[112:115], a[180:183], a[68:71], v[112:115]
    buffer_load_dwordx4 v5, s[4:7], s71 offen offset:2048  lds
    v_mfma_f32_16x16x32_bf16 v[116:119], a[176:179], a[72:75], v[116:119]
    v_mfma_f32_16x16x32_bf16 v[116:119], a[180:183], a[76:79], v[116:119]
    v_mfma_f32_16x16x32_bf16 v[120:123], a[176:179], a[80:83], v[120:123]
    v_mfma_f32_16x16x32_bf16 v[120:123], a[180:183], a[84:87], v[120:123]
    buffer_load_dwordx4 v5, s[8:11], s71 offen offset:3072  lds
    v_mfma_f32_16x16x32_bf16 v[124:127], a[176:179], a[88:91], v[124:127]
    s_add_u32 m0, s67, 81920
    v_mfma_f32_16x16x32_bf16 v[124:127], a[180:183], a[92:95], v[124:127]
    s_add_u32 s71, s71, 114688
    v_mfma_f32_16x16x32_bf16 v[128:131], a[184:187], a[32:35], v[128:131]
    v_mfma_f32_16x16x32_bf16 v[128:131], a[188:191], a[36:39], v[128:131]
    buffer_load_dwordx4 v4, s[4:7], s71 offen offset:0  lds
    v_mfma_f32_16x16x32_bf16 v[132:135], a[184:187], a[40:43], v[132:135]
    ds_read_b64_tr_b16 a[168:169], v17 offset:32768
    v_mfma_f32_16x16x32_bf16 v[132:135], a[188:191], a[44:47], v[132:135]
    v_mfma_f32_16x16x32_bf16 v[136:139], a[184:187], a[48:51], v[136:139]
    ds_read_b64_tr_b16 a[170:171], v17 offset:33280
    v_mfma_f32_16x16x32_bf16 v[136:139], a[188:191], a[52:55], v[136:139]
    buffer_load_dwordx4 v4, s[8:11], s71 offen offset:1024  lds
    v_mfma_f32_16x16x32_bf16 v[140:143], a[184:187], a[56:59], v[140:143]
    ds_read_b64_tr_b16 a[172:173], v17 offset:49152
    v_mfma_f32_16x16x32_bf16 v[140:143], a[188:191], a[60:63], v[140:143]
    v_mfma_f32_16x16x32_bf16 v[144:147], a[184:187], a[64:67], v[144:147]
    ds_read_b64_tr_b16 a[174:175], v17 offset:49664
    v_mfma_f32_16x16x32_bf16 v[144:147], a[188:191], a[68:71], v[144:147]
    buffer_load_dwordx4 v5, s[4:7], s71 offen offset:2048  lds
    v_mfma_f32_16x16x32_bf16 v[148:151], a[184:187], a[72:75], v[148:151]
    s_waitcnt vmcnt(31)
    v_mfma_f32_16x16x32_bf16 v[148:151], a[188:191], a[76:79], v[148:151]
    s_barrier
    v_mfma_f32_16x16x32_bf16 v[152:155], a[184:187], a[80:83], v[152:155]
    v_mfma_f32_16x16x32_bf16 v[152:155], a[188:191], a[84:87], v[152:155]
    buffer_load_dwordx4 v5, s[8:11], s71 offen offset:3072  lds
    ds_read_b128 a[96:99], v14 offset:16384
    v_mfma_f32_16x16x32_bf16 v[156:159], a[184:187], a[88:91], v[156:159]
    s_add_u32 s71, s71, 114688
    v_mfma_f32_16x16x32_bf16 v[156:159], a[188:191], a[92:95], v[156:159]
    s_waitcnt lgkmcnt(7)
    ds_read_b128 a[100:103], v15 offset:16384
    v_mfma_f32_16x16x32_bf16 v[160:163], a[160:163], a[32:35], v[160:163]
    s_waitcnt lgkmcnt(6)
    v_mfma_f32_16x16x32_bf16 v[160:163], a[164:167], a[36:39], v[160:163]
    ds_read_b128 a[104:107], v14 offset:18432
    v_mfma_f32_16x16x32_bf16 v[164:167], a[160:163], a[40:43], v[164:167]
    ds_read_b64_tr_b16 a[176:177], v18 offset:32768
    v_mfma_f32_16x16x32_bf16 v[164:167], a[164:167], a[44:47], v[164:167]
    ds_read_b128 a[108:111], v15 offset:18432
    v_mfma_f32_16x16x32_bf16 v[168:171], a[160:163], a[48:51], v[168:171]
    ds_read_b64_tr_b16 a[178:179], v18 offset:33280
    v_mfma_f32_16x16x32_bf16 v[168:171], a[164:167], a[52:55], v[168:171]
    ds_read_b128 a[112:115], v14 offset:20480
    v_mfma_f32_16x16x32_bf16 v[172:175], a[160:163], a[56:59], v[172:175]
    ds_read_b64_tr_b16 a[180:181], v18 offset:49152
    v_mfma_f32_16x16x32_bf16 v[172:175], a[164:167], a[60:63], v[172:175]
    ds_read_b128 a[116:119], v15 offset:20480
    v_mfma_f32_16x16x32_bf16 v[176:179], a[160:163], a[64:67], v[176:179]
    ds_read_b64_tr_b16 a[182:183], v18 offset:49664
    v_mfma_f32_16x16x32_bf16 v[176:179], a[164:167], a[68:71], v[176:179]
    ds_read_b128 a[120:123], v14 offset:22528
    v_mfma_f32_16x16x32_bf16 v[180:183], a[160:163], a[72:75], v[180:183]
    v_mfma_f32_16x16x32_bf16 v[180:183], a[164:167], a[76:79], v[180:183]
    ds_read_b128 a[124:127], v15 offset:22528
    v_mfma_f32_16x16x32_bf16 v[184:187], a[160:163], a[80:83], v[184:187]
    v_mfma_f32_16x16x32_bf16 v[184:187], a[164:167], a[84:87], v[184:187]
    ds_read_b128 a[128:131], v14 offset:24576
    v_mfma_f32_16x16x32_bf16 v[188:191], a[160:163], a[88:91], v[188:191]
    v_mfma_f32_16x16x32_bf16 v[188:191], a[164:167], a[92:95], v[188:191]
    s_waitcnt lgkmcnt(15)
    ds_read_b128 a[132:135], v15 offset:24576
    v_mfma_f32_16x16x32_bf16 v[192:195], a[168:171], a[32:35], v[192:195]
    s_waitcnt lgkmcnt(14)
    s_add_u32 s70, s70, 16384
    v_mfma_f32_16x16x32_bf16 v[192:195], a[172:175], a[36:39], v[192:195]
    buffer_store_dwordx4 a[248:251], v20, s[24:27], s84 offen offset:2048 sc1
    ds_read_b128 a[136:139], v14 offset:26624
    v_mfma_f32_16x16x32_bf16 v[196:199], a[168:171], a[40:43], v[196:199]
    ds_read_b64_tr_b16 a[184:185], v19 offset:32768
    v_mfma_f32_16x16x32_bf16 v[196:199], a[172:175], a[44:47], v[196:199]
    ds_read_b128 a[140:143], v15 offset:26624
    v_mfma_f32_16x16x32_bf16 v[200:203], a[168:171], a[48:51], v[200:203]
    ds_read_b64_tr_b16 a[186:187], v19 offset:33280
    v_mfma_f32_16x16x32_bf16 v[200:203], a[172:175], a[52:55], v[200:203]
    v_mfma_f32_16x16x32_bf16 v[204:207], a[168:171], a[56:59], v[204:207]
    ds_read_b64_tr_b16 a[188:189], v19 offset:49152
    v_mfma_f32_16x16x32_bf16 v[204:207], a[172:175], a[60:63], v[204:207]
    buffer_store_dwordx4 a[236:239], v20, s[24:27], s81 offen offset:2048 sc1
    v_mfma_f32_16x16x32_bf16 v[208:211], a[168:171], a[64:67], v[208:211]
    ds_read_b64_tr_b16 a[190:191], v19 offset:49664
    v_mfma_f32_16x16x32_bf16 v[208:211], a[172:175], a[68:71], v[208:211]
    v_xor_b32 v16, 0x10000, v16
    v_mfma_f32_16x16x32_bf16 v[212:215], a[168:171], a[72:75], v[212:215]
    v_mfma_f32_16x16x32_bf16 v[212:215], a[172:175], a[76:79], v[212:215]
    v_xor_b32 v17, 0x10000, v17
    v_mfma_f32_16x16x32_bf16 v[216:219], a[168:171], a[80:83], v[216:219]
    v_xor_b32 v18, 0x10000, v18
    v_mfma_f32_16x16x32_bf16 v[216:219], a[172:175], a[84:87], v[216:219]
    buffer_store_dwordx4 a[252:255], v20, s[24:27], s85 offen offset:2048 sc1
    v_xor_b32 v19, 0x10000, v19
    v_mfma_f32_16x16x32_bf16 v[220:223], a[168:171], a[88:91], v[220:223]
    s_add_u32 m0, s67, 98304
    v_mfma_f32_16x16x32_bf16 v[220:223], a[172:175], a[92:95], v[220:223]
    s_waitcnt lgkmcnt(14)
    s_waitcnt lgkmcnt(0)
    v_mfma_f32_16x16x32_bf16 v[224:227], a[176:179], a[32:35], v[224:227]
    s_waitcnt vmcnt(31)
    v_mfma_f32_16x16x32_bf16 v[224:227], a[180:183], a[36:39], v[224:227]
    buffer_load_dwordx4 v2, s[12:15], s72 offen offset:0  lds
    v_mfma_f32_16x16x32_bf16 v[228:231], a[176:179], a[40:43], v[228:231]
    ds_read_b64_tr_b16 a[160:161], v11 offset:0
    v_mfma_f32_16x16x32_bf16 v[228:231], a[180:183], a[44:47], v[228:231]
    ds_read_b128 a[144:147], v14 offset:28672
    v_mfma_f32_16x16x32_bf16 v[232:235], a[176:179], a[48:51], v[232:235]
    s_waitcnt vmcnt(28)
    ds_read_b64_tr_b16 a[162:163], v11 offset:256
    v_mfma_f32_16x16x32_bf16 v[232:235], a[180:183], a[52:55], v[232:235]
    s_add_u32 s76, s76, 1
    buffer_load_dwordx4 v3, s[12:15], s72 offen offset:1024  lds
    v_mfma_f32_16x16x32_bf16 v[236:239], a[176:179], a[56:59], v[236:239]
    ds_read_b64_tr_b16 a[164:165], v11 offset:16384
    v_mfma_f32_16x16x32_bf16 v[236:239], a[180:183], a[60:63], v[236:239]
    ds_read_b128 a[148:151], v15 offset:28672
    v_mfma_f32_16x16x32_bf16 v[240:243], a[176:179], a[64:67], v[240:243]
    ds_read_b64_tr_b16 a[166:167], v11 offset:16640
    v_mfma_f32_16x16x32_bf16 v[240:243], a[180:183], a[68:71], v[240:243]
    buffer_load_dwordx4 v2, s[16:19], s72 offen offset:2048  lds
    v_mfma_f32_16x16x32_bf16 v[244:247], a[176:179], a[72:75], v[244:247]
    v_mfma_f32_16x16x32_bf16 v[244:247], a[180:183], a[76:79], v[244:247]
    ds_read_b128 a[152:155], v14 offset:30720
    v_mfma_f32_16x16x32_bf16 v[248:251], a[176:179], a[80:83], v[248:251]
    v_mfma_f32_16x16x32_bf16 v[248:251], a[180:183], a[84:87], v[248:251]
    buffer_load_dwordx4 v3, s[16:19], s72 offen offset:3072  lds
    v_mfma_f32_16x16x32_bf16 v[252:255], a[176:179], a[88:91], v[252:255]
    s_add_u32 m0, s67, 114688
    v_mfma_f32_16x16x32_bf16 v[252:255], a[180:183], a[92:95], v[252:255]
    s_add_u32 s72, s72, 262144
    ds_read_b128 a[156:159], v15 offset:30720
    v_mfma_f32_16x16x32_bf16 a[0:3], a[184:187], a[32:35], a[0:3]
    v_mfma_f32_16x16x32_bf16 a[0:3], a[188:191], a[36:39], a[0:3]
    buffer_load_dwordx4 v2, s[12:15], s72 offen offset:0  lds
    v_mfma_f32_16x16x32_bf16 a[4:7], a[184:187], a[40:43], a[4:7]
    ds_read_b64_tr_b16 a[168:169], v12 offset:0
    v_mfma_f32_16x16x32_bf16 a[4:7], a[188:191], a[44:47], a[4:7]
    v_mfma_f32_16x16x32_bf16 a[8:11], a[184:187], a[48:51], a[8:11]
    ds_read_b64_tr_b16 a[170:171], v12 offset:256
    v_mfma_f32_16x16x32_bf16 a[8:11], a[188:191], a[52:55], a[8:11]
    buffer_load_dwordx4 v3, s[12:15], s72 offen offset:1024  lds
    v_mfma_f32_16x16x32_bf16 a[12:15], a[184:187], a[56:59], a[12:15]
    ds_read_b64_tr_b16 a[172:173], v12 offset:16384
    v_mfma_f32_16x16x32_bf16 a[12:15], a[188:191], a[60:63], a[12:15]
    v_mfma_f32_16x16x32_bf16 a[16:19], a[184:187], a[64:67], a[16:19]
    ds_read_b64_tr_b16 a[174:175], v12 offset:16640
    v_mfma_f32_16x16x32_bf16 a[16:19], a[188:191], a[68:71], a[16:19]
    buffer_load_dwordx4 v2, s[16:19], s72 offen offset:2048  lds
    v_mfma_f32_16x16x32_bf16 a[20:23], a[184:187], a[72:75], a[20:23]
    v_mfma_f32_16x16x32_bf16 a[20:23], a[188:191], a[76:79], a[20:23]
    s_waitcnt lgkmcnt(0)
    v_mfma_f32_16x16x32_bf16 a[24:27], a[184:187], a[80:83], a[24:27]
    s_barrier
    v_mfma_f32_16x16x32_bf16 a[24:27], a[188:191], a[84:87], a[24:27]
    buffer_load_dwordx4 v3, s[16:19], s72 offen offset:3072  lds
    v_mfma_f32_16x16x32_bf16 a[28:31], a[184:187], a[88:91], a[28:31]
    s_add_u32 s72, s72, 262144
    v_mfma_f32_16x16x32_bf16 a[28:31], a[188:191], a[92:95], a[28:31]
    v_mfma_f32_16x16x32_bf16 v[32:35], a[160:163], a[96:99], v[32:35]
    s_lshl_b32 s86, s68, 6
    v_cmp_eq_u32 vcc, 0, v0
    v_mov_b32 v3, 0x7fffff00
    v_mfma_f32_16x16x32_bf16 v[32:35], a[164:167], a[100:103], v[32:35]
    s_add_u32 s86, s86, 118495232
    v_mfma_f32_16x16x32_bf16 v[36:39], a[160:163], a[104:107], v[36:39]
    s_lshl_b32 s73, s69, 2
    ds_read_b64_tr_b16 a[176:177], v11 offset:1024
    v_mfma_f32_16x16x32_bf16 v[36:39], a[164:167], a[108:111], v[36:39]
    s_add_u32 s73, s73, s86
    v_cndmask_b32 v3, v3, v0, vcc
    v_add_u32 v2, s67, v20
    v_mfma_f32_16x16x32_bf16 v[40:43], a[160:163], a[112:115], v[40:43]
    s_sub_u32 s31, 15, s69
    ds_read_b64_tr_b16 a[178:179], v11 offset:1280
    v_add_u32 v4, 65536, v2
    v_mfma_f32_16x16x32_bf16 v[40:43], a[164:167], a[116:119], v[40:43]
    s_min_u32 s31, s31, s69
    v_lshlrev_b32 v5, 4, v0
    v_add_u32 v5, 65536, v5
    v_mfma_f32_16x16x32_bf16 v[44:47], a[160:163], a[120:123], v[44:47]
    s_lshl_b32 s35, s31, 2
    ds_read_b64_tr_b16 a[180:181], v11 offset:17408
    v_mfma_f32_16x16x32_bf16 v[44:47], a[164:167], a[124:127], v[44:47]
    s_lshr_b32 s35, 219035, s35
    v_mfma_f32_16x16x32_bf16 v[48:51], a[160:163], a[128:131], v[48:51]
    s_and_b32 s35, s35, 15
    ds_read_b64_tr_b16 a[182:183], v11 offset:17664
    v_mfma_f32_16x16x32_bf16 v[48:51], a[164:167], a[132:135], v[48:51]
    s_lshl_b32 s35, s35, 1
    v_mfma_f32_16x16x32_bf16 v[52:55], a[160:163], a[136:139], v[52:55]
    s_mul_i32 s77, s68, 2129920
    v_mfma_f32_16x16x32_bf16 v[52:55], a[164:167], a[140:143], v[52:55]
    s_add_u32 s77, s77, 4210688
    v_mfma_f32_16x16x32_bf16 v[56:59], a[160:163], a[144:147], v[56:59]
    s_cmp_ge_u32 s69, 8
    s_cselect_b32 s32, s35, 0
    v_mfma_f32_16x16x32_bf16 v[56:59], a[164:167], a[148:151], v[56:59]
    s_lshl_b32 s18, s32, 15
    v_mfma_f32_16x16x32_bf16 v[60:63], a[160:163], a[152:155], v[60:63]
    s_add_u32 s18, s18, s77
    v_mfma_f32_16x16x32_bf16 v[60:63], a[164:167], a[156:159], v[60:63]
    s_add_u32 s16, s67, 131072
    v_mfma_f32_16x16x32_bf16 v[64:67], a[168:171], a[96:99], v[64:67]
    s_add_u32 s17, s67, 163840
    v_mfma_f32_16x16x32_bf16 v[64:67], a[172:175], a[100:103], v[64:67]
    s_mov_b32 s19, 32768
    v_mfma_f32_16x16x32_bf16 v[68:71], a[168:171], a[104:107], v[68:71]
    s_mov_b32 s20, 16384
    ds_read_b64_tr_b16 a[184:185], v12 offset:1024
    v_mfma_f32_16x16x32_bf16 v[68:71], a[172:175], a[108:111], v[68:71]
    s_mov_b32 s4, s64
    v_mfma_f32_16x16x32_bf16 v[72:75], a[168:171], a[112:115], v[72:75]
    s_mov_b32 s5, s65
    ds_read_b64_tr_b16 a[186:187], v12 offset:1280
    v_mfma_f32_16x16x32_bf16 v[72:75], a[172:175], a[116:119], v[72:75]
    s_mov_b32 s6, 268435456
    v_mfma_f32_16x16x32_bf16 v[76:79], a[168:171], a[120:123], v[76:79]
    s_mov_b32 s7, 0x20000
    ds_read_b64_tr_b16 a[188:189], v12 offset:17408
    v_mfma_f32_16x16x32_bf16 v[76:79], a[172:175], a[124:127], v[76:79]
    s_mul_i32 s84, s69, 448
    v_mfma_f32_16x16x32_bf16 v[80:83], a[168:171], a[128:131], v[80:83]
    s_lshl_b32 s87, s68, 2
    ds_read_b64_tr_b16 a[190:191], v12 offset:17664
    v_mfma_f32_16x16x32_bf16 v[80:83], a[172:175], a[132:135], v[80:83]
    s_add_u32 s84, s84, s87
    v_mfma_f32_16x16x32_bf16 v[84:87], a[168:171], a[136:139], v[84:87]
    s_add_u32 s84, s84, s66
    v_mfma_f32_16x16x32_bf16 v[84:87], a[172:175], a[140:143], v[84:87]
    s_lshl_b32 s84, s84, 10
    v_mfma_f32_16x16x32_bf16 v[88:91], a[168:171], a[144:147], v[88:91]
    s_add_u32 s84, s84, 56623104
    v_mfma_f32_16x16x32_bf16 v[88:91], a[172:175], a[148:151], v[88:91]
    s_cmp_lt_u32 s68, 14
    s_cselect_b32 s84, s84, 2147483648
    v_mfma_f32_16x16x32_bf16 v[92:95], a[168:171], a[152:155], v[92:95]
    s_lshl_b32 s85, s68, 20
    v_mfma_f32_16x16x32_bf16 v[92:95], a[172:175], a[156:159], v[92:95]
    s_waitcnt lgkmcnt(6)
    s_waitcnt lgkmcnt(0)
    v_mfma_f32_16x16x32_bf16 v[96:99], a[176:179], a[96:99], v[96:99]
    s_waitcnt vmcnt(28)
    v_mfma_f32_16x16x32_bf16 v[96:99], a[180:183], a[100:103], v[96:99]
    s_lshl_b32 s88, s69, 16
    v_mfma_f32_16x16x32_bf16 v[100:103], a[176:179], a[104:107], v[100:103]
    s_add_u32 s85, s85, s88
    ds_read_b64_tr_b16 a[160:161], v16 offset:32768
    v_mfma_f32_16x16x32_bf16 v[100:103], a[180:183], a[108:111], v[100:103]
    s_lshl_b32 s88, s66, 11
    v_mfma_f32_16x16x32_bf16 v[104:107], a[176:179], a[112:115], v[104:107]
    s_waitcnt vmcnt(24)
    ds_read_b64_tr_b16 a[162:163], v16 offset:33280
    v_mfma_f32_16x16x32_bf16 v[104:107], a[180:183], a[116:119], v[104:107]
    s_add_u32 s85, s85, s88
    v_mfma_f32_16x16x32_bf16 v[108:111], a[176:179], a[120:123], v[108:111]
    s_add_u32 s85, s85, 39845888
    ds_read_b64_tr_b16 a[164:165], v16 offset:49152
    v_mfma_f32_16x16x32_bf16 v[108:111], a[180:183], a[124:127], v[108:111]
    s_mov_b32 s83, 0xc1800000
    v_mfma_f32_16x16x32_bf16 v[112:115], a[176:179], a[128:131], v[112:115]
    s_cmp_eq_u32 s32, 0
    s_cselect_b32 s85, 2147483648, s85
    ds_read_b64_tr_b16 a[166:167], v16 offset:49664
    v_mfma_f32_16x16x32_bf16 v[112:115], a[180:183], a[132:135], v[112:115]
    s_lshl_b32 s36, s69, 2
    v_mfma_f32_16x16x32_bf16 v[116:119], a[176:179], a[136:139], v[116:119]
    s_sub_u32 s32, s36, s32
    v_mfma_f32_16x16x32_bf16 v[116:119], a[180:183], a[140:143], v[116:119]
    s_add_u32 s32, s32, 4
    v_mfma_f32_16x16x32_bf16 v[120:123], a[176:179], a[144:147], v[120:123]
    s_mov_b32 s21, -1
    v_mfma_f32_16x16x32_bf16 v[120:123], a[180:183], a[148:151], v[120:123]
    s_mov_b32 s22, 131072
    v_mfma_f32_16x16x32_bf16 v[124:127], a[176:179], a[152:155], v[124:127]
    s_mov_b32 s28, 0
    v_mfma_f32_16x16x32_bf16 v[124:127], a[180:183], a[156:159], v[124:127]
    s_mov_b32 s39, 0
    v_mfma_f32_16x16x32_bf16 v[128:131], a[184:187], a[96:99], v[128:131]
    s_mov_b32 s30, 0
    v_mfma_f32_16x16x32_bf16 v[128:131], a[188:191], a[100:103], v[128:131]
    s_mov_b32 s33, 0x47800000
    v_mfma_f32_16x16x32_bf16 v[132:135], a[184:187], a[104:107], v[132:135]
    s_mov_b32 s38, 0xffff0000
    ds_read_b64_tr_b16 a[168:169], v17 offset:32768
    v_mfma_f32_16x16x32_bf16 v[132:135], a[188:191], a[108:111], v[132:135]
    s_min_u32 s29, s35, 1
    v_mfma_f32_16x16x32_bf16 v[136:139], a[184:187], a[112:115], v[136:139]
    s_lshl_b32 s36, s68, 3
    ds_read_b64_tr_b16 a[170:171], v17 offset:33280
    v_mfma_f32_16x16x32_bf16 v[136:139], a[188:191], a[116:119], v[136:139]
    s_add_u32 s36, s36, s31
    v_mfma_f32_16x16x32_bf16 v[140:143], a[184:187], a[120:123], v[140:143]
    s_lshl_b32 s36, s36, 2
    ds_read_b64_tr_b16 a[172:173], v17 offset:49152
    v_mfma_f32_16x16x32_bf16 v[140:143], a[188:191], a[124:127], v[140:143]
    s_lshl4_add_u32 s78, s31, s68
    v_mfma_f32_16x16x32_bf16 v[144:147], a[184:187], a[128:131], v[144:147]
    s_lshl4_add_u32 s78, s78, s66
    ds_read_b64_tr_b16 a[174:175], v17 offset:49664
    v_mfma_f32_16x16x32_bf16 v[144:147], a[188:191], a[132:135], v[144:147]
    s_waitcnt vmcnt(8)
    v_mfma_f32_16x16x32_bf16 v[148:151], a[184:187], a[136:139], v[148:151]
    s_waitcnt vmcnt(19)
    v_mfma_f32_16x16x32_bf16 v[148:151], a[188:191], a[140:143], v[148:151]
    s_barrier
    v_mfma_f32_16x16x32_bf16 v[152:155], a[184:187], a[144:147], v[152:155]
    s_lshl_b32 s78, s78, 6
    v_mfma_f32_16x16x32_bf16 v[152:155], a[188:191], a[148:151], v[152:155]
    s_add_u32 s78, s78, 118555136
    ds_read_b128 a[32:35], v14 offset:0
    v_mfma_f32_16x16x32_bf16 v[156:159], a[184:187], a[152:155], v[156:159]
    s_add_u32 s36, s36, s66
    buffer_store_dword v23, v3, s[24:27], s73 offen sc1
    v_mfma_f32_16x16x32_bf16 v[156:159], a[188:191], a[156:159], v[156:159]
    s_waitcnt lgkmcnt(7)
    ds_read_b128 a[36:39], v15 offset:0
    v_mfma_f32_16x16x32_bf16 v[160:163], a[160:163], a[96:99], v[160:163]
    s_waitcnt lgkmcnt(6)
    v_mfma_f32_16x16x32_bf16 v[160:163], a[164:167], a[100:103], v[160:163]
    s_mul_i32 s34, s36, 17408
    ds_read_b128 a[40:43], v14 offset:2048
    v_mfma_f32_16x16x32_bf16 v[164:167], a[160:163], a[104:107], v[164:167]
    s_add_u32 s34, s34, 109051904
    ds_read_b64_tr_b16 a[176:177], v18 offset:32768
    v_mfma_f32_16x16x32_bf16 v[164:167], a[164:167], a[108:111], v[164:167]
    s_mov_b32 s74, s78
    ds_read_b128 a[44:47], v15 offset:2048
    v_mfma_f32_16x16x32_bf16 v[168:171], a[160:163], a[112:115], v[168:171]
    s_sub_u32 s36, 15, s31
    ds_read_b64_tr_b16 a[178:179], v18 offset:33280
    v_mfma_f32_16x16x32_bf16 v[168:171], a[164:167], a[116:119], v[168:171]
    s_lshl_b32 s37, s68, 4
    ds_read_b128 a[48:51], v14 offset:4096
    v_mfma_f32_16x16x32_bf16 v[172:175], a[160:163], a[120:123], v[172:175]
    s_add_u32 s37, s37, s36
    ds_read_b64_tr_b16 a[180:181], v18 offset:49152
    v_mfma_f32_16x16x32_bf16 v[172:175], a[164:167], a[124:127], v[172:175]
    s_lshl_b32 s37, s37, 2
    ds_read_b128 a[52:55], v15 offset:4096
    v_mfma_f32_16x16x32_bf16 v[176:179], a[160:163], a[128:131], v[176:179]
    s_add_u32 s37, s37, s66
    ds_read_b64_tr_b16 a[182:183], v18 offset:49664
    v_mfma_f32_16x16x32_bf16 v[176:179], a[164:167], a[132:135], v[176:179]
    s_lshl_b32 s37, s37, 14
    ds_read_b128 a[56:59], v14 offset:6144
    v_mfma_f32_16x16x32_bf16 v[180:183], a[160:163], a[136:139], v[180:183]
    s_add_u32 s37, s37, 39845888
    v_mfma_f32_16x16x32_bf16 v[180:183], a[164:167], a[140:143], v[180:183]
    s_lshl_b32 s36, s36, 4
    ds_read_b128 a[60:63], v15 offset:6144
    v_mfma_f32_16x16x32_bf16 v[184:187], a[160:163], a[144:147], v[184:187]
    s_lshl_b32 s73, s2, 2
    v_mfma_f32_16x16x32_bf16 v[184:187], a[164:167], a[148:151], v[184:187]
    s_add_u32 s73, s73, 118494208
    ds_read_b128 a[64:67], v14 offset:8192
    v_mfma_f32_16x16x32_bf16 v[188:191], a[160:163], a[152:155], v[188:191]
    v_mfma_f32_16x16x32_bf16 v[188:191], a[164:167], a[156:159], v[188:191]
    s_waitcnt lgkmcnt(15)
    ds_read_b128 a[68:71], v15 offset:8192
    v_mfma_f32_16x16x32_bf16 v[192:195], a[168:171], a[96:99], v[192:195]
    s_waitcnt lgkmcnt(14)
    v_mfma_f32_16x16x32_bf16 v[192:195], a[172:175], a[100:103], v[192:195]
    ds_read_b128 a[72:75], v14 offset:10240
    v_mfma_f32_16x16x32_bf16 v[196:199], a[168:171], a[104:107], v[196:199]
    ds_read_b64_tr_b16 a[184:185], v19 offset:32768
    v_mfma_f32_16x16x32_bf16 v[196:199], a[172:175], a[108:111], v[196:199]
    ds_read_b128 a[76:79], v15 offset:10240
    v_mfma_f32_16x16x32_bf16 v[200:203], a[168:171], a[112:115], v[200:203]
    ds_read_b64_tr_b16 a[186:187], v19 offset:33280
    v_mfma_f32_16x16x32_bf16 v[200:203], a[172:175], a[116:119], v[200:203]
    v_mfma_f32_16x16x32_bf16 v[204:207], a[168:171], a[120:123], v[204:207]
    ds_read_b64_tr_b16 a[188:189], v19 offset:49152
    v_mfma_f32_16x16x32_bf16 v[204:207], a[172:175], a[124:127], v[204:207]
    v_mfma_f32_16x16x32_bf16 v[208:211], a[168:171], a[128:131], v[208:211]
    ds_read_b64_tr_b16 a[190:191], v19 offset:49664
    v_mfma_f32_16x16x32_bf16 v[208:211], a[172:175], a[132:135], v[208:211]
    v_xor_b32 v16, 0x10000, v16
    v_mfma_f32_16x16x32_bf16 v[212:215], a[168:171], a[136:139], v[212:215]
    v_mfma_f32_16x16x32_bf16 v[212:215], a[172:175], a[140:143], v[212:215]
    v_xor_b32 v17, 0x10000, v17
    v_mfma_f32_16x16x32_bf16 v[216:219], a[168:171], a[144:147], v[216:219]
    v_xor_b32 v18, 0x10000, v18
    v_mfma_f32_16x16x32_bf16 v[216:219], a[172:175], a[148:151], v[216:219]
    v_xor_b32 v19, 0x10000, v19
    v_mfma_f32_16x16x32_bf16 v[220:223], a[168:171], a[152:155], v[220:223]
    v_mfma_f32_16x16x32_bf16 v[220:223], a[172:175], a[156:159], v[220:223]
    s_waitcnt lgkmcnt(14)
    s_waitcnt lgkmcnt(0)
    v_mfma_f32_16x16x32_bf16 v[224:227], a[176:179], a[96:99], v[224:227]
    s_waitcnt vmcnt(16)
    v_mfma_f32_16x16x32_bf16 v[224:227], a[180:183], a[100:103], v[224:227]
    v_mfma_f32_16x16x32_bf16 v[228:231], a[176:179], a[104:107], v[228:231]
    ds_read_b64_tr_b16 a[160:161], v13 offset:0
    v_mfma_f32_16x16x32_bf16 v[228:231], a[180:183], a[108:111], v[228:231]
    ds_read_b128 a[80:83], v14 offset:12288
    v_mfma_f32_16x16x32_bf16 v[232:235], a[176:179], a[112:115], v[232:235]
    s_waitcnt vmcnt(12)
    ds_read_b64_tr_b16 a[162:163], v13 offset:256
    v_mfma_f32_16x16x32_bf16 v[232:235], a[180:183], a[116:119], v[232:235]
    s_add_u32 s76, s76, 1
    v_mfma_f32_16x16x32_bf16 v[236:239], a[176:179], a[120:123], v[236:239]
    ds_read_b64_tr_b16 a[164:165], v13 offset:16384
    v_mfma_f32_16x16x32_bf16 v[236:239], a[180:183], a[124:127], v[236:239]
    ds_read_b128 a[84:87], v15 offset:12288
    v_mfma_f32_16x16x32_bf16 v[240:243], a[176:179], a[128:131], v[240:243]
    ds_read_b64_tr_b16 a[166:167], v13 offset:16640
    v_mfma_f32_16x16x32_bf16 v[240:243], a[180:183], a[132:135], v[240:243]
    v_mfma_f32_16x16x32_bf16 v[244:247], a[176:179], a[136:139], v[244:247]
    v_mfma_f32_16x16x32_bf16 v[244:247], a[180:183], a[140:143], v[244:247]
    ds_read_b128 a[88:91], v14 offset:14336
    v_mfma_f32_16x16x32_bf16 v[248:251], a[176:179], a[144:147], v[248:251]
    v_mfma_f32_16x16x32_bf16 v[248:251], a[180:183], a[148:151], v[248:251]
    v_mfma_f32_16x16x32_bf16 v[252:255], a[176:179], a[152:155], v[252:255]
    v_mfma_f32_16x16x32_bf16 v[252:255], a[180:183], a[156:159], v[252:255]
    ds_read_b128 a[92:95], v15 offset:14336
    v_mfma_f32_16x16x32_bf16 a[0:3], a[184:187], a[96:99], a[0:3]
    v_mfma_f32_16x16x32_bf16 a[0:3], a[188:191], a[100:103], a[0:3]
    v_mfma_f32_16x16x32_bf16 a[4:7], a[184:187], a[104:107], a[4:7]
    ds_read_b64_tr_b16 a[168:169], v8 offset:0
    v_mfma_f32_16x16x32_bf16 a[4:7], a[188:191], a[108:111], a[4:7]
    v_mfma_f32_16x16x32_bf16 a[8:11], a[184:187], a[112:115], a[8:11]
    ds_read_b64_tr_b16 a[170:171], v8 offset:256
    v_mfma_f32_16x16x32_bf16 a[8:11], a[188:191], a[116:119], a[8:11]
    v_mfma_f32_16x16x32_bf16 a[12:15], a[184:187], a[120:123], a[12:15]
    ds_read_b64_tr_b16 a[172:173], v8 offset:16384
    v_mfma_f32_16x16x32_bf16 a[12:15], a[188:191], a[124:127], a[12:15]
    v_mfma_f32_16x16x32_bf16 a[16:19], a[184:187], a[128:131], a[16:19]
    ds_read_b64_tr_b16 a[174:175], v8 offset:16640
    v_mfma_f32_16x16x32_bf16 a[16:19], a[188:191], a[132:135], a[16:19]
    v_mfma_f32_16x16x32_bf16 a[20:23], a[184:187], a[136:139], a[20:23]
    v_mfma_f32_16x16x32_bf16 a[20:23], a[188:191], a[140:143], a[20:23]
    s_waitcnt lgkmcnt(0)
    v_mfma_f32_16x16x32_bf16 a[24:27], a[184:187], a[144:147], a[24:27]
    s_barrier
    v_mfma_f32_16x16x32_bf16 a[24:27], a[188:191], a[148:151], a[24:27]
    v_mfma_f32_16x16x32_bf16 a[28:31], a[184:187], a[152:155], a[28:31]
    v_mfma_f32_16x16x32_bf16 a[28:31], a[188:191], a[156:159], a[28:31]
fz_last2:
    v_mfma_f32_16x16x32_bf16 v[32:35], a[160:163], a[32:35], v[32:35]
    s_add_u32 s36, s36, s68
    v_mfma_f32_16x16x32_bf16 v[32:35], a[164:167], a[36:39], v[32:35]
    s_lshl_b32 s36, s36, 2
    v_mfma_f32_16x16x32_bf16 v[36:39], a[160:163], a[40:43], v[36:39]
    s_add_u32 s36, s36, 118494208
    ds_read_b64_tr_b16 a[176:177], v13 offset:1024
    v_mfma_f32_16x16x32_bf16 v[36:39], a[164:167], a[44:47], v[36:39]
    s_cmp_ge_u32 s69, 8
    s_cselect_b32 s79, s34, s37
    s_cselect_b32 s78, s78, s36
    v_mfma_f32_16x16x32_bf16 v[40:43], a[160:163], a[48:51], v[40:43]
    s_lshl_b32 s36, s68, 3
    ds_read_b64_tr_b16 a[178:179], v13 offset:1280
    v_mfma_f32_16x16x32_bf16 v[40:43], a[164:167], a[52:55], v[40:43]
    s_add_u32 s36, s36, s66
    v_mfma_f32_16x16x32_bf16 v[44:47], a[160:163], a[56:59], v[44:47]
    s_mul_i32 s36, s36, 57344
    ds_read_b64_tr_b16 a[180:181], v13 offset:17408
    v_mfma_f32_16x16x32_bf16 v[44:47], a[164:167], a[60:63], v[44:47]
    s_add_u32 s80, s36, 56623104
    v_mfma_f32_16x16x32_bf16 v[48:51], a[160:163], a[64:67], v[48:51]
    s_lshl_b32 s36, s68, 6
    ds_read_b64_tr_b16 a[182:183], v13 offset:17664
    v_mfma_f32_16x16x32_bf16 v[48:51], a[164:167], a[68:71], v[48:51]
    s_add_u32 s36, s36, 118494208
    v_mfma_f32_16x16x32_bf16 v[52:55], a[160:163], a[72:75], v[52:55]
    s_cmp_eq_u32 s69, 7
    s_cselect_b32 s37, 49152, 0
    v_mfma_f32_16x16x32_bf16 v[52:55], a[164:167], a[76:79], v[52:55]
    s_add_u32 s80, s80, s37
    v_mfma_f32_16x16x32_bf16 v[56:59], a[160:163], a[80:83], v[56:59]
    s_lshl_b32 s37, s69, 7
    v_mfma_f32_16x16x32_bf16 v[56:59], a[164:167], a[84:87], v[56:59]
    s_cmp_eq_u32 s69, 7
    s_cselect_b32 s37, 1377024, s37
    v_mfma_f32_16x16x32_bf16 v[60:63], a[160:163], a[88:91], v[60:63]
    s_cmp_lt_u32 s69, 8
    s_cselect_b32 s81, s36, 2147483648
    s_cselect_b32 s37, s37, 0
    v_mfma_f32_16x16x32_bf16 v[60:63], a[164:167], a[92:95], v[60:63]
    s_lshl2_add_u32 s3, s2, s66
    v_mfma_f32_16x16x32_bf16 v[64:67], a[168:171], a[32:35], v[64:67]
    s_mul_i32 s3, s3, 30720
    v_mfma_f32_16x16x32_bf16 v[64:67], a[172:175], a[36:39], v[64:67]
    s_add_u32 s3, s3, 65011712
    v_mfma_f32_16x16x32_bf16 v[68:71], a[168:171], a[40:43], v[68:71]
    s_add_u32 s70, s58, s37
    s_addc_u32 s71, s59, 0
    ds_read_b64_tr_b16 a[184:185], v8 offset:1024
    v_mfma_f32_16x16x32_bf16 v[68:71], a[172:175], a[44:47], v[68:71]
    v_mfma_f32_16x16x32_bf16 v[72:75], a[168:171], a[48:51], v[72:75]
    ds_read_b64_tr_b16 a[186:187], v8 offset:1280
    v_mfma_f32_16x16x32_bf16 v[72:75], a[172:175], a[52:55], v[72:75]
    v_mfma_f32_16x16x32_bf16 v[76:79], a[168:171], a[56:59], v[76:79]
    ds_read_b64_tr_b16 a[188:189], v8 offset:17408
    v_mfma_f32_16x16x32_bf16 v[76:79], a[172:175], a[60:63], v[76:79]
    v_mfma_f32_16x16x32_bf16 v[80:83], a[168:171], a[64:67], v[80:83]
    ds_read_b64_tr_b16 a[190:191], v8 offset:17664
    v_mfma_f32_16x16x32_bf16 v[80:83], a[172:175], a[68:71], v[80:83]
    v_mfma_f32_16x16x32_bf16 v[84:87], a[168:171], a[72:75], v[84:87]
    v_mfma_f32_16x16x32_bf16 v[84:87], a[172:175], a[76:79], v[84:87]
    v_mfma_f32_16x16x32_bf16 v[88:91], a[168:171], a[80:83], v[88:91]
    v_mfma_f32_16x16x32_bf16 v[88:91], a[172:175], a[84:87], v[88:91]
    v_mfma_f32_16x16x32_bf16 v[92:95], a[168:171], a[88:91], v[92:95]
    v_mfma_f32_16x16x32_bf16 v[92:95], a[172:175], a[92:95], v[92:95]
    s_waitcnt lgkmcnt(6)
    s_waitcnt lgkmcnt(0)
    v_mfma_f32_16x16x32_bf16 v[96:99], a[176:179], a[32:35], v[96:99]
    s_waitcnt vmcnt(5)
    v_mfma_f32_16x16x32_bf16 v[96:99], a[180:183], a[36:39], v[96:99]
    v_mfma_f32_16x16x32_bf16 v[100:103], a[176:179], a[40:43], v[100:103]
    ds_read_b64_tr_b16 a[160:161], v16 offset:32768
    v_mfma_f32_16x16x32_bf16 v[100:103], a[180:183], a[44:47], v[100:103]
    v_mfma_f32_16x16x32_bf16 v[104:107], a[176:179], a[48:51], v[104:107]
    s_waitcnt vmcnt(1)
    ds_read_b64_tr_b16 a[162:163], v16 offset:33280
    v_mfma_f32_16x16x32_bf16 v[104:107], a[180:183], a[52:55], v[104:107]
    v_mfma_f32_16x16x32_bf16 v[108:111], a[176:179], a[56:59], v[108:111]
    ds_read_b64_tr_b16 a[164:165], v16 offset:49152
    v_mfma_f32_16x16x32_bf16 v[108:111], a[180:183], a[60:63], v[108:111]
    v_mfma_f32_16x16x32_bf16 v[112:115], a[176:179], a[64:67], v[112:115]
    ds_read_b64_tr_b16 a[166:167], v16 offset:49664
    v_mfma_f32_16x16x32_bf16 v[112:115], a[180:183], a[68:71], v[112:115]
    v_mfma_f32_16x16x32_bf16 v[116:119], a[176:179], a[72:75], v[116:119]
    v_mfma_f32_16x16x32_bf16 v[116:119], a[180:183], a[76:79], v[116:119]
    v_mfma_f32_16x16x32_bf16 v[120:123], a[176:179], a[80:83], v[120:123]
    v_mfma_f32_16x16x32_bf16 v[120:123], a[180:183], a[84:87], v[120:123]
    v_mfma_f32_16x16x32_bf16 v[124:127], a[176:179], a[88:91], v[124:127]
    v_mfma_f32_16x16x32_bf16 v[124:127], a[180:183], a[92:95], v[124:127]
    v_mfma_f32_16x16x32_bf16 v[128:131], a[184:187], a[32:35], v[128:131]
    v_mfma_f32_16x16x32_bf16 v[128:131], a[188:191], a[36:39], v[128:131]
    v_mfma_f32_16x16x32_bf16 v[132:135], a[184:187], a[40:43], v[132:135]
    ds_read_b64_tr_b16 a[168:169], v17 offset:32768
    v_mfma_f32_16x16x32_bf16 v[132:135], a[188:191], a[44:47], v[132:135]
    v_mfma_f32_16x16x32_bf16 v[136:139], a[184:187], a[48:51], v[136:139]
    ds_read_b64_tr_b16 a[170:171], v17 offset:33280
    v_mfma_f32_16x16x32_bf16 v[136:139], a[188:191], a[52:55], v[136:139]
    v_mul_f32 v96, v96, v32
    v_mul_f32 v97, v97, v33
    v_mfma_f32_16x16x32_bf16 v[140:143], a[184:187], a[56:59], v[140:143]
    ds_read_b64_tr_b16 a[172:173], v17 offset:49152
    v_mul_f32 v98, v98, v34
    v_mfma_f32_16x16x32_bf16 v[140:143], a[188:191], a[60:63], v[140:143]
    v_mul_f32 v99, v99, v35
    v_mul_f32 v128, v128, v64
    v_mfma_f32_16x16x32_bf16 v[144:147], a[184:187], a[64:67], v[144:147]
    ds_read_b64_tr_b16 a[174:175], v17 offset:49664
    v_mul_f32 v129, v129, v65
    v_mfma_f32_16x16x32_bf16 v[144:147], a[188:191], a[68:71], v[144:147]
    v_mul_f32 v130, v130, v66
    v_mul_f32 v131, v131, v67
    v_mfma_f32_16x16x32_bf16 v[148:151], a[184:187], a[72:75], v[148:151]
    v_mul_f32 v32, s83, v32
    v_mul_f32 v33, s83, v33
    v_mfma_f32_16x16x32_bf16 v[148:151], a[188:191], a[76:79], v[148:151]
    v_mul_f32 v34, s83, v34
    v_mul_f32 v35, s83, v35
    v_mfma_f32_16x16x32_bf16 v[152:155], a[184:187], a[80:83], v[152:155]
    v_mul_f32 v64, s83, v64
    v_mul_f32 v65, s83, v65
    v_mfma_f32_16x16x32_bf16 v[152:155], a[188:191], a[84:87], v[152:155]
    v_mul_f32 v66, s83, v66
    v_mul_f32 v67, s83, v67
    v_mfma_f32_16x16x32_bf16 v[156:159], a[184:187], a[88:91], v[156:159]
    v_exp_f32 v32, v32
    v_mfma_f32_16x16x32_bf16 v[156:159], a[188:191], a[92:95], v[156:159]
    s_waitcnt lgkmcnt(6)
    v_exp_f32 v33, v33
    v_mfma_f32_16x16x32_bf16 v[160:163], a[160:163], a[32:35], v[160:163]
    s_waitcnt lgkmcnt(4)
    v_exp_f32 v34, v34
    v_mfma_f32_16x16x32_bf16 v[160:163], a[164:167], a[36:39], v[160:163]
    v_exp_f32 v35, v35
    v_mfma_f32_16x16x32_bf16 v[164:167], a[160:163], a[40:43], v[164:167]
    ds_read_b64_tr_b16 a[176:177], v18 offset:32768
    v_mfma_f32_16x16x32_bf16 v[164:167], a[164:167], a[44:47], v[164:167]
    v_exp_f32 v64, v64
    v_mfma_f32_16x16x32_bf16 v[168:171], a[160:163], a[48:51], v[168:171]
    ds_read_b64_tr_b16 a[178:179], v18 offset:33280
    v_mfma_f32_16x16x32_bf16 v[168:171], a[164:167], a[52:55], v[168:171]
    v_exp_f32 v65, v65
    v_mfma_f32_16x16x32_bf16 v[172:175], a[160:163], a[56:59], v[172:175]
    ds_read_b64_tr_b16 a[180:181], v18 offset:49152
    v_mfma_f32_16x16x32_bf16 v[172:175], a[164:167], a[60:63], v[172:175]
    v_exp_f32 v66, v66
    v_mfma_f32_16x16x32_bf16 v[176:179], a[160:163], a[64:67], v[176:179]
    ds_read_b64_tr_b16 a[182:183], v18 offset:49664
    v_mfma_f32_16x16x32_bf16 v[176:179], a[164:167], a[68:71], v[176:179]
    v_exp_f32 v67, v67
    v_mfma_f32_16x16x32_bf16 v[180:183], a[160:163], a[72:75], v[180:183]
    v_add_f32 v32, 1.0, v32
    v_add_f32 v33, 1.0, v33
    v_mfma_f32_16x16x32_bf16 v[180:183], a[164:167], a[76:79], v[180:183]
    v_add_f32 v34, 1.0, v34
    v_add_f32 v35, 1.0, v35
    v_mfma_f32_16x16x32_bf16 v[184:187], a[160:163], a[80:83], v[184:187]
    v_add_f32 v64, 1.0, v64
    v_add_f32 v65, 1.0, v65
    v_mfma_f32_16x16x32_bf16 v[184:187], a[164:167], a[84:87], v[184:187]
    v_add_f32 v66, 1.0, v66
    v_add_f32 v67, 1.0, v67
    v_mfma_f32_16x16x32_bf16 v[188:191], a[160:163], a[88:91], v[188:191]
    v_rcp_f32 v32, v32
    v_mfma_f32_16x16x32_bf16 v[188:191], a[164:167], a[92:95], v[188:191]
    s_waitcnt lgkmcnt(6)
    v_rcp_f32 v33, v33
    v_mfma_f32_16x16x32_bf16 v[192:195], a[168:171], a[32:35], v[192:195]
    s_waitcnt lgkmcnt(4)
    v_rcp_f32 v34, v34
    v_mfma_f32_16x16x32_bf16 v[192:195], a[172:175], a[36:39], v[192:195]
    v_rcp_f32 v35, v35
    v_mfma_f32_16x16x32_bf16 v[196:199], a[168:171], a[40:43], v[196:199]
    ds_read_b64_tr_b16 a[184:185], v19 offset:32768
    v_mfma_f32_16x16x32_bf16 v[196:199], a[172:175], a[44:47], v[196:199]
    v_rcp_f32 v64, v64
    v_mfma_f32_16x16x32_bf16 v[200:203], a[168:171], a[48:51], v[200:203]
    buffer_load_dword v21, v22, s[24:27], s86 offen sc1
    ds_read_b64_tr_b16 a[186:187], v19 offset:33280
    v_mfma_f32_16x16x32_bf16 v[200:203], a[172:175], a[52:55], v[200:203]
    v_cvt_pk_bf16_f32 v160, v160, v161
    v_cvt_pk_bf16_f32 v161, v162, v163
    v_mfma_f32_16x16x32_bf16 v[204:207], a[168:171], a[56:59], v[204:207]
    ds_read_b64_tr_b16 a[188:189], v19 offset:49152
    v_cvt_pk_bf16_f32 v162, v192, v193
    v_mfma_f32_16x16x32_bf16 v[204:207], a[172:175], a[60:63], v[204:207]
    v_cvt_pk_bf16_f32 v163, v194, v195
    ds_write_b128 v4, v[160:163] offset:0
    v_mfma_f32_16x16x32_bf16 v[208:211], a[168:171], a[64:67], v[208:211]
    ds_read_b64_tr_b16 a[190:191], v19 offset:49664
    v_mfma_f32_16x16x32_bf16 v[208:211], a[172:175], a[68:71], v[208:211]
    s_add_u32 s88, s85, 0
    buffer_store_dwordx4 v[160:163], v20, s[24:27], s88 offen offset:0 sc1
    v_mfma_f32_16x16x32_bf16 v[212:215], a[168:171], a[72:75], v[212:215]
    v_cvt_pk_bf16_f32 v164, v164, v165
    v_cvt_pk_bf16_f32 v165, v166, v167
    v_mfma_f32_16x16x32_bf16 v[212:215], a[172:175], a[76:79], v[212:215]
    v_cvt_pk_bf16_f32 v166, v196, v197
    v_cvt_pk_bf16_f32 v167, v198, v199
    v_mfma_f32_16x16x32_bf16 v[216:219], a[168:171], a[80:83], v[216:219]
    ds_write_b128 v4, v[164:167] offset:1024
    v_mfma_f32_16x16x32_bf16 v[216:219], a[172:175], a[84:87], v[216:219]
    s_add_u32 s88, s85, 16384
    buffer_store_dwordx4 v[164:167], v20, s[24:27], s88 offen offset:0 sc1
    v_mfma_f32_16x16x32_bf16 v[220:223], a[168:171], a[88:91], v[220:223]
    v_cvt_pk_bf16_f32 v168, v168, v169
    v_cvt_pk_bf16_f32 v169, v170, v171
    v_mfma_f32_16x16x32_bf16 v[220:223], a[172:175], a[92:95], v[220:223]
    s_waitcnt lgkmcnt(6)
    v_cvt_pk_bf16_f32 v170, v200, v201
    v_cvt_pk_bf16_f32 v171, v202, v203
    v_mfma_f32_16x16x32_bf16 v[224:227], a[176:179], a[32:35], v[224:227]
    s_waitcnt lgkmcnt(4)
    ds_write_b128 v4, v[168:171] offset:2048
    v_mfma_f32_16x16x32_bf16 v[224:227], a[180:183], a[36:39], v[224:227]
    s_add_u32 s88, s85, 32768
    buffer_store_dwordx4 v[168:171], v20, s[24:27], s88 offen offset:0 sc1
    v_mfma_f32_16x16x32_bf16 v[228:231], a[176:179], a[40:43], v[228:231]
    v_cvt_pk_bf16_f32 v172, v172, v173
    v_cvt_pk_bf16_f32 v173, v174, v175
    v_mfma_f32_16x16x32_bf16 v[228:231], a[180:183], a[44:47], v[228:231]
    v_cvt_pk_bf16_f32 v174, v204, v205
    v_cvt_pk_bf16_f32 v175, v206, v207
    v_mfma_f32_16x16x32_bf16 v[232:235], a[176:179], a[48:51], v[232:235]
    s_add_u32 s76, s76, 1
    ds_write_b128 v4, v[172:175] offset:3072
    v_mfma_f32_16x16x32_bf16 v[232:235], a[180:183], a[52:55], v[232:235]
    s_add_u32 s88, s85, 49152
    buffer_store_dwordx4 v[172:175], v20, s[24:27], s88 offen offset:0 sc1
    v_mfma_f32_16x16x32_bf16 v[236:239], a[176:179], a[56:59], v[236:239]
    v_cvt_pk_bf16_f32 v176, v176, v177
    v_cvt_pk_bf16_f32 v177, v178, v179
    v_mfma_f32_16x16x32_bf16 v[236:239], a[180:183], a[60:63], v[236:239]
    v_cvt_pk_bf16_f32 v178, v208, v209
    v_cvt_pk_bf16_f32 v179, v210, v211
    v_mfma_f32_16x16x32_bf16 v[240:243], a[176:179], a[64:67], v[240:243]
    ds_write_b128 v4, v[176:179] offset:16384
    v_mfma_f32_16x16x32_bf16 v[240:243], a[180:183], a[68:71], v[240:243]
    s_add_u32 s88, s85, 8192
    buffer_store_dwordx4 v[176:179], v20, s[24:27], s88 offen offset:0 sc1
    v_mfma_f32_16x16x32_bf16 v[244:247], a[176:179], a[72:75], v[244:247]
    v_cvt_pk_bf16_f32 v180, v180, v181
    v_cvt_pk_bf16_f32 v181, v182, v183
    v_mfma_f32_16x16x32_bf16 v[244:247], a[180:183], a[76:79], v[244:247]
    v_cvt_pk_bf16_f32 v182, v212, v213
    v_cvt_pk_bf16_f32 v183, v214, v215
    v_mfma_f32_16x16x32_bf16 v[248:251], a[176:179], a[80:83], v[248:251]
    ds_write_b128 v4, v[180:183] offset:17408
    v_mfma_f32_16x16x32_bf16 v[248:251], a[180:183], a[84:87], v[248:251]
    s_add_u32 s88, s85, 24576
    buffer_store_dwordx4 v[180:183], v20, s[24:27], s88 offen offset:0 sc1
    v_mfma_f32_16x16x32_bf16 v[252:255], a[176:179], a[88:91], v[252:255]
    v_cvt_pk_bf16_f32 v184, v184, v185
    v_cvt_pk_bf16_f32 v185, v186, v187
    v_mfma_f32_16x16x32_bf16 v[252:255], a[180:183], a[92:95], v[252:255]
    s_waitcnt lgkmcnt(2)
    v_cvt_pk_bf16_f32 v186, v216, v217
    v_cvt_pk_bf16_f32 v187, v218, v219
    v_mfma_f32_16x16x32_bf16 a[0:3], a[184:187], a[32:35], a[0:3]
    s_waitcnt lgkmcnt(0)
    ds_write_b128 v4, v[184:187] offset:18432
    v_mfma_f32_16x16x32_bf16 a[0:3], a[188:191], a[36:39], a[0:3]
    s_add_u32 s88, s85, 40960
    buffer_store_dwordx4 v[184:187], v20, s[24:27], s88 offen offset:0 sc1
    v_mfma_f32_16x16x32_bf16 a[4:7], a[184:187], a[40:43], a[4:7]
    v_cvt_pk_bf16_f32 v188, v188, v189
    v_cvt_pk_bf16_f32 v189, v190, v191
    v_mfma_f32_16x16x32_bf16 a[4:7], a[188:191], a[44:47], a[4:7]
    v_cvt_pk_bf16_f32 v190, v220, v221
    v_cvt_pk_bf16_f32 v191, v222, v223
    v_mfma_f32_16x16x32_bf16 a[8:11], a[184:187], a[48:51], a[8:11]
    ds_write_b128 v4, v[188:191] offset:19456
    v_mfma_f32_16x16x32_bf16 a[8:11], a[188:191], a[52:55], a[8:11]
    s_add_u32 s88, s85, 57344
    buffer_store_dwordx4 v[188:191], v20, s[24:27], s88 offen offset:0 sc1
    v_mfma_f32_16x16x32_bf16 a[12:15], a[184:187], a[56:59], a[12:15]
    v_rcp_f32 v65, v65
    v_mfma_f32_16x16x32_bf16 a[12:15], a[188:191], a[60:63], a[12:15]
    v_rcp_f32 v66, v66
    v_mfma_f32_16x16x32_bf16 a[16:19], a[184:187], a[64:67], a[16:19]
    v_rcp_f32 v67, v67
    v_mfma_f32_16x16x32_bf16 a[16:19], a[188:191], a[68:71], a[16:19]
    v_mul_f32 v96, v96, v32
    v_mul_f32 v97, v97, v33
    v_mfma_f32_16x16x32_bf16 a[20:23], a[184:187], a[72:75], a[20:23]
    v_mul_f32 v98, v98, v34
    v_mul_f32 v99, v99, v35
    v_mfma_f32_16x16x32_bf16 a[20:23], a[188:191], a[76:79], a[20:23]
    v_mul_f32 v128, v128, v64
    v_mul_f32 v129, v129, v65
    v_mfma_f32_16x16x32_bf16 a[24:27], a[184:187], a[80:83], a[24:27]
    v_mul_f32 v130, v130, v66
    v_mul_f32 v131, v131, v67
    v_mfma_f32_16x16x32_bf16 a[24:27], a[188:191], a[84:87], a[24:27]
    v_cvt_pk_bf16_f32 v96, v96, v97
    v_cvt_pk_bf16_f32 v97, v98, v99
    v_mfma_f32_16x16x32_bf16 a[28:31], a[184:187], a[88:91], a[28:31]
    v_cvt_pk_bf16_f32 v98, v128, v129
    v_cvt_pk_bf16_f32 v99, v130, v131
    v_mfma_f32_16x16x32_bf16 a[28:31], a[188:191], a[92:95], a[28:31]
    s_add_u32 s88, s84, 0
    buffer_store_dwordx4 v[96:99], v20, s[24:27], s88 offen sc1
    s_nop 0
    v_accvgpr_read_b32 v24, a0
    v_accvgpr_read_b32 v25, a1
    v_accvgpr_read_b32 v26, a2
    v_accvgpr_read_b32 v27, a3
    v_cvt_pk_bf16_f32 v224, v224, v225
    v_cvt_pk_bf16_f32 v225, v226, v227
    v_cvt_pk_bf16_f32 v226, v24, v25
    v_cvt_pk_bf16_f32 v227, v26, v27
    ds_write_b128 v4, v[224:227] offset:32768
    v_accvgpr_read_b32 v28, a4
    v_accvgpr_read_b32 v29, a5
    v_accvgpr_read_b32 v30, a6
    v_accvgpr_read_b32 v31, a7
    v_cvt_pk_bf16_f32 v228, v228, v229
    v_cvt_pk_bf16_f32 v229, v230, v231
    v_cvt_pk_bf16_f32 v230, v28, v29
    v_cvt_pk_bf16_f32 v231, v30, v31
    ds_write_b128 v4, v[228:231] offset:33792
    v_accvgpr_read_b32 v24, a8
    v_accvgpr_read_b32 v25, a9
    v_accvgpr_read_b32 v26, a10
    v_accvgpr_read_b32 v27, a11
    v_cvt_pk_bf16_f32 v232, v232, v233
    v_cvt_pk_bf16_f32 v233, v234, v235
    v_cvt_pk_bf16_f32 v234, v24, v25
    v_cvt_pk_bf16_f32 v235, v26, v27
    ds_write_b128 v4, v[232:235] offset:34816
    v_accvgpr_read_b32 v28, a12
    v_accvgpr_read_b32 v29, a13
    v_accvgpr_read_b32 v30, a14
    v_accvgpr_read_b32 v31, a15
    v_cvt_pk_bf16_f32 v236, v236, v237
    v_cvt_pk_bf16_f32 v237, v238, v239
    v_cvt_pk_bf16_f32 v238, v28, v29
    v_cvt_pk_bf16_f32 v239, v30, v31
    ds_write_b128 v4, v[236:239] offset:35840
    v_accvgpr_read_b32 v24, a16
    v_accvgpr_read_b32 v25, a17
    v_accvgpr_read_b32 v26, a18
    v_accvgpr_read_b32 v27, a19
    v_cvt_pk_bf16_f32 v240, v240, v241
    v_cvt_pk_bf16_f32 v241, v242, v243
    v_cvt_pk_bf16_f32 v242, v24, v25
    v_cvt_pk_bf16_f32 v243, v26, v27
    ds_write_b128 v4, v[240:243] offset:49152
    v_accvgpr_read_b32 v28, a20
    v_accvgpr_read_b32 v29, a21
    v_accvgpr_read_b32 v30, a22
    v_accvgpr_read_b32 v31, a23
    v_cvt_pk_bf16_f32 v244, v244, v245
    v_cvt_pk_bf16_f32 v245, v246, v247
    v_cvt_pk_bf16_f32 v246, v28, v29
    v_cvt_pk_bf16_f32 v247, v30, v31
    ds_write_b128 v4, v[244:247] offset:50176
    v_accvgpr_read_b32 v24, a24
    v_accvgpr_read_b32 v25, a25
    v_accvgpr_read_b32 v26, a26
    v_accvgpr_read_b32 v27, a27
    v_cvt_pk_bf16_f32 v248, v248, v249
    v_cvt_pk_bf16_f32 v249, v250, v251
    v_cvt_pk_bf16_f32 v250, v24, v25
    v_cvt_pk_bf16_f32 v251, v26, v27
    ds_write_b128 v4, v[248:251] offset:51200
    v_accvgpr_read_b32 v28, a28
    v_accvgpr_read_b32 v29, a29
    v_accvgpr_read_b32 v30, a30
    v_accvgpr_read_b32 v31, a31
    v_cvt_pk_bf16_f32 v252, v252, v253
    v_cvt_pk_bf16_f32 v253, v254, v255
    v_cvt_pk_bf16_f32 v254, v28, v29
    v_cvt_pk_bf16_f32 v255, v30, v31
    ds_write_b128 v4, v[252:255] offset:52224
    s_add_u32 s88, s85, 0
    buffer_store_dwordx4 v[224:227], v20, s[24:27], s88 offen offset:1024 sc1
    s_add_u32 s88, s85, 16384
    buffer_store_dwordx4 v[228:231], v20, s[24:27], s88 offen offset:1024 sc1
    s_add_u32 s88, s85, 32768
    buffer_store_dwordx4 v[232:235], v20, s[24:27], s88 offen offset:1024 sc1
    s_add_u32 s88, s85, 49152
    buffer_store_dwordx4 v[236:239], v20, s[24:27], s88 offen offset:1024 sc1
    s_add_u32 s88, s85, 8192
    buffer_store_dwordx4 v[240:243], v20, s[24:27], s88 offen offset:1024 sc1
    s_add_u32 s88, s85, 24576
    buffer_store_dwordx4 v[244:247], v20, s[24:27], s88 offen offset:1024 sc1
    s_add_u32 s88, s85, 40960
    buffer_store_dwordx4 v[248:251], v20, s[24:27], s88 offen offset:1024 sc1
    s_add_u32 s88, s85, 57344
    buffer_store_dwordx4 v[252:255], v20, s[24:27], s88 offen offset:1024 sc1
    s_waitcnt lgkmcnt(0)
    s_barrier
    ds_read_b128 a[0:3], v5 offset:0
    ds_read_b128 a[4:7], v5 offset:32768
    ds_read_b128 a[8:11], v5 offset:4096
    ds_read_b128 a[12:15], v5 offset:36864
    ds_read_b128 a[16:19], v5 offset:8192
    ds_read_b128 a[20:23], v5 offset:40960
    ds_read_b128 a[24:27], v5 offset:12288
    ds_read_b128 a[28:31], v5 offset:45056
    ds_read_b128 a[32:35], v5 offset:16384
    ds_read_b128 a[36:39], v5 offset:49152
    ds_read_b128 a[40:43], v5 offset:20480
    ds_read_b128 a[44:47], v5 offset:53248
    ds_read_b128 a[48:51], v5 offset:24576
    ds_read_b128 a[52:55], v5 offset:57344
    ds_read_b128 a[56:59], v5 offset:28672
    ds_read_b128 a[60:63], v5 offset:61440
    v_pk_mul_f32 v[100:101], v[100:101], v[36:37]
    v_pk_mul_f32 v[102:103], v[102:103], v[38:39]
    v_pk_mul_f32 v[132:133], v[132:133], v[68:69]
    v_pk_mul_f32 v[134:135], v[134:135], v[70:71]
    v_pk_mul_f32 v[36:37], v[36:37], s[82:83] op_sel:[0,1] op_sel_hi:[1,1]
    v_pk_mul_f32 v[38:39], v[38:39], s[82:83] op_sel:[0,1] op_sel_hi:[1,1]
    v_pk_mul_f32 v[68:69], v[68:69], s[82:83] op_sel:[0,1] op_sel_hi:[1,1]
    v_pk_mul_f32 v[70:71], v[70:71], s[82:83] op_sel:[0,1] op_sel_hi:[1,1]
    s_waitcnt vmcnt(17)
    v_cmp_eq_u32 vcc, 0, v21
    v_exp_f32 v36, v36
    v_exp_f32 v37, v37
    v_exp_f32 v38, v38
    v_exp_f32 v39, v39
    s_cmp_eq_u64 vcc, 0
    s_cselect_b32 s6, s6, 0
    s_add_u32 m0, s16, 16384
    s_add_u32 s89, s18, s20
    v_exp_f32 v68, v68
    v_exp_f32 v69, v69
    v_exp_f32 v70, v70
    v_exp_f32 v71, v71
    s_nop 0
    v_pk_add_f32 v[36:37], v[36:37], 1.0 op_sel_hi:[1,0]
    v_pk_add_f32 v[38:39], v[38:39], 1.0 op_sel_hi:[1,0]
    v_pk_add_f32 v[68:69], v[68:69], 1.0 op_sel_hi:[1,0]
    v_pk_add_f32 v[70:71], v[70:71], 1.0 op_sel_hi:[1,0]
    v_rcp_f32 v36, v36
    v_rcp_f32 v37, v37
    v_rcp_f32 v38, v38
    buffer_load_dwordx4 v2, s[4:7], s89 offen offset:0 sc1 lds
    v_rcp_f32 v39, v39
    v_rcp_f32 v68, v68
    v_rcp_f32 v69, v69
    v_rcp_f32 v70, v70
    v_rcp_f32 v71, v71
    s_nop 0
    v_pk_mul_f32 v[100:101], v[100:101], v[36:37]
    v_pk_mul_f32 v[102:103], v[102:103], v[38:39]
    v_pk_mul_f32 v[132:133], v[132:133], v[68:69]
    v_pk_mul_f32 v[134:135], v[134:135], v[70:71]
    v_cvt_pk_bf16_f32 v100, v100, v101
    v_cvt_pk_bf16_f32 v101, v102, v103
    buffer_load_dwordx4 v2, s[4:7], s89 offen offset:1024 sc1 lds
    v_cvt_pk_bf16_f32 v102, v132, v133
    v_cvt_pk_bf16_f32 v103, v134, v135
    s_add_u32 s88, s84, 57344
    buffer_store_dwordx4 v[100:103], v20, s[24:27], s88 offen sc1
    v_pk_mul_f32 v[104:105], v[104:105], v[40:41]
    v_pk_mul_f32 v[106:107], v[106:107], v[42:43]
    v_pk_mul_f32 v[136:137], v[136:137], v[72:73]
    v_pk_mul_f32 v[138:139], v[138:139], v[74:75]
    v_pk_mul_f32 v[40:41], v[40:41], s[82:83] op_sel:[0,1] op_sel_hi:[1,1]
    v_pk_mul_f32 v[42:43], v[42:43], s[82:83] op_sel:[0,1] op_sel_hi:[1,1]
    v_pk_mul_f32 v[72:73], v[72:73], s[82:83] op_sel:[0,1] op_sel_hi:[1,1]
    v_pk_mul_f32 v[74:75], v[74:75], s[82:83] op_sel:[0,1] op_sel_hi:[1,1]
    buffer_load_dwordx4 v2, s[4:7], s89 offen offset:2048 sc1 lds
    v_exp_f32 v40, v40
    v_exp_f32 v41, v41
    v_exp_f32 v42, v42
    v_exp_f32 v43, v43
    v_exp_f32 v72, v72
    v_exp_f32 v73, v73
    v_exp_f32 v74, v74
    v_exp_f32 v75, v75
    s_nop 0
    v_pk_add_f32 v[40:41], v[40:41], 1.0 op_sel_hi:[1,0]
    v_pk_add_f32 v[42:43], v[42:43], 1.0 op_sel_hi:[1,0]
    v_pk_add_f32 v[72:73], v[72:73], 1.0 op_sel_hi:[1,0]
    buffer_load_dwordx4 v2, s[4:7], s89 offen offset:3072 sc1 lds
    s_add_u32 s16, s16, 32768
    s_cmp_eq_u32 s16, s17
    s_cselect_b32 s16, s67, s16
    s_add_u32 s18, s18, s19
    s_mov_b32 m0, s16
    v_pk_add_f32 v[74:75], v[74:75], 1.0 op_sel_hi:[1,0]
    v_rcp_f32 v40, v40
    v_rcp_f32 v41, v41
    v_rcp_f32 v42, v42
    v_rcp_f32 v43, v43
    v_rcp_f32 v72, v72
    v_rcp_f32 v73, v73
    v_rcp_f32 v74, v74
    v_rcp_f32 v75, v75
    s_nop 0
    v_pk_mul_f32 v[104:105], v[104:105], v[40:41]
    v_pk_mul_f32 v[106:107], v[106:107], v[42:43]
    buffer_load_dwordx4 v2, s[4:7], s18 offen offset:0 sc1 lds
    v_pk_mul_f32 v[136:137], v[136:137], v[72:73]
    v_pk_mul_f32 v[138:139], v[138:139], v[74:75]
    v_cvt_pk_bf16_f32 v104, v104, v105
    v_cvt_pk_bf16_f32 v105, v106, v107
    v_cvt_pk_bf16_f32 v106, v136, v137
    v_cvt_pk_bf16_f32 v107, v138, v139
    s_add_u32 s88, s84, 114688
    buffer_store_dwordx4 v[104:107], v20, s[24:27], s88 offen sc1
    v_pk_mul_f32 v[108:109], v[108:109], v[44:45]
    v_pk_mul_f32 v[110:111], v[110:111], v[46:47]
    v_pk_mul_f32 v[140:141], v[140:141], v[76:77]
    v_pk_mul_f32 v[142:143], v[142:143], v[78:79]
    buffer_load_dwordx4 v2, s[4:7], s18 offen offset:1024 sc1 lds
    v_pk_mul_f32 v[44:45], v[44:45], s[82:83] op_sel:[0,1] op_sel_hi:[1,1]
    v_pk_mul_f32 v[46:47], v[46:47], s[82:83] op_sel:[0,1] op_sel_hi:[1,1]
    v_pk_mul_f32 v[76:77], v[76:77], s[82:83] op_sel:[0,1] op_sel_hi:[1,1]
    v_pk_mul_f32 v[78:79], v[78:79], s[82:83] op_sel:[0,1] op_sel_hi:[1,1]
    v_exp_f32 v44, v44
    v_exp_f32 v45, v45
    v_exp_f32 v46, v46
    v_exp_f32 v47, v47
    v_exp_f32 v76, v76
    v_exp_f32 v77, v77
    v_exp_f32 v78, v78
    buffer_load_dwordx4 v2, s[4:7], s18 offen offset:2048 sc1 lds
    v_exp_f32 v79, v79
    s_nop 0
    v_pk_add_f32 v[44:45], v[44:45], 1.0 op_sel_hi:[1,0]
    v_pk_add_f32 v[46:47], v[46:47], 1.0 op_sel_hi:[1,0]
    v_pk_add_f32 v[76:77], v[76:77], 1.0 op_sel_hi:[1,0]
    v_pk_add_f32 v[78:79], v[78:79], 1.0 op_sel_hi:[1,0]
    v_rcp_f32 v44, v44
    v_rcp_f32 v45, v45
    v_rcp_f32 v46, v46
    v_rcp_f32 v47, v47
    v_rcp_f32 v76, v76
    v_rcp_f32 v77, v77
    buffer_load_dwordx4 v2, s[4:7], s18 offen offset:3072 sc1 lds
    s_add_u32 m0, s16, 16384
    s_add_u32 s89, s18, s20
    v_rcp_f32 v78, v78
    v_rcp_f32 v79, v79
    s_nop 0
    v_pk_mul_f32 v[108:109], v[108:109], v[44:45]
    v_pk_mul_f32 v[110:111], v[110:111], v[46:47]
    v_pk_mul_f32 v[140:141], v[140:141], v[76:77]
    v_pk_mul_f32 v[142:143], v[142:143], v[78:79]
    v_cvt_pk_bf16_f32 v108, v108, v109
    v_cvt_pk_bf16_f32 v109, v110, v111
    v_cvt_pk_bf16_f32 v110, v140, v141
    v_cvt_pk_bf16_f32 v111, v142, v143
    s_add_u32 s88, s84, 172032
    buffer_store_dwordx4 v[108:111], v20, s[24:27], s88 offen sc1
    v_pk_mul_f32 v[112:113], v[112:113], v[48:49]
    buffer_load_dwordx4 v2, s[4:7], s89 offen offset:0 sc1 lds
    v_pk_mul_f32 v[114:115], v[114:115], v[50:51]
    v_pk_mul_f32 v[144:145], v[144:145], v[80:81]
    v_pk_mul_f32 v[146:147], v[146:147], v[82:83]
    v_pk_mul_f32 v[48:49], v[48:49], s[82:83] op_sel:[0,1] op_sel_hi:[1,1]
    v_pk_mul_f32 v[50:51], v[50:51], s[82:83] op_sel:[0,1] op_sel_hi:[1,1]
    v_pk_mul_f32 v[80:81], v[80:81], s[82:83] op_sel:[0,1] op_sel_hi:[1,1]
    v_pk_mul_f32 v[82:83], v[82:83], s[82:83] op_sel:[0,1] op_sel_hi:[1,1]
    v_exp_f32 v48, v48
    v_exp_f32 v49, v49
    v_exp_f32 v50, v50
    v_exp_f32 v51, v51
    buffer_load_dwordx4 v2, s[4:7], s89 offen offset:1024 sc1 lds
    v_exp_f32 v80, v80
    v_exp_f32 v81, v81
    v_exp_f32 v82, v82
    v_exp_f32 v83, v83
    s_nop 0
    v_pk_add_f32 v[48:49], v[48:49], 1.0 op_sel_hi:[1,0]
    v_pk_add_f32 v[50:51], v[50:51], 1.0 op_sel_hi:[1,0]
    v_pk_add_f32 v[80:81], v[80:81], 1.0 op_sel_hi:[1,0]
    v_pk_add_f32 v[82:83], v[82:83], 1.0 op_sel_hi:[1,0]
    v_rcp_f32 v48, v48
    v_rcp_f32 v49, v49
    v_rcp_f32 v50, v50
    buffer_load_dwordx4 v2, s[4:7], s89 offen offset:2048 sc1 lds
    v_rcp_f32 v51, v51
    v_rcp_f32 v80, v80
    v_rcp_f32 v81, v81
    v_rcp_f32 v82, v82
    v_rcp_f32 v83, v83
    s_nop 0
    v_pk_mul_f32 v[112:113], v[112:113], v[48:49]
    v_pk_mul_f32 v[114:115], v[114:115], v[50:51]
    v_pk_mul_f32 v[144:145], v[144:145], v[80:81]
    v_pk_mul_f32 v[146:147], v[146:147], v[82:83]
    v_cvt_pk_bf16_f32 v112, v112, v113
    v_cvt_pk_bf16_f32 v113, v114, v115
    buffer_load_dwordx4 v2, s[4:7], s89 offen offset:3072 sc1 lds
    s_add_u32 s16, s16, 32768
    s_cmp_eq_u32 s16, s17
    s_cselect_b32 s16, s67, s16
    s_add_u32 s18, s18, s19
    s_mov_b32 m0, s16
    v_cvt_pk_bf16_f32 v114, v144, v145
    v_cvt_pk_bf16_f32 v115, v146, v147
    s_add_u32 s88, s84, 229376
    buffer_store_dwordx4 v[112:115], v20, s[24:27], s88 offen sc1
    v_pk_mul_f32 v[116:117], v[116:117], v[52:53]
    v_pk_mul_f32 v[118:119], v[118:119], v[54:55]
    v_pk_mul_f32 v[148:149], v[148:149], v[84:85]
    v_pk_mul_f32 v[150:151], v[150:151], v[86:87]
    v_pk_mul_f32 v[52:53], v[52:53], s[82:83] op_sel:[0,1] op_sel_hi:[1,1]
    v_pk_mul_f32 v[54:55], v[54:55], s[82:83] op_sel:[0,1] op_sel_hi:[1,1]
    v_pk_mul_f32 v[84:85], v[84:85], s[82:83] op_sel:[0,1] op_sel_hi:[1,1]
    v_pk_mul_f32 v[86:87], v[86:87], s[82:83] op_sel:[0,1] op_sel_hi:[1,1]
    buffer_load_dwordx4 v2, s[4:7], s18 offen offset:0 sc1 lds
    v_exp_f32 v52, v52
    v_exp_f32 v53, v53
    v_exp_f32 v54, v54
    v_exp_f32 v55, v55
    v_exp_f32 v84, v84
    v_exp_f32 v85, v85
    v_exp_f32 v86, v86
    v_exp_f32 v87, v87
    s_nop 0
    v_pk_add_f32 v[52:53], v[52:53], 1.0 op_sel_hi:[1,0]
    v_pk_add_f32 v[54:55], v[54:55], 1.0 op_sel_hi:[1,0]
    v_pk_add_f32 v[84:85], v[84:85], 1.0 op_sel_hi:[1,0]
    buffer_load_dwordx4 v2, s[4:7], s18 offen offset:1024 sc1 lds
    v_pk_add_f32 v[86:87], v[86:87], 1.0 op_sel_hi:[1,0]
    v_rcp_f32 v52, v52
    v_rcp_f32 v53, v53
    v_rcp_f32 v54, v54
    v_rcp_f32 v55, v55
    v_rcp_f32 v84, v84
    v_rcp_f32 v85, v85
    v_rcp_f32 v86, v86
    v_rcp_f32 v87, v87
    s_nop 0
    v_pk_mul_f32 v[116:117], v[116:117], v[52:53]
    v_pk_mul_f32 v[118:119], v[118:119], v[54:55]
    buffer_load_dwordx4 v2, s[4:7], s18 offen offset:2048 sc1 lds
    v_pk_mul_f32 v[148:149], v[148:149], v[84:85]
    v_pk_mul_f32 v[150:151], v[150:151], v[86:87]
    v_cvt_pk_bf16_f32 v116, v116, v117
    v_cvt_pk_bf16_f32 v117, v118, v119
    v_cvt_pk_bf16_f32 v118, v148, v149
    v_cvt_pk_bf16_f32 v119, v150, v151
    s_add_u32 s88, s84, 286720
    buffer_store_dwordx4 v[116:119], v20, s[24:27], s88 offen sc1
    v_pk_mul_f32 v[120:121], v[120:121], v[56:57]
    v_pk_mul_f32 v[122:123], v[122:123], v[58:59]
    v_pk_mul_f32 v[152:153], v[152:153], v[88:89]
    v_pk_mul_f32 v[154:155], v[154:155], v[90:91]
    buffer_load_dwordx4 v2, s[4:7], s18 offen offset:3072 sc1 lds
    s_add_u32 m0, s16, 16384
    s_add_u32 s89, s18, s20
    v_pk_mul_f32 v[56:57], v[56:57], s[82:83] op_sel:[0,1] op_sel_hi:[1,1]
    v_pk_mul_f32 v[58:59], v[58:59], s[82:83] op_sel:[0,1] op_sel_hi:[1,1]
    v_pk_mul_f32 v[88:89], v[88:89], s[82:83] op_sel:[0,1] op_sel_hi:[1,1]
    v_pk_mul_f32 v[90:91], v[90:91], s[82:83] op_sel:[0,1] op_sel_hi:[1,1]
    v_exp_f32 v56, v56
    v_exp_f32 v57, v57
    v_exp_f32 v58, v58
    v_exp_f32 v59, v59
    v_exp_f32 v88, v88
    v_exp_f32 v89, v89
    v_exp_f32 v90, v90
    buffer_load_dwordx4 v2, s[4:7], s89 offen offset:0 sc1 lds
    v_exp_f32 v91, v91
    s_nop 0
    v_pk_add_f32 v[56:57], v[56:57], 1.0 op_sel_hi:[1,0]
    v_pk_add_f32 v[58:59], v[58:59], 1.0 op_sel_hi:[1,0]
    v_pk_add_f32 v[88:89], v[88:89], 1.0 op_sel_hi:[1,0]
    v_pk_add_f32 v[90:91], v[90:91], 1.0 op_sel_hi:[1,0]
    v_rcp_f32 v56, v56
    v_rcp_f32 v57, v57
    v_rcp_f32 v58, v58
    v_rcp_f32 v59, v59
    v_rcp_f32 v88, v88
    v_rcp_f32 v89, v89
    buffer_load_dwordx4 v2, s[4:7], s89 offen offset:1024 sc1 lds
    v_rcp_f32 v90, v90
    v_rcp_f32 v91, v91
    s_nop 0
    v_pk_mul_f32 v[120:121], v[120:121], v[56:57]
    v_pk_mul_f32 v[122:123], v[122:123], v[58:59]
    v_pk_mul_f32 v[152:153], v[152:153], v[88:89]
    v_pk_mul_f32 v[154:155], v[154:155], v[90:91]
    v_cvt_pk_bf16_f32 v120, v120, v121
    v_cvt_pk_bf16_f32 v121, v122, v123
    v_cvt_pk_bf16_f32 v122, v152, v153
    v_cvt_pk_bf16_f32 v123, v154, v155
    s_add_u32 s88, s84, 344064
    buffer_store_dwordx4 v[120:123], v20, s[24:27], s88 offen sc1
    v_pk_mul_f32 v[124:125], v[124:125], v[60:61]
    buffer_load_dwordx4 v2, s[4:7], s89 offen offset:2048 sc1 lds
    v_pk_mul_f32 v[126:127], v[126:127], v[62:63]
    v_pk_mul_f32 v[156:157], v[156:157], v[92:93]
    v_pk_mul_f32 v[158:159], v[158:159], v[94:95]
    v_pk_mul_f32 v[60:61], v[60:61], s[82:83] op_sel:[0,1] op_sel_hi:[1,1]
    v_pk_mul_f32 v[62:63], v[62:63], s[82:83] op_sel:[0,1] op_sel_hi:[1,1]
    v_pk_mul_f32 v[92:93], v[92:93], s[82:83] op_sel:[0,1] op_sel_hi:[1,1]
    v_pk_mul_f32 v[94:95], v[94:95], s[82:83] op_sel:[0,1] op_sel_hi:[1,1]
    v_exp_f32 v60, v60
    v_exp_f32 v61, v61
    v_exp_f32 v62, v62
    v_exp_f32 v63, v63
    buffer_load_dwordx4 v2, s[4:7], s89 offen offset:3072 sc1 lds
    s_add_u32 s16, s16, 32768
    s_cmp_eq_u32 s16, s17
    s_cselect_b32 s16, s67, s16
    s_add_u32 s18, s18, s19
    v_exp_f32 v92, v92
    v_exp_f32 v93, v93
    v_exp_f32 v94, v94
    v_exp_f32 v95, v95
    s_nop 0
    v_pk_add_f32 v[60:61], v[60:61], 1.0 op_sel_hi:[1,0]
    v_pk_add_f32 v[62:63], v[62:63], 1.0 op_sel_hi:[1,0]
    v_pk_add_f32 v[92:93], v[92:93], 1.0 op_sel_hi:[1,0]
    v_pk_add_f32 v[94:95], v[94:95], 1.0 op_sel_hi:[1,0]
    v_rcp_f32 v60, v60
    v_rcp_f32 v61, v61
    v_rcp_f32 v62, v62
    v_rcp_f32 v63, v63
    v_rcp_f32 v92, v92
    v_rcp_f32 v93, v93
    v_rcp_f32 v94, v94
    v_rcp_f32 v95, v95
    s_nop 0
    v_pk_mul_f32 v[124:125], v[124:125], v[60:61]
    v_pk_mul_f32 v[126:127], v[126:127], v[62:63]
    v_pk_mul_f32 v[156:157], v[156:157], v[92:93]
    v_pk_mul_f32 v[158:159], v[158:159], v[94:95]
    v_cvt_pk_bf16_f32 v124, v124, v125
    v_cvt_pk_bf16_f32 v125, v126, v127
    v_cvt_pk_bf16_f32 v126, v156, v157
    v_cvt_pk_bf16_f32 v127, v158, v159
    s_add_u32 s88, s84, 401408
    buffer_store_dwordx4 v[124:127], v20, s[24:27], s88 offen sc1
    s_cmp_eq_u32 s6, 0
    s_cbranch_scc1 fz_kslow
fz_kok:
    v_lshlrev_b32 v4, 4, v1
    v_cmp_eq_u32 vcc, 0, v0
    v_mov_b32 v3, 0x7fffff00
    v_lshrrev_b32 v18, 3, v0
    v_and_b32 v19, 7, v18
    v_and_b32 v18, 24, v18
    v_lshl_add_u32 v18, v18, 2, v19
    v_cndmask_b32 v3, v3, v0, vcc
    v_mul_u32_u24 v18, 896, v18
    v_bfe_u32 v19, v1, 1, 2
    v_lshrrev_b32 v26, 4, v1
    v_lshlrev_b32 v27, 1, v26
    v_and_b32 v27, 2, v27
    v_xor_b32 v19, v19, v27
    v_lshl_add_u32 v18, v19, 5, v18
    v_and_b32 v19, 1, v1
    v_lshl_add_u32 v6, v19, 4, v18
    v_add_u32 v5, s22, v4
    v_add_u32 v7, 6144, v6
    v_add_u32 v8, 12288, v6
    v_add_u32 v9, 18432, v6
    v_mov_b32 v120, v2
    v_mov_b32 v84, 0
    v_mov_b32 v121, v2
    v_mov_b32 v85, 0
    v_mov_b32 v122, v2
    v_mov_b32 v86, 0
    v_mov_b32 v123, v2
    v_mov_b32 v87, 0
    v_bfe_u32 v18, v1, 2, 2
    v_lshrrev_b32 v19, 5, v1
    v_mfma_f32_32x32x16_bf16 v[128:143], v[84:87], v[84:87], 0
    v_lshl_add_u32 v18, v19, 3, v18
    v_and_b32 v19, 3, v1
    v_lshlrev_b32 v18, 7, v18
    v_mfma_f32_32x32x16_bf16 v[160:175], v[84:87], v[84:87], 0
    v_lshl_add_u32 v18, v19, 3, v18
    v_and_b32 v19, 16, v1
    v_lshl_add_u32 v18, v19, 1, v18
    v_mfma_f32_32x32x16_bf16 v[192:207], v[84:87], v[84:87], 0
    v_and_b32 v19, 8, v1
    v_lshl_add_u32 v10, v19, 3, v18
    v_lshlrev_b32 v12, 2, v1
    v_mfma_f32_32x32x16_bf16 v[224:239], v[84:87], v[84:87], 0
    v_xor_b32 v11, 64, v10
    v_and_b32 v12, 60, v12
    v_and_b32 v18, 15, v1
    s_lshl_b32 s86, s66, 4
    v_add_u32 v18, s86, v18
    v_lshlrev_b32 v26, 2, v26
    v_sub_u32 v18, v18, v26
    v_mov_b32 v19, 0xf149f2ca
    v_mfma_f32_32x32x16_bf16 v[144:159], v[84:87], v[84:87], 0
    v_cmp_gt_i32 s[86:87], 0, v18
    v_cmp_gt_i32 s[88:89], 1, v18
    s_nop 0
    v_cndmask_b32 v56, 0, v19, s[86:87]
    v_cndmask_b32 v57, 0, v19, s[88:89]
    v_cmp_gt_i32 s[86:87], 2, v18
    v_cmp_gt_i32 s[88:89], 3, v18
    s_nop 0
    v_cndmask_b32 v58, 0, v19, s[86:87]
    v_cndmask_b32 v59, 0, v19, s[88:89]
    v_mfma_f32_32x32x16_bf16 v[176:191], v[84:87], v[84:87], 0
    v_cmp_gt_i32 s[86:87], 16, v18
    v_cmp_gt_i32 s[88:89], 17, v18
    s_nop 0
    v_cndmask_b32 v60, 0, v19, s[86:87]
    v_cndmask_b32 v61, 0, v19, s[88:89]
    v_cmp_gt_i32 s[86:87], 18, v18
    v_cmp_gt_i32 s[88:89], 19, v18
    s_nop 0
    v_cndmask_b32 v62, 0, v19, s[86:87]
    v_cndmask_b32 v63, 0, v19, s[88:89]
    v_mfma_f32_32x32x16_bf16 v[208:223], v[84:87], v[84:87], 0
    v_cmp_gt_i32 s[86:87], 32, v18
    v_cmp_gt_i32 s[88:89], 33, v18
    s_nop 0
    v_cndmask_b32 v64, 0, v19, s[86:87]
    v_cndmask_b32 v65, 0, v19, s[88:89]
    v_cmp_gt_i32 s[86:87], 34, v18
    v_cmp_gt_i32 s[88:89], 35, v18
    s_nop 0
    v_cndmask_b32 v66, 0, v19, s[86:87]
    v_cndmask_b32 v67, 0, v19, s[88:89]
    v_mfma_f32_32x32x16_bf16 v[240:255], v[84:87], v[84:87], 0
    v_cmp_gt_i32 s[86:87], 48, v18
    v_cmp_gt_i32 s[88:89], 49, v18
    s_nop 0
    v_cndmask_b32 v68, 0, v19, s[86:87]
    v_cndmask_b32 v69, 0, v19, s[88:89]
    v_cmp_gt_i32 s[86:87], 50, v18
    v_cmp_gt_i32 s[88:89], 51, v18
    s_nop 0
    v_cndmask_b32 v70, 0, v19, s[86:87]
    v_cndmask_b32 v71, 0, v19, s[88:89]
    s_cmp_eq_u32 s69, 0
    s_cselect_b32 s86, 1.0, 0
    v_mul_f32 v48, s86, v56
    v_mul_f32 v49, s86, v57
    v_mul_f32 v50, s86, v58
    v_mul_f32 v51, s86, v59
    v_mul_f32 v52, s86, v60
    v_mul_f32 v53, s86, v61
    v_mul_f32 v54, s86, v62
    v_mul_f32 v55, s86, v63
    s_waitcnt vmcnt(22) lgkmcnt(0)
    s_barrier
    s_mov_b32 m0, s16
    ds_read_b128 a[64:67], v5 offset:16384
    ds_read_b128 a[68:71], v5 offset:17408
    ds_read_b128 a[72:75], v5 offset:18432
    ds_read_b128 a[76:79], v5 offset:19456
    ds_read_b128 a[80:83], v5 offset:20480
    ds_read_b128 a[84:87], v5 offset:21504
    ds_read_b128 a[88:91], v5 offset:22528
    ds_read_b128 a[92:95], v5 offset:23552
    ds_read_b128 a[96:99], v5 offset:24576
    ds_read_b128 a[100:103], v5 offset:25600
    buffer_load_dwordx4 v120, s[4:7], s18 offen offset:0 sc1 lds
    buffer_load_dwordx4 v121, s[4:7], s18 offen offset:1024 sc1 lds
    buffer_load_dwordx4 v122, s[4:7], s18 offen offset:2048 sc1 lds
    buffer_load_dwordx4 v123, s[4:7], s18 offen offset:3072 sc1 lds
    s_sub_u32 s86, s69, 6
    s_cmp_lt_u32 s86, 3
    s_cbranch_scc1 fz_pfo
fz_pfr:
fz_pro:
    s_waitcnt lgkmcnt(9)
    v_mfma_f32_16x16x32_bf16 v[88:91], a[64:67], a[0:3], v[48:51]
    s_waitcnt lgkmcnt(8)
    ds_read_b128 a[104:107], v5 offset:26624
    v_mfma_f32_16x16x32_bf16 v[88:91], a[68:71], a[4:7], v[88:91]
    s_waitcnt lgkmcnt(8)
    v_mfma_f32_16x16x32_bf16 v[88:91], a[72:75], a[8:11], v[88:91]
    s_waitcnt lgkmcnt(7)
    ds_read_b128 a[108:111], v5 offset:27648
    v_mfma_f32_16x16x32_bf16 v[88:91], a[76:79], a[12:15], v[88:91]
    s_waitcnt lgkmcnt(7)
    v_mfma_f32_16x16x32_bf16 v[88:91], a[80:83], a[16:19], v[88:91]
    s_waitcnt lgkmcnt(6)
    ds_read_b128 a[112:115], v5 offset:28672
    v_mfma_f32_16x16x32_bf16 v[88:91], a[84:87], a[20:23], v[88:91]
    s_waitcnt lgkmcnt(6)
    v_mfma_f32_16x16x32_bf16 v[88:91], a[88:91], a[24:27], v[88:91]
    s_waitcnt lgkmcnt(5)
    ds_read_b128 a[116:119], v5 offset:29696
    v_mfma_f32_16x16x32_bf16 v[88:91], a[92:95], a[28:31], v[88:91]
    s_add_u32 s22, s22, 32768
    v_mfma_f32_16x16x32_bf16 v[92:95], a[64:67], a[32:35], 0
    s_cmp_eq_u32 s22, 163840
    ds_read_b128 a[120:123], v5 offset:30720
    v_mfma_f32_16x16x32_bf16 v[92:95], a[68:71], a[36:39], v[92:95]
    s_cselect_b32 s22, 0, s22
    v_mfma_f32_16x16x32_bf16 v[92:95], a[72:75], a[40:43], v[92:95]
    ds_read_b128 a[124:127], v5 offset:31744
    v_mfma_f32_16x16x32_bf16 v[92:95], a[76:79], a[44:47], v[92:95]
    v_mfma_f32_16x16x32_bf16 v[92:95], a[80:83], a[48:51], v[92:95]
    v_mfma_f32_16x16x32_bf16 v[92:95], a[84:87], a[52:55], v[92:95]
    v_mfma_f32_16x16x32_bf16 v[92:95], a[88:91], a[56:59], v[92:95]
    v_mfma_f32_16x16x32_bf16 v[92:95], a[92:95], a[60:63], v[92:95]
    s_waitcnt lgkmcnt(7)
    v_mfma_f32_16x16x32_bf16 v[96:99], a[96:99], a[0:3], v[52:55]
    s_waitcnt lgkmcnt(6)
    v_mfma_f32_16x16x32_bf16 v[96:99], a[100:103], a[4:7], v[96:99]
    s_waitcnt lgkmcnt(5)
    v_mfma_f32_16x16x32_bf16 v[96:99], a[104:107], a[8:11], v[96:99]
    s_waitcnt lgkmcnt(4)
    s_add_u32 m0, s16, 16384
    s_add_u32 s89, s18, s20
    v_mfma_f32_16x16x32_bf16 v[96:99], a[108:111], a[12:15], v[96:99]
    s_waitcnt lgkmcnt(3)
    buffer_load_dwordx4 v120, s[4:7], s89 offen offset:0 sc1 lds
    v_mfma_f32_16x16x32_bf16 v[96:99], a[112:115], a[16:19], v[96:99]
    s_waitcnt lgkmcnt(2)
    v_add_u32 v5, s22, v4
    v_mfma_f32_16x16x32_bf16 v[96:99], a[116:119], a[20:23], v[96:99]
    s_waitcnt lgkmcnt(1)
    buffer_load_dwordx4 v121, s[4:7], s89 offen offset:1024 sc1 lds
    v_mfma_f32_16x16x32_bf16 v[96:99], a[120:123], a[24:27], v[96:99]
    s_waitcnt lgkmcnt(0)
    v_mfma_f32_16x16x32_bf16 v[96:99], a[124:127], a[28:31], v[96:99]
    buffer_load_dwordx4 v122, s[4:7], s89 offen offset:2048 sc1 lds
    v_mfma_f32_16x16x32_bf16 v[100:103], a[96:99], a[32:35], 0
    v_mfma_f32_16x16x32_bf16 v[100:103], a[100:103], a[36:39], v[100:103]
    s_add_u32 s16, s16, 32768
    buffer_load_dwordx4 v123, s[4:7], s89 offen offset:3072 sc1 lds
    v_mfma_f32_16x16x32_bf16 v[100:103], a[104:107], a[40:43], v[100:103]
    s_cmp_eq_u32 s16, s17
    v_mfma_f32_16x16x32_bf16 v[100:103], a[108:111], a[44:47], v[100:103]
    s_cselect_b32 s16, s67, s16
    v_mfma_f32_16x16x32_bf16 v[100:103], a[112:115], a[48:51], v[100:103]
    s_add_u32 s18, s18, s19
    v_mfma_f32_16x16x32_bf16 v[100:103], a[116:119], a[52:55], v[100:103]
    v_mfma_f32_16x16x32_bf16 v[100:103], a[120:123], a[56:59], v[100:103]
    v_mfma_f32_16x16x32_bf16 v[100:103], a[124:127], a[60:63], v[100:103]
    s_waitcnt vmcnt(8)
    s_barrier
    s_mov_b32 m0, s16
    ds_read_b128 a[64:67], v5 offset:16384
    ds_read_b128 a[68:71], v5 offset:17408
    ds_read_b128 a[72:75], v5 offset:18432
    ds_read_b128 a[76:79], v5 offset:19456
    ds_read_b128 a[80:83], v5 offset:20480
    ds_read_b128 a[84:87], v5 offset:21504
    ds_read_b128 a[88:91], v5 offset:22528
    ds_read_b128 a[92:95], v5 offset:23552
    ds_read_b128 a[96:99], v5 offset:24576
    ds_read_b128 a[100:103], v5 offset:25600
    buffer_store_dword v11, v3, s[24:27], s73 offen sc1
    buffer_load_dwordx4 v120, s[4:7], s18 offen offset:0 sc1 lds
    buffer_load_dwordx4 v121, s[4:7], s18 offen offset:1024 sc1 lds
    buffer_load_dwordx4 v122, s[4:7], s18 offen offset:2048 sc1 lds
    buffer_load_dwordx4 v123, s[4:7], s18 offen offset:3072 sc1 lds
    s_mov_b32 s73, 2147483648
    v_max3_f32 v18, v88, v89, v90
    v_max3_f32 v18, v18, v91, v96
    v_max3_f32 v18, v18, v97, v98
    v_max_f32 v18, v18, v99
    v_max3_f32 v19, v92, v93, v94
    v_max3_f32 v19, v19, v95, v100
    v_max3_f32 v19, v19, v101, v102
    v_max_f32 v19, v19, v103
    v_mov_b32 v26, v18
    v_mov_b32 v27, v19
    s_nop 0
    v_permlane32_swap_b32 v18, v26
    v_permlane32_swap_b32 v19, v27
    v_max_f32 v18, v18, v26
    v_max_f32 v19, v19, v27
    v_mov_b32 v26, v18
    v_mov_b32 v27, v19
    s_nop 0
    v_permlane16_swap_b32 v18, v26
    v_permlane16_swap_b32 v19, v27
    v_max_f32 v18, v18, v26
    v_max_f32 v19, v19, v27
    v_sub_f32 v88, v88, v18
    v_sub_f32 v89, v89, v18
    v_sub_f32 v90, v90, v18
    v_sub_f32 v91, v91, v18
    v_sub_f32 v96, v96, v18
    v_sub_f32 v97, v97, v18
    v_sub_f32 v98, v98, v18
    v_sub_f32 v99, v99, v18
    v_sub_f32 v92, v92, v19
    v_sub_f32 v93, v93, v19
    v_sub_f32 v94, v94, v19
    v_sub_f32 v95, v95, v19
    v_sub_f32 v100, v100, v19
    v_sub_f32 v101, v101, v19
    v_sub_f32 v102, v102, v19
    v_sub_f32 v103, v103, v19
    v_exp_f32 v32, v88
    v_exp_f32 v33, v89
    v_exp_f32 v34, v90
    v_exp_f32 v35, v91
    v_exp_f32 v36, v96
    v_exp_f32 v37, v97
    v_exp_f32 v38, v98
    v_exp_f32 v39, v99
    s_nop 0
    v_add_f32 v24, v32, v33
    v_add_f32 v24, v24, v34
    v_add_f32 v24, v24, v35
    v_add_f32 v24, v24, v36
    v_add_f32 v24, v24, v37
    v_add_f32 v24, v24, v38
    v_add_f32 v24, v24, v39
    v_cvt_pk_bf16_f32 v72, v32, v33
    v_cvt_pk_bf16_f32 v73, v34, v35
    v_cvt_pk_bf16_f32 v74, v36, v37
    v_cvt_pk_bf16_f32 v75, v38, v39
    v_sub_f32 v40, 0, v18
    v_sub_f32 v41, 0, v18
    v_sub_f32 v42, 0, v18
    v_sub_f32 v43, 0, v18
    v_mov_b32 v20, 0
    v_sub_f32 v44, 0, v19
    v_sub_f32 v45, 0, v19
    v_sub_f32 v46, 0, v19
    v_sub_f32 v47, 0, v19
    v_mov_b32 v21, 0
    s_lshr_b32 s23, s32, 1
    s_lshl_b32 s86, s28, 1
    s_add_u32 s23, s23, s86
    s_sub_u32 s23, s23, 3
    s_cbranch_scc0 fz_loop
    v_add_f32 v48, v40, v64
    v_add_f32 v49, v40, v65
    v_add_f32 v50, v40, v66
    v_add_f32 v51, v40, v67
    v_add_f32 v52, v40, v68
    v_add_f32 v53, v40, v69
    v_add_f32 v54, v40, v70
    v_add_f32 v55, v40, v71
    s_branch fz_T1
fz_proe:
    .p2align 6
fz_loop:
    s_waitcnt lgkmcnt(9)
    v_mfma_f32_16x16x32_bf16 v[104:107], a[64:67], a[0:3], v[40:43]
    s_waitcnt lgkmcnt(8)
    ds_read_b128 a[104:107], v5 offset:26624
    v_mfma_f32_16x16x32_bf16 v[104:107], a[68:71], a[4:7], v[104:107]
    s_waitcnt lgkmcnt(8)
    v_exp_f32 v32, v92
    v_mfma_f32_16x16x32_bf16 v[104:107], a[72:75], a[8:11], v[104:107]
    s_waitcnt lgkmcnt(7)
    ds_read_b128 a[108:111], v5 offset:27648
    v_mfma_f32_16x16x32_bf16 v[104:107], a[76:79], a[12:15], v[104:107]
    s_waitcnt lgkmcnt(7)
    v_exp_f32 v33, v93
    v_mfma_f32_16x16x32_bf16 v[104:107], a[80:83], a[16:19], v[104:107]
    s_waitcnt lgkmcnt(6)
    ds_read_b128 a[112:115], v5 offset:28672
    v_add_f32 v25, v32, v33
    v_mfma_f32_16x16x32_bf16 v[104:107], a[84:87], a[20:23], v[104:107]
    s_waitcnt lgkmcnt(6)
    v_exp_f32 v34, v94
    v_mfma_f32_16x16x32_bf16 v[104:107], a[88:91], a[24:27], v[104:107]
    s_waitcnt lgkmcnt(5)
    ds_read_b128 a[116:119], v5 offset:29696
    v_add_f32 v25, v25, v34
    v_mfma_f32_16x16x32_bf16 v[104:107], a[92:95], a[28:31], v[104:107]
    s_mov_b32 s30, 0
    v_exp_f32 v35, v95
    v_mfma_f32_16x16x32_bf16 v[108:111], a[64:67], a[32:35], v[44:47]
    ds_read_b128 a[120:123], v5 offset:30720
    v_add_f32 v25, v25, v35
    v_mfma_f32_16x16x32_bf16 v[108:111], a[68:71], a[36:39], v[108:111]
    v_exp_f32 v36, v100
    v_mfma_f32_16x16x32_bf16 v[108:111], a[72:75], a[40:43], v[108:111]
    ds_read_b128 a[124:127], v5 offset:31744
    v_add_f32 v25, v25, v36
    v_mfma_f32_16x16x32_bf16 v[108:111], a[76:79], a[44:47], v[108:111]
    v_exp_f32 v37, v101
    v_mfma_f32_16x16x32_bf16 v[108:111], a[80:83], a[48:51], v[108:111]
    ds_read_b128 a[64:67], v5 offset:0
    v_add_f32 v25, v25, v37
    v_mfma_f32_16x16x32_bf16 v[108:111], a[84:87], a[52:55], v[108:111]
    v_exp_f32 v38, v102
    v_mfma_f32_16x16x32_bf16 v[108:111], a[88:91], a[56:59], v[108:111]
    ds_read_b128 a[68:71], v5 offset:1024
    v_add_f32 v25, v25, v38
    v_mfma_f32_16x16x32_bf16 v[108:111], a[92:95], a[60:63], v[108:111]
    s_waitcnt lgkmcnt(9)
    v_exp_f32 v39, v103
    v_mfma_f32_16x16x32_bf16 v[112:115], a[96:99], a[0:3], v[40:43]
    s_waitcnt lgkmcnt(8)
    ds_read_b128 a[72:75], v5 offset:2048
    v_add_f32 v25, v25, v39
    v_mfma_f32_16x16x32_bf16 v[112:115], a[100:103], a[4:7], v[112:115]
    s_waitcnt lgkmcnt(8)
    v_cvt_pk_bf16_f32 v76, v32, v33
    v_cvt_pk_bf16_f32 v77, v34, v35
    v_mfma_f32_16x16x32_bf16 v[112:115], a[104:107], a[8:11], v[112:115]
    s_waitcnt lgkmcnt(7)
    s_add_u32 m0, s16, 16384
    s_add_u32 s89, s18, s20
    ds_read_b128 a[76:79], v5 offset:3072
    v_mfma_f32_16x16x32_bf16 v[112:115], a[108:111], a[12:15], v[112:115]
    s_waitcnt lgkmcnt(7)
    buffer_load_dwordx4 v120, s[4:7], s89 offen offset:0 sc1 lds
    v_cvt_pk_bf16_f32 v78, v36, v37
    v_mfma_f32_16x16x32_bf16 v[112:115], a[112:115], a[16:19], v[112:115]
    s_waitcnt lgkmcnt(6)
    ds_read_b128 a[80:83], v5 offset:4096
    v_cvt_pk_bf16_f32 v79, v38, v39
    v_mfma_f32_16x16x32_bf16 v[112:115], a[116:119], a[20:23], v[112:115]
    s_waitcnt lgkmcnt(6)
    buffer_load_dwordx4 v121, s[4:7], s89 offen offset:1024 sc1 lds
    v_max_f32 v18, v24, v25
    v_mfma_f32_16x16x32_bf16 v[112:115], a[120:123], a[24:27], v[112:115]
    s_waitcnt lgkmcnt(5)
    ds_read_b128 a[84:87], v5 offset:5120
    v_cmp_lt_f32 vcc, s33, v18
    v_mfma_f32_16x16x32_bf16 v[112:115], a[124:127], a[28:31], v[112:115]
    buffer_load_dwordx4 v122, s[4:7], s89 offen offset:2048 sc1 lds
    v_mfma_f32_16x16x32_bf16 v[116:119], a[96:99], a[32:35], v[44:47]
    ds_read_b128 a[88:91], v5 offset:6144
    v_mfma_f32_16x16x32_bf16 v[116:119], a[100:103], a[36:39], v[116:119]
    s_add_u32 s16, s16, 32768
    buffer_load_dwordx4 v123, s[4:7], s89 offen offset:3072 sc1 lds
    v_mfma_f32_16x16x32_bf16 v[116:119], a[104:107], a[40:43], v[116:119]
    s_cmp_eq_u32 s16, s17
    ds_read_b128 a[92:95], v5 offset:7168
    v_mfma_f32_16x16x32_bf16 v[116:119], a[108:111], a[44:47], v[116:119]
    s_cselect_b32 s16, s67, s16
    v_mfma_f32_16x16x32_bf16 v[116:119], a[112:115], a[48:51], v[116:119]
    s_add_u32 s18, s18, s19
    ds_read_b128 a[96:99], v5 offset:8192
    v_mfma_f32_16x16x32_bf16 v[116:119], a[116:119], a[52:55], v[116:119]
    v_mfma_f32_16x16x32_bf16 v[116:119], a[120:123], a[56:59], v[116:119]
    ds_read_b128 a[100:103], v5 offset:9216
    v_mfma_f32_16x16x32_bf16 v[116:119], a[124:127], a[60:63], v[116:119]
    s_cbranch_vccnz fz_rare0
fz_ret_le:
    s_cmp_eq_u32 s18, s21
    s_cbranch_scc1 fz_sw0
fz_sw0r:
    s_waitcnt lgkmcnt(9)
    v_mfma_f32_16x16x32_bf16 v[128:131], a[64:67], v[72:75], v[128:131]
    s_add_u32 s22, s22, 32768
    ds_read_b128 a[104:107], v5 offset:10240
    v_add_f32 v20, v20, v24
    v_mfma_f32_16x16x32_bf16 v[136:139], a[64:67], v[76:79], v[136:139]
    s_waitcnt lgkmcnt(9)
    v_add_f32 v21, v21, v25
    v_mfma_f32_16x16x32_bf16 v[132:135], a[68:71], v[72:75], v[132:135]
    s_cmp_eq_u32 s22, 163840
    ds_read_b128 a[108:111], v5 offset:11264
    v_mfma_f32_16x16x32_bf16 v[140:143], a[68:71], v[76:79], v[140:143]
    s_waitcnt lgkmcnt(9)
    v_exp_f32 v32, v104
    v_mfma_f32_16x16x32_bf16 v[144:147], a[72:75], v[72:75], v[144:147]
    s_cselect_b32 s22, 0, s22
    ds_read_b128 a[112:115], v5 offset:12288
    v_mfma_f32_16x16x32_bf16 v[152:155], a[72:75], v[76:79], v[152:155]
    s_waitcnt lgkmcnt(9)
    v_exp_f32 v33, v105
    v_mfma_f32_16x16x32_bf16 v[148:151], a[76:79], v[72:75], v[148:151]
    ds_read_b128 a[116:119], v5 offset:13312
    v_add_f32 v24, v32, v33
    v_mfma_f32_16x16x32_bf16 v[156:159], a[76:79], v[76:79], v[156:159]
    s_waitcnt lgkmcnt(9)
    v_exp_f32 v34, v106
    v_mfma_f32_16x16x32_bf16 v[160:163], a[80:83], v[72:75], v[160:163]
    ds_read_b128 a[120:123], v5 offset:14336
    v_add_f32 v24, v24, v34
    v_mfma_f32_16x16x32_bf16 v[168:171], a[80:83], v[76:79], v[168:171]
    s_waitcnt lgkmcnt(9)
    v_exp_f32 v35, v107
    v_mfma_f32_16x16x32_bf16 v[164:167], a[84:87], v[72:75], v[164:167]
    ds_read_b128 a[124:127], v5 offset:15360
    v_add_f32 v24, v24, v35
    v_mfma_f32_16x16x32_bf16 v[172:175], a[84:87], v[76:79], v[172:175]
    s_waitcnt lgkmcnt(9)
    s_waitcnt vmcnt(16)
    s_barrier
    v_add_u32 v5, s22, v4
    v_mfma_f32_16x16x32_bf16 v[176:179], a[88:91], v[72:75], v[176:179]
    s_mov_b32 m0, s16
    ds_read_b128 a[64:67], v5 offset:16384
    v_mfma_f32_16x16x32_bf16 v[184:187], a[88:91], v[76:79], v[184:187]
    s_waitcnt lgkmcnt(9)
    buffer_load_dwordx4 v120, s[4:7], s18 offen offset:0 sc1 lds
    v_mfma_f32_16x16x32_bf16 v[180:183], a[92:95], v[72:75], v[180:183]
    ds_read_b128 a[68:71], v5 offset:17408
    v_mfma_f32_16x16x32_bf16 v[188:191], a[92:95], v[76:79], v[188:191]
    s_waitcnt lgkmcnt(9)
    v_exp_f32 v36, v112
    v_mfma_f32_16x16x32_bf16 v[192:195], a[96:99], v[72:75], v[192:195]
    ds_read_b128 a[72:75], v5 offset:18432
    v_add_f32 v24, v24, v36
    v_mfma_f32_16x16x32_bf16 v[200:203], a[96:99], v[76:79], v[200:203]
    s_waitcnt lgkmcnt(9)
    buffer_load_dwordx4 v121, s[4:7], s18 offen offset:1024 sc1 lds
    v_mfma_f32_16x16x32_bf16 v[196:199], a[100:103], v[72:75], v[196:199]
    ds_read_b128 a[76:79], v5 offset:19456
    v_mfma_f32_16x16x32_bf16 v[204:207], a[100:103], v[76:79], v[204:207]
    s_waitcnt lgkmcnt(9)
    v_exp_f32 v37, v113
    v_mfma_f32_16x16x32_bf16 v[208:211], a[104:107], v[72:75], v[208:211]
    ds_read_b128 a[80:83], v5 offset:20480
    v_add_f32 v24, v24, v37
    v_mfma_f32_16x16x32_bf16 v[216:219], a[104:107], v[76:79], v[216:219]
    s_waitcnt lgkmcnt(9)
    buffer_load_dwordx4 v122, s[4:7], s18 offen offset:2048 sc1 lds
    v_mfma_f32_16x16x32_bf16 v[212:215], a[108:111], v[72:75], v[212:215]
    ds_read_b128 a[84:87], v5 offset:21504
    v_mfma_f32_16x16x32_bf16 v[220:223], a[108:111], v[76:79], v[220:223]
    s_waitcnt lgkmcnt(9)
    v_exp_f32 v38, v114
    v_mfma_f32_16x16x32_bf16 v[224:227], a[112:115], v[72:75], v[224:227]
    ds_read_b128 a[88:91], v5 offset:22528
    v_add_f32 v24, v24, v38
    v_mfma_f32_16x16x32_bf16 v[232:235], a[112:115], v[76:79], v[232:235]
    s_waitcnt lgkmcnt(9)
    buffer_load_dwordx4 v123, s[4:7], s18 offen offset:3072 sc1 lds
    v_mfma_f32_16x16x32_bf16 v[228:231], a[116:119], v[72:75], v[228:231]
    s_sub_u32 s23, s23, 1
    ds_read_b128 a[92:95], v5 offset:23552
    v_mfma_f32_16x16x32_bf16 v[236:239], a[116:119], v[76:79], v[236:239]
    s_waitcnt lgkmcnt(9)
    v_exp_f32 v39, v115
    v_mfma_f32_16x16x32_bf16 v[240:243], a[120:123], v[72:75], v[240:243]
    ds_read_b128 a[96:99], v5 offset:24576
    v_add_f32 v24, v24, v39
    v_mfma_f32_16x16x32_bf16 v[248:251], a[120:123], v[76:79], v[248:251]
    s_waitcnt lgkmcnt(9)
    v_cvt_pk_bf16_f32 v80, v32, v33
    v_cvt_pk_bf16_f32 v81, v34, v35
    v_mfma_f32_16x16x32_bf16 v[244:247], a[124:127], v[72:75], v[244:247]
    ds_read_b128 a[100:103], v5 offset:25600
    v_cvt_pk_bf16_f32 v82, v36, v37
    v_mfma_f32_16x16x32_bf16 v[252:255], a[124:127], v[76:79], v[252:255]
    v_cvt_pk_bf16_f32 v83, v38, v39
    s_cbranch_scc1 fz_exit
fz_lo:
    s_waitcnt lgkmcnt(9)
    v_mfma_f32_16x16x32_bf16 v[88:91], a[64:67], a[0:3], v[40:43]
    s_waitcnt lgkmcnt(8)
    ds_read_b128 a[104:107], v5 offset:26624
    v_mfma_f32_16x16x32_bf16 v[88:91], a[68:71], a[4:7], v[88:91]
    s_waitcnt lgkmcnt(8)
    v_exp_f32 v32, v108
    v_mfma_f32_16x16x32_bf16 v[88:91], a[72:75], a[8:11], v[88:91]
    s_waitcnt lgkmcnt(7)
    ds_read_b128 a[108:111], v5 offset:27648
    v_mfma_f32_16x16x32_bf16 v[88:91], a[76:79], a[12:15], v[88:91]
    s_waitcnt lgkmcnt(7)
    v_exp_f32 v33, v109
    v_mfma_f32_16x16x32_bf16 v[88:91], a[80:83], a[16:19], v[88:91]
    s_waitcnt lgkmcnt(6)
    ds_read_b128 a[112:115], v5 offset:28672
    v_add_f32 v25, v32, v33
    v_mfma_f32_16x16x32_bf16 v[88:91], a[84:87], a[20:23], v[88:91]
    s_waitcnt lgkmcnt(6)
    v_exp_f32 v34, v110
    v_mfma_f32_16x16x32_bf16 v[88:91], a[88:91], a[24:27], v[88:91]
    s_waitcnt lgkmcnt(5)
    ds_read_b128 a[116:119], v5 offset:29696
    v_add_f32 v25, v25, v34
    v_mfma_f32_16x16x32_bf16 v[88:91], a[92:95], a[28:31], v[88:91]
    s_mov_b32 s30, 0
    v_exp_f32 v35, v111
    v_mfma_f32_16x16x32_bf16 v[92:95], a[64:67], a[32:35], v[44:47]
    ds_read_b128 a[120:123], v5 offset:30720
    v_add_f32 v25, v25, v35
    v_mfma_f32_16x16x32_bf16 v[92:95], a[68:71], a[36:39], v[92:95]
    v_exp_f32 v36, v116
    v_mfma_f32_16x16x32_bf16 v[92:95], a[72:75], a[40:43], v[92:95]
    ds_read_b128 a[124:127], v5 offset:31744
    v_add_f32 v25, v25, v36
    v_mfma_f32_16x16x32_bf16 v[92:95], a[76:79], a[44:47], v[92:95]
    v_exp_f32 v37, v117
    v_mfma_f32_16x16x32_bf16 v[92:95], a[80:83], a[48:51], v[92:95]
    ds_read_b128 a[64:67], v5 offset:0
    v_add_f32 v25, v25, v37
    v_mfma_f32_16x16x32_bf16 v[92:95], a[84:87], a[52:55], v[92:95]
    v_exp_f32 v38, v118
    v_mfma_f32_16x16x32_bf16 v[92:95], a[88:91], a[56:59], v[92:95]
    ds_read_b128 a[68:71], v5 offset:1024
    v_add_f32 v25, v25, v38
    v_mfma_f32_16x16x32_bf16 v[92:95], a[92:95], a[60:63], v[92:95]
    s_waitcnt lgkmcnt(9)
    v_exp_f32 v39, v119
    v_mfma_f32_16x16x32_bf16 v[96:99], a[96:99], a[0:3], v[40:43]
    s_waitcnt lgkmcnt(8)
    ds_read_b128 a[72:75], v5 offset:2048
    v_add_f32 v25, v25, v39
    v_mfma_f32_16x16x32_bf16 v[96:99], a[100:103], a[4:7], v[96:99]
    s_waitcnt lgkmcnt(8)
    v_cvt_pk_bf16_f32 v84, v32, v33
    v_cvt_pk_bf16_f32 v85, v34, v35
    v_mfma_f32_16x16x32_bf16 v[96:99], a[104:107], a[8:11], v[96:99]
    s_waitcnt lgkmcnt(7)
    s_add_u32 m0, s16, 16384
    s_add_u32 s89, s18, s20
    ds_read_b128 a[76:79], v5 offset:3072
    v_mfma_f32_16x16x32_bf16 v[96:99], a[108:111], a[12:15], v[96:99]
    s_waitcnt lgkmcnt(7)
    buffer_load_dwordx4 v120, s[4:7], s89 offen offset:0 sc1 lds
    v_cvt_pk_bf16_f32 v86, v36, v37
    v_mfma_f32_16x16x32_bf16 v[96:99], a[112:115], a[16:19], v[96:99]
    s_waitcnt lgkmcnt(6)
    ds_read_b128 a[80:83], v5 offset:4096
    v_cvt_pk_bf16_f32 v87, v38, v39
    v_mfma_f32_16x16x32_bf16 v[96:99], a[116:119], a[20:23], v[96:99]
    s_waitcnt lgkmcnt(6)
    buffer_load_dwordx4 v121, s[4:7], s89 offen offset:1024 sc1 lds
    v_max_f32 v18, v24, v25
    v_mfma_f32_16x16x32_bf16 v[96:99], a[120:123], a[24:27], v[96:99]
    s_waitcnt lgkmcnt(5)
    ds_read_b128 a[84:87], v5 offset:5120
    v_cmp_lt_f32 vcc, s33, v18
    v_mfma_f32_16x16x32_bf16 v[96:99], a[124:127], a[28:31], v[96:99]
    buffer_load_dwordx4 v122, s[4:7], s89 offen offset:2048 sc1 lds
    v_mfma_f32_16x16x32_bf16 v[100:103], a[96:99], a[32:35], v[44:47]
    ds_read_b128 a[88:91], v5 offset:6144
    v_mfma_f32_16x16x32_bf16 v[100:103], a[100:103], a[36:39], v[100:103]
    s_add_u32 s16, s16, 32768
    buffer_load_dwordx4 v123, s[4:7], s89 offen offset:3072 sc1 lds
    v_mfma_f32_16x16x32_bf16 v[100:103], a[104:107], a[40:43], v[100:103]
    s_cmp_eq_u32 s16, s17
    ds_read_b128 a[92:95], v5 offset:7168
    v_mfma_f32_16x16x32_bf16 v[100:103], a[108:111], a[44:47], v[100:103]
    s_cselect_b32 s16, s67, s16
    v_mfma_f32_16x16x32_bf16 v[100:103], a[112:115], a[48:51], v[100:103]
    s_add_u32 s18, s18, s19
    ds_read_b128 a[96:99], v5 offset:8192
    v_mfma_f32_16x16x32_bf16 v[100:103], a[116:119], a[52:55], v[100:103]
    v_mfma_f32_16x16x32_bf16 v[100:103], a[120:123], a[56:59], v[100:103]
    ds_read_b128 a[100:103], v5 offset:9216
    v_mfma_f32_16x16x32_bf16 v[100:103], a[124:127], a[60:63], v[100:103]
    s_cbranch_vccnz fz_rare1
fz_ret_lo:
    s_waitcnt lgkmcnt(9)
    v_mfma_f32_16x16x32_bf16 v[128:131], a[64:67], v[80:83], v[128:131]
    s_add_u32 s22, s22, 32768
    ds_read_b128 a[104:107], v5 offset:10240
    v_add_f32 v20, v20, v24
    v_mfma_f32_16x16x32_bf16 v[136:139], a[64:67], v[84:87], v[136:139]
    s_waitcnt lgkmcnt(9)
    v_add_f32 v21, v21, v25
    v_mfma_f32_16x16x32_bf16 v[132:135], a[68:71], v[80:83], v[132:135]
    s_cmp_eq_u32 s22, 163840
    ds_read_b128 a[108:111], v5 offset:11264
    v_mfma_f32_16x16x32_bf16 v[140:143], a[68:71], v[84:87], v[140:143]
    s_waitcnt lgkmcnt(9)
    v_exp_f32 v32, v88
    v_mfma_f32_16x16x32_bf16 v[144:147], a[72:75], v[80:83], v[144:147]
    s_cselect_b32 s22, 0, s22
    ds_read_b128 a[112:115], v5 offset:12288
    v_mfma_f32_16x16x32_bf16 v[152:155], a[72:75], v[84:87], v[152:155]
    s_waitcnt lgkmcnt(9)
    v_exp_f32 v33, v89
    v_mfma_f32_16x16x32_bf16 v[148:151], a[76:79], v[80:83], v[148:151]
    ds_read_b128 a[116:119], v5 offset:13312
    v_add_f32 v24, v32, v33
    v_mfma_f32_16x16x32_bf16 v[156:159], a[76:79], v[84:87], v[156:159]
    s_waitcnt lgkmcnt(9)
    v_exp_f32 v34, v90
    v_mfma_f32_16x16x32_bf16 v[160:163], a[80:83], v[80:83], v[160:163]
    ds_read_b128 a[120:123], v5 offset:14336
    v_add_f32 v24, v24, v34
    v_mfma_f32_16x16x32_bf16 v[168:171], a[80:83], v[84:87], v[168:171]
    s_waitcnt lgkmcnt(9)
    v_exp_f32 v35, v91
    v_mfma_f32_16x16x32_bf16 v[164:167], a[84:87], v[80:83], v[164:167]
    ds_read_b128 a[124:127], v5 offset:15360
    v_add_f32 v24, v24, v35
    v_mfma_f32_16x16x32_bf16 v[172:175], a[84:87], v[84:87], v[172:175]
    s_waitcnt lgkmcnt(9)
    s_waitcnt vmcnt(16)
    s_barrier
    v_add_u32 v5, s22, v4
    v_mfma_f32_16x16x32_bf16 v[176:179], a[88:91], v[80:83], v[176:179]
    s_mov_b32 m0, s16
    ds_read_b128 a[64:67], v5 offset:16384
    v_mfma_f32_16x16x32_bf16 v[184:187], a[88:91], v[84:87], v[184:187]
    s_waitcnt lgkmcnt(9)
    buffer_load_dwordx4 v120, s[4:7], s18 offen offset:0 sc1 lds
    v_mfma_f32_16x16x32_bf16 v[180:183], a[92:95], v[80:83], v[180:183]
    ds_read_b128 a[68:71], v5 offset:17408
    v_mfma_f32_16x16x32_bf16 v[188:191], a[92:95], v[84:87], v[188:191]
    s_waitcnt lgkmcnt(9)
    v_exp_f32 v36, v96
    v_mfma_f32_16x16x32_bf16 v[192:195], a[96:99], v[80:83], v[192:195]
    ds_read_b128 a[72:75], v5 offset:18432
    v_add_f32 v24, v24, v36
    v_mfma_f32_16x16x32_bf16 v[200:203], a[96:99], v[84:87], v[200:203]
    s_waitcnt lgkmcnt(9)
    buffer_load_dwordx4 v121, s[4:7], s18 offen offset:1024 sc1 lds
    v_mfma_f32_16x16x32_bf16 v[196:199], a[100:103], v[80:83], v[196:199]
    ds_read_b128 a[76:79], v5 offset:19456
    v_mfma_f32_16x16x32_bf16 v[204:207], a[100:103], v[84:87], v[204:207]
    s_waitcnt lgkmcnt(9)
    v_exp_f32 v37, v97
    v_mfma_f32_16x16x32_bf16 v[208:211], a[104:107], v[80:83], v[208:211]
    ds_read_b128 a[80:83], v5 offset:20480
    v_add_f32 v24, v24, v37
    v_mfma_f32_16x16x32_bf16 v[216:219], a[104:107], v[84:87], v[216:219]
    s_waitcnt lgkmcnt(9)
    buffer_load_dwordx4 v122, s[4:7], s18 offen offset:2048 sc1 lds
    v_mfma_f32_16x16x32_bf16 v[212:215], a[108:111], v[80:83], v[212:215]
    ds_read_b128 a[84:87], v5 offset:21504
    v_mfma_f32_16x16x32_bf16 v[220:223], a[108:111], v[84:87], v[220:223]
    s_waitcnt lgkmcnt(9)
    v_exp_f32 v38, v98
    v_mfma_f32_16x16x32_bf16 v[224:227], a[112:115], v[80:83], v[224:227]
    ds_read_b128 a[88:91], v5 offset:22528
    v_add_f32 v24, v24, v38
    v_mfma_f32_16x16x32_bf16 v[232:235], a[112:115], v[84:87], v[232:235]
    s_waitcnt lgkmcnt(9)
    buffer_load_dwordx4 v123, s[4:7], s18 offen offset:3072 sc1 lds
    v_mfma_f32_16x16x32_bf16 v[228:231], a[116:119], v[80:83], v[228:231]
    ds_read_b128 a[92:95], v5 offset:23552
    v_mfma_f32_16x16x32_bf16 v[236:239], a[116:119], v[84:87], v[236:239]
    s_waitcnt lgkmcnt(9)
    v_exp_f32 v39, v99
    v_mfma_f32_16x16x32_bf16 v[240:243], a[120:123], v[80:83], v[240:243]
    ds_read_b128 a[96:99], v5 offset:24576
    v_add_f32 v24, v24, v39
    v_mfma_f32_16x16x32_bf16 v[248:251], a[120:123], v[84:87], v[248:251]
    s_waitcnt lgkmcnt(9)
    v_cvt_pk_bf16_f32 v72, v32, v33
    v_cvt_pk_bf16_f32 v73, v34, v35
    v_mfma_f32_16x16x32_bf16 v[244:247], a[124:127], v[80:83], v[244:247]
    ds_read_b128 a[100:103], v5 offset:25600
    v_cvt_pk_bf16_f32 v74, v36, v37
    v_mfma_f32_16x16x32_bf16 v[252:255], a[124:127], v[84:87], v[252:255]
    v_cvt_pk_bf16_f32 v75, v38, v39
    s_branch fz_loop
fz_sw0:
    s_mul_i32 s86, s68, 229376
    s_add_u32 s4, s50, s86
    s_addc_u32 s5, s51, 0
    s_mov_b32 s6, 229376
    s_mov_b32 s18, 0
    s_mov_b32 s19, 128
    s_mov_b32 s20, 114688
    s_mov_b32 s21, -1
    v_mov_b32 v120, v6
    v_mov_b32 v121, v7
    v_mov_b32 v122, v8
    v_mov_b32 v123, v9
    s_branch fz_sw0r
fz_sw1:
    s_mul_i32 s86, s68, 229376
    s_add_u32 s4, s50, s86
    s_addc_u32 s5, s51, 0
    s_mov_b32 s6, 229376
    s_mov_b32 s18, 0
    s_mov_b32 s19, 128
    s_mov_b32 s20, 114688
    s_mov_b32 s21, -1
    v_mov_b32 v120, v6
    v_mov_b32 v121, v7
    v_mov_b32 v122, v8
    v_mov_b32 v123, v9
    s_branch fz_sw1r
fz_L1:
    ds_read_b128 a[64:67], v5 offset:0
    ds_read_b128 a[68:71], v5 offset:1024
    ds_read_b128 a[72:75], v5 offset:2048
    ds_read_b128 a[76:79], v5 offset:3072
    ds_read_b128 a[80:83], v5 offset:4096
    ds_read_b128 a[84:87], v5 offset:5120
    ds_read_b128 a[88:91], v5 offset:6144
    ds_read_b128 a[92:95], v5 offset:7168
    ds_read_b128 a[96:99], v5 offset:8192
    ds_read_b128 a[100:103], v5 offset:9216
    buffer_load_dword v126, v12, s[24:27], s81 offen sc1
    s_add_u32 m0, s16, 16384
    s_add_u32 s89, s18, s20
    v_exp_f32 v32, v108
    v_exp_f32 v33, v109
    v_exp_f32 v34, v110
    v_exp_f32 v35, v111
    v_exp_f32 v36, v116
    v_exp_f32 v37, v117
    v_exp_f32 v38, v118
    v_exp_f32 v39, v119
    s_nop 0
    v_add_f32 v25, v32, v33
    v_add_f32 v25, v25, v34
    v_add_f32 v25, v25, v35
    v_add_f32 v25, v25, v36
    v_add_f32 v25, v25, v37
    v_add_f32 v25, v25, v38
    v_add_f32 v25, v25, v39
    v_cvt_pk_bf16_f32 v84, v32, v33
    v_cvt_pk_bf16_f32 v85, v34, v35
    v_cvt_pk_bf16_f32 v86, v36, v37
    v_cvt_pk_bf16_f32 v87, v38, v39
    buffer_load_dwordx4 v120, s[4:7], s89 offen offset:0 sc1 lds
    buffer_load_dwordx4 v121, s[4:7], s89 offen offset:1024 sc1 lds
    buffer_load_dwordx4 v122, s[4:7], s89 offen offset:2048 sc1 lds
    buffer_load_dwordx4 v123, s[4:7], s89 offen offset:3072 sc1 lds
    s_add_u32 s16, s16, 32768
    s_cmp_eq_u32 s16, s17
    s_cselect_b32 s16, s67, s16
    s_add_u32 s18, s18, s19
    v_max_f32 v18, v24, v25
    v_cmp_lt_f32 vcc, s33, v18
    s_mov_b32 s30, 1
    s_cbranch_vccnz fz_rare1
fz_ret_L1:
    s_waitcnt lgkmcnt(9)
    v_mfma_f32_16x16x32_bf16 v[128:131], a[64:67], v[80:83], v[128:131]
    s_add_u32 s22, s22, 32768
    ds_read_b128 a[104:107], v5 offset:10240
    v_add_f32 v20, v20, v24
    v_mfma_f32_16x16x32_bf16 v[136:139], a[64:67], v[84:87], v[136:139]
    s_waitcnt lgkmcnt(9)
    v_add_f32 v21, v21, v25
    v_mfma_f32_16x16x32_bf16 v[132:135], a[68:71], v[80:83], v[132:135]
    s_cmp_eq_u32 s22, 163840
    ds_read_b128 a[108:111], v5 offset:11264
    v_mfma_f32_16x16x32_bf16 v[140:143], a[68:71], v[84:87], v[140:143]
    s_waitcnt lgkmcnt(9)
    v_mfma_f32_16x16x32_bf16 v[144:147], a[72:75], v[80:83], v[144:147]
    s_cselect_b32 s22, 0, s22
    ds_read_b128 a[112:115], v5 offset:12288
    v_mfma_f32_16x16x32_bf16 v[152:155], a[72:75], v[84:87], v[152:155]
    s_waitcnt lgkmcnt(9)
    v_mfma_f32_16x16x32_bf16 v[148:151], a[76:79], v[80:83], v[148:151]
    ds_read_b128 a[116:119], v5 offset:13312
    v_mfma_f32_16x16x32_bf16 v[156:159], a[76:79], v[84:87], v[156:159]
    s_waitcnt lgkmcnt(9)
    v_mfma_f32_16x16x32_bf16 v[160:163], a[80:83], v[80:83], v[160:163]
    ds_read_b128 a[120:123], v5 offset:14336
    v_mfma_f32_16x16x32_bf16 v[168:171], a[80:83], v[84:87], v[168:171]
    s_waitcnt lgkmcnt(9)
    v_mfma_f32_16x16x32_bf16 v[164:167], a[84:87], v[80:83], v[164:167]
    ds_read_b128 a[124:127], v5 offset:15360
    v_mfma_f32_16x16x32_bf16 v[172:175], a[84:87], v[84:87], v[172:175]
    s_waitcnt lgkmcnt(9)
    s_waitcnt vmcnt(16)
    s_barrier
    v_add_u32 v5, s22, v4
    v_mfma_f32_16x16x32_bf16 v[176:179], a[88:91], v[80:83], v[176:179]
    s_mov_b32 m0, s16
    v_add_u32 v14, s22, v10
    v_add_u32 v15, s22, v11
    v_mfma_f32_16x16x32_bf16 v[184:187], a[88:91], v[84:87], v[184:187]
    s_waitcnt lgkmcnt(8)
    buffer_load_dwordx4 v120, s[4:7], s18 offen offset:0 sc1 lds
    v_mfma_f32_16x16x32_bf16 v[180:183], a[92:95], v[80:83], v[180:183]
    v_mfma_f32_16x16x32_bf16 v[188:191], a[92:95], v[84:87], v[188:191]
    s_waitcnt lgkmcnt(7)
    v_mfma_f32_16x16x32_bf16 v[192:195], a[96:99], v[80:83], v[192:195]
    v_mfma_f32_16x16x32_bf16 v[200:203], a[96:99], v[84:87], v[200:203]
    s_waitcnt lgkmcnt(6)
    buffer_load_dwordx4 v121, s[4:7], s18 offen offset:1024 sc1 lds
    v_mfma_f32_16x16x32_bf16 v[196:199], a[100:103], v[80:83], v[196:199]
    v_mfma_f32_16x16x32_bf16 v[204:207], a[100:103], v[84:87], v[204:207]
    s_waitcnt lgkmcnt(5)
    v_mfma_f32_16x16x32_bf16 v[208:211], a[104:107], v[80:83], v[208:211]
    v_mfma_f32_16x16x32_bf16 v[216:219], a[104:107], v[84:87], v[216:219]
    s_waitcnt lgkmcnt(4)
    buffer_load_dwordx4 v122, s[4:7], s18 offen offset:2048 sc1 lds
    v_mfma_f32_16x16x32_bf16 v[212:215], a[108:111], v[80:83], v[212:215]
    v_mfma_f32_16x16x32_bf16 v[220:223], a[108:111], v[84:87], v[220:223]
    s_waitcnt lgkmcnt(3)
    v_mfma_f32_16x16x32_bf16 v[224:227], a[112:115], v[80:83], v[224:227]
    v_mfma_f32_16x16x32_bf16 v[232:235], a[112:115], v[84:87], v[232:235]
    s_waitcnt lgkmcnt(2)
    buffer_load_dwordx4 v123, s[4:7], s18 offen offset:3072 sc1 lds
    v_mfma_f32_16x16x32_bf16 v[228:231], a[116:119], v[80:83], v[228:231]
    v_mfma_f32_16x16x32_bf16 v[236:239], a[116:119], v[84:87], v[236:239]
    s_waitcnt lgkmcnt(1)
    v_mfma_f32_16x16x32_bf16 v[240:243], a[120:123], v[80:83], v[240:243]
    v_mfma_f32_16x16x32_bf16 v[248:251], a[120:123], v[84:87], v[248:251]
    s_waitcnt lgkmcnt(0)
    v_mfma_f32_16x16x32_bf16 v[244:247], a[124:127], v[80:83], v[244:247]
    v_mfma_f32_16x16x32_bf16 v[252:255], a[124:127], v[84:87], v[252:255]
    ds_read_b64_tr_b16 a[64:65], v14 offset:0
    ds_read_b64_tr_b16 a[66:67], v14 offset:2048
    ds_read_b64_tr_b16 a[68:69], v14 offset:512
    ds_read_b64_tr_b16 a[70:71], v14 offset:2560
    ds_read_b64_tr_b16 a[72:73], v14 offset:4096
    ds_read_b64_tr_b16 a[74:75], v14 offset:6144
    ds_read_b64_tr_b16 a[76:77], v14 offset:4608
    ds_read_b64_tr_b16 a[78:79], v14 offset:6656
    ds_read_b64_tr_b16 a[80:81], v14 offset:8192
    ds_read_b64_tr_b16 a[82:83], v14 offset:10240
    ds_read_b64_tr_b16 a[84:85], v14 offset:8704
    ds_read_b64_tr_b16 a[86:87], v14 offset:10752
    ds_read_b64_tr_b16 a[88:89], v14 offset:12288
    ds_read_b64_tr_b16 a[90:91], v14 offset:14336
    ds_read_b64_tr_b16 a[92:93], v14 offset:12800
    ds_read_b64_tr_b16 a[94:95], v14 offset:14848
    ds_read_b64_tr_b16 a[96:97], v14 offset:16384
    ds_read_b64_tr_b16 a[98:99], v14 offset:18432
    ds_read_b64_tr_b16 a[100:101], v14 offset:16896
    ds_read_b64_tr_b16 a[102:103], v14 offset:18944
    v_mov_b32 v22, v40
    v_mov_b32 v23, v44
    s_add_u32 s86, s34, 16384
    buffer_store_dwordx4 v[20:23], v4, s[24:27], s86 offen sc1
    s_add_u32 s86, s34, 0
    v_cvt_pk_bf16_f32 v128, v128, v129
    v_cvt_pk_bf16_f32 v129, v130, v131
    v_cvt_pk_bf16_f32 v130, v132, v133
    v_cvt_pk_bf16_f32 v131, v134, v135
    buffer_store_dwordx4 v[128:131], v4, s[24:27], s86 offen offset:0 sc1
    v_cvt_pk_bf16_f32 v136, v136, v137
    v_cvt_pk_bf16_f32 v137, v138, v139
    v_cvt_pk_bf16_f32 v138, v140, v141
    v_cvt_pk_bf16_f32 v139, v142, v143
    buffer_store_dwordx4 v[136:139], v4, s[24:27], s86 offen offset:1024 sc1
    v_accvgpr_read_b32 v128, a192
    v_accvgpr_read_b32 v129, a193
    v_accvgpr_read_b32 v130, a194
    v_accvgpr_read_b32 v131, a195
    v_cvt_pk_bf16_f32 v144, v144, v145
    v_cvt_pk_bf16_f32 v145, v146, v147
    v_cvt_pk_bf16_f32 v146, v148, v149
    v_cvt_pk_bf16_f32 v147, v150, v151
    buffer_store_dwordx4 v[144:147], v4, s[24:27], s86 offen offset:2048 sc1
    v_accvgpr_read_b32 v136, a196
    v_accvgpr_read_b32 v137, a197
    v_accvgpr_read_b32 v138, a198
    v_accvgpr_read_b32 v139, a199
    v_cvt_pk_bf16_f32 v152, v152, v153
    v_cvt_pk_bf16_f32 v153, v154, v155
    v_cvt_pk_bf16_f32 v154, v156, v157
    v_cvt_pk_bf16_f32 v155, v158, v159
    buffer_store_dwordx4 v[152:155], v4, s[24:27], s86 offen offset:3072 sc1
    v_accvgpr_read_b32 v144, a200
    v_accvgpr_read_b32 v145, a201
    v_accvgpr_read_b32 v146, a202
    v_accvgpr_read_b32 v147, a203
    s_add_u32 s86, s34, 4096
    v_cvt_pk_bf16_f32 v160, v160, v161
    v_cvt_pk_bf16_f32 v161, v162, v163
    v_cvt_pk_bf16_f32 v162, v164, v165
    v_cvt_pk_bf16_f32 v163, v166, v167
    buffer_store_dwordx4 v[160:163], v4, s[24:27], s86 offen offset:0 sc1
    v_accvgpr_read_b32 v152, a204
    v_accvgpr_read_b32 v153, a205
    v_accvgpr_read_b32 v154, a206
    v_accvgpr_read_b32 v155, a207
    v_cvt_pk_bf16_f32 v168, v168, v169
    v_cvt_pk_bf16_f32 v169, v170, v171
    v_cvt_pk_bf16_f32 v170, v172, v173
    v_cvt_pk_bf16_f32 v171, v174, v175
    buffer_store_dwordx4 v[168:171], v4, s[24:27], s86 offen offset:1024 sc1
    v_accvgpr_read_b32 v160, a208
    v_accvgpr_read_b32 v161, a209
    v_accvgpr_read_b32 v162, a210
    v_accvgpr_read_b32 v163, a211
    v_cvt_pk_bf16_f32 v176, v176, v177
    v_cvt_pk_bf16_f32 v177, v178, v179
    v_cvt_pk_bf16_f32 v178, v180, v181
    v_cvt_pk_bf16_f32 v179, v182, v183
    buffer_store_dwordx4 v[176:179], v4, s[24:27], s86 offen offset:2048 sc1
    v_accvgpr_read_b32 v168, a212
    v_accvgpr_read_b32 v169, a213
    v_accvgpr_read_b32 v170, a214
    v_accvgpr_read_b32 v171, a215
    v_cvt_pk_bf16_f32 v184, v184, v185
    v_cvt_pk_bf16_f32 v185, v186, v187
    v_cvt_pk_bf16_f32 v186, v188, v189
    v_cvt_pk_bf16_f32 v187, v190, v191
    buffer_store_dwordx4 v[184:187], v4, s[24:27], s86 offen offset:3072 sc1
    v_accvgpr_read_b32 v176, a216
    v_accvgpr_read_b32 v177, a217
    v_accvgpr_read_b32 v178, a218
    v_accvgpr_read_b32 v179, a219
    s_add_u32 s86, s34, 8192
    v_cvt_pk_bf16_f32 v192, v192, v193
    v_cvt_pk_bf16_f32 v193, v194, v195
    v_cvt_pk_bf16_f32 v194, v196, v197
    v_cvt_pk_bf16_f32 v195, v198, v199
    buffer_store_dwordx4 v[192:195], v4, s[24:27], s86 offen offset:0 sc1
    v_accvgpr_read_b32 v184, a220
    v_accvgpr_read_b32 v185, a221
    v_accvgpr_read_b32 v186, a222
    v_accvgpr_read_b32 v187, a223
    v_cvt_pk_bf16_f32 v200, v200, v201
    v_cvt_pk_bf16_f32 v201, v202, v203
    v_cvt_pk_bf16_f32 v202, v204, v205
    v_cvt_pk_bf16_f32 v203, v206, v207
    buffer_store_dwordx4 v[200:203], v4, s[24:27], s86 offen offset:1024 sc1
    v_accvgpr_read_b32 v192, a224
    v_accvgpr_read_b32 v193, a225
    v_accvgpr_read_b32 v194, a226
    v_accvgpr_read_b32 v195, a227
    v_cvt_pk_bf16_f32 v208, v208, v209
    v_cvt_pk_bf16_f32 v209, v210, v211
    v_cvt_pk_bf16_f32 v210, v212, v213
    v_cvt_pk_bf16_f32 v211, v214, v215
    buffer_store_dwordx4 v[208:211], v4, s[24:27], s86 offen offset:2048 sc1
    v_accvgpr_read_b32 v200, a228
    v_accvgpr_read_b32 v201, a229
    v_accvgpr_read_b32 v202, a230
    v_accvgpr_read_b32 v203, a231
    v_cvt_pk_bf16_f32 v216, v216, v217
    v_cvt_pk_bf16_f32 v217, v218, v219
    v_cvt_pk_bf16_f32 v218, v220, v221
    v_cvt_pk_bf16_f32 v219, v222, v223
    buffer_store_dwordx4 v[216:219], v4, s[24:27], s86 offen offset:3072 sc1
    v_accvgpr_read_b32 v208, a232
    v_accvgpr_read_b32 v209, a233
    v_accvgpr_read_b32 v210, a234
    v_accvgpr_read_b32 v211, a235
    s_add_u32 s86, s34, 12288
    v_cvt_pk_bf16_f32 v224, v224, v225
    v_cvt_pk_bf16_f32 v225, v226, v227
    v_cvt_pk_bf16_f32 v226, v228, v229
    v_cvt_pk_bf16_f32 v227, v230, v231
    buffer_store_dwordx4 v[224:227], v4, s[24:27], s86 offen offset:0 sc1
    v_accvgpr_read_b32 v216, a236
    v_accvgpr_read_b32 v217, a237
    v_accvgpr_read_b32 v218, a238
    v_accvgpr_read_b32 v219, a239
    v_cvt_pk_bf16_f32 v232, v232, v233
    v_cvt_pk_bf16_f32 v233, v234, v235
    v_cvt_pk_bf16_f32 v234, v236, v237
    v_cvt_pk_bf16_f32 v235, v238, v239
    buffer_store_dwordx4 v[232:235], v4, s[24:27], s86 offen offset:1024 sc1
    v_accvgpr_read_b32 v224, a240
    v_accvgpr_read_b32 v225, a241
    v_accvgpr_read_b32 v226, a242
    v_accvgpr_read_b32 v227, a243
    v_cvt_pk_bf16_f32 v240, v240, v241
    v_cvt_pk_bf16_f32 v241, v242, v243
    v_cvt_pk_bf16_f32 v242, v244, v245
    v_cvt_pk_bf16_f32 v243, v246, v247
    buffer_store_dwordx4 v[240:243], v4, s[24:27], s86 offen offset:2048 sc1
    v_accvgpr_read_b32 v232, a244
    v_accvgpr_read_b32 v233, a245
    v_accvgpr_read_b32 v234, a246
    v_accvgpr_read_b32 v235, a247
    v_cvt_pk_bf16_f32 v248, v248, v249
    v_cvt_pk_bf16_f32 v249, v250, v251
    v_cvt_pk_bf16_f32 v250, v252, v253
    v_cvt_pk_bf16_f32 v251, v254, v255
    buffer_store_dwordx4 v[248:251], v4, s[24:27], s86 offen offset:3072 sc1
    v_accvgpr_read_b32 v240, a248
    v_accvgpr_read_b32 v241, a249
    v_accvgpr_read_b32 v242, a250
    v_accvgpr_read_b32 v243, a251
    v_mov_b32 v20, v124
    v_mov_b32 v21, v125
    s_mov_b32 s75, 5
    v_accvgpr_read_b32 v248, a252
    v_accvgpr_read_b32 v249, a253
    v_accvgpr_read_b32 v250, a254
    v_accvgpr_read_b32 v251, a255
    s_waitcnt vmcnt(21)
    s_branch fz_oent
fz_exit:
    s_cmp_lg_u32 s28, 0
    s_cbranch_scc1 fz_L1
fz_T0:
    v_add_f32 v48, v40, v56
    v_add_f32 v49, v40, v57
    v_add_f32 v50, v40, v58
    v_add_f32 v51, v40, v59
    v_add_f32 v52, v40, v60
    v_add_f32 v53, v40, v61
    v_add_f32 v54, v40, v62
    v_add_f32 v55, v40, v63
    s_waitcnt lgkmcnt(9)
    v_mfma_f32_16x16x32_bf16 v[88:91], a[64:67], a[0:3], v[48:51]
    s_waitcnt lgkmcnt(8)
    ds_read_b128 a[104:107], v5 offset:26624
    v_mfma_f32_16x16x32_bf16 v[88:91], a[68:71], a[4:7], v[88:91]
    s_waitcnt lgkmcnt(8)
    v_exp_f32 v32, v108
    v_mfma_f32_16x16x32_bf16 v[88:91], a[72:75], a[8:11], v[88:91]
    s_waitcnt lgkmcnt(7)
    ds_read_b128 a[108:111], v5 offset:27648
    v_mfma_f32_16x16x32_bf16 v[88:91], a[76:79], a[12:15], v[88:91]
    s_waitcnt lgkmcnt(7)
    v_exp_f32 v33, v109
    v_mfma_f32_16x16x32_bf16 v[88:91], a[80:83], a[16:19], v[88:91]
    s_waitcnt lgkmcnt(6)
    ds_read_b128 a[112:115], v5 offset:28672
    v_add_f32 v25, v32, v33
    v_mfma_f32_16x16x32_bf16 v[88:91], a[84:87], a[20:23], v[88:91]
    s_waitcnt lgkmcnt(6)
    v_exp_f32 v34, v110
    v_mfma_f32_16x16x32_bf16 v[88:91], a[88:91], a[24:27], v[88:91]
    s_waitcnt lgkmcnt(5)
    ds_read_b128 a[116:119], v5 offset:29696
    v_add_f32 v25, v25, v34
    v_mfma_f32_16x16x32_bf16 v[88:91], a[92:95], a[28:31], v[88:91]
    s_mov_b32 s30, 2
    v_exp_f32 v35, v111
    v_mfma_f32_16x16x32_bf16 v[92:95], a[64:67], a[32:35], v[44:47]
    ds_read_b128 a[120:123], v5 offset:30720
    v_add_f32 v25, v25, v35
    v_mfma_f32_16x16x32_bf16 v[92:95], a[68:71], a[36:39], v[92:95]
    v_exp_f32 v36, v116
    v_mfma_f32_16x16x32_bf16 v[92:95], a[72:75], a[40:43], v[92:95]
    ds_read_b128 a[124:127], v5 offset:31744
    v_add_f32 v25, v25, v36
    v_mfma_f32_16x16x32_bf16 v[92:95], a[76:79], a[44:47], v[92:95]
    v_exp_f32 v37, v117
    v_mfma_f32_16x16x32_bf16 v[92:95], a[80:83], a[48:51], v[92:95]
    ds_read_b128 a[64:67], v5 offset:0
    v_add_f32 v25, v25, v37
    v_mfma_f32_16x16x32_bf16 v[92:95], a[84:87], a[52:55], v[92:95]
    v_exp_f32 v38, v118
    v_mfma_f32_16x16x32_bf16 v[92:95], a[88:91], a[56:59], v[92:95]
    ds_read_b128 a[68:71], v5 offset:1024
    v_add_f32 v25, v25, v38
    v_mfma_f32_16x16x32_bf16 v[92:95], a[92:95], a[60:63], v[92:95]
    s_waitcnt lgkmcnt(9)
    v_exp_f32 v39, v119
    v_mfma_f32_16x16x32_bf16 v[96:99], a[96:99], a[0:3], v[52:55]
    s_waitcnt lgkmcnt(8)
    ds_read_b128 a[72:75], v5 offset:2048
    v_add_f32 v25, v25, v39
    v_mfma_f32_16x16x32_bf16 v[96:99], a[100:103], a[4:7], v[96:99]
    s_waitcnt lgkmcnt(8)
    v_cvt_pk_bf16_f32 v84, v32, v33
    v_cvt_pk_bf16_f32 v85, v34, v35
    v_mfma_f32_16x16x32_bf16 v[96:99], a[104:107], a[8:11], v[96:99]
    s_waitcnt lgkmcnt(7)
    s_add_u32 m0, s16, 16384
    s_add_u32 s89, s18, s20
    ds_read_b128 a[76:79], v5 offset:3072
    v_mfma_f32_16x16x32_bf16 v[96:99], a[108:111], a[12:15], v[96:99]
    s_waitcnt lgkmcnt(7)
    buffer_load_dwordx4 v120, s[4:7], s89 offen offset:0 sc1 lds
    v_cvt_pk_bf16_f32 v86, v36, v37
    v_mfma_f32_16x16x32_bf16 v[96:99], a[112:115], a[16:19], v[96:99]
    s_waitcnt lgkmcnt(6)
    ds_read_b128 a[80:83], v5 offset:4096
    v_cvt_pk_bf16_f32 v87, v38, v39
    v_mfma_f32_16x16x32_bf16 v[96:99], a[116:119], a[20:23], v[96:99]
    s_waitcnt lgkmcnt(6)
    buffer_load_dwordx4 v121, s[4:7], s89 offen offset:1024 sc1 lds
    v_max_f32 v18, v24, v25
    v_mfma_f32_16x16x32_bf16 v[96:99], a[120:123], a[24:27], v[96:99]
    s_waitcnt lgkmcnt(5)
    ds_read_b128 a[84:87], v5 offset:5120
    v_cmp_lt_f32 vcc, s33, v18
    v_mfma_f32_16x16x32_bf16 v[96:99], a[124:127], a[28:31], v[96:99]
    buffer_load_dwordx4 v122, s[4:7], s89 offen offset:2048 sc1 lds
    v_mfma_f32_16x16x32_bf16 v[100:103], a[96:99], a[32:35], v[44:47]
    ds_read_b128 a[88:91], v5 offset:6144
    v_mfma_f32_16x16x32_bf16 v[100:103], a[100:103], a[36:39], v[100:103]
    s_add_u32 s16, s16, 32768
    buffer_load_dwordx4 v123, s[4:7], s89 offen offset:3072 sc1 lds
    v_mfma_f32_16x16x32_bf16 v[100:103], a[104:107], a[40:43], v[100:103]
    s_cmp_eq_u32 s16, s17
    ds_read_b128 a[92:95], v5 offset:7168
    v_mfma_f32_16x16x32_bf16 v[100:103], a[108:111], a[44:47], v[100:103]
    s_cselect_b32 s16, s67, s16
    v_mfma_f32_16x16x32_bf16 v[100:103], a[112:115], a[48:51], v[100:103]
    s_add_u32 s18, s18, s19
    ds_read_b128 a[96:99], v5 offset:8192
    v_mfma_f32_16x16x32_bf16 v[100:103], a[116:119], a[52:55], v[100:103]
    v_mfma_f32_16x16x32_bf16 v[100:103], a[120:123], a[56:59], v[100:103]
    ds_read_b128 a[100:103], v5 offset:9216
    v_mfma_f32_16x16x32_bf16 v[100:103], a[124:127], a[60:63], v[100:103]
    s_cbranch_vccnz fz_rare1
fz_ret_T0:
    s_waitcnt lgkmcnt(9)
    v_mfma_f32_16x16x32_bf16 v[128:131], a[64:67], v[80:83], v[128:131]
    s_add_u32 s22, s22, 32768
    ds_read_b128 a[104:107], v5 offset:10240
    v_add_f32 v20, v20, v24
    v_mfma_f32_16x16x32_bf16 v[136:139], a[64:67], v[84:87], v[136:139]
    s_waitcnt lgkmcnt(9)
    v_add_f32 v21, v21, v25
    v_mfma_f32_16x16x32_bf16 v[132:135], a[68:71], v[80:83], v[132:135]
    s_cmp_eq_u32 s22, 163840
    ds_read_b128 a[108:111], v5 offset:11264
    v_mfma_f32_16x16x32_bf16 v[140:143], a[68:71], v[84:87], v[140:143]
    s_waitcnt lgkmcnt(9)
    v_exp_f32 v32, v88
    v_mfma_f32_16x16x32_bf16 v[144:147], a[72:75], v[80:83], v[144:147]
    s_cselect_b32 s22, 0, s22
    ds_read_b128 a[112:115], v5 offset:12288
    v_mfma_f32_16x16x32_bf16 v[152:155], a[72:75], v[84:87], v[152:155]
    s_waitcnt lgkmcnt(9)
    v_exp_f32 v33, v89
    v_mfma_f32_16x16x32_bf16 v[148:151], a[76:79], v[80:83], v[148:151]
    ds_read_b128 a[116:119], v5 offset:13312
    v_add_f32 v24, v32, v33
    v_mfma_f32_16x16x32_bf16 v[156:159], a[76:79], v[84:87], v[156:159]
    s_waitcnt lgkmcnt(9)
    v_exp_f32 v34, v90
    v_mfma_f32_16x16x32_bf16 v[160:163], a[80:83], v[80:83], v[160:163]
    ds_read_b128 a[120:123], v5 offset:14336
    v_add_f32 v24, v24, v34
    v_mfma_f32_16x16x32_bf16 v[168:171], a[80:83], v[84:87], v[168:171]
    s_waitcnt lgkmcnt(9)
    v_exp_f32 v35, v91
    v_mfma_f32_16x16x32_bf16 v[164:167], a[84:87], v[80:83], v[164:167]
    ds_read_b128 a[124:127], v5 offset:15360
    v_add_f32 v24, v24, v35
    v_mfma_f32_16x16x32_bf16 v[172:175], a[84:87], v[84:87], v[172:175]
    s_waitcnt lgkmcnt(9)
    s_waitcnt vmcnt(16)
    s_barrier
    v_add_u32 v5, s22, v4
    v_mfma_f32_16x16x32_bf16 v[176:179], a[88:91], v[80:83], v[176:179]
    s_mov_b32 m0, s16
    ds_read_b128 a[64:67], v5 offset:16384
    v_mfma_f32_16x16x32_bf16 v[184:187], a[88:91], v[84:87], v[184:187]
    s_waitcnt lgkmcnt(9)
    buffer_load_dwordx4 v120, s[4:7], s18 offen offset:0 sc1 lds
    v_mfma_f32_16x16x32_bf16 v[180:183], a[92:95], v[80:83], v[180:183]
    ds_read_b128 a[68:71], v5 offset:17408
    v_mfma_f32_16x16x32_bf16 v[188:191], a[92:95], v[84:87], v[188:191]
    s_waitcnt lgkmcnt(9)
    v_exp_f32 v36, v96
    v_mfma_f32_16x16x32_bf16 v[192:195], a[96:99], v[80:83], v[192:195]
    ds_read_b128 a[72:75], v5 offset:18432
    v_add_f32 v24, v24, v36
    v_mfma_f32_16x16x32_bf16 v[200:203], a[96:99], v[84:87], v[200:203]
    s_waitcnt lgkmcnt(9)
    buffer_load_dwordx4 v121, s[4:7], s18 offen offset:1024 sc1 lds
    v_mfma_f32_16x16x32_bf16 v[196:199], a[100:103], v[80:83], v[196:199]
    ds_read_b128 a[76:79], v5 offset:19456
    v_mfma_f32_16x16x32_bf16 v[204:207], a[100:103], v[84:87], v[204:207]
    s_waitcnt lgkmcnt(9)
    v_exp_f32 v37, v97
    v_mfma_f32_16x16x32_bf16 v[208:211], a[104:107], v[80:83], v[208:211]
    ds_read_b128 a[80:83], v5 offset:20480
    v_add_f32 v24, v24, v37
    v_mfma_f32_16x16x32_bf16 v[216:219], a[104:107], v[84:87], v[216:219]
    s_waitcnt lgkmcnt(9)
    buffer_load_dwordx4 v122, s[4:7], s18 offen offset:2048 sc1 lds
    v_mfma_f32_16x16x32_bf16 v[212:215], a[108:111], v[80:83], v[212:215]
    ds_read_b128 a[84:87], v5 offset:21504
    v_mfma_f32_16x16x32_bf16 v[220:223], a[108:111], v[84:87], v[220:223]
    s_waitcnt lgkmcnt(9)
    v_exp_f32 v38, v98
    v_mfma_f32_16x16x32_bf16 v[224:227], a[112:115], v[80:83], v[224:227]
    ds_read_b128 a[88:91], v5 offset:22528
    v_add_f32 v24, v24, v38
    v_mfma_f32_16x16x32_bf16 v[232:235], a[112:115], v[84:87], v[232:235]
    s_waitcnt lgkmcnt(9)
    buffer_load_dwordx4 v123, s[4:7], s18 offen offset:3072 sc1 lds
    v_mfma_f32_16x16x32_bf16 v[228:231], a[116:119], v[80:83], v[228:231]
    ds_read_b128 a[92:95], v5 offset:23552
    v_mfma_f32_16x16x32_bf16 v[236:239], a[116:119], v[84:87], v[236:239]
    s_waitcnt lgkmcnt(9)
    v_exp_f32 v39, v99
    v_mfma_f32_16x16x32_bf16 v[240:243], a[120:123], v[80:83], v[240:243]
    ds_read_b128 a[96:99], v5 offset:24576
    v_add_f32 v24, v24, v39
    v_mfma_f32_16x16x32_bf16 v[248:251], a[120:123], v[84:87], v[248:251]
    s_waitcnt lgkmcnt(9)
    v_cvt_pk_bf16_f32 v72, v32, v33
    v_cvt_pk_bf16_f32 v73, v34, v35
    v_mfma_f32_16x16x32_bf16 v[244:247], a[124:127], v[80:83], v[244:247]
    ds_read_b128 a[100:103], v5 offset:25600
    v_cvt_pk_bf16_f32 v74, v36, v37
    v_mfma_f32_16x16x32_bf16 v[252:255], a[124:127], v[84:87], v[252:255]
    v_cvt_pk_bf16_f32 v75, v38, v39
    v_add_f32 v48, v40, v64
    v_add_f32 v49, v40, v65
    v_add_f32 v50, v40, v66
    v_add_f32 v51, v40, v67
    v_add_f32 v52, v40, v68
    v_add_f32 v53, v40, v69
    v_add_f32 v54, v40, v70
    v_add_f32 v55, v40, v71
fz_T1:
    s_waitcnt lgkmcnt(9)
    v_mfma_f32_16x16x32_bf16 v[104:107], a[64:67], a[0:3], v[48:51]
    s_waitcnt lgkmcnt(8)
    ds_read_b128 a[104:107], v5 offset:26624
    v_mfma_f32_16x16x32_bf16 v[104:107], a[68:71], a[4:7], v[104:107]
    s_waitcnt lgkmcnt(8)
    v_exp_f32 v32, v92
    v_mfma_f32_16x16x32_bf16 v[104:107], a[72:75], a[8:11], v[104:107]
    s_waitcnt lgkmcnt(7)
    ds_read_b128 a[108:111], v5 offset:27648
    v_mfma_f32_16x16x32_bf16 v[104:107], a[76:79], a[12:15], v[104:107]
    s_waitcnt lgkmcnt(7)
    v_exp_f32 v33, v93
    v_mfma_f32_16x16x32_bf16 v[104:107], a[80:83], a[16:19], v[104:107]
    s_waitcnt lgkmcnt(6)
    ds_read_b128 a[112:115], v5 offset:28672
    v_add_f32 v25, v32, v33
    v_mfma_f32_16x16x32_bf16 v[104:107], a[84:87], a[20:23], v[104:107]
    s_waitcnt lgkmcnt(6)
    v_exp_f32 v34, v94
    v_mfma_f32_16x16x32_bf16 v[104:107], a[88:91], a[24:27], v[104:107]
    s_waitcnt lgkmcnt(5)
    ds_read_b128 a[116:119], v5 offset:29696
    v_add_f32 v25, v25, v34
    v_mfma_f32_16x16x32_bf16 v[104:107], a[92:95], a[28:31], v[104:107]
    s_mov_b32 s30, 1
    v_exp_f32 v35, v95
    v_mfma_f32_16x16x32_bf16 v[108:111], a[64:67], a[32:35], v[44:47]
    ds_read_b128 a[120:123], v5 offset:30720
    v_add_f32 v25, v25, v35
    v_mfma_f32_16x16x32_bf16 v[108:111], a[68:71], a[36:39], v[108:111]
    v_exp_f32 v36, v100
    v_mfma_f32_16x16x32_bf16 v[108:111], a[72:75], a[40:43], v[108:111]
    ds_read_b128 a[124:127], v5 offset:31744
    v_add_f32 v25, v25, v36
    v_mfma_f32_16x16x32_bf16 v[108:111], a[76:79], a[44:47], v[108:111]
    v_exp_f32 v37, v101
    v_mfma_f32_16x16x32_bf16 v[108:111], a[80:83], a[48:51], v[108:111]
    ds_read_b128 a[64:67], v5 offset:0
    v_add_f32 v25, v25, v37
    v_mfma_f32_16x16x32_bf16 v[108:111], a[84:87], a[52:55], v[108:111]
    v_exp_f32 v38, v102
    v_mfma_f32_16x16x32_bf16 v[108:111], a[88:91], a[56:59], v[108:111]
    ds_read_b128 a[68:71], v5 offset:1024
    v_add_f32 v25, v25, v38
    v_mfma_f32_16x16x32_bf16 v[108:111], a[92:95], a[60:63], v[108:111]
    s_waitcnt lgkmcnt(9)
    v_exp_f32 v39, v103
    v_mfma_f32_16x16x32_bf16 v[112:115], a[96:99], a[0:3], v[52:55]
    s_waitcnt lgkmcnt(8)
    ds_read_b128 a[72:75], v5 offset:2048
    v_add_f32 v25, v25, v39
    v_mfma_f32_16x16x32_bf16 v[112:115], a[100:103], a[4:7], v[112:115]
    s_waitcnt lgkmcnt(8)
    v_cvt_pk_bf16_f32 v76, v32, v33
    v_cvt_pk_bf16_f32 v77, v34, v35
    v_mfma_f32_16x16x32_bf16 v[112:115], a[104:107], a[8:11], v[112:115]
    s_waitcnt lgkmcnt(7)
    s_add_u32 m0, s16, 16384
    s_add_u32 s89, s18, s20
    ds_read_b128 a[76:79], v5 offset:3072
    v_mfma_f32_16x16x32_bf16 v[112:115], a[108:111], a[12:15], v[112:115]
    s_waitcnt lgkmcnt(7)
    buffer_load_dwordx4 v120, s[4:7], s89 offen offset:0 sc1 lds
    v_cvt_pk_bf16_f32 v78, v36, v37
    v_mfma_f32_16x16x32_bf16 v[112:115], a[112:115], a[16:19], v[112:115]
    s_waitcnt lgkmcnt(6)
    ds_read_b128 a[80:83], v5 offset:4096
    v_cvt_pk_bf16_f32 v79, v38, v39
    v_mfma_f32_16x16x32_bf16 v[112:115], a[116:119], a[20:23], v[112:115]
    s_waitcnt lgkmcnt(6)
    buffer_load_dwordx4 v121, s[4:7], s89 offen offset:1024 sc1 lds
    v_max_f32 v18, v24, v25
    v_mfma_f32_16x16x32_bf16 v[112:115], a[120:123], a[24:27], v[112:115]
    s_waitcnt lgkmcnt(5)
    ds_read_b128 a[84:87], v5 offset:5120
    v_cmp_lt_f32 vcc, s33, v18
    v_mfma_f32_16x16x32_bf16 v[112:115], a[124:127], a[28:31], v[112:115]
    buffer_load_dwordx4 v122, s[4:7], s89 offen offset:2048 sc1 lds
    v_mfma_f32_16x16x32_bf16 v[116:119], a[96:99], a[32:35], v[44:47]
    ds_read_b128 a[88:91], v5 offset:6144
    v_mfma_f32_16x16x32_bf16 v[116:119], a[100:103], a[36:39], v[116:119]
    s_add_u32 s16, s16, 32768
    buffer_load_dwordx4 v123, s[4:7], s89 offen offset:3072 sc1 lds
    v_mfma_f32_16x16x32_bf16 v[116:119], a[104:107], a[40:43], v[116:119]
    s_cmp_eq_u32 s16, s17
    ds_read_b128 a[92:95], v5 offset:7168
    v_mfma_f32_16x16x32_bf16 v[116:119], a[108:111], a[44:47], v[116:119]
    s_cselect_b32 s16, s67, s16
    v_mfma_f32_16x16x32_bf16 v[116:119], a[112:115], a[48:51], v[116:119]
    s_add_u32 s18, s18, s19
    ds_read_b128 a[96:99], v5 offset:8192
    v_mfma_f32_16x16x32_bf16 v[116:119], a[116:119], a[52:55], v[116:119]
    v_mfma_f32_16x16x32_bf16 v[116:119], a[120:123], a[56:59], v[116:119]
    ds_read_b128 a[100:103], v5 offset:9216
    v_mfma_f32_16x16x32_bf16 v[116:119], a[124:127], a[60:63], v[116:119]
    s_cbranch_vccnz fz_rare0
fz_ret_T1:
    s_cmp_ge_u32 s69, 8
    s_cselect_b32 s86, 0, s35
    s_cmp_eq_u32 s86, 0
    s_cbranch_scc1 fz_sw1
    s_mov_b32 s18, s77
    s_add_u32 s86, s86, 1
    s_lshl_b32 s86, s86, 15
    s_add_u32 s21, s77, s86
fz_sw1r:
    s_waitcnt lgkmcnt(9)
    v_mfma_f32_16x16x32_bf16 v[128:131], a[64:67], v[72:75], v[128:131]
    s_add_u32 s22, s22, 32768
    ds_read_b128 a[104:107], v5 offset:10240
    v_add_f32 v20, v20, v24
    v_mfma_f32_16x16x32_bf16 v[136:139], a[64:67], v[76:79], v[136:139]
    s_waitcnt lgkmcnt(9)
    v_add_f32 v21, v21, v25
    v_mfma_f32_16x16x32_bf16 v[132:135], a[68:71], v[72:75], v[132:135]
    s_cmp_eq_u32 s22, 163840
    ds_read_b128 a[108:111], v5 offset:11264
    v_mfma_f32_16x16x32_bf16 v[140:143], a[68:71], v[76:79], v[140:143]
    s_waitcnt lgkmcnt(9)
    v_exp_f32 v32, v104
    v_mfma_f32_16x16x32_bf16 v[144:147], a[72:75], v[72:75], v[144:147]
    s_cselect_b32 s22, 0, s22
    ds_read_b128 a[112:115], v5 offset:12288
    v_mfma_f32_16x16x32_bf16 v[152:155], a[72:75], v[76:79], v[152:155]
    s_waitcnt lgkmcnt(9)
    v_exp_f32 v33, v105
    v_mfma_f32_16x16x32_bf16 v[148:151], a[76:79], v[72:75], v[148:151]
    ds_read_b128 a[116:119], v5 offset:13312
    v_add_f32 v24, v32, v33
    v_mfma_f32_16x16x32_bf16 v[156:159], a[76:79], v[76:79], v[156:159]
    s_waitcnt lgkmcnt(9)
    v_exp_f32 v34, v106
    v_mfma_f32_16x16x32_bf16 v[160:163], a[80:83], v[72:75], v[160:163]
    ds_read_b128 a[120:123], v5 offset:14336
    v_add_f32 v24, v24, v34
    v_mfma_f32_16x16x32_bf16 v[168:171], a[80:83], v[76:79], v[168:171]
    s_waitcnt lgkmcnt(9)
    v_exp_f32 v35, v107
    v_mfma_f32_16x16x32_bf16 v[164:167], a[84:87], v[72:75], v[164:167]
    ds_read_b128 a[124:127], v5 offset:15360
    v_add_f32 v24, v24, v35
    v_mfma_f32_16x16x32_bf16 v[172:175], a[84:87], v[76:79], v[172:175]
    s_waitcnt lgkmcnt(9)
    s_waitcnt vmcnt(16)
    s_barrier
    v_add_u32 v5, s22, v4
    v_mfma_f32_16x16x32_bf16 v[176:179], a[88:91], v[72:75], v[176:179]
    s_mov_b32 m0, s16
    ds_read_b128 a[64:67], v5 offset:16384
    v_mfma_f32_16x16x32_bf16 v[184:187], a[88:91], v[76:79], v[184:187]
    s_waitcnt lgkmcnt(9)
    buffer_load_dwordx4 v120, s[4:7], s18 offen offset:0 sc1 lds
    v_mfma_f32_16x16x32_bf16 v[180:183], a[92:95], v[72:75], v[180:183]
    ds_read_b128 a[68:71], v5 offset:17408
    v_mfma_f32_16x16x32_bf16 v[188:191], a[92:95], v[76:79], v[188:191]
    s_waitcnt lgkmcnt(9)
    v_exp_f32 v36, v112
    v_mfma_f32_16x16x32_bf16 v[192:195], a[96:99], v[72:75], v[192:195]
    ds_read_b128 a[72:75], v5 offset:18432
    v_add_f32 v24, v24, v36
    v_mfma_f32_16x16x32_bf16 v[200:203], a[96:99], v[76:79], v[200:203]
    s_waitcnt lgkmcnt(9)
    buffer_load_dwordx4 v121, s[4:7], s18 offen offset:1024 sc1 lds
    v_mfma_f32_16x16x32_bf16 v[196:199], a[100:103], v[72:75], v[196:199]
    ds_read_b128 a[76:79], v5 offset:19456
    v_mfma_f32_16x16x32_bf16 v[204:207], a[100:103], v[76:79], v[204:207]
    s_waitcnt lgkmcnt(9)
    v_exp_f32 v37, v113
    v_mfma_f32_16x16x32_bf16 v[208:211], a[104:107], v[72:75], v[208:211]
    ds_read_b128 a[80:83], v5 offset:20480
    v_add_f32 v24, v24, v37
    v_mfma_f32_16x16x32_bf16 v[216:219], a[104:107], v[76:79], v[216:219]
    s_waitcnt lgkmcnt(9)
    buffer_load_dwordx4 v122, s[4:7], s18 offen offset:2048 sc1 lds
    v_mfma_f32_16x16x32_bf16 v[212:215], a[108:111], v[72:75], v[212:215]
    ds_read_b128 a[84:87], v5 offset:21504
    v_mfma_f32_16x16x32_bf16 v[220:223], a[108:111], v[76:79], v[220:223]
    s_waitcnt lgkmcnt(9)
    v_exp_f32 v38, v114
    v_mfma_f32_16x16x32_bf16 v[224:227], a[112:115], v[72:75], v[224:227]
    ds_read_b128 a[88:91], v5 offset:22528
    v_add_f32 v24, v24, v38
    v_mfma_f32_16x16x32_bf16 v[232:235], a[112:115], v[76:79], v[232:235]
    s_waitcnt lgkmcnt(9)
    buffer_load_dwordx4 v123, s[4:7], s18 offen offset:3072 sc1 lds
    v_mfma_f32_16x16x32_bf16 v[228:231], a[116:119], v[72:75], v[228:231]
    ds_read_b128 a[92:95], v5 offset:23552
    v_mfma_f32_16x16x32_bf16 v[236:239], a[116:119], v[76:79], v[236:239]
    s_waitcnt lgkmcnt(9)
    v_exp_f32 v39, v115
    v_mfma_f32_16x16x32_bf16 v[240:243], a[120:123], v[72:75], v[240:243]
    ds_read_b128 a[96:99], v5 offset:24576
    v_add_f32 v24, v24, v39
    v_mfma_f32_16x16x32_bf16 v[248:251], a[120:123], v[76:79], v[248:251]
    s_waitcnt lgkmcnt(9)
    v_cvt_pk_bf16_f32 v80, v32, v33
    v_cvt_pk_bf16_f32 v81, v34, v35
    v_mfma_f32_16x16x32_bf16 v[244:247], a[124:127], v[72:75], v[244:247]
    ds_read_b128 a[100:103], v5 offset:25600
    v_cvt_pk_bf16_f32 v82, v36, v37
    v_mfma_f32_16x16x32_bf16 v[252:255], a[124:127], v[76:79], v[252:255]
    v_cvt_pk_bf16_f32 v83, v38, v39
    v_add_f32 v48, v44, v56
    v_add_f32 v49, v44, v57
    v_add_f32 v50, v44, v58
    v_add_f32 v51, v44, v59
    v_add_f32 v52, v44, v60
    v_add_f32 v53, v44, v61
    v_add_f32 v54, v44, v62
    v_add_f32 v55, v44, v63
    buffer_load_dword v28, off, s[24:27], s78 sc1
    s_waitcnt lgkmcnt(9)
    v_mfma_f32_16x16x32_bf16 v[92:95], a[64:67], a[32:35], v[48:51]
    s_waitcnt lgkmcnt(8)
    s_add_u32 m0, s16, 16384
    s_add_u32 s89, s18, s20
    ds_read_b128 a[104:107], v5 offset:26624
    v_mfma_f32_16x16x32_bf16 v[92:95], a[68:71], a[36:39], v[92:95]
    s_waitcnt lgkmcnt(8)
    buffer_load_dwordx4 v120, s[4:7], s89 offen offset:0 sc1 lds
    ds_read_b128 a[108:111], v5 offset:27648
    v_mfma_f32_16x16x32_bf16 v[92:95], a[72:75], a[40:43], v[92:95]
    s_waitcnt lgkmcnt(8)
    ds_read_b128 a[112:115], v5 offset:28672
    v_mfma_f32_16x16x32_bf16 v[92:95], a[76:79], a[44:47], v[92:95]
    s_waitcnt lgkmcnt(8)
    ds_read_b128 a[116:119], v5 offset:29696
    v_mfma_f32_16x16x32_bf16 v[92:95], a[80:83], a[48:51], v[92:95]
    s_waitcnt lgkmcnt(8)
    buffer_load_dwordx4 v121, s[4:7], s89 offen offset:1024 sc1 lds
    ds_read_b128 a[120:123], v5 offset:30720
    v_mfma_f32_16x16x32_bf16 v[92:95], a[84:87], a[52:55], v[92:95]
    s_waitcnt lgkmcnt(8)
    ds_read_b128 a[124:127], v5 offset:31744
    v_mfma_f32_16x16x32_bf16 v[92:95], a[88:91], a[56:59], v[92:95]
    s_waitcnt lgkmcnt(8)
    ds_read_b128 a[64:67], v5 offset:0
    v_mfma_f32_16x16x32_bf16 v[92:95], a[92:95], a[60:63], v[92:95]
    s_waitcnt lgkmcnt(8)
    buffer_load_dwordx4 v122, s[4:7], s89 offen offset:2048 sc1 lds
    ds_read_b128 a[68:71], v5 offset:1024
    v_mfma_f32_16x16x32_bf16 v[100:103], a[96:99], a[32:35], v[52:55]
    s_waitcnt lgkmcnt(8)
    ds_read_b128 a[72:75], v5 offset:2048
    v_mfma_f32_16x16x32_bf16 v[100:103], a[100:103], a[36:39], v[100:103]
    s_waitcnt lgkmcnt(8)
    ds_read_b128 a[76:79], v5 offset:3072
    v_mfma_f32_16x16x32_bf16 v[100:103], a[104:107], a[40:43], v[100:103]
    s_waitcnt lgkmcnt(8)
    buffer_load_dwordx4 v123, s[4:7], s89 offen offset:3072 sc1 lds
    ds_read_b128 a[80:83], v5 offset:4096
    v_mfma_f32_16x16x32_bf16 v[100:103], a[108:111], a[44:47], v[100:103]
    s_waitcnt lgkmcnt(8)
    ds_read_b128 a[84:87], v5 offset:5120
    v_mfma_f32_16x16x32_bf16 v[100:103], a[112:115], a[48:51], v[100:103]
    s_waitcnt lgkmcnt(8)
    ds_read_b128 a[88:91], v5 offset:6144
    v_mfma_f32_16x16x32_bf16 v[100:103], a[116:119], a[52:55], v[100:103]
    s_waitcnt lgkmcnt(8)
    ds_read_b128 a[92:95], v5 offset:7168
    v_mfma_f32_16x16x32_bf16 v[100:103], a[120:123], a[56:59], v[100:103]
    s_waitcnt lgkmcnt(8)
    ds_read_b128 a[96:99], v5 offset:8192
    v_mfma_f32_16x16x32_bf16 v[100:103], a[124:127], a[60:63], v[100:103]
    s_mov_b32 s30, 3
    ds_read_b128 a[100:103], v5 offset:9216
    v_exp_f32 v32, v108
    v_exp_f32 v33, v109
    s_nop 0
    v_add_f32 v25, v32, v33
    v_exp_f32 v34, v110
    s_nop 0
    v_add_f32 v25, v25, v34
    v_exp_f32 v35, v111
    s_nop 0
    v_add_f32 v25, v25, v35
    v_exp_f32 v36, v116
    s_nop 0
    v_add_f32 v25, v25, v36
    v_exp_f32 v37, v117
    s_nop 0
    v_add_f32 v25, v25, v37
    v_exp_f32 v38, v118
    s_nop 0
    v_add_f32 v25, v25, v38
    v_exp_f32 v39, v119
    s_nop 0
    v_add_f32 v25, v25, v39
    v_cvt_pk_bf16_f32 v84, v32, v33
    v_cvt_pk_bf16_f32 v85, v34, v35
    v_cvt_pk_bf16_f32 v86, v36, v37
    v_cvt_pk_bf16_f32 v87, v38, v39
    v_max_f32 v18, v24, v25
    v_cmp_lt_f32 vcc, s33, v18
    s_add_u32 s16, s16, 32768
    s_cmp_eq_u32 s16, s17
    s_cselect_b32 s16, s67, s16
    s_add_u32 s18, s18, s19
    s_cbranch_vccnz fz_rare1
fz_ret_T2:
    s_waitcnt lgkmcnt(9)
    v_mfma_f32_16x16x32_bf16 v[128:131], a[64:67], v[80:83], v[128:131]
    s_add_u32 s22, s22, 32768
    ds_read_b128 a[104:107], v5 offset:10240
    v_add_f32 v20, v20, v24
    v_mfma_f32_16x16x32_bf16 v[136:139], a[64:67], v[84:87], v[136:139]
    s_waitcnt lgkmcnt(9)
    v_add_f32 v21, v21, v25
    v_mfma_f32_16x16x32_bf16 v[132:135], a[68:71], v[80:83], v[132:135]
    s_cmp_eq_u32 s22, 163840
    ds_read_b128 a[108:111], v5 offset:11264
    v_mfma_f32_16x16x32_bf16 v[140:143], a[68:71], v[84:87], v[140:143]
    s_waitcnt lgkmcnt(9)
    v_exp_f32 v32, v92
    v_mfma_f32_16x16x32_bf16 v[144:147], a[72:75], v[80:83], v[144:147]
    s_cselect_b32 s22, 0, s22
    ds_read_b128 a[112:115], v5 offset:12288
    v_mfma_f32_16x16x32_bf16 v[152:155], a[72:75], v[84:87], v[152:155]
    s_waitcnt lgkmcnt(9)
    v_exp_f32 v33, v93
    v_mfma_f32_16x16x32_bf16 v[148:151], a[76:79], v[80:83], v[148:151]
    ds_read_b128 a[116:119], v5 offset:13312
    v_add_f32 v25, v32, v33
    v_mfma_f32_16x16x32_bf16 v[156:159], a[76:79], v[84:87], v[156:159]
    s_waitcnt lgkmcnt(9)
    v_exp_f32 v34, v94
    v_mfma_f32_16x16x32_bf16 v[160:163], a[80:83], v[80:83], v[160:163]
    ds_read_b128 a[120:123], v5 offset:14336
    v_add_f32 v25, v25, v34
    v_mfma_f32_16x16x32_bf16 v[168:171], a[80:83], v[84:87], v[168:171]
    s_waitcnt lgkmcnt(9)
    v_exp_f32 v35, v95
    v_mfma_f32_16x16x32_bf16 v[164:167], a[84:87], v[80:83], v[164:167]
    ds_read_b128 a[124:127], v5 offset:15360
    v_add_f32 v25, v25, v35
    v_mfma_f32_16x16x32_bf16 v[172:175], a[84:87], v[84:87], v[172:175]
    s_waitcnt lgkmcnt(9)
    s_waitcnt vmcnt(17)
    s_barrier
    v_add_u32 v5, s22, v4
    v_mfma_f32_16x16x32_bf16 v[176:179], a[88:91], v[80:83], v[176:179]
    s_mov_b32 m0, s16
    ds_read_b128 a[64:67], v5 offset:16384
    v_mfma_f32_16x16x32_bf16 v[184:187], a[88:91], v[84:87], v[184:187]
    s_waitcnt lgkmcnt(9)
    buffer_load_dwordx4 v120, s[4:7], s18 offen offset:0 sc1 lds
    v_mfma_f32_16x16x32_bf16 v[180:183], a[92:95], v[80:83], v[180:183]
    ds_read_b128 a[68:71], v5 offset:17408
    v_mfma_f32_16x16x32_bf16 v[188:191], a[92:95], v[84:87], v[188:191]
    s_waitcnt lgkmcnt(9)
    v_exp_f32 v36, v100
    v_mfma_f32_16x16x32_bf16 v[192:195], a[96:99], v[80:83], v[192:195]
    ds_read_b128 a[72:75], v5 offset:18432
    v_add_f32 v25, v25, v36
    v_mfma_f32_16x16x32_bf16 v[200:203], a[96:99], v[84:87], v[200:203]
    s_waitcnt lgkmcnt(9)
    buffer_load_dwordx4 v121, s[4:7], s18 offen offset:1024 sc1 lds
    v_mfma_f32_16x16x32_bf16 v[196:199], a[100:103], v[80:83], v[196:199]
    ds_read_b128 a[76:79], v5 offset:19456
    v_mfma_f32_16x16x32_bf16 v[204:207], a[100:103], v[84:87], v[204:207]
    s_waitcnt lgkmcnt(9)
    v_exp_f32 v37, v101
    v_mfma_f32_16x16x32_bf16 v[208:211], a[104:107], v[80:83], v[208:211]
    ds_read_b128 a[80:83], v5 offset:20480
    v_add_f32 v25, v25, v37
    v_mfma_f32_16x16x32_bf16 v[216:219], a[104:107], v[84:87], v[216:219]
    s_waitcnt lgkmcnt(9)
    buffer_load_dwordx4 v122, s[4:7], s18 offen offset:2048 sc1 lds
    v_mfma_f32_16x16x32_bf16 v[212:215], a[108:111], v[80:83], v[212:215]
    ds_read_b128 a[84:87], v5 offset:21504
    v_mfma_f32_16x16x32_bf16 v[220:223], a[108:111], v[84:87], v[220:223]
    s_waitcnt lgkmcnt(9)
    v_exp_f32 v38, v102
    v_mfma_f32_16x16x32_bf16 v[224:227], a[112:115], v[80:83], v[224:227]
    ds_read_b128 a[88:91], v5 offset:22528
    v_add_f32 v25, v25, v38
    v_mfma_f32_16x16x32_bf16 v[232:235], a[112:115], v[84:87], v[232:235]
    s_waitcnt lgkmcnt(9)
    buffer_load_dwordx4 v123, s[4:7], s18 offen offset:3072 sc1 lds
    v_mfma_f32_16x16x32_bf16 v[228:231], a[116:119], v[80:83], v[228:231]
    ds_read_b128 a[92:95], v5 offset:23552
    v_mfma_f32_16x16x32_bf16 v[236:239], a[116:119], v[84:87], v[236:239]
    s_waitcnt lgkmcnt(9)
    v_exp_f32 v39, v103
    v_mfma_f32_16x16x32_bf16 v[240:243], a[120:123], v[80:83], v[240:243]
    ds_read_b128 a[96:99], v5 offset:24576
    v_add_f32 v25, v25, v39
    v_mfma_f32_16x16x32_bf16 v[248:251], a[120:123], v[84:87], v[248:251]
    s_waitcnt lgkmcnt(9)
    v_cvt_pk_bf16_f32 v76, v32, v33
    v_cvt_pk_bf16_f32 v77, v34, v35
    v_mfma_f32_16x16x32_bf16 v[244:247], a[124:127], v[80:83], v[244:247]
    ds_read_b128 a[100:103], v5 offset:25600
    v_cvt_pk_bf16_f32 v78, v36, v37
    v_mfma_f32_16x16x32_bf16 v[252:255], a[124:127], v[84:87], v[252:255]
    v_cvt_pk_bf16_f32 v79, v38, v39
    v_add_f32 v48, v44, v64
    v_add_f32 v49, v44, v65
    v_add_f32 v50, v44, v66
    v_add_f32 v51, v44, v67
    v_add_f32 v52, v44, v68
    v_add_f32 v53, v44, v69
    v_add_f32 v54, v44, v70
    v_add_f32 v55, v44, v71
    s_waitcnt vmcnt(8)
    v_readfirstlane_b32 s87, v28
    s_min_u32 s39, s87, s29
    s_cmp_lg_u32 s39, 0
    s_cselect_b32 s87, s79, 2147483648
    s_add_u32 s86, s87, 16384
    buffer_load_dwordx4 v[28:31], v4, s[24:27], s86 offen sc1
    s_add_u32 s86, s87, 0
    buffer_load_dwordx4 a[128:131], v4, s[24:27], s86 offen offset:0 sc1
    buffer_load_dwordx4 a[132:135], v4, s[24:27], s86 offen offset:1024 sc1
    buffer_load_dwordx4 a[136:139], v4, s[24:27], s86 offen offset:2048 sc1
    buffer_load_dwordx4 a[140:143], v4, s[24:27], s86 offen offset:3072 sc1
    s_add_u32 s86, s87, 4096
    buffer_load_dwordx4 a[144:147], v4, s[24:27], s86 offen offset:0 sc1
    buffer_load_dwordx4 a[148:151], v4, s[24:27], s86 offen offset:1024 sc1
    buffer_load_dwordx4 a[152:155], v4, s[24:27], s86 offen offset:2048 sc1
    buffer_load_dwordx4 a[156:159], v4, s[24:27], s86 offen offset:3072 sc1
    s_add_u32 s86, s87, 8192
    buffer_load_dwordx4 a[160:163], v4, s[24:27], s86 offen offset:0 sc1
    buffer_load_dwordx4 a[164:167], v4, s[24:27], s86 offen offset:1024 sc1
    buffer_load_dwordx4 a[168:171], v4, s[24:27], s86 offen offset:2048 sc1
    buffer_load_dwordx4 a[172:175], v4, s[24:27], s86 offen offset:3072 sc1
    s_add_u32 s86, s87, 12288
    buffer_load_dwordx4 a[176:179], v4, s[24:27], s86 offen offset:0 sc1
    buffer_load_dwordx4 a[180:183], v4, s[24:27], s86 offen offset:1024 sc1
    buffer_load_dwordx4 a[184:187], v4, s[24:27], s86 offen offset:2048 sc1
    buffer_load_dwordx4 a[188:191], v4, s[24:27], s86 offen offset:3072 sc1
    s_waitcnt lgkmcnt(9)
    v_mfma_f32_16x16x32_bf16 v[108:111], a[64:67], a[32:35], v[48:51]
    s_waitcnt lgkmcnt(8)
    s_add_u32 m0, s16, 16384
    s_add_u32 s89, s18, s20
    ds_read_b128 a[104:107], v5 offset:26624
    v_mfma_f32_16x16x32_bf16 v[108:111], a[68:71], a[36:39], v[108:111]
    s_waitcnt lgkmcnt(8)
    buffer_load_dwordx4 v120, s[4:7], s89 offen offset:0 sc1 lds
    ds_read_b128 a[108:111], v5 offset:27648
    v_mfma_f32_16x16x32_bf16 v[108:111], a[72:75], a[40:43], v[108:111]
    s_waitcnt lgkmcnt(8)
    ds_read_b128 a[112:115], v5 offset:28672
    v_max_f32 v18, v24, v25
    v_mfma_f32_16x16x32_bf16 v[108:111], a[76:79], a[44:47], v[108:111]
    s_waitcnt lgkmcnt(8)
    ds_read_b128 a[116:119], v5 offset:29696
    v_cmp_lt_f32 vcc, s33, v18
    v_mfma_f32_16x16x32_bf16 v[108:111], a[80:83], a[48:51], v[108:111]
    s_waitcnt lgkmcnt(8)
    buffer_load_dwordx4 v121, s[4:7], s89 offen offset:1024 sc1 lds
    ds_read_b128 a[120:123], v5 offset:30720
    v_mfma_f32_16x16x32_bf16 v[108:111], a[84:87], a[52:55], v[108:111]
    s_waitcnt lgkmcnt(8)
    ds_read_b128 a[124:127], v5 offset:31744
    v_mfma_f32_16x16x32_bf16 v[108:111], a[88:91], a[56:59], v[108:111]
    s_waitcnt lgkmcnt(8)
    ds_read_b128 a[64:67], v5 offset:0
    v_mfma_f32_16x16x32_bf16 v[108:111], a[92:95], a[60:63], v[108:111]
    s_waitcnt lgkmcnt(8)
    buffer_load_dwordx4 v122, s[4:7], s89 offen offset:2048 sc1 lds
    ds_read_b128 a[68:71], v5 offset:1024
    v_mfma_f32_16x16x32_bf16 v[116:119], a[96:99], a[32:35], v[52:55]
    s_waitcnt lgkmcnt(8)
    ds_read_b128 a[72:75], v5 offset:2048
    v_mfma_f32_16x16x32_bf16 v[116:119], a[100:103], a[36:39], v[116:119]
    s_waitcnt lgkmcnt(8)
    ds_read_b128 a[76:79], v5 offset:3072
    v_mfma_f32_16x16x32_bf16 v[116:119], a[104:107], a[40:43], v[116:119]
    s_waitcnt lgkmcnt(8)
    buffer_load_dwordx4 v123, s[4:7], s89 offen offset:3072 sc1 lds
    ds_read_b128 a[80:83], v5 offset:4096
    v_mfma_f32_16x16x32_bf16 v[116:119], a[108:111], a[44:47], v[116:119]
    s_waitcnt lgkmcnt(8)
    ds_read_b128 a[84:87], v5 offset:5120
    v_mfma_f32_16x16x32_bf16 v[116:119], a[112:115], a[48:51], v[116:119]
    s_waitcnt lgkmcnt(8)
    ds_read_b128 a[88:91], v5 offset:6144
    v_mfma_f32_16x16x32_bf16 v[116:119], a[116:119], a[52:55], v[116:119]
    s_waitcnt lgkmcnt(8)
    ds_read_b128 a[92:95], v5 offset:7168
    v_mfma_f32_16x16x32_bf16 v[116:119], a[120:123], a[56:59], v[116:119]
    s_waitcnt lgkmcnt(8)
    ds_read_b128 a[96:99], v5 offset:8192
    v_mfma_f32_16x16x32_bf16 v[116:119], a[124:127], a[60:63], v[116:119]
    s_mov_b32 s30, 2
    ds_read_b128 a[100:103], v5 offset:9216
    s_add_u32 s16, s16, 32768
    s_cmp_eq_u32 s16, s17
    s_cselect_b32 s16, s67, s16
    s_add_u32 s18, s18, s19
    s_cbranch_vccnz fz_rare0
fz_ret_T3:
    s_waitcnt lgkmcnt(9)
    v_mfma_f32_16x16x32_bf16 v[136:139], a[64:67], v[76:79], v[136:139]
    s_waitcnt lgkmcnt(8)
    s_add_u32 s22, s22, 32768
    ds_read_b128 a[104:107], v5 offset:10240
    v_mfma_f32_16x16x32_bf16 v[140:143], a[68:71], v[76:79], v[140:143]
    s_waitcnt lgkmcnt(8)
    ds_read_b128 a[108:111], v5 offset:11264
    v_add_f32 v21, v21, v25
    v_mfma_f32_16x16x32_bf16 v[152:155], a[72:75], v[76:79], v[152:155]
    s_waitcnt lgkmcnt(8)
    s_cmp_eq_u32 s22, 163840
    ds_read_b128 a[112:115], v5 offset:12288
    v_mfma_f32_16x16x32_bf16 v[156:159], a[76:79], v[76:79], v[156:159]
    s_waitcnt lgkmcnt(8)
    ds_read_b128 a[116:119], v5 offset:13312
    v_mfma_f32_16x16x32_bf16 v[168:171], a[80:83], v[76:79], v[168:171]
    s_waitcnt lgkmcnt(8)
    s_cselect_b32 s22, 0, s22
    ds_read_b128 a[120:123], v5 offset:14336
    v_mfma_f32_16x16x32_bf16 v[172:175], a[84:87], v[76:79], v[172:175]
    s_waitcnt lgkmcnt(8)
    ds_read_b128 a[124:127], v5 offset:15360
    v_add_u32 v5, s22, v4
    v_mfma_f32_16x16x32_bf16 v[184:187], a[88:91], v[76:79], v[184:187]
    s_waitcnt lgkmcnt(8)
    s_waitcnt vmcnt(33)
    s_barrier
    ds_read_b128 a[64:67], v5 offset:0
    v_mfma_f32_16x16x32_bf16 v[188:191], a[92:95], v[76:79], v[188:191]
    s_waitcnt lgkmcnt(8)
    s_mov_b32 m0, s16
    ds_read_b128 a[68:71], v5 offset:1024
    v_mfma_f32_16x16x32_bf16 v[200:203], a[96:99], v[76:79], v[200:203]
    s_waitcnt lgkmcnt(8)
    buffer_load_dwordx4 v120, s[4:7], s18 offen offset:0 sc1 lds
    ds_read_b128 a[72:75], v5 offset:2048
    v_mfma_f32_16x16x32_bf16 v[204:207], a[100:103], v[76:79], v[204:207]
    s_waitcnt lgkmcnt(8)
    ds_read_b128 a[76:79], v5 offset:3072
    v_mfma_f32_16x16x32_bf16 v[216:219], a[104:107], v[76:79], v[216:219]
    s_waitcnt lgkmcnt(8)
    buffer_load_dwordx4 v121, s[4:7], s18 offen offset:1024 sc1 lds
    ds_read_b128 a[80:83], v5 offset:4096
    v_mfma_f32_16x16x32_bf16 v[220:223], a[108:111], v[76:79], v[220:223]
    s_waitcnt lgkmcnt(8)
    ds_read_b128 a[84:87], v5 offset:5120
    v_mfma_f32_16x16x32_bf16 v[232:235], a[112:115], v[76:79], v[232:235]
    s_waitcnt lgkmcnt(8)
    buffer_load_dwordx4 v122, s[4:7], s18 offen offset:2048 sc1 lds
    ds_read_b128 a[88:91], v5 offset:6144
    v_mfma_f32_16x16x32_bf16 v[236:239], a[116:119], v[76:79], v[236:239]
    s_waitcnt lgkmcnt(8)
    ds_read_b128 a[92:95], v5 offset:7168
    v_mfma_f32_16x16x32_bf16 v[248:251], a[120:123], v[76:79], v[248:251]
    s_waitcnt lgkmcnt(8)
    buffer_load_dwordx4 v123, s[4:7], s18 offen offset:3072 sc1 lds
    ds_read_b128 a[96:99], v5 offset:8192
    v_mfma_f32_16x16x32_bf16 v[252:255], a[124:127], v[76:79], v[252:255]
    ds_read_b128 a[100:103], v5 offset:9216
    v_exp_f32 v32, v108
    v_exp_f32 v33, v109
    s_nop 0
    v_add_f32 v25, v32, v33
    v_exp_f32 v34, v110
    s_nop 0
    v_add_f32 v25, v25, v34
    v_exp_f32 v35, v111
    s_nop 0
    v_add_f32 v25, v25, v35
    v_exp_f32 v36, v116
    s_nop 0
    v_add_f32 v25, v25, v36
    v_exp_f32 v37, v117
    s_nop 0
    v_add_f32 v25, v25, v37
    v_exp_f32 v38, v118
    s_nop 0
    v_add_f32 v25, v25, v38
    v_exp_f32 v39, v119
    s_nop 0
    v_add_f32 v25, v25, v39
    v_cvt_pk_bf16_f32 v84, v32, v33
    v_cvt_pk_bf16_f32 v85, v34, v35
    v_cvt_pk_bf16_f32 v86, v36, v37
    v_cvt_pk_bf16_f32 v87, v38, v39
    buffer_load_dword v126, v12, s[24:27], s81 offen sc1
    s_add_u32 m0, s16, 16384
    s_add_u32 s89, s18, s20
    v_max_f32 v18, v24, v25
    v_cmp_lt_f32 vcc, s33, v18
    buffer_load_dwordx4 v120, s[4:7], s89 offen offset:0 sc1 lds
    buffer_load_dwordx4 v121, s[4:7], s89 offen offset:1024 sc1 lds
    buffer_load_dwordx4 v122, s[4:7], s89 offen offset:2048 sc1 lds
    buffer_load_dwordx4 v123, s[4:7], s89 offen offset:3072 sc1 lds
    s_add_u32 s16, s16, 32768
    s_cmp_eq_u32 s16, s17
    s_cselect_b32 s16, s67, s16
    s_add_u32 s18, s18, s19
    s_mov_b32 s30, 4
    s_cbranch_vccnz fz_rare1
fz_ret_T4:
    s_waitcnt lgkmcnt(9)
    v_mfma_f32_16x16x32_bf16 v[136:139], a[64:67], v[84:87], v[136:139]
    s_waitcnt lgkmcnt(8)
    s_add_u32 s22, s22, 32768
    ds_read_b128 a[104:107], v5 offset:10240
    v_mfma_f32_16x16x32_bf16 v[140:143], a[68:71], v[84:87], v[140:143]
    s_waitcnt lgkmcnt(8)
    ds_read_b128 a[108:111], v5 offset:11264
    v_add_f32 v21, v21, v25
    v_mfma_f32_16x16x32_bf16 v[152:155], a[72:75], v[84:87], v[152:155]
    s_waitcnt lgkmcnt(8)
    s_cmp_eq_u32 s22, 163840
    ds_read_b128 a[112:115], v5 offset:12288
    v_mfma_f32_16x16x32_bf16 v[156:159], a[76:79], v[84:87], v[156:159]
    s_waitcnt lgkmcnt(8)
    ds_read_b128 a[116:119], v5 offset:13312
    v_mfma_f32_16x16x32_bf16 v[168:171], a[80:83], v[84:87], v[168:171]
    s_waitcnt lgkmcnt(8)
    s_cselect_b32 s22, 0, s22
    ds_read_b128 a[120:123], v5 offset:14336
    v_mfma_f32_16x16x32_bf16 v[172:175], a[84:87], v[84:87], v[172:175]
    s_waitcnt lgkmcnt(8)
    ds_read_b128 a[124:127], v5 offset:15360
    v_add_u32 v5, s22, v4
    v_mfma_f32_16x16x32_bf16 v[184:187], a[88:91], v[84:87], v[184:187]
    s_waitcnt lgkmcnt(8)
    s_waitcnt vmcnt(34)
    s_barrier
    v_mfma_f32_16x16x32_bf16 v[188:191], a[92:95], v[84:87], v[188:191]
    s_waitcnt lgkmcnt(7)
    s_mov_b32 m0, s16
    v_add_u32 v14, s22, v10
    v_mfma_f32_16x16x32_bf16 v[200:203], a[96:99], v[84:87], v[200:203]
    s_waitcnt lgkmcnt(6)
    buffer_load_dwordx4 v120, s[4:7], s18 offen offset:0 sc1 lds
    v_add_u32 v15, s22, v11
    v_mfma_f32_16x16x32_bf16 v[204:207], a[100:103], v[84:87], v[204:207]
    s_waitcnt lgkmcnt(5)
    v_mfma_f32_16x16x32_bf16 v[216:219], a[104:107], v[84:87], v[216:219]
    s_waitcnt lgkmcnt(4)
    buffer_load_dwordx4 v121, s[4:7], s18 offen offset:1024 sc1 lds
    v_mfma_f32_16x16x32_bf16 v[220:223], a[108:111], v[84:87], v[220:223]
    s_waitcnt lgkmcnt(3)
    v_mfma_f32_16x16x32_bf16 v[232:235], a[112:115], v[84:87], v[232:235]
    s_waitcnt lgkmcnt(2)
    buffer_load_dwordx4 v122, s[4:7], s18 offen offset:2048 sc1 lds
    v_mfma_f32_16x16x32_bf16 v[236:239], a[116:119], v[84:87], v[236:239]
    s_waitcnt lgkmcnt(1)
    v_mfma_f32_16x16x32_bf16 v[248:251], a[120:123], v[84:87], v[248:251]
    s_waitcnt lgkmcnt(0)
    buffer_load_dwordx4 v123, s[4:7], s18 offen offset:3072 sc1 lds
    v_mfma_f32_16x16x32_bf16 v[252:255], a[124:127], v[84:87], v[252:255]
    s_cmp_eq_u32 s29, s39
    s_cbranch_scc1 fz_seen
fz_unseen:
    s_mov_b32 s82, 100000
fz_spp:
    s_sub_u32 s82, s82, 1
    s_cbranch_scc1 fz_spxp
    buffer_load_dword v28, off, s[24:27], s78 sc1
    s_waitcnt vmcnt(0)
    v_readfirstlane_b32 s87, v28
    s_min_u32 s39, s87, s29
    s_cmp_lg_u32 s39, 0
    s_cbranch_scc0 fz_spp
fz_spxp:
    s_add_u32 s86, s79, 16384
    buffer_load_dwordx4 v[28:31], v4, s[24:27], s86 offen sc1
    s_add_u32 s86, s79, 0
    buffer_load_dwordx4 a[128:131], v4, s[24:27], s86 offen offset:0 sc1
    buffer_load_dwordx4 a[132:135], v4, s[24:27], s86 offen offset:1024 sc1
    buffer_load_dwordx4 a[136:139], v4, s[24:27], s86 offen offset:2048 sc1
    buffer_load_dwordx4 a[140:143], v4, s[24:27], s86 offen offset:3072 sc1
    s_add_u32 s86, s79, 4096
    buffer_load_dwordx4 a[144:147], v4, s[24:27], s86 offen offset:0 sc1
    buffer_load_dwordx4 a[148:151], v4, s[24:27], s86 offen offset:1024 sc1
    buffer_load_dwordx4 a[152:155], v4, s[24:27], s86 offen offset:2048 sc1
    buffer_load_dwordx4 a[156:159], v4, s[24:27], s86 offen offset:3072 sc1
    s_add_u32 s86, s79, 8192
    buffer_load_dwordx4 a[160:163], v4, s[24:27], s86 offen offset:0 sc1
    buffer_load_dwordx4 a[164:167], v4, s[24:27], s86 offen offset:1024 sc1
    buffer_load_dwordx4 a[168:171], v4, s[24:27], s86 offen offset:2048 sc1
    buffer_load_dwordx4 a[172:175], v4, s[24:27], s86 offen offset:3072 sc1
    s_add_u32 s86, s79, 12288
    buffer_load_dwordx4 a[176:179], v4, s[24:27], s86 offen offset:0 sc1
    buffer_load_dwordx4 a[180:183], v4, s[24:27], s86 offen offset:1024 sc1
    buffer_load_dwordx4 a[184:187], v4, s[24:27], s86 offen offset:2048 sc1
    buffer_load_dwordx4 a[188:191], v4, s[24:27], s86 offen offset:3072 sc1
    s_waitcnt vmcnt(0)
fz_seen:
    s_cmp_lg_u32 s21, -1
    s_cbranch_scc1 fz_stash
fz_went:
    ds_read_b64_tr_b16 a[64:65], v14 offset:0
    ds_read_b64_tr_b16 a[66:67], v14 offset:2048
    ds_read_b64_tr_b16 a[68:69], v14 offset:512
    ds_read_b64_tr_b16 a[70:71], v14 offset:2560
    ds_read_b64_tr_b16 a[72:73], v14 offset:4096
    ds_read_b64_tr_b16 a[74:75], v14 offset:6144
    ds_read_b64_tr_b16 a[76:77], v14 offset:4608
    ds_read_b64_tr_b16 a[78:79], v14 offset:6656
    ds_read_b64_tr_b16 a[80:81], v14 offset:8192
    ds_read_b64_tr_b16 a[82:83], v14 offset:10240
    ds_read_b64_tr_b16 a[84:85], v14 offset:8704
    ds_read_b64_tr_b16 a[86:87], v14 offset:10752
    ds_read_b64_tr_b16 a[88:89], v14 offset:12288
    ds_read_b64_tr_b16 a[90:91], v14 offset:14336
    ds_read_b64_tr_b16 a[92:93], v14 offset:12800
    ds_read_b64_tr_b16 a[94:95], v14 offset:14848
    ds_read_b64_tr_b16 a[96:97], v14 offset:16384
    ds_read_b64_tr_b16 a[98:99], v14 offset:18432
    ds_read_b64_tr_b16 a[100:101], v14 offset:16896
    ds_read_b64_tr_b16 a[102:103], v14 offset:18944
    s_mov_b32 s75, -1
    s_cmp_eq_u32 s29, 0
    s_cbranch_scc1 fz_nocomb
fz_comb:
    s_waitcnt vmcnt(17)
    v_sub_f32 v18, v40, v30
    v_sub_f32 v19, v44, v31
    v_max_f32 v26, v18, v19
    v_cmp_lt_f32 vcc, 0x41800000, v26
    s_cbranch_vccnz fz_crare
fz_cmb:
    v_exp_f32 v18, v18
    v_exp_f32 v19, v19
    s_nop 0
    v_fmac_f32 v20, v28, v18
    v_fmac_f32 v21, v29, v19
    v_accvgpr_read_b32 v33, a128
    v_accvgpr_read_b32 v35, a129
    v_accvgpr_read_b32 v37, a130
    v_accvgpr_read_b32 v39, a131
    v_lshlrev_b32 v32, 16, v33
    v_and_b32 v33, s38, v33
    v_lshlrev_b32 v34, 16, v35
    v_and_b32 v35, s38, v35
    v_lshlrev_b32 v36, 16, v37
    v_and_b32 v37, s38, v37
    v_lshlrev_b32 v38, 16, v39
    v_and_b32 v39, s38, v39
    v_pk_fma_f32 v[128:129], v[32:33], v[18:19], v[128:129] op_sel:[0,0,0] op_sel_hi:[1,0,1]
    v_pk_fma_f32 v[130:131], v[34:35], v[18:19], v[130:131] op_sel:[0,0,0] op_sel_hi:[1,0,1]
    v_pk_fma_f32 v[132:133], v[36:37], v[18:19], v[132:133] op_sel:[0,0,0] op_sel_hi:[1,0,1]
    v_pk_fma_f32 v[134:135], v[38:39], v[18:19], v[134:135] op_sel:[0,0,0] op_sel_hi:[1,0,1]
    v_accvgpr_read_b32 v33, a132
    v_accvgpr_read_b32 v35, a133
    v_accvgpr_read_b32 v37, a134
    v_accvgpr_read_b32 v39, a135
    v_lshlrev_b32 v32, 16, v33
    v_and_b32 v33, s38, v33
    v_lshlrev_b32 v34, 16, v35
    v_and_b32 v35, s38, v35
    v_lshlrev_b32 v36, 16, v37
    v_and_b32 v37, s38, v37
    v_lshlrev_b32 v38, 16, v39
    v_and_b32 v39, s38, v39
    v_pk_fma_f32 v[136:137], v[32:33], v[18:19], v[136:137] op_sel:[0,1,0] op_sel_hi:[1,1,1]
    v_pk_fma_f32 v[138:139], v[34:35], v[18:19], v[138:139] op_sel:[0,1,0] op_sel_hi:[1,1,1]
    v_pk_fma_f32 v[140:141], v[36:37], v[18:19], v[140:141] op_sel:[0,1,0] op_sel_hi:[1,1,1]
    v_pk_fma_f32 v[142:143], v[38:39], v[18:19], v[142:143] op_sel:[0,1,0] op_sel_hi:[1,1,1]
    v_accvgpr_read_b32 v33, a136
    v_accvgpr_read_b32 v35, a137
    v_accvgpr_read_b32 v37, a138
    v_accvgpr_read_b32 v39, a139
    v_lshlrev_b32 v32, 16, v33
    v_and_b32 v33, s38, v33
    v_lshlrev_b32 v34, 16, v35
    v_and_b32 v35, s38, v35
    v_lshlrev_b32 v36, 16, v37
    v_and_b32 v37, s38, v37
    v_lshlrev_b32 v38, 16, v39
    v_and_b32 v39, s38, v39
    v_pk_fma_f32 v[144:145], v[32:33], v[18:19], v[144:145] op_sel:[0,0,0] op_sel_hi:[1,0,1]
    v_pk_fma_f32 v[146:147], v[34:35], v[18:19], v[146:147] op_sel:[0,0,0] op_sel_hi:[1,0,1]
    v_pk_fma_f32 v[148:149], v[36:37], v[18:19], v[148:149] op_sel:[0,0,0] op_sel_hi:[1,0,1]
    v_pk_fma_f32 v[150:151], v[38:39], v[18:19], v[150:151] op_sel:[0,0,0] op_sel_hi:[1,0,1]
    v_accvgpr_read_b32 v33, a140
    v_accvgpr_read_b32 v35, a141
    v_accvgpr_read_b32 v37, a142
    v_accvgpr_read_b32 v39, a143
    v_lshlrev_b32 v32, 16, v33
    v_and_b32 v33, s38, v33
    v_lshlrev_b32 v34, 16, v35
    v_and_b32 v35, s38, v35
    v_lshlrev_b32 v36, 16, v37
    v_and_b32 v37, s38, v37
    v_lshlrev_b32 v38, 16, v39
    v_and_b32 v39, s38, v39
    v_pk_fma_f32 v[152:153], v[32:33], v[18:19], v[152:153] op_sel:[0,1,0] op_sel_hi:[1,1,1]
    v_pk_fma_f32 v[154:155], v[34:35], v[18:19], v[154:155] op_sel:[0,1,0] op_sel_hi:[1,1,1]
    v_pk_fma_f32 v[156:157], v[36:37], v[18:19], v[156:157] op_sel:[0,1,0] op_sel_hi:[1,1,1]
    v_pk_fma_f32 v[158:159], v[38:39], v[18:19], v[158:159] op_sel:[0,1,0] op_sel_hi:[1,1,1]
    v_accvgpr_read_b32 v33, a144
    v_accvgpr_read_b32 v35, a145
    v_accvgpr_read_b32 v37, a146
    v_accvgpr_read_b32 v39, a147
    v_lshlrev_b32 v32, 16, v33
    v_and_b32 v33, s38, v33
    v_lshlrev_b32 v34, 16, v35
    v_and_b32 v35, s38, v35
    v_lshlrev_b32 v36, 16, v37
    v_and_b32 v37, s38, v37
    v_lshlrev_b32 v38, 16, v39
    v_and_b32 v39, s38, v39
    v_pk_fma_f32 v[160:161], v[32:33], v[18:19], v[160:161] op_sel:[0,0,0] op_sel_hi:[1,0,1]
    v_pk_fma_f32 v[162:163], v[34:35], v[18:19], v[162:163] op_sel:[0,0,0] op_sel_hi:[1,0,1]
    v_pk_fma_f32 v[164:165], v[36:37], v[18:19], v[164:165] op_sel:[0,0,0] op_sel_hi:[1,0,1]
    v_pk_fma_f32 v[166:167], v[38:39], v[18:19], v[166:167] op_sel:[0,0,0] op_sel_hi:[1,0,1]
    v_accvgpr_read_b32 v33, a148
    v_accvgpr_read_b32 v35, a149
    v_accvgpr_read_b32 v37, a150
    v_accvgpr_read_b32 v39, a151
    v_lshlrev_b32 v32, 16, v33
    v_and_b32 v33, s38, v33
    v_lshlrev_b32 v34, 16, v35
    v_and_b32 v35, s38, v35
    v_lshlrev_b32 v36, 16, v37
    v_and_b32 v37, s38, v37
    v_lshlrev_b32 v38, 16, v39
    v_and_b32 v39, s38, v39
    v_pk_fma_f32 v[168:169], v[32:33], v[18:19], v[168:169] op_sel:[0,1,0] op_sel_hi:[1,1,1]
    v_pk_fma_f32 v[170:171], v[34:35], v[18:19], v[170:171] op_sel:[0,1,0] op_sel_hi:[1,1,1]
    v_pk_fma_f32 v[172:173], v[36:37], v[18:19], v[172:173] op_sel:[0,1,0] op_sel_hi:[1,1,1]
    v_pk_fma_f32 v[174:175], v[38:39], v[18:19], v[174:175] op_sel:[0,1,0] op_sel_hi:[1,1,1]
    v_accvgpr_read_b32 v33, a152
    v_accvgpr_read_b32 v35, a153
    v_accvgpr_read_b32 v37, a154
    v_accvgpr_read_b32 v39, a155
    v_lshlrev_b32 v32, 16, v33
    v_and_b32 v33, s38, v33
    v_lshlrev_b32 v34, 16, v35
    v_and_b32 v35, s38, v35
    v_lshlrev_b32 v36, 16, v37
    v_and_b32 v37, s38, v37
    v_lshlrev_b32 v38, 16, v39
    v_and_b32 v39, s38, v39
    v_pk_fma_f32 v[176:177], v[32:33], v[18:19], v[176:177] op_sel:[0,0,0] op_sel_hi:[1,0,1]
    v_pk_fma_f32 v[178:179], v[34:35], v[18:19], v[178:179] op_sel:[0,0,0] op_sel_hi:[1,0,1]
    v_pk_fma_f32 v[180:181], v[36:37], v[18:19], v[180:181] op_sel:[0,0,0] op_sel_hi:[1,0,1]
    v_pk_fma_f32 v[182:183], v[38:39], v[18:19], v[182:183] op_sel:[0,0,0] op_sel_hi:[1,0,1]
    v_accvgpr_read_b32 v33, a156
    v_accvgpr_read_b32 v35, a157
    v_accvgpr_read_b32 v37, a158
    v_accvgpr_read_b32 v39, a159
    v_lshlrev_b32 v32, 16, v33
    v_and_b32 v33, s38, v33
    v_lshlrev_b32 v34, 16, v35
    v_and_b32 v35, s38, v35
    v_lshlrev_b32 v36, 16, v37
    v_and_b32 v37, s38, v37
    v_lshlrev_b32 v38, 16, v39
    v_and_b32 v39, s38, v39
    v_pk_fma_f32 v[184:185], v[32:33], v[18:19], v[184:185] op_sel:[0,1,0] op_sel_hi:[1,1,1]
    v_pk_fma_f32 v[186:187], v[34:35], v[18:19], v[186:187] op_sel:[0,1,0] op_sel_hi:[1,1,1]
    v_pk_fma_f32 v[188:189], v[36:37], v[18:19], v[188:189] op_sel:[0,1,0] op_sel_hi:[1,1,1]
    v_pk_fma_f32 v[190:191], v[38:39], v[18:19], v[190:191] op_sel:[0,1,0] op_sel_hi:[1,1,1]
    v_accvgpr_read_b32 v33, a160
    v_accvgpr_read_b32 v35, a161
    v_accvgpr_read_b32 v37, a162
    v_accvgpr_read_b32 v39, a163
    v_lshlrev_b32 v32, 16, v33
    v_and_b32 v33, s38, v33
    v_lshlrev_b32 v34, 16, v35
    v_and_b32 v35, s38, v35
    v_lshlrev_b32 v36, 16, v37
    v_and_b32 v37, s38, v37
    v_lshlrev_b32 v38, 16, v39
    v_and_b32 v39, s38, v39
    v_pk_fma_f32 v[192:193], v[32:33], v[18:19], v[192:193] op_sel:[0,0,0] op_sel_hi:[1,0,1]
    v_pk_fma_f32 v[194:195], v[34:35], v[18:19], v[194:195] op_sel:[0,0,0] op_sel_hi:[1,0,1]
    v_pk_fma_f32 v[196:197], v[36:37], v[18:19], v[196:197] op_sel:[0,0,0] op_sel_hi:[1,0,1]
    v_pk_fma_f32 v[198:199], v[38:39], v[18:19], v[198:199] op_sel:[0,0,0] op_sel_hi:[1,0,1]
    v_accvgpr_read_b32 v33, a164
    v_accvgpr_read_b32 v35, a165
    v_accvgpr_read_b32 v37, a166
    v_accvgpr_read_b32 v39, a167
    v_lshlrev_b32 v32, 16, v33
    v_and_b32 v33, s38, v33
    v_lshlrev_b32 v34, 16, v35
    v_and_b32 v35, s38, v35
    v_lshlrev_b32 v36, 16, v37
    v_and_b32 v37, s38, v37
    v_lshlrev_b32 v38, 16, v39
    v_and_b32 v39, s38, v39
    v_pk_fma_f32 v[200:201], v[32:33], v[18:19], v[200:201] op_sel:[0,1,0] op_sel_hi:[1,1,1]
    v_pk_fma_f32 v[202:203], v[34:35], v[18:19], v[202:203] op_sel:[0,1,0] op_sel_hi:[1,1,1]
    v_pk_fma_f32 v[204:205], v[36:37], v[18:19], v[204:205] op_sel:[0,1,0] op_sel_hi:[1,1,1]
    v_pk_fma_f32 v[206:207], v[38:39], v[18:19], v[206:207] op_sel:[0,1,0] op_sel_hi:[1,1,1]
    v_accvgpr_read_b32 v33, a168
    v_accvgpr_read_b32 v35, a169
    v_accvgpr_read_b32 v37, a170
    v_accvgpr_read_b32 v39, a171
    v_lshlrev_b32 v32, 16, v33
    v_and_b32 v33, s38, v33
    v_lshlrev_b32 v34, 16, v35
    v_and_b32 v35, s38, v35
    v_lshlrev_b32 v36, 16, v37
    v_and_b32 v37, s38, v37
    v_lshlrev_b32 v38, 16, v39
    v_and_b32 v39, s38, v39
    v_pk_fma_f32 v[208:209], v[32:33], v[18:19], v[208:209] op_sel:[0,0,0] op_sel_hi:[1,0,1]
    v_pk_fma_f32 v[210:211], v[34:35], v[18:19], v[210:211] op_sel:[0,0,0] op_sel_hi:[1,0,1]
    v_pk_fma_f32 v[212:213], v[36:37], v[18:19], v[212:213] op_sel:[0,0,0] op_sel_hi:[1,0,1]
    v_pk_fma_f32 v[214:215], v[38:39], v[18:19], v[214:215] op_sel:[0,0,0] op_sel_hi:[1,0,1]
    v_accvgpr_read_b32 v33, a172
    v_accvgpr_read_b32 v35, a173
    v_accvgpr_read_b32 v37, a174
    v_accvgpr_read_b32 v39, a175
    v_lshlrev_b32 v32, 16, v33
    v_and_b32 v33, s38, v33
    v_lshlrev_b32 v34, 16, v35
    v_and_b32 v35, s38, v35
    v_lshlrev_b32 v36, 16, v37
    v_and_b32 v37, s38, v37
    v_lshlrev_b32 v38, 16, v39
    v_and_b32 v39, s38, v39
    v_pk_fma_f32 v[216:217], v[32:33], v[18:19], v[216:217] op_sel:[0,1,0] op_sel_hi:[1,1,1]
    v_pk_fma_f32 v[218:219], v[34:35], v[18:19], v[218:219] op_sel:[0,1,0] op_sel_hi:[1,1,1]
    v_pk_fma_f32 v[220:221], v[36:37], v[18:19], v[220:221] op_sel:[0,1,0] op_sel_hi:[1,1,1]
    v_pk_fma_f32 v[222:223], v[38:39], v[18:19], v[222:223] op_sel:[0,1,0] op_sel_hi:[1,1,1]
    v_accvgpr_read_b32 v33, a176
    v_accvgpr_read_b32 v35, a177
    v_accvgpr_read_b32 v37, a178
    v_accvgpr_read_b32 v39, a179
    v_lshlrev_b32 v32, 16, v33
    v_and_b32 v33, s38, v33
    v_lshlrev_b32 v34, 16, v35
    v_and_b32 v35, s38, v35
    v_lshlrev_b32 v36, 16, v37
    v_and_b32 v37, s38, v37
    v_lshlrev_b32 v38, 16, v39
    v_and_b32 v39, s38, v39
    v_pk_fma_f32 v[224:225], v[32:33], v[18:19], v[224:225] op_sel:[0,0,0] op_sel_hi:[1,0,1]
    v_pk_fma_f32 v[226:227], v[34:35], v[18:19], v[226:227] op_sel:[0,0,0] op_sel_hi:[1,0,1]
    v_pk_fma_f32 v[228:229], v[36:37], v[18:19], v[228:229] op_sel:[0,0,0] op_sel_hi:[1,0,1]
    v_pk_fma_f32 v[230:231], v[38:39], v[18:19], v[230:231] op_sel:[0,0,0] op_sel_hi:[1,0,1]
    v_accvgpr_read_b32 v33, a180
    v_accvgpr_read_b32 v35, a181
    v_accvgpr_read_b32 v37, a182
    v_accvgpr_read_b32 v39, a183
    v_lshlrev_b32 v32, 16, v33
    v_and_b32 v33, s38, v33
    v_lshlrev_b32 v34, 16, v35
    v_and_b32 v35, s38, v35
    v_lshlrev_b32 v36, 16, v37
    v_and_b32 v37, s38, v37
    v_lshlrev_b32 v38, 16, v39
    v_and_b32 v39, s38, v39
    v_pk_fma_f32 v[232:233], v[32:33], v[18:19], v[232:233] op_sel:[0,1,0] op_sel_hi:[1,1,1]
    v_pk_fma_f32 v[234:235], v[34:35], v[18:19], v[234:235] op_sel:[0,1,0] op_sel_hi:[1,1,1]
    v_pk_fma_f32 v[236:237], v[36:37], v[18:19], v[236:237] op_sel:[0,1,0] op_sel_hi:[1,1,1]
    v_pk_fma_f32 v[238:239], v[38:39], v[18:19], v[238:239] op_sel:[0,1,0] op_sel_hi:[1,1,1]
    v_accvgpr_read_b32 v33, a184
    v_accvgpr_read_b32 v35, a185
    v_accvgpr_read_b32 v37, a186
    v_accvgpr_read_b32 v39, a187
    v_lshlrev_b32 v32, 16, v33
    v_and_b32 v33, s38, v33
    v_lshlrev_b32 v34, 16, v35
    v_and_b32 v35, s38, v35
    v_lshlrev_b32 v36, 16, v37
    v_and_b32 v37, s38, v37
    v_lshlrev_b32 v38, 16, v39
    v_and_b32 v39, s38, v39
    v_pk_fma_f32 v[240:241], v[32:33], v[18:19], v[240:241] op_sel:[0,0,0] op_sel_hi:[1,0,1]
    v_pk_fma_f32 v[242:243], v[34:35], v[18:19], v[242:243] op_sel:[0,0,0] op_sel_hi:[1,0,1]
    v_pk_fma_f32 v[244:245], v[36:37], v[18:19], v[244:245] op_sel:[0,0,0] op_sel_hi:[1,0,1]
    v_pk_fma_f32 v[246:247], v[38:39], v[18:19], v[246:247] op_sel:[0,0,0] op_sel_hi:[1,0,1]
    v_accvgpr_read_b32 v33, a188
    v_accvgpr_read_b32 v35, a189
    v_accvgpr_read_b32 v37, a190
    v_accvgpr_read_b32 v39, a191
    v_lshlrev_b32 v32, 16, v33
    v_and_b32 v33, s38, v33
    v_lshlrev_b32 v34, 16, v35
    v_and_b32 v35, s38, v35
    v_lshlrev_b32 v36, 16, v37
    v_and_b32 v37, s38, v37
    v_lshlrev_b32 v38, 16, v39
    v_and_b32 v39, s38, v39
    v_pk_fma_f32 v[248:249], v[32:33], v[18:19], v[248:249] op_sel:[0,1,0] op_sel_hi:[1,1,1]
    v_pk_fma_f32 v[250:251], v[34:35], v[18:19], v[250:251] op_sel:[0,1,0] op_sel_hi:[1,1,1]
    v_pk_fma_f32 v[252:253], v[36:37], v[18:19], v[252:253] op_sel:[0,1,0] op_sel_hi:[1,1,1]
    v_pk_fma_f32 v[254:255], v[38:39], v[18:19], v[254:255] op_sel:[0,1,0] op_sel_hi:[1,1,1]
fz_nocomb:
    v_mov_b32 v26, v20
    v_mov_b32 v27, v21
    s_nop 0
    v_permlane32_swap_b32 v20, v26
    v_permlane32_swap_b32 v21, v27
    v_add_f32 v20, v20, v26
    v_add_f32 v21, v21, v27
    v_mov_b32 v26, v20
    v_mov_b32 v27, v21
    s_nop 0
    v_permlane16_swap_b32 v20, v26
    v_permlane16_swap_b32 v21, v27
    v_add_f32 v20, v20, v26
    v_add_f32 v21, v21, v27
    v_rcp_f32 v20, v20
    v_rcp_f32 v21, v21
    v_cvt_pk_bf16_f32 v128, v128, v129
    v_cvt_pk_bf16_f32 v129, v130, v131
    v_cvt_pk_bf16_f32 v130, v132, v133
    v_cvt_pk_bf16_f32 v131, v134, v135
    v_cvt_pk_bf16_f32 v144, v144, v145
    v_cvt_pk_bf16_f32 v145, v146, v147
    v_cvt_pk_bf16_f32 v146, v148, v149
    v_cvt_pk_bf16_f32 v147, v150, v151
    v_cvt_pk_bf16_f32 v160, v160, v161
    v_cvt_pk_bf16_f32 v161, v162, v163
    v_cvt_pk_bf16_f32 v162, v164, v165
    v_cvt_pk_bf16_f32 v163, v166, v167
    v_cvt_pk_bf16_f32 v176, v176, v177
    v_cvt_pk_bf16_f32 v177, v178, v179
    v_cvt_pk_bf16_f32 v178, v180, v181
    v_cvt_pk_bf16_f32 v179, v182, v183
    v_cvt_pk_bf16_f32 v192, v192, v193
    v_cvt_pk_bf16_f32 v193, v194, v195
    v_cvt_pk_bf16_f32 v194, v196, v197
    v_cvt_pk_bf16_f32 v195, v198, v199
    v_cvt_pk_bf16_f32 v208, v208, v209
    v_cvt_pk_bf16_f32 v209, v210, v211
    v_cvt_pk_bf16_f32 v210, v212, v213
    v_cvt_pk_bf16_f32 v211, v214, v215
    v_cvt_pk_bf16_f32 v224, v224, v225
    v_cvt_pk_bf16_f32 v225, v226, v227
    v_cvt_pk_bf16_f32 v226, v228, v229
    v_cvt_pk_bf16_f32 v227, v230, v231
    v_cvt_pk_bf16_f32 v240, v240, v241
    v_cvt_pk_bf16_f32 v241, v242, v243
    v_cvt_pk_bf16_f32 v242, v244, v245
    v_cvt_pk_bf16_f32 v243, v246, v247
    v_cvt_pk_bf16_f32 v136, v136, v137
    v_cvt_pk_bf16_f32 v137, v138, v139
    v_cvt_pk_bf16_f32 v138, v140, v141
    v_cvt_pk_bf16_f32 v139, v142, v143
    v_cvt_pk_bf16_f32 v152, v152, v153
    v_cvt_pk_bf16_f32 v153, v154, v155
    v_cvt_pk_bf16_f32 v154, v156, v157
    v_cvt_pk_bf16_f32 v155, v158, v159
    v_cvt_pk_bf16_f32 v168, v168, v169
    v_cvt_pk_bf16_f32 v169, v170, v171
    v_cvt_pk_bf16_f32 v170, v172, v173
    v_cvt_pk_bf16_f32 v171, v174, v175
    v_cvt_pk_bf16_f32 v184, v184, v185
    v_cvt_pk_bf16_f32 v185, v186, v187
    v_cvt_pk_bf16_f32 v186, v188, v189
    v_cvt_pk_bf16_f32 v187, v190, v191
    v_cvt_pk_bf16_f32 v200, v200, v201
    v_cvt_pk_bf16_f32 v201, v202, v203
    v_cvt_pk_bf16_f32 v202, v204, v205
    v_cvt_pk_bf16_f32 v203, v206, v207
    v_cvt_pk_bf16_f32 v216, v216, v217
    v_cvt_pk_bf16_f32 v217, v218, v219
    v_cvt_pk_bf16_f32 v218, v220, v221
    v_cvt_pk_bf16_f32 v219, v222, v223
    v_cvt_pk_bf16_f32 v232, v232, v233
    v_cvt_pk_bf16_f32 v233, v234, v235
    v_cvt_pk_bf16_f32 v234, v236, v237
    v_cvt_pk_bf16_f32 v235, v238, v239
    v_cvt_pk_bf16_f32 v248, v248, v249
    v_cvt_pk_bf16_f32 v249, v250, v251
    v_cvt_pk_bf16_f32 v250, v252, v253
    v_cvt_pk_bf16_f32 v251, v254, v255
    s_waitcnt vmcnt(4)
fz_oent:
    v_permlane16_swap_b32 v128, v136
    s_lshl3_add_u32 s86, s69, s66
    v_permlane16_swap_b32 v129, v137
    s_mul_i32 s36, s86, 245760
    v_permlane16_swap_b32 v130, v138
    s_and_b32 s86, s68, 7
    v_permlane16_swap_b32 v131, v139
    s_lshr_b32 s87, s68, 3
    v_permlane16_swap_b32 v144, v152
    s_lshl1_add_u32 s86, s86, s87
    v_permlane16_swap_b32 v145, v153
    s_lshl_b32 s87, s86, 8
    v_permlane16_swap_b32 v146, v154
    s_add_u32 s36, s36, s87
    v_permlane16_swap_b32 v147, v155
    s_add_u32 s36, s36, 65007616
    v_permlane16_swap_b32 v160, v168
    s_lshl_b32 s87, s69, 14
    v_permlane16_swap_b32 v161, v169
    s_lshl_b32 s86, s69, 10
    v_permlane16_swap_b32 v162, v170
    s_sub_u32 s86, s86, 261888
    v_permlane16_swap_b32 v163, v171
    s_lshl_b32 s88, s68, 5
    v_permlane16_swap_b32 v176, v184
    s_and_b32 s88, s88, 192
    v_permlane16_swap_b32 v177, v185
    s_add_u32 s88, s88, 118554624
    v_permlane16_swap_b32 v178, v186
    s_add_u32 s86, s86, s88
    v_permlane16_swap_b32 v179, v187
    s_add_u32 s87, s87, s88
    v_permlane16_swap_b32 v192, v200
    s_lshl4_add_u32 s79, s2, s66
    v_permlane16_swap_b32 v193, v201
    s_lshl_b32 s79, s79, 6
    v_permlane16_swap_b32 v194, v202
    s_add_u32 s79, s79, 118554624
    v_permlane16_swap_b32 v195, v203
    s_mov_b32 s37, 2147483648
    v_permlane16_swap_b32 v208, v216
    s_mov_b32 s23, 6
    v_permlane16_swap_b32 v209, v217
    s_lshr_b32 s88, s2, 1
    v_permlane16_swap_b32 v210, v218
    s_lshl2_add_u32 s88, s88, s66
    v_permlane16_swap_b32 v211, v219
    s_mul_i32 s78, s88, 3584
    v_permlane16_swap_b32 v224, v232
    s_and_b32 s88, s2, 1
    v_permlane16_swap_b32 v225, v233
    s_lshl_b32 s88, s88, 6
    v_permlane16_swap_b32 v226, v234
    s_add_u32 s78, s78, s88
    v_permlane16_swap_b32 v227, v235
    s_mov_b32 s8, s40
    v_permlane16_swap_b32 v240, v248
    s_mov_b32 s9, s41
    v_permlane16_swap_b32 v241, v249
    s_mov_b32 s10, 1835008
    v_permlane16_swap_b32 v242, v250
    s_mov_b32 s11, 0x20000
    v_permlane16_swap_b32 v243, v251
    v_permlane16_swap_b32 v20, v21
    v_bfe_u32 v18, v4, 6, 2
    v_and_b32 v19, 48, v4
    v_mul_u32_u24 v18, 30720, v18
    v_bfe_u32 v26, v4, 5, 3
    v_lshl_add_u32 v18, v19, 1, v18
    v_lshrrev_b32 v19, 9, v4
    v_and_b32 v30, 16, v4
    v_lshl_add_u32 v18, v19, 4, v18
    v_bfe_u32 v19, v4, 8, 1
    v_lshl_add_u32 v26, v26, 10, s87
    v_mul_u32_u24 v27, 983040, v19
    v_lshl_add_u32 v26, v30, 9, v26
    v_add_u32 v18, v18, v27
    v_min_u32 v30, 368, v4
    v_cmp_gt_u32 vcc, 256, v4
    v_lshl_add_u32 v30, v30, 10, s86
    v_mul_u32_u24 v27, 229120, v19
    v_cndmask_b32 v26, v30, v26, vcc
    v_cmp_eq_u32 vcc, 0, v4
    v_add_u32 v27, v27, v4
    v_bfe_u32 v80, v4, 5, 2
    v_cndmask_b32 v3, v3, v4, vcc
    v_mul_u32_u24 v28, 896, v80
    v_lshrrev_b32 v80, 9, v4
    v_lshl_add_u32 v28, v19, 4, v28
    v_lshlrev_b32 v29, 30, v80
    v_lshl_add_u32 v28, v80, 7, v28
    v_bfe_u32 v80, v4, 7, 1
    v_bfe_u32 v19, v4, 4, 1
    v_lshl_add_u32 v28, v80, 5, v28
    v_cmp_eq_u32 vcc, 0, v126
    v_lshl_add_u32 v28, v19, 3, v28
    v_add_u32 v29, v29, v28
    s_add_u32 m0, s16, 16384
    s_add_u32 s89, s18, s20
    buffer_load_dwordx2 v[32:33], v28, s[8:11], s78 offen offset:0
    buffer_load_dwordx2 v[34:35], v28, s[8:11], s78 offen offset:256
    buffer_load_dwordx2 v[36:37], v28, s[8:11], s78 offen offset:512
    buffer_load_dwordx2 v[38:39], v29, s[8:11], s78 offen offset:768
    s_cmp_lt_u32 s69, 8
    s_cbranch_scc1 fz_hld
    .p2align 6
fz_oloop:
    s_waitcnt lgkmcnt(12)
    v_mfma_f32_32x32x16_bf16 v[88:103], a[64:67], v[128:131], 0
    s_add_u32 s22, s22, 32768
    buffer_load_dwordx4 v6, s[4:7], s89 offen offset:0 sc1 lds
    ds_read_b64_tr_b16 a[104:105], v14 offset:20480
    ds_read_b64_tr_b16 a[106:107], v14 offset:22528
    v_mfma_f32_32x32x16_bf16 v[88:103], a[68:71], v[136:139], v[88:103]
    s_cmp_eq_u32 s22, 163840
    s_cselect_b32 s22, 0, s22
    buffer_load_dwordx4 v7, s[4:7], s89 offen offset:1024 sc1 lds
    ds_read_b64_tr_b16 a[108:109], v14 offset:20992
    ds_read_b64_tr_b16 a[110:111], v14 offset:23040
    v_mfma_f32_32x32x16_bf16 v[88:103], a[72:75], v[144:147], v[88:103]
    ds_read_b64_tr_b16 a[112:113], v14 offset:24576
    ds_read_b64_tr_b16 a[114:115], v14 offset:26624
    v_mul_f32 v104, v104, v20
    v_mul_f32 v105, v105, v20
    v_mfma_f32_32x32x16_bf16 v[88:103], a[76:79], v[152:155], v[88:103]
    s_waitcnt lgkmcnt(10)
    ds_read_b64_tr_b16 a[116:117], v14 offset:25088
    ds_read_b64_tr_b16 a[118:119], v14 offset:27136
    v_mul_f32 v106, v106, v20
    v_mul_f32 v107, v107, v20
    v_mfma_f32_32x32x16_bf16 v[88:103], a[80:83], v[160:163], v[88:103]
    ds_read_b64_tr_b16 a[120:121], v14 offset:28672
    ds_read_b64_tr_b16 a[122:123], v14 offset:30720
    v_mul_f32 v108, v108, v20
    v_mul_f32 v109, v109, v20
    v_mfma_f32_32x32x16_bf16 v[88:103], a[84:87], v[168:171], v[88:103]
    buffer_load_dwordx4 v8, s[4:7], s89 offen offset:2048 sc1 lds
    ds_read_b64_tr_b16 a[124:125], v14 offset:29184
    ds_read_b64_tr_b16 a[126:127], v14 offset:31232
    v_mul_f32 v110, v110, v20
    v_mul_f32 v111, v111, v20
    v_mfma_f32_32x32x16_bf16 v[88:103], a[88:91], v[176:179], v[88:103]
    ds_read_b64_tr_b16 a[64:65], v15 offset:0
    ds_read_b64_tr_b16 a[66:67], v15 offset:2048
    v_cvt_pk_bf16_f32 v104, v104, v105
    v_cvt_pk_bf16_f32 v105, v106, v107
    v_mfma_f32_32x32x16_bf16 v[88:103], a[92:95], v[184:187], v[88:103]
    s_waitcnt lgkmcnt(10)
    ds_read_b64_tr_b16 a[68:69], v15 offset:512
    ds_read_b64_tr_b16 a[70:71], v15 offset:2560
    v_cvt_pk_bf16_f32 v106, v108, v109
    v_cvt_pk_bf16_f32 v107, v110, v111
    v_mfma_f32_32x32x16_bf16 v[88:103], a[96:99], v[192:195], v[88:103]
    ds_read_b64_tr_b16 a[72:73], v15 offset:4096
    ds_read_b64_tr_b16 a[74:75], v15 offset:6144
    buffer_store_dwordx4 v[104:107], v18, s[24:27], s37 offen offset:0 sc1
    v_mul_f32 v112, v112, v20
    v_mul_f32 v113, v113, v20
    v_mfma_f32_32x32x16_bf16 v[88:103], a[100:103], v[200:203], v[88:103]
    ds_read_b64_tr_b16 a[76:77], v15 offset:4608
    ds_read_b64_tr_b16 a[78:79], v15 offset:6656
    v_mul_f32 v114, v114, v20
    v_mul_f32 v115, v115, v20
    v_mfma_f32_32x32x16_bf16 v[88:103], a[104:107], v[208:211], v[88:103]
    buffer_load_dwordx4 v9, s[4:7], s89 offen offset:3072 sc1 lds
    ds_read_b64_tr_b16 a[80:81], v15 offset:8192
    ds_read_b64_tr_b16 a[82:83], v15 offset:10240
    v_mul_f32 v116, v116, v20
    v_mul_f32 v117, v117, v20
    v_mfma_f32_32x32x16_bf16 v[88:103], a[108:111], v[216:219], v[88:103]
    s_waitcnt lgkmcnt(10)
    ds_read_b64_tr_b16 a[84:85], v15 offset:8704
    ds_read_b64_tr_b16 a[86:87], v15 offset:10752
    v_mul_f32 v118, v118, v20
    v_mul_f32 v119, v119, v20
    v_mfma_f32_32x32x16_bf16 v[88:103], a[112:115], v[224:227], v[88:103]
    s_add_u32 s16, s16, 32768
    ds_read_b64_tr_b16 a[88:89], v15 offset:12288
    ds_read_b64_tr_b16 a[90:91], v15 offset:14336
    v_cvt_pk_bf16_f32 v108, v112, v113
    v_cvt_pk_bf16_f32 v109, v114, v115
    v_mfma_f32_32x32x16_bf16 v[88:103], a[116:119], v[232:235], v[88:103]
    s_add_u32 s36, s36, 4096
    ds_read_b64_tr_b16 a[92:93], v15 offset:12800
    ds_read_b64_tr_b16 a[94:95], v15 offset:14848
    v_cvt_pk_bf16_f32 v110, v116, v117
    v_cvt_pk_bf16_f32 v111, v118, v119
    v_mfma_f32_32x32x16_bf16 v[88:103], a[120:123], v[240:243], v[88:103]
    s_cmp_eq_u32 s16, s17
    s_cselect_b32 s16, s67, s16
    ds_read_b64_tr_b16 a[96:97], v15 offset:16384
    ds_read_b64_tr_b16 a[98:99], v15 offset:18432
    buffer_store_dwordx4 v[108:111], v18, s[24:27], s37 offen offset:128 sc1
    v_mfma_f32_32x32x16_bf16 v[88:103], a[124:127], v[248:251], v[88:103]
    s_waitcnt lgkmcnt(10)
    s_add_u32 s18, s18, s19
    ds_read_b64_tr_b16 a[100:101], v15 offset:16896
    ds_read_b64_tr_b16 a[102:103], v15 offset:18944
    v_mfma_f32_32x32x16_bf16 v[104:119], a[64:67], v[128:131], 0
    s_cmp_eq_u32 s18, 896
    s_cselect_b32 s6, 0, s6
    s_add_u32 s37, s36, 122880
    ds_read_b64_tr_b16 a[104:105], v15 offset:20480
    ds_read_b64_tr_b16 a[106:107], v15 offset:22528
    v_mfma_f32_32x32x16_bf16 v[104:119], a[68:71], v[136:139], v[104:119]
    s_cmp_eq_u32 s23, 0
    s_cselect_b32 s73, s79, 2147483648
    ds_read_b64_tr_b16 a[108:109], v15 offset:20992
    ds_read_b64_tr_b16 a[110:111], v15 offset:23040
    v_mfma_f32_32x32x16_bf16 v[104:119], a[72:75], v[144:147], v[104:119]
    ds_read_b64_tr_b16 a[112:113], v15 offset:24576
    ds_read_b64_tr_b16 a[114:115], v15 offset:26624
    v_add_u32 v14, s22, v10
    v_mul_f32 v88, v88, v20
    v_mul_f32 v89, v89, v20
    v_mfma_f32_32x32x16_bf16 v[104:119], a[76:79], v[152:155], v[104:119]
    s_waitcnt lgkmcnt(10)
    ds_read_b64_tr_b16 a[116:117], v15 offset:25088
    ds_read_b64_tr_b16 a[118:119], v15 offset:27136
    v_mul_f32 v90, v90, v20
    v_mul_f32 v91, v91, v20
    v_mfma_f32_32x32x16_bf16 v[104:119], a[80:83], v[160:163], v[104:119]
    ds_read_b64_tr_b16 a[120:121], v15 offset:28672
    ds_read_b64_tr_b16 a[122:123], v15 offset:30720
    v_mul_f32 v92, v92, v20
    v_mul_f32 v93, v93, v20
    v_mfma_f32_32x32x16_bf16 v[104:119], a[84:87], v[168:171], v[104:119]
    s_mov_b32 m0, s16
    ds_read_b64_tr_b16 a[124:125], v15 offset:29184
    ds_read_b64_tr_b16 a[126:127], v15 offset:31232
    v_mul_f32 v94, v94, v20
    v_mul_f32 v95, v95, v20
    v_mfma_f32_32x32x16_bf16 v[104:119], a[88:91], v[176:179], v[104:119]
    s_waitcnt vmcnt(26)
    s_barrier
    ds_read_b64_tr_b16 a[64:65], v14 offset:0
    ds_read_b64_tr_b16 a[66:67], v14 offset:2048
    v_cvt_pk_bf16_f32 v88, v88, v89
    v_cvt_pk_bf16_f32 v89, v90, v91
    v_mfma_f32_32x32x16_bf16 v[104:119], a[92:95], v[184:187], v[104:119]
    s_waitcnt lgkmcnt(10)
    buffer_store_dword v11, v3, s[24:27], s73 offen sc1
    ds_read_b64_tr_b16 a[68:69], v14 offset:512
    ds_read_b64_tr_b16 a[70:71], v14 offset:2560
    v_cvt_pk_bf16_f32 v90, v92, v93
    v_cvt_pk_bf16_f32 v91, v94, v95
    v_mfma_f32_32x32x16_bf16 v[104:119], a[96:99], v[192:195], v[104:119]
    ds_read_b64_tr_b16 a[72:73], v14 offset:4096
    ds_read_b64_tr_b16 a[74:75], v14 offset:6144
    buffer_store_dwordx4 v[88:91], v18, s[24:27], s36 offen offset:0 sc1
    v_mul_f32 v96, v96, v20
    v_mul_f32 v97, v97, v20
    v_mfma_f32_32x32x16_bf16 v[104:119], a[100:103], v[200:203], v[104:119]
    buffer_load_dwordx4 v6, s[4:7], s18 offen offset:0 sc1 lds
    ds_read_b64_tr_b16 a[76:77], v14 offset:4608
    ds_read_b64_tr_b16 a[78:79], v14 offset:6656
    v_mul_f32 v98, v98, v20
    v_mul_f32 v99, v99, v20
    v_mfma_f32_32x32x16_bf16 v[104:119], a[104:107], v[208:211], v[104:119]
    buffer_load_dwordx4 v7, s[4:7], s18 offen offset:1024 sc1 lds
    ds_read_b64_tr_b16 a[80:81], v14 offset:8192
    ds_read_b64_tr_b16 a[82:83], v14 offset:10240
    v_mul_f32 v100, v100, v20
    v_mul_f32 v101, v101, v20
    v_mfma_f32_32x32x16_bf16 v[104:119], a[108:111], v[216:219], v[104:119]
    s_waitcnt lgkmcnt(10)
    ds_read_b64_tr_b16 a[84:85], v14 offset:8704
    ds_read_b64_tr_b16 a[86:87], v14 offset:10752
    v_mul_f32 v102, v102, v20
    v_mul_f32 v103, v103, v20
    v_mfma_f32_32x32x16_bf16 v[104:119], a[112:115], v[224:227], v[104:119]
    buffer_load_dwordx4 v8, s[4:7], s18 offen offset:2048 sc1 lds
    ds_read_b64_tr_b16 a[88:89], v14 offset:12288
    ds_read_b64_tr_b16 a[90:91], v14 offset:14336
    v_cvt_pk_bf16_f32 v92, v96, v97
    v_cvt_pk_bf16_f32 v93, v98, v99
    v_mfma_f32_32x32x16_bf16 v[104:119], a[116:119], v[232:235], v[104:119]
    buffer_load_dwordx4 v9, s[4:7], s18 offen offset:3072 sc1 lds
    ds_read_b64_tr_b16 a[92:93], v14 offset:12800
    ds_read_b64_tr_b16 a[94:95], v14 offset:14848
    v_cvt_pk_bf16_f32 v94, v100, v101
    v_cvt_pk_bf16_f32 v95, v102, v103
    v_mfma_f32_32x32x16_bf16 v[104:119], a[120:123], v[240:243], v[104:119]
    s_add_u32 m0, s16, 16384
    ds_read_b64_tr_b16 a[96:97], v14 offset:16384
    ds_read_b64_tr_b16 a[98:99], v14 offset:18432
    buffer_store_dwordx4 v[92:95], v18, s[24:27], s36 offen offset:128 sc1
    v_mfma_f32_32x32x16_bf16 v[104:119], a[124:127], v[248:251], v[104:119]
    s_add_u32 s89, s18, s20
    ds_read_b64_tr_b16 a[100:101], v14 offset:16896
    ds_read_b64_tr_b16 a[102:103], v14 offset:18944
    v_add_u32 v15, s22, v11
    s_sub_u32 s23, s23, 1
    s_cbranch_scc0 fz_oloop
fz_oend:
    s_nop 7
    s_nop 5
    v_mul_f32 v104, v104, v20
    v_mul_f32 v105, v105, v20
    v_mul_f32 v106, v106, v20
    v_mul_f32 v107, v107, v20
    v_mul_f32 v108, v108, v20
    v_mul_f32 v109, v109, v20
    v_mul_f32 v110, v110, v20
    v_mul_f32 v111, v111, v20
    v_cvt_pk_bf16_f32 v104, v104, v105
    v_cvt_pk_bf16_f32 v105, v106, v107
    v_cvt_pk_bf16_f32 v106, v108, v109
    v_cvt_pk_bf16_f32 v107, v110, v111
    buffer_store_dwordx4 v[104:107], v18, s[24:27], s37 offen offset:0 sc1
    v_mul_f32 v112, v112, v20
    v_mul_f32 v113, v113, v20
    v_mul_f32 v114, v114, v20
    v_mul_f32 v115, v115, v20
    v_mul_f32 v116, v116, v20
    v_mul_f32 v117, v117, v20
    v_mul_f32 v118, v118, v20
    v_mul_f32 v119, v119, v20
    v_cvt_pk_bf16_f32 v108, v112, v113
    v_cvt_pk_bf16_f32 v109, v114, v115
    v_cvt_pk_bf16_f32 v110, v116, v117
    v_cvt_pk_bf16_f32 v111, v118, v119
    buffer_store_dwordx4 v[108:111], v18, s[24:27], s37 offen offset:128 sc1
    s_branch fz_fin
fz_hld:
    s_cmp_eq_u64 vcc, 0
    s_cbranch_scc1 fz_spxh
fz_hsp:
    s_mov_b32 s82, 100000
fz_sph:
    s_sub_u32 s82, s82, 1
    s_cbranch_scc1 fz_spxh
    buffer_load_dword v126, v12, s[24:27], s81 offen sc1
    s_waitcnt vmcnt(0)
    v_cmp_eq_u32 vcc, 0, v126
    s_nop 3
    s_cmp_eq_u64 vcc, 0
    s_cbranch_scc0 fz_sph
fz_spxh:
    s_waitcnt lgkmcnt(12)
    v_mfma_f32_32x32x16_bf16 v[88:103], a[64:67], v[128:131], 0
    s_add_u32 s22, s22, 32768
    s_cmp_eq_u32 s75, 5
    s_cselect_b32 s73, s74, 2147483648
    buffer_load_dwordx4 v6, s[4:7], s89 offen offset:0 sc1 lds
    ds_read_b64_tr_b16 a[104:105], v14 offset:20480
    ds_read_b64_tr_b16 a[106:107], v14 offset:22528
    v_mfma_f32_32x32x16_bf16 v[88:103], a[68:71], v[136:139], v[88:103]
    s_cmp_eq_u32 s22, 163840
    s_cselect_b32 s22, 0, s22
    buffer_load_dwordx4 v7, s[4:7], s89 offen offset:1024 sc1 lds
    ds_read_b64_tr_b16 a[108:109], v14 offset:20992
    ds_read_b64_tr_b16 a[110:111], v14 offset:23040
    v_mfma_f32_32x32x16_bf16 v[88:103], a[72:75], v[144:147], v[88:103]
    buffer_load_dwordx4 a[0:3], v27, s[24:27], s80 offen offset:0 sc1
    ds_read_b64_tr_b16 a[112:113], v14 offset:24576
    ds_read_b64_tr_b16 a[114:115], v14 offset:26624
    v_mfma_f32_32x32x16_bf16 v[88:103], a[76:79], v[152:155], v[88:103]
    s_waitcnt lgkmcnt(10)
    ds_read_b64_tr_b16 a[116:117], v14 offset:25088
    ds_read_b64_tr_b16 a[118:119], v14 offset:27136
    v_mfma_f32_32x32x16_bf16 v[88:103], a[80:83], v[160:163], v[88:103]
    buffer_load_dwordx4 a[4:7], v27, s[24:27], s80 offen offset:256 sc1
    ds_read_b64_tr_b16 a[120:121], v14 offset:28672
    ds_read_b64_tr_b16 a[122:123], v14 offset:30720
    v_mfma_f32_32x32x16_bf16 v[88:103], a[84:87], v[168:171], v[88:103]
    buffer_load_dwordx4 v8, s[4:7], s89 offen offset:2048 sc1 lds
    ds_read_b64_tr_b16 a[124:125], v14 offset:29184
    ds_read_b64_tr_b16 a[126:127], v14 offset:31232
    v_mfma_f32_32x32x16_bf16 v[88:103], a[88:91], v[176:179], v[88:103]
    buffer_load_dwordx4 a[8:11], v27, s[24:27], s80 offen offset:1024 sc1
    ds_read_b64_tr_b16 a[64:65], v15 offset:0
    ds_read_b64_tr_b16 a[66:67], v15 offset:2048
    v_mfma_f32_32x32x16_bf16 v[88:103], a[92:95], v[184:187], v[88:103]
    s_waitcnt lgkmcnt(10)
    ds_read_b64_tr_b16 a[68:69], v15 offset:512
    ds_read_b64_tr_b16 a[70:71], v15 offset:2560
    v_mfma_f32_32x32x16_bf16 v[88:103], a[96:99], v[192:195], v[88:103]
    ds_read_b64_tr_b16 a[72:73], v15 offset:4096
    ds_read_b64_tr_b16 a[74:75], v15 offset:6144
    v_mfma_f32_32x32x16_bf16 v[88:103], a[100:103], v[200:203], v[88:103]
    buffer_load_dwordx4 a[12:15], v27, s[24:27], s80 offen offset:1280 sc1
    ds_read_b64_tr_b16 a[76:77], v15 offset:4608
    ds_read_b64_tr_b16 a[78:79], v15 offset:6656
    v_mfma_f32_32x32x16_bf16 v[88:103], a[104:107], v[208:211], v[88:103]
    buffer_load_dwordx4 v9, s[4:7], s89 offen offset:3072 sc1 lds
    ds_read_b64_tr_b16 a[80:81], v15 offset:8192
    ds_read_b64_tr_b16 a[82:83], v15 offset:10240
    v_mfma_f32_32x32x16_bf16 v[88:103], a[108:111], v[216:219], v[88:103]
    s_waitcnt lgkmcnt(10)
    ds_read_b64_tr_b16 a[84:85], v15 offset:8704
    ds_read_b64_tr_b16 a[86:87], v15 offset:10752
    v_mfma_f32_32x32x16_bf16 v[88:103], a[112:115], v[224:227], v[88:103]
    s_add_u32 s16, s16, 32768
    ds_read_b64_tr_b16 a[88:89], v15 offset:12288
    ds_read_b64_tr_b16 a[90:91], v15 offset:14336
    v_mfma_f32_32x32x16_bf16 v[88:103], a[116:119], v[232:235], v[88:103]
    s_add_u32 s36, s36, 4096
    ds_read_b64_tr_b16 a[92:93], v15 offset:12800
    ds_read_b64_tr_b16 a[94:95], v15 offset:14848
    v_mfma_f32_32x32x16_bf16 v[88:103], a[120:123], v[240:243], v[88:103]
    s_cmp_eq_u32 s16, s17
    s_cselect_b32 s16, s67, s16
    ds_read_b64_tr_b16 a[96:97], v15 offset:16384
    ds_read_b64_tr_b16 a[98:99], v15 offset:18432
    v_mfma_f32_32x32x16_bf16 v[88:103], a[124:127], v[248:251], v[88:103]
    s_waitcnt lgkmcnt(10)
    s_add_u32 s18, s18, s19
    ds_read_b64_tr_b16 a[100:101], v15 offset:16896
    ds_read_b64_tr_b16 a[102:103], v15 offset:18944
    v_mfma_f32_32x32x16_bf16 v[104:119], a[64:67], v[128:131], 0
    s_add_u32 s37, s36, 122880
    buffer_load_dwordx4 a[16:19], v27, s[24:27], s80 offen offset:2048 sc1
    ds_read_b64_tr_b16 a[104:105], v15 offset:20480
    ds_read_b64_tr_b16 a[106:107], v15 offset:22528
    v_mfma_f32_32x32x16_bf16 v[104:119], a[68:71], v[136:139], v[104:119]
    buffer_load_dwordx4 a[20:23], v27, s[24:27], s80 offen offset:2304 sc1
    ds_read_b64_tr_b16 a[108:109], v15 offset:20992
    ds_read_b64_tr_b16 a[110:111], v15 offset:23040
    v_mfma_f32_32x32x16_bf16 v[104:119], a[72:75], v[144:147], v[104:119]
    ds_read_b64_tr_b16 a[112:113], v15 offset:24576
    ds_read_b64_tr_b16 a[114:115], v15 offset:26624
    v_add_u32 v14, s22, v10
    v_mul_f32 v88, v88, v20
    v_mul_f32 v89, v89, v20
    v_mfma_f32_32x32x16_bf16 v[104:119], a[76:79], v[152:155], v[104:119]
    s_waitcnt lgkmcnt(10)
    ds_read_b64_tr_b16 a[116:117], v15 offset:25088
    ds_read_b64_tr_b16 a[118:119], v15 offset:27136
    v_mul_f32 v90, v90, v20
    v_mul_f32 v91, v91, v20
    v_mfma_f32_32x32x16_bf16 v[104:119], a[80:83], v[160:163], v[104:119]
    buffer_load_dwordx4 a[24:27], v27, s[24:27], s80 offen offset:3072 sc1
    ds_read_b64_tr_b16 a[120:121], v15 offset:28672
    ds_read_b64_tr_b16 a[122:123], v15 offset:30720
    v_mul_f32 v92, v92, v20
    v_mul_f32 v93, v93, v20
    v_mfma_f32_32x32x16_bf16 v[104:119], a[84:87], v[168:171], v[104:119]
    s_mov_b32 m0, s16
    ds_read_b64_tr_b16 a[124:125], v15 offset:29184
    ds_read_b64_tr_b16 a[126:127], v15 offset:31232
    v_mul_f32 v94, v94, v20
    v_mul_f32 v95, v95, v20
    v_mfma_f32_32x32x16_bf16 v[104:119], a[88:91], v[176:179], v[104:119]
    s_barrier
    ds_read_b64_tr_b16 a[64:65], v14 offset:0
    ds_read_b64_tr_b16 a[66:67], v14 offset:2048
    v_cvt_pk_bf16_f32 v88, v88, v89
    v_cvt_pk_bf16_f32 v89, v90, v91
    v_mfma_f32_32x32x16_bf16 v[104:119], a[92:95], v[184:187], v[104:119]
    s_waitcnt lgkmcnt(10)
    ds_read_b64_tr_b16 a[68:69], v14 offset:512
    ds_read_b64_tr_b16 a[70:71], v14 offset:2560
    v_cvt_pk_bf16_f32 v90, v92, v93
    v_cvt_pk_bf16_f32 v91, v94, v95
    v_mfma_f32_32x32x16_bf16 v[104:119], a[96:99], v[192:195], v[104:119]
    ds_read_b64_tr_b16 a[72:73], v14 offset:4096
    ds_read_b64_tr_b16 a[74:75], v14 offset:6144
    buffer_store_dwordx4 v[88:91], v18, s[24:27], s36 offen offset:0 sc1
    v_mul_f32 v96, v96, v20
    v_mul_f32 v97, v97, v20
    v_mfma_f32_32x32x16_bf16 v[104:119], a[100:103], v[200:203], v[104:119]
    buffer_load_dwordx4 v6, s[4:7], s18 offen offset:0 sc1 lds
    ds_read_b64_tr_b16 a[76:77], v14 offset:4608
    ds_read_b64_tr_b16 a[78:79], v14 offset:6656
    v_mul_f32 v98, v98, v20
    v_mul_f32 v99, v99, v20
    v_mfma_f32_32x32x16_bf16 v[104:119], a[104:107], v[208:211], v[104:119]
    buffer_load_dwordx4 v7, s[4:7], s18 offen offset:1024 sc1 lds
    ds_read_b64_tr_b16 a[80:81], v14 offset:8192
    ds_read_b64_tr_b16 a[82:83], v14 offset:10240
    v_mul_f32 v100, v100, v20
    v_mul_f32 v101, v101, v20
    v_mfma_f32_32x32x16_bf16 v[104:119], a[108:111], v[216:219], v[104:119]
    s_waitcnt lgkmcnt(10)
    ds_read_b64_tr_b16 a[84:85], v14 offset:8704
    ds_read_b64_tr_b16 a[86:87], v14 offset:10752
    v_mul_f32 v102, v102, v20
    v_mul_f32 v103, v103, v20
    v_mfma_f32_32x32x16_bf16 v[104:119], a[112:115], v[224:227], v[104:119]
    buffer_load_dwordx4 v8, s[4:7], s18 offen offset:2048 sc1 lds
    ds_read_b64_tr_b16 a[88:89], v14 offset:12288
    ds_read_b64_tr_b16 a[90:91], v14 offset:14336
    v_cvt_pk_bf16_f32 v92, v96, v97
    v_cvt_pk_bf16_f32 v93, v98, v99
    v_mfma_f32_32x32x16_bf16 v[104:119], a[116:119], v[232:235], v[104:119]
    buffer_load_dwordx4 v9, s[4:7], s18 offen offset:3072 sc1 lds
    ds_read_b64_tr_b16 a[92:93], v14 offset:12800
    ds_read_b64_tr_b16 a[94:95], v14 offset:14848
    v_cvt_pk_bf16_f32 v94, v100, v101
    v_cvt_pk_bf16_f32 v95, v102, v103
    v_mfma_f32_32x32x16_bf16 v[104:119], a[120:123], v[240:243], v[104:119]
    s_add_u32 m0, s16, 16384
    ds_read_b64_tr_b16 a[96:97], v14 offset:16384
    ds_read_b64_tr_b16 a[98:99], v14 offset:18432
    buffer_store_dwordx4 v[92:95], v18, s[24:27], s36 offen offset:128 sc1
    v_mfma_f32_32x32x16_bf16 v[104:119], a[124:127], v[248:251], v[104:119]
    s_add_u32 s89, s18, s20
    ds_read_b64_tr_b16 a[100:101], v14 offset:16896
    ds_read_b64_tr_b16 a[102:103], v14 offset:18944
    v_add_u32 v15, s22, v11
    s_waitcnt lgkmcnt(12)
    v_mfma_f32_32x32x16_bf16 v[88:103], a[64:67], v[128:131], 0
    s_add_u32 s22, s22, 32768
    buffer_load_dwordx4 v6, s[4:7], s89 offen offset:0 sc1 lds
    ds_read_b64_tr_b16 a[104:105], v14 offset:20480
    ds_read_b64_tr_b16 a[106:107], v14 offset:22528
    v_mfma_f32_32x32x16_bf16 v[88:103], a[68:71], v[136:139], v[88:103]
    s_cmp_eq_u32 s22, 163840
    s_cselect_b32 s22, 0, s22
    buffer_load_dwordx4 v7, s[4:7], s89 offen offset:1024 sc1 lds
    ds_read_b64_tr_b16 a[108:109], v14 offset:20992
    ds_read_b64_tr_b16 a[110:111], v14 offset:23040
    v_mfma_f32_32x32x16_bf16 v[88:103], a[72:75], v[144:147], v[88:103]
    buffer_load_dwordx4 a[28:31], v27, s[24:27], s80 offen offset:3328 sc1
    s_add_u32 s80, s80, 4096
    ds_read_b64_tr_b16 a[112:113], v14 offset:24576
    ds_read_b64_tr_b16 a[114:115], v14 offset:26624
    v_mul_f32 v104, v104, v20
    v_mul_f32 v105, v105, v20
    v_mfma_f32_32x32x16_bf16 v[88:103], a[76:79], v[152:155], v[88:103]
    s_waitcnt lgkmcnt(10)
    ds_read_b64_tr_b16 a[116:117], v14 offset:25088
    ds_read_b64_tr_b16 a[118:119], v14 offset:27136
    v_mul_f32 v106, v106, v20
    v_mul_f32 v107, v107, v20
    v_mfma_f32_32x32x16_bf16 v[88:103], a[80:83], v[160:163], v[88:103]
    buffer_load_dwordx4 a[32:35], v27, s[24:27], s80 offen offset:0 sc1
    ds_read_b64_tr_b16 a[120:121], v14 offset:28672
    ds_read_b64_tr_b16 a[122:123], v14 offset:30720
    v_mul_f32 v108, v108, v20
    v_mul_f32 v109, v109, v20
    v_mfma_f32_32x32x16_bf16 v[88:103], a[84:87], v[168:171], v[88:103]
    buffer_load_dwordx4 v8, s[4:7], s89 offen offset:2048 sc1 lds
    ds_read_b64_tr_b16 a[124:125], v14 offset:29184
    ds_read_b64_tr_b16 a[126:127], v14 offset:31232
    v_mul_f32 v110, v110, v20
    v_mul_f32 v111, v111, v20
    v_mfma_f32_32x32x16_bf16 v[88:103], a[88:91], v[176:179], v[88:103]
    buffer_load_dwordx4 a[36:39], v27, s[24:27], s80 offen offset:256 sc1
    ds_read_b64_tr_b16 a[64:65], v15 offset:0
    ds_read_b64_tr_b16 a[66:67], v15 offset:2048
    v_cvt_pk_bf16_f32 v104, v104, v105
    v_cvt_pk_bf16_f32 v105, v106, v107
    v_mfma_f32_32x32x16_bf16 v[88:103], a[92:95], v[184:187], v[88:103]
    s_waitcnt lgkmcnt(10)
    ds_read_b64_tr_b16 a[68:69], v15 offset:512
    ds_read_b64_tr_b16 a[70:71], v15 offset:2560
    v_cvt_pk_bf16_f32 v106, v108, v109
    v_cvt_pk_bf16_f32 v107, v110, v111
    v_mfma_f32_32x32x16_bf16 v[88:103], a[96:99], v[192:195], v[88:103]
    ds_read_b64_tr_b16 a[72:73], v15 offset:4096
    ds_read_b64_tr_b16 a[74:75], v15 offset:6144
    buffer_store_dwordx4 v[104:107], v18, s[24:27], s37 offen offset:0 sc1
    v_mul_f32 v112, v112, v20
    v_mul_f32 v113, v113, v20
    v_mfma_f32_32x32x16_bf16 v[88:103], a[100:103], v[200:203], v[88:103]
    buffer_load_dwordx4 a[40:43], v27, s[24:27], s80 offen offset:1024 sc1
    ds_read_b64_tr_b16 a[76:77], v15 offset:4608
    ds_read_b64_tr_b16 a[78:79], v15 offset:6656
    v_mul_f32 v114, v114, v20
    v_mul_f32 v115, v115, v20
    v_mfma_f32_32x32x16_bf16 v[88:103], a[104:107], v[208:211], v[88:103]
    buffer_load_dwordx4 v9, s[4:7], s89 offen offset:3072 sc1 lds
    ds_read_b64_tr_b16 a[80:81], v15 offset:8192
    ds_read_b64_tr_b16 a[82:83], v15 offset:10240
    v_mul_f32 v116, v116, v20
    v_mul_f32 v117, v117, v20
    v_mfma_f32_32x32x16_bf16 v[88:103], a[108:111], v[216:219], v[88:103]
    s_waitcnt lgkmcnt(10)
    ds_read_b64_tr_b16 a[84:85], v15 offset:8704
    ds_read_b64_tr_b16 a[86:87], v15 offset:10752
    v_mul_f32 v118, v118, v20
    v_mul_f32 v119, v119, v20
    v_mfma_f32_32x32x16_bf16 v[88:103], a[112:115], v[224:227], v[88:103]
    s_add_u32 s16, s16, 32768
    ds_read_b64_tr_b16 a[88:89], v15 offset:12288
    ds_read_b64_tr_b16 a[90:91], v15 offset:14336
    v_cvt_pk_bf16_f32 v108, v112, v113
    v_cvt_pk_bf16_f32 v109, v114, v115
    v_mfma_f32_32x32x16_bf16 v[88:103], a[116:119], v[232:235], v[88:103]
    s_add_u32 s36, s36, 4096
    ds_read_b64_tr_b16 a[92:93], v15 offset:12800
    ds_read_b64_tr_b16 a[94:95], v15 offset:14848
    v_cvt_pk_bf16_f32 v110, v116, v117
    v_cvt_pk_bf16_f32 v111, v118, v119
    v_mfma_f32_32x32x16_bf16 v[88:103], a[120:123], v[240:243], v[88:103]
    s_cmp_eq_u32 s16, s17
    s_cselect_b32 s16, s67, s16
    ds_read_b64_tr_b16 a[96:97], v15 offset:16384
    ds_read_b64_tr_b16 a[98:99], v15 offset:18432
    buffer_store_dwordx4 v[108:111], v18, s[24:27], s37 offen offset:128 sc1
    v_mfma_f32_32x32x16_bf16 v[88:103], a[124:127], v[248:251], v[88:103]
    s_waitcnt lgkmcnt(10)
    s_add_u32 s18, s18, s19
    ds_read_b64_tr_b16 a[100:101], v15 offset:16896
    ds_read_b64_tr_b16 a[102:103], v15 offset:18944
    v_mfma_f32_32x32x16_bf16 v[104:119], a[64:67], v[128:131], 0
    s_add_u32 s37, s36, 122880
    buffer_load_dwordx4 a[44:47], v27, s[24:27], s80 offen offset:1280 sc1
    ds_read_b64_tr_b16 a[104:105], v15 offset:20480
    ds_read_b64_tr_b16 a[106:107], v15 offset:22528
    v_mfma_f32_32x32x16_bf16 v[104:119], a[68:71], v[136:139], v[104:119]
    buffer_load_dwordx4 a[48:51], v27, s[24:27], s80 offen offset:2048 sc1
    ds_read_b64_tr_b16 a[108:109], v15 offset:20992
    ds_read_b64_tr_b16 a[110:111], v15 offset:23040
    v_mfma_f32_32x32x16_bf16 v[104:119], a[72:75], v[144:147], v[104:119]
    ds_read_b64_tr_b16 a[112:113], v15 offset:24576
    ds_read_b64_tr_b16 a[114:115], v15 offset:26624
    v_add_u32 v14, s22, v10
    v_mul_f32 v88, v88, v20
    v_mul_f32 v89, v89, v20
    v_mfma_f32_32x32x16_bf16 v[104:119], a[76:79], v[152:155], v[104:119]
    s_waitcnt lgkmcnt(10)
    ds_read_b64_tr_b16 a[116:117], v15 offset:25088
    ds_read_b64_tr_b16 a[118:119], v15 offset:27136
    v_mul_f32 v90, v90, v20
    v_mul_f32 v91, v91, v20
    v_mfma_f32_32x32x16_bf16 v[104:119], a[80:83], v[160:163], v[104:119]
    buffer_load_dwordx4 a[52:55], v27, s[24:27], s80 offen offset:2304 sc1
    ds_read_b64_tr_b16 a[120:121], v15 offset:28672
    ds_read_b64_tr_b16 a[122:123], v15 offset:30720
    v_mul_f32 v92, v92, v20
    v_mul_f32 v93, v93, v20
    v_mfma_f32_32x32x16_bf16 v[104:119], a[84:87], v[168:171], v[104:119]
    s_mov_b32 m0, s16
    ds_read_b64_tr_b16 a[124:125], v15 offset:29184
    ds_read_b64_tr_b16 a[126:127], v15 offset:31232
    v_mul_f32 v94, v94, v20
    v_mul_f32 v95, v95, v20
    v_mfma_f32_32x32x16_bf16 v[104:119], a[88:91], v[176:179], v[104:119]
    s_waitcnt vmcnt(34)
    s_barrier
    buffer_store_dword v11, v3, s[24:27], s73 offen sc1
    ds_read_b64_tr_b16 a[64:65], v14 offset:0
    ds_read_b64_tr_b16 a[66:67], v14 offset:2048
    v_cvt_pk_bf16_f32 v88, v88, v89
    v_cvt_pk_bf16_f32 v89, v90, v91
    v_mfma_f32_32x32x16_bf16 v[104:119], a[92:95], v[184:187], v[104:119]
    s_waitcnt lgkmcnt(10)
    ds_read_b64_tr_b16 a[68:69], v14 offset:512
    ds_read_b64_tr_b16 a[70:71], v14 offset:2560
    v_cvt_pk_bf16_f32 v90, v92, v93
    v_cvt_pk_bf16_f32 v91, v94, v95
    v_mfma_f32_32x32x16_bf16 v[104:119], a[96:99], v[192:195], v[104:119]
    ds_read_b64_tr_b16 a[72:73], v14 offset:4096
    ds_read_b64_tr_b16 a[74:75], v14 offset:6144
    buffer_store_dwordx4 v[88:91], v18, s[24:27], s36 offen offset:0 sc1
    v_mul_f32 v96, v96, v20
    v_mul_f32 v97, v97, v20
    v_mfma_f32_32x32x16_bf16 v[104:119], a[100:103], v[200:203], v[104:119]
    buffer_load_dwordx4 v6, s[4:7], s18 offen offset:0 sc1 lds
    ds_read_b64_tr_b16 a[76:77], v14 offset:4608
    ds_read_b64_tr_b16 a[78:79], v14 offset:6656
    v_mul_f32 v98, v98, v20
    v_mul_f32 v99, v99, v20
    v_mfma_f32_32x32x16_bf16 v[104:119], a[104:107], v[208:211], v[104:119]
    buffer_load_dwordx4 v7, s[4:7], s18 offen offset:1024 sc1 lds
    ds_read_b64_tr_b16 a[80:81], v14 offset:8192
    ds_read_b64_tr_b16 a[82:83], v14 offset:10240
    v_mul_f32 v100, v100, v20
    v_mul_f32 v101, v101, v20
    v_mfma_f32_32x32x16_bf16 v[104:119], a[108:111], v[216:219], v[104:119]
    s_waitcnt lgkmcnt(10)
    ds_read_b64_tr_b16 a[84:85], v14 offset:8704
    ds_read_b64_tr_b16 a[86:87], v14 offset:10752
    v_mul_f32 v102, v102, v20
    v_mul_f32 v103, v103, v20
    v_mfma_f32_32x32x16_bf16 v[104:119], a[112:115], v[224:227], v[104:119]
    buffer_load_dwordx4 v8, s[4:7], s18 offen offset:2048 sc1 lds
    ds_read_b64_tr_b16 a[88:89], v14 offset:12288
    ds_read_b64_tr_b16 a[90:91], v14 offset:14336
    v_cvt_pk_bf16_f32 v92, v96, v97
    v_cvt_pk_bf16_f32 v93, v98, v99
    v_mfma_f32_32x32x16_bf16 v[104:119], a[116:119], v[232:235], v[104:119]
    buffer_load_dwordx4 v9, s[4:7], s18 offen offset:3072 sc1 lds
    ds_read_b64_tr_b16 a[92:93], v14 offset:12800
    ds_read_b64_tr_b16 a[94:95], v14 offset:14848
    v_cvt_pk_bf16_f32 v94, v100, v101
    v_cvt_pk_bf16_f32 v95, v102, v103
    v_mfma_f32_32x32x16_bf16 v[104:119], a[120:123], v[240:243], v[104:119]
    s_add_u32 m0, s16, 16384
    ds_read_b64_tr_b16 a[96:97], v14 offset:16384
    ds_read_b64_tr_b16 a[98:99], v14 offset:18432
    buffer_store_dwordx4 v[92:95], v18, s[24:27], s36 offen offset:128 sc1
    v_mfma_f32_32x32x16_bf16 v[104:119], a[124:127], v[248:251], v[104:119]
    s_add_u32 s89, s18, s20
    ds_read_b64_tr_b16 a[100:101], v14 offset:16896
    ds_read_b64_tr_b16 a[102:103], v14 offset:18944
    v_add_u32 v15, s22, v11
fz_b2:
    s_waitcnt lgkmcnt(12)
    v_mfma_f32_32x32x16_bf16 v[88:103], a[64:67], v[128:131], 0
    s_add_u32 s22, s22, 32768
    buffer_load_dwordx4 v6, s[4:7], s89 offen offset:0 sc1 lds
    ds_read_b64_tr_b16 a[104:105], v14 offset:20480
    ds_read_b64_tr_b16 a[106:107], v14 offset:22528
    v_mfma_f32_32x32x16_bf16 v[88:103], a[68:71], v[136:139], v[88:103]
    s_cmp_eq_u32 s22, 163840
    s_cselect_b32 s22, 0, s22
    buffer_load_dwordx4 v7, s[4:7], s89 offen offset:1024 sc1 lds
    ds_read_b64_tr_b16 a[108:109], v14 offset:20992
    ds_read_b64_tr_b16 a[110:111], v14 offset:23040
    v_mfma_f32_32x32x16_bf16 v[88:103], a[72:75], v[144:147], v[88:103]
    buffer_load_dwordx4 a[56:59], v27, s[24:27], s80 offen offset:3072 sc1
    ds_read_b64_tr_b16 a[112:113], v14 offset:24576
    ds_read_b64_tr_b16 a[114:115], v14 offset:26624
    v_mul_f32 v104, v104, v20
    v_mul_f32 v105, v105, v20
    v_mfma_f32_32x32x16_bf16 v[88:103], a[76:79], v[152:155], v[88:103]
    s_waitcnt lgkmcnt(10)
    ds_read_b64_tr_b16 a[116:117], v14 offset:25088
    ds_read_b64_tr_b16 a[118:119], v14 offset:27136
    v_mul_f32 v106, v106, v20
    v_mul_f32 v107, v107, v20
    v_mfma_f32_32x32x16_bf16 v[88:103], a[80:83], v[160:163], v[88:103]
    buffer_load_dwordx4 a[60:63], v27, s[24:27], s80 offen offset:3328 sc1
    s_add_u32 s80, s80, 4096
    s_cmp_eq_u32 s69, 7
    s_cselect_b32 s80, 2147483648, s80
    ds_read_b64_tr_b16 a[120:121], v14 offset:28672
    ds_read_b64_tr_b16 a[122:123], v14 offset:30720
    v_mul_f32 v108, v108, v20
    v_mul_f32 v109, v109, v20
    v_mfma_f32_32x32x16_bf16 v[88:103], a[84:87], v[168:171], v[88:103]
    buffer_load_dwordx4 v8, s[4:7], s89 offen offset:2048 sc1 lds
    ds_read_b64_tr_b16 a[124:125], v14 offset:29184
    ds_read_b64_tr_b16 a[126:127], v14 offset:31232
    v_mul_f32 v110, v110, v20
    v_mul_f32 v111, v111, v20
    v_mfma_f32_32x32x16_bf16 v[88:103], a[88:91], v[176:179], v[88:103]
    buffer_load_dwordx4 a[128:131], v27, s[24:27], s80 offen offset:0 sc1
    ds_read_b64_tr_b16 a[64:65], v15 offset:0
    ds_read_b64_tr_b16 a[66:67], v15 offset:2048
    v_cvt_pk_bf16_f32 v104, v104, v105
    v_cvt_pk_bf16_f32 v105, v106, v107
    v_mfma_f32_32x32x16_bf16 v[88:103], a[92:95], v[184:187], v[88:103]
    s_waitcnt lgkmcnt(10)
    ds_read_b64_tr_b16 a[68:69], v15 offset:512
    ds_read_b64_tr_b16 a[70:71], v15 offset:2560
    v_cvt_pk_bf16_f32 v106, v108, v109
    v_cvt_pk_bf16_f32 v107, v110, v111
    v_mfma_f32_32x32x16_bf16 v[88:103], a[96:99], v[192:195], v[88:103]
    ds_read_b64_tr_b16 a[72:73], v15 offset:4096
    ds_read_b64_tr_b16 a[74:75], v15 offset:6144
    buffer_store_dwordx4 v[104:107], v18, s[24:27], s37 offen offset:0 sc1
    v_mul_f32 v112, v112, v20
    v_mul_f32 v113, v113, v20
    v_mfma_f32_32x32x16_bf16 v[88:103], a[100:103], v[200:203], v[88:103]
    buffer_load_dwordx4 a[132:135], v27, s[24:27], s80 offen offset:256 sc1
    ds_read_b64_tr_b16 a[76:77], v15 offset:4608
    ds_read_b64_tr_b16 a[78:79], v15 offset:6656
    v_mul_f32 v114, v114, v20
    v_mul_f32 v115, v115, v20
    v_mfma_f32_32x32x16_bf16 v[88:103], a[104:107], v[208:211], v[88:103]
    buffer_load_dwordx4 v9, s[4:7], s89 offen offset:3072 sc1 lds
    ds_read_b64_tr_b16 a[80:81], v15 offset:8192
    ds_read_b64_tr_b16 a[82:83], v15 offset:10240
    v_mul_f32 v116, v116, v20
    v_mul_f32 v117, v117, v20
    v_mfma_f32_32x32x16_bf16 v[88:103], a[108:111], v[216:219], v[88:103]
    s_waitcnt lgkmcnt(10)
    ds_read_b64_tr_b16 a[84:85], v15 offset:8704
    ds_read_b64_tr_b16 a[86:87], v15 offset:10752
    v_mul_f32 v118, v118, v20
    v_mul_f32 v119, v119, v20
    v_mfma_f32_32x32x16_bf16 v[88:103], a[112:115], v[224:227], v[88:103]
    s_add_u32 s16, s16, 32768
    ds_read_b64_tr_b16 a[88:89], v15 offset:12288
    ds_read_b64_tr_b16 a[90:91], v15 offset:14336
    v_cvt_pk_bf16_f32 v108, v112, v113
    v_cvt_pk_bf16_f32 v109, v114, v115
    v_mfma_f32_32x32x16_bf16 v[88:103], a[116:119], v[232:235], v[88:103]
    s_add_u32 s36, s36, 4096
    ds_read_b64_tr_b16 a[92:93], v15 offset:12800
    ds_read_b64_tr_b16 a[94:95], v15 offset:14848
    v_cvt_pk_bf16_f32 v110, v116, v117
    v_cvt_pk_bf16_f32 v111, v118, v119
    v_mfma_f32_32x32x16_bf16 v[88:103], a[120:123], v[240:243], v[88:103]
    s_cmp_eq_u32 s16, s17
    s_cselect_b32 s16, s67, s16
    ds_read_b64_tr_b16 a[96:97], v15 offset:16384
    ds_read_b64_tr_b16 a[98:99], v15 offset:18432
    buffer_store_dwordx4 v[108:111], v18, s[24:27], s37 offen offset:128 sc1
    v_mfma_f32_32x32x16_bf16 v[88:103], a[124:127], v[248:251], v[88:103]
    s_waitcnt lgkmcnt(10)
    s_add_u32 s18, s18, s19
    ds_read_b64_tr_b16 a[100:101], v15 offset:16896
    ds_read_b64_tr_b16 a[102:103], v15 offset:18944
    v_mfma_f32_32x32x16_bf16 v[104:119], a[64:67], v[128:131], 0
    s_add_u32 s37, s36, 122880
    buffer_load_dwordx4 a[136:139], v27, s[24:27], s80 offen offset:1024 sc1
    ds_read_b64_tr_b16 a[104:105], v15 offset:20480
    ds_read_b64_tr_b16 a[106:107], v15 offset:22528
    v_mfma_f32_32x32x16_bf16 v[104:119], a[68:71], v[136:139], v[104:119]
    buffer_load_dwordx4 a[140:143], v27, s[24:27], s80 offen offset:1280 sc1
    ds_read_b64_tr_b16 a[108:109], v15 offset:20992
    ds_read_b64_tr_b16 a[110:111], v15 offset:23040
    v_mfma_f32_32x32x16_bf16 v[104:119], a[72:75], v[144:147], v[104:119]
    ds_read_b64_tr_b16 a[112:113], v15 offset:24576
    ds_read_b64_tr_b16 a[114:115], v15 offset:26624
    v_add_u32 v14, s22, v10
    v_mul_f32 v88, v88, v20
    v_mul_f32 v89, v89, v20
    v_mfma_f32_32x32x16_bf16 v[104:119], a[76:79], v[152:155], v[104:119]
    s_waitcnt lgkmcnt(10)
    ds_read_b64_tr_b16 a[116:117], v15 offset:25088
    ds_read_b64_tr_b16 a[118:119], v15 offset:27136
    v_mul_f32 v90, v90, v20
    v_mul_f32 v91, v91, v20
    v_mfma_f32_32x32x16_bf16 v[104:119], a[80:83], v[160:163], v[104:119]
    buffer_load_dwordx4 a[144:147], v27, s[24:27], s80 offen offset:2048 sc1
    ds_read_b64_tr_b16 a[120:121], v15 offset:28672
    ds_read_b64_tr_b16 a[122:123], v15 offset:30720
    v_mul_f32 v92, v92, v20
    v_mul_f32 v93, v93, v20
    v_mfma_f32_32x32x16_bf16 v[104:119], a[84:87], v[168:171], v[104:119]
    s_mov_b32 m0, s16
    ds_read_b64_tr_b16 a[124:125], v15 offset:29184
    ds_read_b64_tr_b16 a[126:127], v15 offset:31232
    v_mul_f32 v94, v94, v20
    v_mul_f32 v95, v95, v20
    v_mfma_f32_32x32x16_bf16 v[104:119], a[88:91], v[176:179], v[104:119]
    s_waitcnt vmcnt(42)
    s_barrier
    ds_read_b64_tr_b16 a[64:65], v14 offset:0
    ds_read_b64_tr_b16 a[66:67], v14 offset:2048
    v_cvt_pk_bf16_f32 v88, v88, v89
    v_cvt_pk_bf16_f32 v89, v90, v91
    v_mfma_f32_32x32x16_bf16 v[104:119], a[92:95], v[184:187], v[104:119]
    s_waitcnt lgkmcnt(10)
    ds_read_b64_tr_b16 a[68:69], v14 offset:512
    ds_read_b64_tr_b16 a[70:71], v14 offset:2560
    v_cvt_pk_bf16_f32 v90, v92, v93
    v_cvt_pk_bf16_f32 v91, v94, v95
    v_mfma_f32_32x32x16_bf16 v[104:119], a[96:99], v[192:195], v[104:119]
    ds_read_b64_tr_b16 a[72:73], v14 offset:4096
    ds_read_b64_tr_b16 a[74:75], v14 offset:6144
    buffer_store_dwordx4 v[88:91], v18, s[24:27], s36 offen offset:0 sc1
    v_mul_f32 v96, v96, v20
    v_mul_f32 v97, v97, v20
    v_mfma_f32_32x32x16_bf16 v[104:119], a[100:103], v[200:203], v[104:119]
    buffer_load_dwordx4 v6, s[4:7], s18 offen offset:0 sc1 lds
    ds_read_b64_tr_b16 a[76:77], v14 offset:4608
    ds_read_b64_tr_b16 a[78:79], v14 offset:6656
    v_mul_f32 v98, v98, v20
    v_mul_f32 v99, v99, v20
    v_mfma_f32_32x32x16_bf16 v[104:119], a[104:107], v[208:211], v[104:119]
    buffer_load_dwordx4 v7, s[4:7], s18 offen offset:1024 sc1 lds
    ds_read_b64_tr_b16 a[80:81], v14 offset:8192
    ds_read_b64_tr_b16 a[82:83], v14 offset:10240
    v_mul_f32 v100, v100, v20
    v_mul_f32 v101, v101, v20
    v_mfma_f32_32x32x16_bf16 v[104:119], a[108:111], v[216:219], v[104:119]
    s_waitcnt lgkmcnt(10)
    ds_read_b64_tr_b16 a[84:85], v14 offset:8704
    ds_read_b64_tr_b16 a[86:87], v14 offset:10752
    v_mul_f32 v102, v102, v20
    v_mul_f32 v103, v103, v20
    v_mfma_f32_32x32x16_bf16 v[104:119], a[112:115], v[224:227], v[104:119]
    buffer_load_dwordx4 v8, s[4:7], s18 offen offset:2048 sc1 lds
    ds_read_b64_tr_b16 a[88:89], v14 offset:12288
    ds_read_b64_tr_b16 a[90:91], v14 offset:14336
    v_cvt_pk_bf16_f32 v92, v96, v97
    v_cvt_pk_bf16_f32 v93, v98, v99
    v_mfma_f32_32x32x16_bf16 v[104:119], a[116:119], v[232:235], v[104:119]
    buffer_load_dwordx4 v9, s[4:7], s18 offen offset:3072 sc1 lds
    ds_read_b64_tr_b16 a[92:93], v14 offset:12800
    ds_read_b64_tr_b16 a[94:95], v14 offset:14848
    v_cvt_pk_bf16_f32 v94, v100, v101
    v_cvt_pk_bf16_f32 v95, v102, v103
    v_mfma_f32_32x32x16_bf16 v[104:119], a[120:123], v[240:243], v[104:119]
    s_add_u32 m0, s16, 16384
    ds_read_b64_tr_b16 a[96:97], v14 offset:16384
    ds_read_b64_tr_b16 a[98:99], v14 offset:18432
    buffer_store_dwordx4 v[92:95], v18, s[24:27], s36 offen offset:128 sc1
    v_mfma_f32_32x32x16_bf16 v[104:119], a[124:127], v[248:251], v[104:119]
    s_add_u32 s89, s18, s20
    ds_read_b64_tr_b16 a[100:101], v14 offset:16896
    ds_read_b64_tr_b16 a[102:103], v14 offset:18944
    v_add_u32 v15, s22, v11
    s_waitcnt lgkmcnt(12)
    v_mfma_f32_32x32x16_bf16 v[88:103], a[64:67], v[128:131], 0
    s_add_u32 s22, s22, 32768
    buffer_load_dwordx4 v6, s[4:7], s89 offen offset:0 sc1 lds
    ds_read_b64_tr_b16 a[104:105], v14 offset:20480
    ds_read_b64_tr_b16 a[106:107], v14 offset:22528
    v_mfma_f32_32x32x16_bf16 v[88:103], a[68:71], v[136:139], v[88:103]
    s_cmp_eq_u32 s22, 163840
    s_cselect_b32 s22, 0, s22
    buffer_load_dwordx4 v7, s[4:7], s89 offen offset:1024 sc1 lds
    ds_read_b64_tr_b16 a[108:109], v14 offset:20992
    ds_read_b64_tr_b16 a[110:111], v14 offset:23040
    v_mfma_f32_32x32x16_bf16 v[88:103], a[72:75], v[144:147], v[88:103]
    s_sub_u32 s87, s70, s58
    buffer_load_dwordx4 a[148:151], v27, s[24:27], s80 offen offset:2304 sc1
    ds_read_b64_tr_b16 a[112:113], v14 offset:24576
    ds_read_b64_tr_b16 a[114:115], v14 offset:26624
    v_mul_f32 v104, v104, v20
    v_mul_f32 v105, v105, v20
    v_mfma_f32_32x32x16_bf16 v[88:103], a[76:79], v[152:155], v[88:103]
    s_waitcnt lgkmcnt(10)
    s_mov_b32 s86, 1605632
    ds_read_b64_tr_b16 a[116:117], v14 offset:25088
    ds_read_b64_tr_b16 a[118:119], v14 offset:27136
    v_mul_f32 v106, v106, v20
    v_mul_f32 v107, v107, v20
    v_mfma_f32_32x32x16_bf16 v[88:103], a[80:83], v[160:163], v[88:103]
    s_cmp_eq_u32 s69, 6
    s_cselect_b32 s86, 1376256, s86
    buffer_load_dwordx4 a[152:155], v27, s[24:27], s80 offen offset:3072 sc1
    ds_read_b64_tr_b16 a[120:121], v14 offset:28672
    ds_read_b64_tr_b16 a[122:123], v14 offset:30720
    v_mul_f32 v108, v108, v20
    v_mul_f32 v109, v109, v20
    v_mfma_f32_32x32x16_bf16 v[88:103], a[84:87], v[168:171], v[88:103]
    buffer_load_dwordx4 v8, s[4:7], s89 offen offset:2048 sc1 lds
    ds_read_b64_tr_b16 a[124:125], v14 offset:29184
    ds_read_b64_tr_b16 a[126:127], v14 offset:31232
    v_mul_f32 v110, v110, v20
    v_mul_f32 v111, v111, v20
    v_mfma_f32_32x32x16_bf16 v[88:103], a[88:91], v[176:179], v[88:103]
    buffer_load_dwordx4 a[156:159], v27, s[24:27], s80 offen offset:3328 sc1
    s_add_u32 s80, s80, 4096
    ds_read_b64_tr_b16 a[64:65], v15 offset:0
    ds_read_b64_tr_b16 a[66:67], v15 offset:2048
    v_cvt_pk_bf16_f32 v104, v104, v105
    v_cvt_pk_bf16_f32 v105, v106, v107
    v_mfma_f32_32x32x16_bf16 v[88:103], a[92:95], v[184:187], v[88:103]
    s_waitcnt lgkmcnt(10)
    ds_read_b64_tr_b16 a[68:69], v15 offset:512
    ds_read_b64_tr_b16 a[70:71], v15 offset:2560
    v_cvt_pk_bf16_f32 v106, v108, v109
    v_cvt_pk_bf16_f32 v107, v110, v111
    v_mfma_f32_32x32x16_bf16 v[88:103], a[96:99], v[192:195], v[88:103]
    ds_read_b64_tr_b16 a[72:73], v15 offset:4096
    ds_read_b64_tr_b16 a[74:75], v15 offset:6144
    buffer_store_dwordx4 v[104:107], v18, s[24:27], s37 offen offset:0 sc1
    v_mul_f32 v112, v112, v20
    v_mul_f32 v113, v113, v20
    v_mfma_f32_32x32x16_bf16 v[88:103], a[100:103], v[200:203], v[88:103]
    buffer_load_dwordx4 a[160:163], v27, s[24:27], s80 offen offset:0 sc1
    ds_read_b64_tr_b16 a[76:77], v15 offset:4608
    ds_read_b64_tr_b16 a[78:79], v15 offset:6656
    v_mul_f32 v114, v114, v20
    v_mul_f32 v115, v115, v20
    v_mfma_f32_32x32x16_bf16 v[88:103], a[104:107], v[208:211], v[88:103]
    buffer_load_dwordx4 v9, s[4:7], s89 offen offset:3072 sc1 lds
    ds_read_b64_tr_b16 a[80:81], v15 offset:8192
    ds_read_b64_tr_b16 a[82:83], v15 offset:10240
    v_mul_f32 v116, v116, v20
    v_mul_f32 v117, v117, v20
    v_mfma_f32_32x32x16_bf16 v[88:103], a[108:111], v[216:219], v[88:103]
    s_waitcnt lgkmcnt(10)
    ds_read_b64_tr_b16 a[84:85], v15 offset:8704
    ds_read_b64_tr_b16 a[86:87], v15 offset:10752
    v_mul_f32 v118, v118, v20
    v_mul_f32 v119, v119, v20
    v_mfma_f32_32x32x16_bf16 v[88:103], a[112:115], v[224:227], v[88:103]
    s_add_u32 s16, s16, 32768
    ds_read_b64_tr_b16 a[88:89], v15 offset:12288
    ds_read_b64_tr_b16 a[90:91], v15 offset:14336
    v_cvt_pk_bf16_f32 v108, v112, v113
    v_cvt_pk_bf16_f32 v109, v114, v115
    v_mfma_f32_32x32x16_bf16 v[88:103], a[116:119], v[232:235], v[88:103]
    s_add_u32 s36, s36, 4096
    ds_read_b64_tr_b16 a[92:93], v15 offset:12800
    ds_read_b64_tr_b16 a[94:95], v15 offset:14848
    v_cvt_pk_bf16_f32 v110, v116, v117
    v_cvt_pk_bf16_f32 v111, v118, v119
    v_mfma_f32_32x32x16_bf16 v[88:103], a[120:123], v[240:243], v[88:103]
    s_cmp_eq_u32 s16, s17
    s_cselect_b32 s16, s67, s16
    ds_read_b64_tr_b16 a[96:97], v15 offset:16384
    ds_read_b64_tr_b16 a[98:99], v15 offset:18432
    buffer_store_dwordx4 v[108:111], v18, s[24:27], s37 offen offset:128 sc1
    v_mfma_f32_32x32x16_bf16 v[88:103], a[124:127], v[248:251], v[88:103]
    s_waitcnt lgkmcnt(10)
    s_add_u32 s18, s18, s19
    ds_read_b64_tr_b16 a[100:101], v15 offset:16896
    ds_read_b64_tr_b16 a[102:103], v15 offset:18944
    v_mfma_f32_32x32x16_bf16 v[104:119], a[64:67], v[128:131], 0
    s_sub_u32 s6, s86, s87
    s_mov_b64 s[4:5], s[70:71]
    s_mov_b32 s18, 0
    s_mov_b32 s19, 229376
    buffer_load_dwordx4 a[164:167], v27, s[24:27], s80 offen offset:256 sc1
    ds_read_b64_tr_b16 a[104:105], v15 offset:20480
    ds_read_b64_tr_b16 a[106:107], v15 offset:22528
    v_mfma_f32_32x32x16_bf16 v[104:119], a[68:71], v[136:139], v[104:119]
    s_add_u32 s37, s36, 122880
    buffer_load_dwordx4 a[168:171], v27, s[24:27], s80 offen offset:1024 sc1
    ds_read_b64_tr_b16 a[108:109], v15 offset:20992
    ds_read_b64_tr_b16 a[110:111], v15 offset:23040
    v_mfma_f32_32x32x16_bf16 v[104:119], a[72:75], v[144:147], v[104:119]
    ds_read_b64_tr_b16 a[112:113], v15 offset:24576
    ds_read_b64_tr_b16 a[114:115], v15 offset:26624
    v_add_u32 v14, s22, v10
    v_mul_f32 v88, v88, v20
    v_mul_f32 v89, v89, v20
    v_mfma_f32_32x32x16_bf16 v[104:119], a[76:79], v[152:155], v[104:119]
    s_waitcnt lgkmcnt(10)
    ds_read_b64_tr_b16 a[116:117], v15 offset:25088
    ds_read_b64_tr_b16 a[118:119], v15 offset:27136
    v_mul_f32 v90, v90, v20
    v_mul_f32 v91, v91, v20
    v_mfma_f32_32x32x16_bf16 v[104:119], a[80:83], v[160:163], v[104:119]
    buffer_load_dwordx4 a[172:175], v27, s[24:27], s80 offen offset:1280 sc1
    ds_read_b64_tr_b16 a[120:121], v15 offset:28672
    ds_read_b64_tr_b16 a[122:123], v15 offset:30720
    v_mul_f32 v92, v92, v20
    v_mul_f32 v93, v93, v20
    v_mfma_f32_32x32x16_bf16 v[104:119], a[84:87], v[168:171], v[104:119]
    s_mov_b32 m0, s16
    ds_read_b64_tr_b16 a[124:125], v15 offset:29184
    ds_read_b64_tr_b16 a[126:127], v15 offset:31232
    v_mul_f32 v94, v94, v20
    v_mul_f32 v95, v95, v20
    v_mfma_f32_32x32x16_bf16 v[104:119], a[88:91], v[176:179], v[104:119]
    s_waitcnt vmcnt(43)
    s_barrier
    ds_read_b64_tr_b16 a[64:65], v14 offset:0
    ds_read_b64_tr_b16 a[66:67], v14 offset:2048
    v_cvt_pk_bf16_f32 v88, v88, v89
    v_cvt_pk_bf16_f32 v89, v90, v91
    v_mfma_f32_32x32x16_bf16 v[104:119], a[92:95], v[184:187], v[104:119]
    s_waitcnt lgkmcnt(10)
    ds_read_b64_tr_b16 a[68:69], v14 offset:512
    ds_read_b64_tr_b16 a[70:71], v14 offset:2560
    v_cvt_pk_bf16_f32 v90, v92, v93
    v_cvt_pk_bf16_f32 v91, v94, v95
    v_mfma_f32_32x32x16_bf16 v[104:119], a[96:99], v[192:195], v[104:119]
    ds_read_b64_tr_b16 a[72:73], v14 offset:4096
    ds_read_b64_tr_b16 a[74:75], v14 offset:6144
    buffer_store_dwordx4 v[88:91], v18, s[24:27], s36 offen offset:0 sc1
    v_mul_f32 v96, v96, v20
    v_mul_f32 v97, v97, v20
    v_mfma_f32_32x32x16_bf16 v[104:119], a[100:103], v[200:203], v[104:119]
    buffer_load_dwordx4 v6, s[4:7], s18 offen offset:0 sc1 lds
    ds_read_b64_tr_b16 a[76:77], v14 offset:4608
    ds_read_b64_tr_b16 a[78:79], v14 offset:6656
    v_mul_f32 v98, v98, v20
    v_mul_f32 v99, v99, v20
    v_mfma_f32_32x32x16_bf16 v[104:119], a[104:107], v[208:211], v[104:119]
    buffer_load_dwordx4 v7, s[4:7], s18 offen offset:1024 sc1 lds
    ds_read_b64_tr_b16 a[80:81], v14 offset:8192
    ds_read_b64_tr_b16 a[82:83], v14 offset:10240
    v_mul_f32 v100, v100, v20
    v_mul_f32 v101, v101, v20
    v_mfma_f32_32x32x16_bf16 v[104:119], a[108:111], v[216:219], v[104:119]
    s_waitcnt lgkmcnt(10)
    ds_read_b64_tr_b16 a[84:85], v14 offset:8704
    ds_read_b64_tr_b16 a[86:87], v14 offset:10752
    v_mul_f32 v102, v102, v20
    v_mul_f32 v103, v103, v20
    v_mfma_f32_32x32x16_bf16 v[104:119], a[112:115], v[224:227], v[104:119]
    buffer_load_dwordx4 v8, s[4:7], s18 offen offset:2048 sc1 lds
    ds_read_b64_tr_b16 a[88:89], v14 offset:12288
    ds_read_b64_tr_b16 a[90:91], v14 offset:14336
    v_cvt_pk_bf16_f32 v92, v96, v97
    v_cvt_pk_bf16_f32 v93, v98, v99
    v_mfma_f32_32x32x16_bf16 v[104:119], a[116:119], v[232:235], v[104:119]
    buffer_load_dwordx4 v9, s[4:7], s18 offen offset:3072 sc1 lds
    ds_read_b64_tr_b16 a[92:93], v14 offset:12800
    ds_read_b64_tr_b16 a[94:95], v14 offset:14848
    v_cvt_pk_bf16_f32 v94, v100, v101
    v_cvt_pk_bf16_f32 v95, v102, v103
    v_mfma_f32_32x32x16_bf16 v[104:119], a[120:123], v[240:243], v[104:119]
    s_add_u32 m0, s16, 16384
    ds_read_b64_tr_b16 a[96:97], v14 offset:16384
    ds_read_b64_tr_b16 a[98:99], v14 offset:18432
    buffer_store_dwordx4 v[92:95], v18, s[24:27], s36 offen offset:128 sc1
    v_mfma_f32_32x32x16_bf16 v[104:119], a[124:127], v[248:251], v[104:119]
    s_add_u32 s89, s18, s20
    ds_read_b64_tr_b16 a[100:101], v14 offset:16896
    ds_read_b64_tr_b16 a[102:103], v14 offset:18944
    v_add_u32 v15, s22, v11
    s_waitcnt lgkmcnt(12)
    v_mfma_f32_32x32x16_bf16 v[88:103], a[64:67], v[128:131], 0
    s_add_u32 s22, s22, 32768
    buffer_load_dwordx4 v6, s[4:7], s89 offen offset:0 sc1 lds
    ds_read_b64_tr_b16 a[104:105], v14 offset:20480
    ds_read_b64_tr_b16 a[106:107], v14 offset:22528
    v_mfma_f32_32x32x16_bf16 v[88:103], a[68:71], v[136:139], v[88:103]
    s_cmp_eq_u32 s22, 163840
    s_cselect_b32 s22, 0, s22
    buffer_load_dwordx4 v7, s[4:7], s89 offen offset:1024 sc1 lds
    ds_read_b64_tr_b16 a[108:109], v14 offset:20992
    ds_read_b64_tr_b16 a[110:111], v14 offset:23040
    v_mfma_f32_32x32x16_bf16 v[88:103], a[72:75], v[144:147], v[88:103]
    buffer_load_dwordx4 a[176:179], v27, s[24:27], s80 offen offset:2048 sc1
    ds_read_b64_tr_b16 a[112:113], v14 offset:24576
    ds_read_b64_tr_b16 a[114:115], v14 offset:26624
    v_mul_f32 v104, v104, v20
    v_mul_f32 v105, v105, v20
    v_mfma_f32_32x32x16_bf16 v[88:103], a[76:79], v[152:155], v[88:103]
    s_waitcnt lgkmcnt(10)
    ds_read_b64_tr_b16 a[116:117], v14 offset:25088
    ds_read_b64_tr_b16 a[118:119], v14 offset:27136
    v_mul_f32 v106, v106, v20
    v_mul_f32 v107, v107, v20
    v_mfma_f32_32x32x16_bf16 v[88:103], a[80:83], v[160:163], v[88:103]
    buffer_load_dwordx4 a[180:183], v27, s[24:27], s80 offen offset:2304 sc1
    ds_read_b64_tr_b16 a[120:121], v14 offset:28672
    ds_read_b64_tr_b16 a[122:123], v14 offset:30720
    v_mul_f32 v108, v108, v20
    v_mul_f32 v109, v109, v20
    v_mfma_f32_32x32x16_bf16 v[88:103], a[84:87], v[168:171], v[88:103]
    buffer_load_dwordx4 v8, s[4:7], s89 offen offset:2048 sc1 lds
    ds_read_b64_tr_b16 a[124:125], v14 offset:29184
    ds_read_b64_tr_b16 a[126:127], v14 offset:31232
    v_mul_f32 v110, v110, v20
    v_mul_f32 v111, v111, v20
    v_mfma_f32_32x32x16_bf16 v[88:103], a[88:91], v[176:179], v[88:103]
    buffer_load_dwordx4 a[184:187], v27, s[24:27], s80 offen offset:3072 sc1
    ds_read_b64_tr_b16 a[64:65], v15 offset:0
    ds_read_b64_tr_b16 a[66:67], v15 offset:2048
    v_cvt_pk_bf16_f32 v104, v104, v105
    v_cvt_pk_bf16_f32 v105, v106, v107
    v_mfma_f32_32x32x16_bf16 v[88:103], a[92:95], v[184:187], v[88:103]
    s_waitcnt lgkmcnt(10)
    ds_read_b64_tr_b16 a[68:69], v15 offset:512
    ds_read_b64_tr_b16 a[70:71], v15 offset:2560
    v_cvt_pk_bf16_f32 v106, v108, v109
    v_cvt_pk_bf16_f32 v107, v110, v111
    v_mfma_f32_32x32x16_bf16 v[88:103], a[96:99], v[192:195], v[88:103]
    ds_read_b64_tr_b16 a[72:73], v15 offset:4096
    ds_read_b64_tr_b16 a[74:75], v15 offset:6144
    buffer_store_dwordx4 v[104:107], v18, s[24:27], s37 offen offset:0 sc1
    v_mul_f32 v112, v112, v20
    v_mul_f32 v113, v113, v20
    v_mfma_f32_32x32x16_bf16 v[88:103], a[100:103], v[200:203], v[88:103]
    buffer_load_dwordx4 a[188:191], v27, s[24:27], s80 offen offset:3328 sc1
    s_add_u32 s80, s80, 4096
    ds_read_b64_tr_b16 a[76:77], v15 offset:4608
    ds_read_b64_tr_b16 a[78:79], v15 offset:6656
    v_mul_f32 v114, v114, v20
    v_mul_f32 v115, v115, v20
    v_mfma_f32_32x32x16_bf16 v[88:103], a[104:107], v[208:211], v[88:103]
    buffer_load_dwordx4 v9, s[4:7], s89 offen offset:3072 sc1 lds
    ds_read_b64_tr_b16 a[80:81], v15 offset:8192
    ds_read_b64_tr_b16 a[82:83], v15 offset:10240
    v_mul_f32 v116, v116, v20
    v_mul_f32 v117, v117, v20
    v_mfma_f32_32x32x16_bf16 v[88:103], a[108:111], v[216:219], v[88:103]
    s_waitcnt lgkmcnt(10)
    ds_read_b64_tr_b16 a[84:85], v15 offset:8704
    ds_read_b64_tr_b16 a[86:87], v15 offset:10752
    v_mul_f32 v118, v118, v20
    v_mul_f32 v119, v119, v20
    v_mfma_f32_32x32x16_bf16 v[88:103], a[112:115], v[224:227], v[88:103]
    s_add_u32 s16, s16, 32768
    ds_read_b64_tr_b16 a[88:89], v15 offset:12288
    ds_read_b64_tr_b16 a[90:91], v15 offset:14336
    v_cvt_pk_bf16_f32 v108, v112, v113
    v_cvt_pk_bf16_f32 v109, v114, v115
    v_mfma_f32_32x32x16_bf16 v[88:103], a[116:119], v[232:235], v[88:103]
    s_add_u32 s36, s36, 4096
    ds_read_b64_tr_b16 a[92:93], v15 offset:12800
    ds_read_b64_tr_b16 a[94:95], v15 offset:14848
    v_cvt_pk_bf16_f32 v110, v116, v117
    v_cvt_pk_bf16_f32 v111, v118, v119
    v_mfma_f32_32x32x16_bf16 v[88:103], a[120:123], v[240:243], v[88:103]
    s_cmp_eq_u32 s16, s17
    s_cselect_b32 s16, s67, s16
    ds_read_b64_tr_b16 a[96:97], v15 offset:16384
    ds_read_b64_tr_b16 a[98:99], v15 offset:18432
    buffer_store_dwordx4 v[108:111], v18, s[24:27], s37 offen offset:128 sc1
    v_mfma_f32_32x32x16_bf16 v[88:103], a[124:127], v[248:251], v[88:103]
    s_waitcnt lgkmcnt(10)
    s_add_u32 s18, s18, s19
    ds_read_b64_tr_b16 a[100:101], v15 offset:16896
    ds_read_b64_tr_b16 a[102:103], v15 offset:18944
    v_mfma_f32_32x32x16_bf16 v[104:119], a[64:67], v[128:131], 0
    s_add_u32 s37, s36, 122880
    buffer_load_dwordx4 a[192:195], v27, s[24:27], s80 offen offset:0 sc1
    ds_read_b64_tr_b16 a[104:105], v15 offset:20480
    ds_read_b64_tr_b16 a[106:107], v15 offset:22528
    v_mfma_f32_32x32x16_bf16 v[104:119], a[68:71], v[136:139], v[104:119]
    buffer_load_dwordx4 a[196:199], v27, s[24:27], s80 offen offset:256 sc1
    ds_read_b64_tr_b16 a[108:109], v15 offset:20992
    ds_read_b64_tr_b16 a[110:111], v15 offset:23040
    v_mfma_f32_32x32x16_bf16 v[104:119], a[72:75], v[144:147], v[104:119]
    ds_read_b64_tr_b16 a[112:113], v15 offset:24576
    ds_read_b64_tr_b16 a[114:115], v15 offset:26624
    v_add_u32 v14, s22, v10
    v_mul_f32 v88, v88, v20
    v_mul_f32 v89, v89, v20
    v_mfma_f32_32x32x16_bf16 v[104:119], a[76:79], v[152:155], v[104:119]
    s_waitcnt lgkmcnt(10)
    ds_read_b64_tr_b16 a[116:117], v15 offset:25088
    ds_read_b64_tr_b16 a[118:119], v15 offset:27136
    v_mul_f32 v90, v90, v20
    v_mul_f32 v91, v91, v20
    v_mfma_f32_32x32x16_bf16 v[104:119], a[80:83], v[160:163], v[104:119]
    buffer_load_dwordx4 a[200:203], v27, s[24:27], s80 offen offset:1024 sc1
    ds_read_b64_tr_b16 a[120:121], v15 offset:28672
    ds_read_b64_tr_b16 a[122:123], v15 offset:30720
    v_mul_f32 v92, v92, v20
    v_mul_f32 v93, v93, v20
    v_mfma_f32_32x32x16_bf16 v[104:119], a[84:87], v[168:171], v[104:119]
    s_mov_b32 m0, s16
    ds_read_b64_tr_b16 a[124:125], v15 offset:29184
    ds_read_b64_tr_b16 a[126:127], v15 offset:31232
    v_mul_f32 v94, v94, v20
    v_mul_f32 v95, v95, v20
    v_mfma_f32_32x32x16_bf16 v[104:119], a[88:91], v[176:179], v[104:119]
    s_waitcnt vmcnt(42)
    s_barrier
    ds_read_b64_tr_b16 a[64:65], v14 offset:0
    ds_read_b64_tr_b16 a[66:67], v14 offset:2048
    v_cvt_pk_bf16_f32 v88, v88, v89
    v_cvt_pk_bf16_f32 v89, v90, v91
    v_mfma_f32_32x32x16_bf16 v[104:119], a[92:95], v[184:187], v[104:119]
    s_waitcnt lgkmcnt(10)
    ds_read_b64_tr_b16 a[68:69], v14 offset:512
    ds_read_b64_tr_b16 a[70:71], v14 offset:2560
    v_cvt_pk_bf16_f32 v90, v92, v93
    v_cvt_pk_bf16_f32 v91, v94, v95
    v_mfma_f32_32x32x16_bf16 v[104:119], a[96:99], v[192:195], v[104:119]
    ds_read_b64_tr_b16 a[72:73], v14 offset:4096
    ds_read_b64_tr_b16 a[74:75], v14 offset:6144
    buffer_store_dwordx4 v[88:91], v18, s[24:27], s36 offen offset:0 sc1
    v_mul_f32 v96, v96, v20
    v_mul_f32 v97, v97, v20
    v_mfma_f32_32x32x16_bf16 v[104:119], a[100:103], v[200:203], v[104:119]
    buffer_load_dwordx4 v6, s[4:7], s18 offen offset:0 sc1 lds
    ds_read_b64_tr_b16 a[76:77], v14 offset:4608
    ds_read_b64_tr_b16 a[78:79], v14 offset:6656
    v_mul_f32 v98, v98, v20
    v_mul_f32 v99, v99, v20
    v_mfma_f32_32x32x16_bf16 v[104:119], a[104:107], v[208:211], v[104:119]
    buffer_load_dwordx4 v7, s[4:7], s18 offen offset:1024 sc1 lds
    ds_read_b64_tr_b16 a[80:81], v14 offset:8192
    ds_read_b64_tr_b16 a[82:83], v14 offset:10240
    v_mul_f32 v100, v100, v20
    v_mul_f32 v101, v101, v20
    v_mfma_f32_32x32x16_bf16 v[104:119], a[108:111], v[216:219], v[104:119]
    s_waitcnt lgkmcnt(10)
    ds_read_b64_tr_b16 a[84:85], v14 offset:8704
    ds_read_b64_tr_b16 a[86:87], v14 offset:10752
    v_mul_f32 v102, v102, v20
    v_mul_f32 v103, v103, v20
    v_mfma_f32_32x32x16_bf16 v[104:119], a[112:115], v[224:227], v[104:119]
    buffer_load_dwordx4 v8, s[4:7], s18 offen offset:2048 sc1 lds
    ds_read_b64_tr_b16 a[88:89], v14 offset:12288
    ds_read_b64_tr_b16 a[90:91], v14 offset:14336
    v_cvt_pk_bf16_f32 v92, v96, v97
    v_cvt_pk_bf16_f32 v93, v98, v99
    v_mfma_f32_32x32x16_bf16 v[104:119], a[116:119], v[232:235], v[104:119]
    buffer_load_dwordx4 v9, s[4:7], s18 offen offset:3072 sc1 lds
    ds_read_b64_tr_b16 a[92:93], v14 offset:12800
    ds_read_b64_tr_b16 a[94:95], v14 offset:14848
    v_cvt_pk_bf16_f32 v94, v100, v101
    v_cvt_pk_bf16_f32 v95, v102, v103
    v_mfma_f32_32x32x16_bf16 v[104:119], a[120:123], v[240:243], v[104:119]
    s_add_u32 m0, s16, 16384
    ds_read_b64_tr_b16 a[96:97], v14 offset:16384
    ds_read_b64_tr_b16 a[98:99], v14 offset:18432
    buffer_store_dwordx4 v[92:95], v18, s[24:27], s36 offen offset:128 sc1
    v_mfma_f32_32x32x16_bf16 v[104:119], a[124:127], v[248:251], v[104:119]
    s_add_u32 s89, s18, s20
    ds_read_b64_tr_b16 a[100:101], v14 offset:16896
    ds_read_b64_tr_b16 a[102:103], v14 offset:18944
    v_add_u32 v15, s22, v11
    s_waitcnt lgkmcnt(12)
    v_mfma_f32_32x32x16_bf16 v[88:103], a[64:67], v[128:131], 0
    s_add_u32 s22, s22, 32768
    buffer_load_dwordx4 v6, s[4:7], s89 offen offset:0 sc1 lds
    ds_read_b64_tr_b16 a[104:105], v14 offset:20480
    ds_read_b64_tr_b16 a[106:107], v14 offset:22528
    v_mfma_f32_32x32x16_bf16 v[88:103], a[68:71], v[136:139], v[88:103]
    s_cmp_eq_u32 s22, 163840
    s_cselect_b32 s22, 0, s22
    buffer_load_dwordx4 v7, s[4:7], s89 offen offset:1024 sc1 lds
    ds_read_b64_tr_b16 a[108:109], v14 offset:20992
    ds_read_b64_tr_b16 a[110:111], v14 offset:23040
    v_mfma_f32_32x32x16_bf16 v[88:103], a[72:75], v[144:147], v[88:103]
    buffer_load_dwordx4 a[204:207], v27, s[24:27], s80 offen offset:1280 sc1
    ds_read_b64_tr_b16 a[112:113], v14 offset:24576
    ds_read_b64_tr_b16 a[114:115], v14 offset:26624
    v_mul_f32 v104, v104, v20
    v_mul_f32 v105, v105, v20
    v_mfma_f32_32x32x16_bf16 v[88:103], a[76:79], v[152:155], v[88:103]
    s_waitcnt lgkmcnt(10)
    ds_read_b64_tr_b16 a[116:117], v14 offset:25088
    ds_read_b64_tr_b16 a[118:119], v14 offset:27136
    v_mul_f32 v106, v106, v20
    v_mul_f32 v107, v107, v20
    v_mfma_f32_32x32x16_bf16 v[88:103], a[80:83], v[160:163], v[88:103]
    buffer_load_dwordx4 a[208:211], v27, s[24:27], s80 offen offset:2048 sc1
    ds_read_b64_tr_b16 a[120:121], v14 offset:28672
    ds_read_b64_tr_b16 a[122:123], v14 offset:30720
    v_mul_f32 v108, v108, v20
    v_mul_f32 v109, v109, v20
    v_mfma_f32_32x32x16_bf16 v[88:103], a[84:87], v[168:171], v[88:103]
    buffer_load_dwordx4 v8, s[4:7], s89 offen offset:2048 sc1 lds
    ds_read_b64_tr_b16 a[124:125], v14 offset:29184
    ds_read_b64_tr_b16 a[126:127], v14 offset:31232
    v_mul_f32 v110, v110, v20
    v_mul_f32 v111, v111, v20
    v_mfma_f32_32x32x16_bf16 v[88:103], a[88:91], v[176:179], v[88:103]
    buffer_load_dwordx4 a[212:215], v27, s[24:27], s80 offen offset:2304 sc1
    ds_read_b64_tr_b16 a[64:65], v15 offset:0
    ds_read_b64_tr_b16 a[66:67], v15 offset:2048
    v_cvt_pk_bf16_f32 v104, v104, v105
    v_cvt_pk_bf16_f32 v105, v106, v107
    v_mfma_f32_32x32x16_bf16 v[88:103], a[92:95], v[184:187], v[88:103]
    s_waitcnt lgkmcnt(10)
    ds_read_b64_tr_b16 a[68:69], v15 offset:512
    ds_read_b64_tr_b16 a[70:71], v15 offset:2560
    v_cvt_pk_bf16_f32 v106, v108, v109
    v_cvt_pk_bf16_f32 v107, v110, v111
    v_mfma_f32_32x32x16_bf16 v[88:103], a[96:99], v[192:195], v[88:103]
    ds_read_b64_tr_b16 a[72:73], v15 offset:4096
    ds_read_b64_tr_b16 a[74:75], v15 offset:6144
    buffer_store_dwordx4 v[104:107], v18, s[24:27], s37 offen offset:0 sc1
    v_mul_f32 v112, v112, v20
    v_mul_f32 v113, v113, v20
    v_mfma_f32_32x32x16_bf16 v[88:103], a[100:103], v[200:203], v[88:103]
    buffer_load_dwordx4 a[216:219], v27, s[24:27], s80 offen offset:3072 sc1
    ds_read_b64_tr_b16 a[76:77], v15 offset:4608
    ds_read_b64_tr_b16 a[78:79], v15 offset:6656
    v_mul_f32 v114, v114, v20
    v_mul_f32 v115, v115, v20
    v_mfma_f32_32x32x16_bf16 v[88:103], a[104:107], v[208:211], v[88:103]
    buffer_load_dwordx4 v9, s[4:7], s89 offen offset:3072 sc1 lds
    ds_read_b64_tr_b16 a[80:81], v15 offset:8192
    ds_read_b64_tr_b16 a[82:83], v15 offset:10240
    v_mul_f32 v116, v116, v20
    v_mul_f32 v117, v117, v20
    v_mfma_f32_32x32x16_bf16 v[88:103], a[108:111], v[216:219], v[88:103]
    s_waitcnt lgkmcnt(10)
    ds_read_b64_tr_b16 a[84:85], v15 offset:8704
    ds_read_b64_tr_b16 a[86:87], v15 offset:10752
    v_mul_f32 v118, v118, v20
    v_mul_f32 v119, v119, v20
    v_mfma_f32_32x32x16_bf16 v[88:103], a[112:115], v[224:227], v[88:103]
    s_add_u32 s16, s16, 32768
    ds_read_b64_tr_b16 a[88:89], v15 offset:12288
    ds_read_b64_tr_b16 a[90:91], v15 offset:14336
    v_cvt_pk_bf16_f32 v108, v112, v113
    v_cvt_pk_bf16_f32 v109, v114, v115
    v_mfma_f32_32x32x16_bf16 v[88:103], a[116:119], v[232:235], v[88:103]
    s_add_u32 s36, s36, 4096
    ds_read_b64_tr_b16 a[92:93], v15 offset:12800
    ds_read_b64_tr_b16 a[94:95], v15 offset:14848
    v_cvt_pk_bf16_f32 v110, v116, v117
    v_cvt_pk_bf16_f32 v111, v118, v119
    v_mfma_f32_32x32x16_bf16 v[88:103], a[120:123], v[240:243], v[88:103]
    s_cmp_eq_u32 s16, s17
    s_cselect_b32 s16, s67, s16
    ds_read_b64_tr_b16 a[96:97], v15 offset:16384
    ds_read_b64_tr_b16 a[98:99], v15 offset:18432
    buffer_store_dwordx4 v[108:111], v18, s[24:27], s37 offen offset:128 sc1
    v_mfma_f32_32x32x16_bf16 v[88:103], a[124:127], v[248:251], v[88:103]
    s_waitcnt lgkmcnt(10)
    s_add_u32 s18, s18, s19
    ds_read_b64_tr_b16 a[100:101], v15 offset:16896
    ds_read_b64_tr_b16 a[102:103], v15 offset:18944
    v_mfma_f32_32x32x16_bf16 v[104:119], a[64:67], v[128:131], 0
    s_add_u32 s37, s36, 122880
    buffer_load_dwordx4 a[220:223], v27, s[24:27], s80 offen offset:3328 sc1
    s_add_u32 s80, s80, 4096
    ds_read_b64_tr_b16 a[104:105], v15 offset:20480
    ds_read_b64_tr_b16 a[106:107], v15 offset:22528
    v_mfma_f32_32x32x16_bf16 v[104:119], a[68:71], v[136:139], v[104:119]
    buffer_load_dwordx4 a[224:227], v27, s[24:27], s80 offen offset:0 sc1
    ds_read_b64_tr_b16 a[108:109], v15 offset:20992
    ds_read_b64_tr_b16 a[110:111], v15 offset:23040
    v_mfma_f32_32x32x16_bf16 v[104:119], a[72:75], v[144:147], v[104:119]
    ds_read_b64_tr_b16 a[112:113], v15 offset:24576
    ds_read_b64_tr_b16 a[114:115], v15 offset:26624
    v_add_u32 v14, s22, v10
    v_mul_f32 v88, v88, v20
    v_mul_f32 v89, v89, v20
    v_mfma_f32_32x32x16_bf16 v[104:119], a[76:79], v[152:155], v[104:119]
    s_waitcnt lgkmcnt(10)
    ds_read_b64_tr_b16 a[116:117], v15 offset:25088
    ds_read_b64_tr_b16 a[118:119], v15 offset:27136
    v_mul_f32 v90, v90, v20
    v_mul_f32 v91, v91, v20
    v_mfma_f32_32x32x16_bf16 v[104:119], a[80:83], v[160:163], v[104:119]
    buffer_load_dwordx4 a[228:231], v27, s[24:27], s80 offen offset:256 sc1
    ds_read_b64_tr_b16 a[120:121], v15 offset:28672
    ds_read_b64_tr_b16 a[122:123], v15 offset:30720
    v_mul_f32 v92, v92, v20
    v_mul_f32 v93, v93, v20
    v_mfma_f32_32x32x16_bf16 v[104:119], a[84:87], v[168:171], v[104:119]
    s_mov_b32 m0, s16
    ds_read_b64_tr_b16 a[124:125], v15 offset:29184
    ds_read_b64_tr_b16 a[126:127], v15 offset:31232
    v_mul_f32 v94, v94, v20
    v_mul_f32 v95, v95, v20
    v_mfma_f32_32x32x16_bf16 v[104:119], a[88:91], v[176:179], v[104:119]
    s_waitcnt vmcnt(42)
    s_barrier
    ds_read_b64_tr_b16 a[64:65], v14 offset:0
    ds_read_b64_tr_b16 a[66:67], v14 offset:2048
    v_cvt_pk_bf16_f32 v88, v88, v89
    v_cvt_pk_bf16_f32 v89, v90, v91
    v_mfma_f32_32x32x16_bf16 v[104:119], a[92:95], v[184:187], v[104:119]
    s_waitcnt lgkmcnt(10)
    ds_read_b64_tr_b16 a[68:69], v14 offset:512
    ds_read_b64_tr_b16 a[70:71], v14 offset:2560
    v_cvt_pk_bf16_f32 v90, v92, v93
    v_cvt_pk_bf16_f32 v91, v94, v95
    v_mfma_f32_32x32x16_bf16 v[104:119], a[96:99], v[192:195], v[104:119]
    ds_read_b64_tr_b16 a[72:73], v14 offset:4096
    ds_read_b64_tr_b16 a[74:75], v14 offset:6144
    buffer_store_dwordx4 v[88:91], v18, s[24:27], s36 offen offset:0 sc1
    v_mul_f32 v96, v96, v20
    v_mul_f32 v97, v97, v20
    v_mfma_f32_32x32x16_bf16 v[104:119], a[100:103], v[200:203], v[104:119]
    buffer_load_dwordx4 v6, s[4:7], s18 offen offset:0 sc1 lds
    ds_read_b64_tr_b16 a[76:77], v14 offset:4608
    ds_read_b64_tr_b16 a[78:79], v14 offset:6656
    v_mul_f32 v98, v98, v20
    v_mul_f32 v99, v99, v20
    v_mfma_f32_32x32x16_bf16 v[104:119], a[104:107], v[208:211], v[104:119]
    buffer_load_dwordx4 v7, s[4:7], s18 offen offset:1024 sc1 lds
    ds_read_b64_tr_b16 a[80:81], v14 offset:8192
    ds_read_b64_tr_b16 a[82:83], v14 offset:10240
    v_mul_f32 v100, v100, v20
    v_mul_f32 v101, v101, v20
    v_mfma_f32_32x32x16_bf16 v[104:119], a[108:111], v[216:219], v[104:119]
    s_waitcnt lgkmcnt(10)
    ds_read_b64_tr_b16 a[84:85], v14 offset:8704
    ds_read_b64_tr_b16 a[86:87], v14 offset:10752
    v_mul_f32 v102, v102, v20
    v_mul_f32 v103, v103, v20
    v_mfma_f32_32x32x16_bf16 v[104:119], a[112:115], v[224:227], v[104:119]
    buffer_load_dwordx4 v8, s[4:7], s18 offen offset:2048 sc1 lds
    ds_read_b64_tr_b16 a[88:89], v14 offset:12288
    ds_read_b64_tr_b16 a[90:91], v14 offset:14336
    v_cvt_pk_bf16_f32 v92, v96, v97
    v_cvt_pk_bf16_f32 v93, v98, v99
    v_mfma_f32_32x32x16_bf16 v[104:119], a[116:119], v[232:235], v[104:119]
    buffer_load_dwordx4 v9, s[4:7], s18 offen offset:3072 sc1 lds
    ds_read_b64_tr_b16 a[92:93], v14 offset:12800
    ds_read_b64_tr_b16 a[94:95], v14 offset:14848
    v_cvt_pk_bf16_f32 v94, v100, v101
    v_cvt_pk_bf16_f32 v95, v102, v103
    v_mfma_f32_32x32x16_bf16 v[104:119], a[120:123], v[240:243], v[104:119]
    s_add_u32 m0, s16, 16384
    ds_read_b64_tr_b16 a[96:97], v14 offset:16384
    ds_read_b64_tr_b16 a[98:99], v14 offset:18432
    buffer_store_dwordx4 v[92:95], v18, s[24:27], s36 offen offset:128 sc1
    v_mfma_f32_32x32x16_bf16 v[104:119], a[124:127], v[248:251], v[104:119]
    s_add_u32 s89, s18, s20
    ds_read_b64_tr_b16 a[100:101], v14 offset:16896
    ds_read_b64_tr_b16 a[102:103], v14 offset:18944
    v_add_u32 v15, s22, v11
    s_waitcnt lgkmcnt(12)
    v_mfma_f32_32x32x16_bf16 v[88:103], a[64:67], v[128:131], 0
    s_add_u32 s22, s22, 32768
    s_mov_b32 s73, s79
    buffer_load_dwordx4 v6, s[4:7], s89 offen offset:0 sc1 lds
    ds_read_b64_tr_b16 a[104:105], v14 offset:20480
    ds_read_b64_tr_b16 a[106:107], v14 offset:22528
    v_mfma_f32_32x32x16_bf16 v[88:103], a[68:71], v[136:139], v[88:103]
    s_cmp_eq_u32 s22, 163840
    s_cselect_b32 s22, 0, s22
    buffer_load_dwordx4 v7, s[4:7], s89 offen offset:1024 sc1 lds
    ds_read_b64_tr_b16 a[108:109], v14 offset:20992
    ds_read_b64_tr_b16 a[110:111], v14 offset:23040
    v_mfma_f32_32x32x16_bf16 v[88:103], a[72:75], v[144:147], v[88:103]
    buffer_load_dwordx4 a[232:235], v27, s[24:27], s80 offen offset:1024 sc1
    ds_read_b64_tr_b16 a[112:113], v14 offset:24576
    ds_read_b64_tr_b16 a[114:115], v14 offset:26624
    v_mul_f32 v104, v104, v20
    v_mul_f32 v105, v105, v20
    v_mfma_f32_32x32x16_bf16 v[88:103], a[76:79], v[152:155], v[88:103]
    s_waitcnt lgkmcnt(10)
    ds_read_b64_tr_b16 a[116:117], v14 offset:25088
    ds_read_b64_tr_b16 a[118:119], v14 offset:27136
    v_mul_f32 v106, v106, v20
    v_mul_f32 v107, v107, v20
    v_mfma_f32_32x32x16_bf16 v[88:103], a[80:83], v[160:163], v[88:103]
    buffer_load_dwordx4 a[236:239], v27, s[24:27], s80 offen offset:1280 sc1
    ds_read_b64_tr_b16 a[120:121], v14 offset:28672
    ds_read_b64_tr_b16 a[122:123], v14 offset:30720
    v_mul_f32 v108, v108, v20
    v_mul_f32 v109, v109, v20
    v_mfma_f32_32x32x16_bf16 v[88:103], a[84:87], v[168:171], v[88:103]
    buffer_load_dwordx4 v8, s[4:7], s89 offen offset:2048 sc1 lds
    ds_read_b64_tr_b16 a[124:125], v14 offset:29184
    ds_read_b64_tr_b16 a[126:127], v14 offset:31232
    v_mul_f32 v110, v110, v20
    v_mul_f32 v111, v111, v20
    v_mfma_f32_32x32x16_bf16 v[88:103], a[88:91], v[176:179], v[88:103]
    buffer_load_dwordx4 a[240:243], v27, s[24:27], s80 offen offset:2048 sc1
    ds_read_b64_tr_b16 a[64:65], v15 offset:0
    ds_read_b64_tr_b16 a[66:67], v15 offset:2048
    v_cvt_pk_bf16_f32 v104, v104, v105
    v_cvt_pk_bf16_f32 v105, v106, v107
    v_mfma_f32_32x32x16_bf16 v[88:103], a[92:95], v[184:187], v[88:103]
    s_waitcnt lgkmcnt(10)
    ds_read_b64_tr_b16 a[68:69], v15 offset:512
    ds_read_b64_tr_b16 a[70:71], v15 offset:2560
    v_cvt_pk_bf16_f32 v106, v108, v109
    v_cvt_pk_bf16_f32 v107, v110, v111
    v_mfma_f32_32x32x16_bf16 v[88:103], a[96:99], v[192:195], v[88:103]
    ds_read_b64_tr_b16 a[72:73], v15 offset:4096
    ds_read_b64_tr_b16 a[74:75], v15 offset:6144
    buffer_store_dwordx4 v[104:107], v18, s[24:27], s37 offen offset:0 sc1
    v_mul_f32 v112, v112, v20
    v_mul_f32 v113, v113, v20
    v_mfma_f32_32x32x16_bf16 v[88:103], a[100:103], v[200:203], v[88:103]
    buffer_load_dwordx4 a[244:247], v27, s[24:27], s80 offen offset:2304 sc1
    ds_read_b64_tr_b16 a[76:77], v15 offset:4608
    ds_read_b64_tr_b16 a[78:79], v15 offset:6656
    v_mul_f32 v114, v114, v20
    v_mul_f32 v115, v115, v20
    v_mfma_f32_32x32x16_bf16 v[88:103], a[104:107], v[208:211], v[88:103]
    buffer_load_dwordx4 v9, s[4:7], s89 offen offset:3072 sc1 lds
    ds_read_b64_tr_b16 a[80:81], v15 offset:8192
    ds_read_b64_tr_b16 a[82:83], v15 offset:10240
    v_mul_f32 v116, v116, v20
    v_mul_f32 v117, v117, v20
    v_mfma_f32_32x32x16_bf16 v[88:103], a[108:111], v[216:219], v[88:103]
    s_waitcnt lgkmcnt(10)
    ds_read_b64_tr_b16 a[84:85], v15 offset:8704
    ds_read_b64_tr_b16 a[86:87], v15 offset:10752
    v_mul_f32 v118, v118, v20
    v_mul_f32 v119, v119, v20
    v_mfma_f32_32x32x16_bf16 v[88:103], a[112:115], v[224:227], v[88:103]
    s_add_u32 s16, s16, 32768
    ds_read_b64_tr_b16 a[88:89], v15 offset:12288
    ds_read_b64_tr_b16 a[90:91], v15 offset:14336
    v_cvt_pk_bf16_f32 v108, v112, v113
    v_cvt_pk_bf16_f32 v109, v114, v115
    v_mfma_f32_32x32x16_bf16 v[88:103], a[116:119], v[232:235], v[88:103]
    s_add_u32 s36, s36, 4096
    ds_read_b64_tr_b16 a[92:93], v15 offset:12800
    ds_read_b64_tr_b16 a[94:95], v15 offset:14848
    v_cvt_pk_bf16_f32 v110, v116, v117
    v_cvt_pk_bf16_f32 v111, v118, v119
    v_mfma_f32_32x32x16_bf16 v[88:103], a[120:123], v[240:243], v[88:103]
    s_cmp_eq_u32 s16, s17
    s_cselect_b32 s16, s67, s16
    ds_read_b64_tr_b16 a[96:97], v15 offset:16384
    ds_read_b64_tr_b16 a[98:99], v15 offset:18432
    buffer_store_dwordx4 v[108:111], v18, s[24:27], s37 offen offset:128 sc1
    v_mfma_f32_32x32x16_bf16 v[88:103], a[124:127], v[248:251], v[88:103]
    s_waitcnt lgkmcnt(10)
    s_add_u32 s18, s18, s19
    ds_read_b64_tr_b16 a[100:101], v15 offset:16896
    ds_read_b64_tr_b16 a[102:103], v15 offset:18944
    v_mfma_f32_32x32x16_bf16 v[104:119], a[64:67], v[128:131], 0
    s_add_u32 s37, s36, 122880
    buffer_load_dwordx4 a[248:251], v27, s[24:27], s80 offen offset:3072 sc1
    ds_read_b64_tr_b16 a[104:105], v15 offset:20480
    ds_read_b64_tr_b16 a[106:107], v15 offset:22528
    v_mfma_f32_32x32x16_bf16 v[104:119], a[68:71], v[136:139], v[104:119]
    buffer_load_dwordx4 a[252:255], v27, s[24:27], s80 offen offset:3328 sc1
    s_add_u32 s80, s80, 4096
    ds_read_b64_tr_b16 a[108:109], v15 offset:20992
    ds_read_b64_tr_b16 a[110:111], v15 offset:23040
    v_mfma_f32_32x32x16_bf16 v[104:119], a[72:75], v[144:147], v[104:119]
    ds_read_b64_tr_b16 a[112:113], v15 offset:24576
    ds_read_b64_tr_b16 a[114:115], v15 offset:26624
    v_add_u32 v14, s22, v10
    v_mul_f32 v88, v88, v20
    v_mul_f32 v89, v89, v20
    v_mfma_f32_32x32x16_bf16 v[104:119], a[76:79], v[152:155], v[104:119]
    s_waitcnt lgkmcnt(10)
    ds_read_b64_tr_b16 a[116:117], v15 offset:25088
    ds_read_b64_tr_b16 a[118:119], v15 offset:27136
    v_mul_f32 v90, v90, v20
    v_mul_f32 v91, v91, v20
    v_mfma_f32_32x32x16_bf16 v[104:119], a[80:83], v[160:163], v[104:119]
    buffer_load_dwordx4 v[132:135], v27, s[24:27], s80 offen offset:0 sc1
    ds_read_b64_tr_b16 a[120:121], v15 offset:28672
    ds_read_b64_tr_b16 a[122:123], v15 offset:30720
    v_mul_f32 v92, v92, v20
    v_mul_f32 v93, v93, v20
    v_mfma_f32_32x32x16_bf16 v[104:119], a[84:87], v[168:171], v[104:119]
    s_mov_b32 m0, s16
    ds_read_b64_tr_b16 a[124:125], v15 offset:29184
    ds_read_b64_tr_b16 a[126:127], v15 offset:31232
    v_mul_f32 v94, v94, v20
    v_mul_f32 v95, v95, v20
    v_mfma_f32_32x32x16_bf16 v[104:119], a[88:91], v[176:179], v[104:119]
    s_waitcnt vmcnt(41)
    s_barrier
    buffer_store_dword v11, v3, s[24:27], s73 offen sc1
    ds_read_b64_tr_b16 a[64:65], v14 offset:0
    ds_read_b64_tr_b16 a[66:67], v14 offset:2048
    v_cvt_pk_bf16_f32 v88, v88, v89
    v_cvt_pk_bf16_f32 v89, v90, v91
    v_mfma_f32_32x32x16_bf16 v[104:119], a[92:95], v[184:187], v[104:119]
    s_waitcnt lgkmcnt(10)
    ds_read_b64_tr_b16 a[68:69], v14 offset:512
    ds_read_b64_tr_b16 a[70:71], v14 offset:2560
    v_cvt_pk_bf16_f32 v90, v92, v93
    v_cvt_pk_bf16_f32 v91, v94, v95
    v_mfma_f32_32x32x16_bf16 v[104:119], a[96:99], v[192:195], v[104:119]
    ds_read_b64_tr_b16 a[72:73], v14 offset:4096
    ds_read_b64_tr_b16 a[74:75], v14 offset:6144
    buffer_store_dwordx4 v[88:91], v18, s[24:27], s36 offen offset:0 sc1
    v_mul_f32 v96, v96, v20
    v_mul_f32 v97, v97, v20
    v_mfma_f32_32x32x16_bf16 v[104:119], a[100:103], v[200:203], v[104:119]
    buffer_load_dwordx4 v6, s[4:7], s18 offen offset:0 sc1 lds
    ds_read_b64_tr_b16 a[76:77], v14 offset:4608
    ds_read_b64_tr_b16 a[78:79], v14 offset:6656
    v_mul_f32 v98, v98, v20
    v_mul_f32 v99, v99, v20
    v_mfma_f32_32x32x16_bf16 v[104:119], a[104:107], v[208:211], v[104:119]
    buffer_load_dwordx4 v7, s[4:7], s18 offen offset:1024 sc1 lds
    ds_read_b64_tr_b16 a[80:81], v14 offset:8192
    ds_read_b64_tr_b16 a[82:83], v14 offset:10240
    v_mul_f32 v100, v100, v20
    v_mul_f32 v101, v101, v20
    v_mfma_f32_32x32x16_bf16 v[104:119], a[108:111], v[216:219], v[104:119]
    s_waitcnt lgkmcnt(10)
    ds_read_b64_tr_b16 a[84:85], v14 offset:8704
    ds_read_b64_tr_b16 a[86:87], v14 offset:10752
    v_mul_f32 v102, v102, v20
    v_mul_f32 v103, v103, v20
    v_mfma_f32_32x32x16_bf16 v[104:119], a[112:115], v[224:227], v[104:119]
    buffer_load_dwordx4 v8, s[4:7], s18 offen offset:2048 sc1 lds
    ds_read_b64_tr_b16 a[88:89], v14 offset:12288
    ds_read_b64_tr_b16 a[90:91], v14 offset:14336
    v_cvt_pk_bf16_f32 v92, v96, v97
    v_cvt_pk_bf16_f32 v93, v98, v99
    v_mfma_f32_32x32x16_bf16 v[104:119], a[116:119], v[232:235], v[104:119]
    buffer_load_dwordx4 v9, s[4:7], s18 offen offset:3072 sc1 lds
    ds_read_b64_tr_b16 a[92:93], v14 offset:12800
    ds_read_b64_tr_b16 a[94:95], v14 offset:14848
    v_cvt_pk_bf16_f32 v94, v100, v101
    v_cvt_pk_bf16_f32 v95, v102, v103
    v_mfma_f32_32x32x16_bf16 v[104:119], a[120:123], v[240:243], v[104:119]
    s_add_u32 m0, s16, 16384
    ds_read_b64_tr_b16 a[96:97], v14 offset:16384
    ds_read_b64_tr_b16 a[98:99], v14 offset:18432
    buffer_store_dwordx4 v[92:95], v18, s[24:27], s36 offen offset:128 sc1
    v_mfma_f32_32x32x16_bf16 v[104:119], a[124:127], v[248:251], v[104:119]
    s_waitcnt vmcnt(63)
    s_add_u32 s89, s18, s20
    ds_read_b64_tr_b16 a[100:101], v14 offset:16896
    ds_read_b64_tr_b16 a[102:103], v14 offset:18944
    v_add_u32 v15, s22, v11
fz_ffn:
    s_waitcnt lgkmcnt(12)
    v_mfma_f32_32x32x16_bf16 v[88:103], a[64:67], a[0:3], 0
    s_add_u32 s22, s22, 32768
    buffer_load_dwordx4 v[140:143], v27, s[24:27], s80 offen offset:256 sc1
    buffer_load_dwordx4 v6, s[4:7], s89 offen offset:0 sc1 lds
    ds_read_b64_tr_b16 a[104:105], v14 offset:20480
    ds_read_b64_tr_b16 a[106:107], v14 offset:22528
    v_mfma_f32_32x32x16_bf16 v[88:103], a[68:71], a[4:7], v[88:103]
    s_cmp_eq_u32 s22, 163840
    s_cselect_b32 s22, 0, s22
    buffer_load_dwordx4 v7, s[4:7], s89 offen offset:1024 sc1 lds
    ds_read_b64_tr_b16 a[108:109], v14 offset:20992
    ds_read_b64_tr_b16 a[110:111], v14 offset:23040
    v_mfma_f32_32x32x16_bf16 v[88:103], a[72:75], a[8:11], v[88:103]
    buffer_load_dwordx4 v[148:151], v27, s[24:27], s80 offen offset:1024 sc1
    ds_read_b64_tr_b16 a[112:113], v14 offset:24576
    ds_read_b64_tr_b16 a[114:115], v14 offset:26624
    v_mul_f32 v104, v104, v20
    v_mul_f32 v105, v105, v20
    v_mfma_f32_32x32x16_bf16 v[88:103], a[76:79], a[12:15], v[88:103]
    s_waitcnt lgkmcnt(10)
    ds_read_b64_tr_b16 a[116:117], v14 offset:25088
    ds_read_b64_tr_b16 a[118:119], v14 offset:27136
    v_mul_f32 v106, v106, v20
    v_mul_f32 v107, v107, v20
    v_mfma_f32_32x32x16_bf16 v[88:103], a[80:83], a[16:19], v[88:103]
    buffer_load_dwordx4 v[156:159], v27, s[24:27], s80 offen offset:1280 sc1
    ds_read_b64_tr_b16 a[120:121], v14 offset:28672
    ds_read_b64_tr_b16 a[122:123], v14 offset:30720
    v_mul_f32 v108, v108, v20
    v_mul_f32 v109, v109, v20
    v_mfma_f32_32x32x16_bf16 v[88:103], a[84:87], a[20:23], v[88:103]
    buffer_load_dwordx4 v8, s[4:7], s89 offen offset:2048 sc1 lds
    ds_read_b64_tr_b16 a[124:125], v14 offset:29184
    ds_read_b64_tr_b16 a[126:127], v14 offset:31232
    v_mul_f32 v110, v110, v20
    v_mul_f32 v111, v111, v20
    v_mfma_f32_32x32x16_bf16 v[88:103], a[88:91], a[24:27], v[88:103]
    buffer_load_dwordx4 v[164:167], v27, s[24:27], s80 offen offset:2048 sc1
    ds_read_b64_tr_b16 a[64:65], v15 offset:0
    ds_read_b64_tr_b16 a[66:67], v15 offset:2048
    v_cvt_pk_bf16_f32 v104, v104, v105
    v_cvt_pk_bf16_f32 v105, v106, v107
    v_mfma_f32_32x32x16_bf16 v[88:103], a[92:95], a[28:31], v[88:103]
    s_waitcnt lgkmcnt(10)
    ds_read_b64_tr_b16 a[68:69], v15 offset:512
    ds_read_b64_tr_b16 a[70:71], v15 offset:2560
    v_cvt_pk_bf16_f32 v106, v108, v109
    v_cvt_pk_bf16_f32 v107, v110, v111
    v_mfma_f32_32x32x16_bf16 v[88:103], a[96:99], a[32:35], v[88:103]
    ds_read_b64_tr_b16 a[72:73], v15 offset:4096
    ds_read_b64_tr_b16 a[74:75], v15 offset:6144
    buffer_store_dwordx4 v[104:107], v18, s[24:27], s37 offen offset:0 sc1
    v_mul_f32 v112, v112, v20
    v_mul_f32 v113, v113, v20
    v_mfma_f32_32x32x16_bf16 v[88:103], a[100:103], a[36:39], v[88:103]
    buffer_load_dwordx4 v[172:175], v27, s[24:27], s80 offen offset:2304 sc1
    ds_read_b64_tr_b16 a[76:77], v15 offset:4608
    ds_read_b64_tr_b16 a[78:79], v15 offset:6656
    v_mul_f32 v114, v114, v20
    v_mul_f32 v115, v115, v20
    v_mfma_f32_32x32x16_bf16 v[88:103], a[104:107], a[40:43], v[88:103]
    buffer_load_dwordx4 v9, s[4:7], s89 offen offset:3072 sc1 lds
    ds_read_b64_tr_b16 a[80:81], v15 offset:8192
    ds_read_b64_tr_b16 a[82:83], v15 offset:10240
    v_mul_f32 v116, v116, v20
    v_mul_f32 v117, v117, v20
    v_mfma_f32_32x32x16_bf16 v[88:103], a[108:111], a[44:47], v[88:103]
    s_waitcnt lgkmcnt(10)
    ds_read_b64_tr_b16 a[84:85], v15 offset:8704
    ds_read_b64_tr_b16 a[86:87], v15 offset:10752
    v_mul_f32 v118, v118, v20
    v_mul_f32 v119, v119, v20
    v_mfma_f32_32x32x16_bf16 v[88:103], a[112:115], a[48:51], v[88:103]
    s_add_u32 s16, s16, 32768
    buffer_load_dwordx4 v[180:183], v27, s[24:27], s80 offen offset:3072 sc1
    ds_read_b64_tr_b16 a[88:89], v15 offset:12288
    ds_read_b64_tr_b16 a[90:91], v15 offset:14336
    v_cvt_pk_bf16_f32 v108, v112, v113
    v_cvt_pk_bf16_f32 v109, v114, v115
    v_mfma_f32_32x32x16_bf16 v[88:103], a[116:119], a[52:55], v[88:103]
    ds_read_b64_tr_b16 a[92:93], v15 offset:12800
    ds_read_b64_tr_b16 a[94:95], v15 offset:14848
    v_cvt_pk_bf16_f32 v110, v116, v117
    v_cvt_pk_bf16_f32 v111, v118, v119
    v_mfma_f32_32x32x16_bf16 v[88:103], a[120:123], a[56:59], v[88:103]
    s_cmp_eq_u32 s16, s17
    s_cselect_b32 s16, s67, s16
    ds_read_b64_tr_b16 a[96:97], v15 offset:16384
    ds_read_b64_tr_b16 a[98:99], v15 offset:18432
    buffer_store_dwordx4 v[108:111], v18, s[24:27], s37 offen offset:128 sc1
    v_mfma_f32_32x32x16_bf16 v[88:103], a[124:127], a[60:63], v[88:103]
    s_waitcnt lgkmcnt(10)
    s_add_u32 s18, s18, s19
    ds_read_b64_tr_b16 a[100:101], v15 offset:16896
    ds_read_b64_tr_b16 a[102:103], v15 offset:18944
    v_mfma_f32_32x32x16_bf16 v[104:119], a[64:67], a[0:3], 0
    s_add_u32 s73, s79, 4
    buffer_load_dwordx4 v[188:191], v27, s[24:27], s80 offen offset:3328 sc1
    s_add_u32 s80, s80, 4096
    ds_read_b64_tr_b16 a[104:105], v15 offset:20480
    ds_read_b64_tr_b16 a[106:107], v15 offset:22528
    v_mov_b32 v20, 0x42f5fdf0
    v_mfma_f32_32x32x16_bf16 v[104:119], a[68:71], a[4:7], v[104:119]
    s_lshl3_add_u32 s87, s68, s66
    s_mul_i32 s36, s87, 245760
    s_lshl_b32 s86, s69, 8
    s_add_u32 s36, s36, s86
    buffer_load_dwordx4 v[196:199], v27, s[24:27], s80 offen offset:0 sc1
    ds_read_b64_tr_b16 a[108:109], v15 offset:20992
    ds_read_b64_tr_b16 a[110:111], v15 offset:23040
    v_mfma_f32_32x32x16_bf16 v[104:119], a[72:75], a[8:11], v[104:119]
    s_add_u32 s36, s36, 65040384
    s_add_u32 s37, s36, 122880
    s_add_u32 s79, s79, 256
    ds_read_b64_tr_b16 a[112:113], v15 offset:24576
    ds_read_b64_tr_b16 a[114:115], v15 offset:26624
    v_add_u32 v14, s22, v10
    v_mfma_f32_32x32x16_bf16 v[104:119], a[76:79], a[12:15], v[104:119]
    s_waitcnt lgkmcnt(10)
    ds_read_b64_tr_b16 a[116:117], v15 offset:25088
    ds_read_b64_tr_b16 a[118:119], v15 offset:27136
    v_mfma_f32_32x32x16_bf16 v[104:119], a[80:83], a[16:19], v[104:119]
    buffer_load_dwordx4 v[204:207], v27, s[24:27], s80 offen offset:256 sc1
    ds_read_b64_tr_b16 a[120:121], v15 offset:28672
    ds_read_b64_tr_b16 a[122:123], v15 offset:30720
    v_mfma_f32_32x32x16_bf16 v[104:119], a[84:87], a[20:23], v[104:119]
    s_mov_b32 m0, s16
    ds_read_b64_tr_b16 a[124:125], v15 offset:29184
    ds_read_b64_tr_b16 a[126:127], v15 offset:31232
    v_mfma_f32_32x32x16_bf16 v[104:119], a[88:91], a[24:27], v[104:119]
    s_waitcnt vmcnt(45)
    s_barrier
    ds_read_b64_tr_b16 a[64:65], v14 offset:0
    ds_read_b64_tr_b16 a[66:67], v14 offset:2048
    v_mfma_f32_32x32x16_bf16 v[104:119], a[92:95], a[28:31], v[104:119]
    s_waitcnt lgkmcnt(10)
    buffer_load_dwordx4 v[212:215], v27, s[24:27], s80 offen offset:1024 sc1
    ds_read_b64_tr_b16 a[68:69], v14 offset:512
    ds_read_b64_tr_b16 a[70:71], v14 offset:2560
    v_mfma_f32_32x32x16_bf16 v[104:119], a[96:99], a[32:35], v[104:119]
    ds_read_b64_tr_b16 a[72:73], v14 offset:4096
    ds_read_b64_tr_b16 a[74:75], v14 offset:6144
    v_mfma_f32_32x32x16_bf16 v[104:119], a[100:103], a[36:39], v[104:119]
    buffer_load_dwordx4 v6, s[4:7], s18 offen offset:0 sc1 lds
    ds_read_b64_tr_b16 a[76:77], v14 offset:4608
    ds_read_b64_tr_b16 a[78:79], v14 offset:6656
    v_mfma_f32_32x32x16_bf16 v[104:119], a[104:107], a[40:43], v[104:119]
    buffer_load_dwordx4 v7, s[4:7], s18 offen offset:1024 sc1 lds
    ds_read_b64_tr_b16 a[80:81], v14 offset:8192
    ds_read_b64_tr_b16 a[82:83], v14 offset:10240
    v_mfma_f32_32x32x16_bf16 v[104:119], a[108:111], a[44:47], v[104:119]
    s_waitcnt lgkmcnt(10)
    ds_read_b64_tr_b16 a[84:85], v14 offset:8704
    ds_read_b64_tr_b16 a[86:87], v14 offset:10752
    v_mfma_f32_32x32x16_bf16 v[104:119], a[112:115], a[48:51], v[104:119]
    buffer_load_dwordx4 v8, s[4:7], s18 offen offset:2048 sc1 lds
    ds_read_b64_tr_b16 a[88:89], v14 offset:12288
    ds_read_b64_tr_b16 a[90:91], v14 offset:14336
    v_mfma_f32_32x32x16_bf16 v[104:119], a[116:119], a[52:55], v[104:119]
    buffer_load_dwordx4 v9, s[4:7], s18 offen offset:3072 sc1 lds
    ds_read_b64_tr_b16 a[92:93], v14 offset:12800
    ds_read_b64_tr_b16 a[94:95], v14 offset:14848
    v_mfma_f32_32x32x16_bf16 v[104:119], a[120:123], a[56:59], v[104:119]
    s_add_u32 m0, s16, 16384
    s_add_u32 s89, s18, s20
    ds_read_b64_tr_b16 a[96:97], v14 offset:16384
    ds_read_b64_tr_b16 a[98:99], v14 offset:18432
    v_mfma_f32_32x32x16_bf16 v[104:119], a[124:127], a[60:63], v[104:119]
    s_waitcnt vmcnt(63)
    buffer_load_dwordx4 v[220:223], v27, s[24:27], s80 offen offset:1280 sc1
    ds_read_b64_tr_b16 a[100:101], v14 offset:16896
    ds_read_b64_tr_b16 a[102:103], v14 offset:18944
    v_add_u32 v15, s22, v11
    s_cmp_eq_u32 s69, 7
    s_cbranch_scc1 fz_short
fz_x0:
    s_waitcnt lgkmcnt(12)
    v_mfma_f32_32x32x16_bf16 v[88:103], a[64:67], a[128:131], v[88:103]
    s_add_u32 s22, s22, 32768
    buffer_load_dwordx4 v[228:231], v27, s[24:27], s80 offen offset:2048 sc1
    buffer_load_dwordx4 v6, s[4:7], s89 offen offset:0 sc1 lds
    ds_read_b64_tr_b16 a[104:105], v14 offset:20480
    ds_read_b64_tr_b16 a[106:107], v14 offset:22528
    v_mfma_f32_32x32x16_bf16 v[88:103], a[68:71], a[132:135], v[88:103]
    s_cmp_eq_u32 s22, 163840
    s_cselect_b32 s22, 0, s22
    buffer_load_dwordx4 v7, s[4:7], s89 offen offset:1024 sc1 lds
    ds_read_b64_tr_b16 a[108:109], v14 offset:20992
    ds_read_b64_tr_b16 a[110:111], v14 offset:23040
    v_mfma_f32_32x32x16_bf16 v[88:103], a[72:75], a[136:139], v[88:103]
    buffer_load_dwordx4 v[236:239], v27, s[24:27], s80 offen offset:2304 sc1
    ds_read_b64_tr_b16 a[112:113], v14 offset:24576
    ds_read_b64_tr_b16 a[114:115], v14 offset:26624
    v_mfma_f32_32x32x16_bf16 v[88:103], a[76:79], a[140:143], v[88:103]
    s_waitcnt lgkmcnt(10)
    ds_read_b64_tr_b16 a[116:117], v14 offset:25088
    ds_read_b64_tr_b16 a[118:119], v14 offset:27136
    v_mfma_f32_32x32x16_bf16 v[88:103], a[80:83], a[144:147], v[88:103]
    buffer_load_dwordx4 v[244:247], v27, s[24:27], s80 offen offset:3072 sc1
    ds_read_b64_tr_b16 a[120:121], v14 offset:28672
    ds_read_b64_tr_b16 a[122:123], v14 offset:30720
    v_mfma_f32_32x32x16_bf16 v[88:103], a[84:87], a[148:151], v[88:103]
    buffer_load_dwordx4 v8, s[4:7], s89 offen offset:2048 sc1 lds
    ds_read_b64_tr_b16 a[124:125], v14 offset:29184
    ds_read_b64_tr_b16 a[126:127], v14 offset:31232
    v_mfma_f32_32x32x16_bf16 v[88:103], a[88:91], a[152:155], v[88:103]
    buffer_load_dwordx4 v[252:255], v27, s[24:27], s80 offen offset:3328 sc1
    s_add_u32 s80, s80, 4096
    ds_read_b64_tr_b16 a[64:65], v15 offset:0
    ds_read_b64_tr_b16 a[66:67], v15 offset:2048
    v_mfma_f32_32x32x16_bf16 v[88:103], a[92:95], a[156:159], v[88:103]
    s_waitcnt lgkmcnt(10)
    ds_read_b64_tr_b16 a[68:69], v15 offset:512
    ds_read_b64_tr_b16 a[70:71], v15 offset:2560
    v_mfma_f32_32x32x16_bf16 v[88:103], a[96:99], a[160:163], v[88:103]
    ds_read_b64_tr_b16 a[72:73], v15 offset:4096
    ds_read_b64_tr_b16 a[74:75], v15 offset:6144
    v_mfma_f32_32x32x16_bf16 v[88:103], a[100:103], a[164:167], v[88:103]
    buffer_load_dwordx4 v[128:131], v27, s[24:27], s80 offen offset:0 sc1
    ds_read_b64_tr_b16 a[76:77], v15 offset:4608
    ds_read_b64_tr_b16 a[78:79], v15 offset:6656
    v_mfma_f32_32x32x16_bf16 v[88:103], a[104:107], a[168:171], v[88:103]
    buffer_load_dwordx4 v9, s[4:7], s89 offen offset:3072 sc1 lds
    ds_read_b64_tr_b16 a[80:81], v15 offset:8192
    ds_read_b64_tr_b16 a[82:83], v15 offset:10240
    v_mfma_f32_32x32x16_bf16 v[88:103], a[108:111], a[172:175], v[88:103]
    s_waitcnt lgkmcnt(10)
    ds_read_b64_tr_b16 a[84:85], v15 offset:8704
    ds_read_b64_tr_b16 a[86:87], v15 offset:10752
    v_mfma_f32_32x32x16_bf16 v[88:103], a[112:115], a[176:179], v[88:103]
    s_add_u32 s16, s16, 32768
    buffer_load_dwordx4 v[136:139], v27, s[24:27], s80 offen offset:256 sc1
    ds_read_b64_tr_b16 a[88:89], v15 offset:12288
    ds_read_b64_tr_b16 a[90:91], v15 offset:14336
    v_mfma_f32_32x32x16_bf16 v[88:103], a[116:119], a[180:183], v[88:103]
    ds_read_b64_tr_b16 a[92:93], v15 offset:12800
    ds_read_b64_tr_b16 a[94:95], v15 offset:14848
    v_mfma_f32_32x32x16_bf16 v[88:103], a[120:123], a[184:187], v[88:103]
    s_cmp_eq_u32 s16, s17
    s_cselect_b32 s16, s67, s16
    ds_read_b64_tr_b16 a[96:97], v15 offset:16384
    ds_read_b64_tr_b16 a[98:99], v15 offset:18432
    v_mfma_f32_32x32x16_bf16 v[88:103], a[124:127], a[188:191], v[88:103]
    s_waitcnt lgkmcnt(10)
    s_add_u32 s18, s18, s19
    ds_read_b64_tr_b16 a[100:101], v15 offset:16896
    ds_read_b64_tr_b16 a[102:103], v15 offset:18944
    v_mfma_f32_32x32x16_bf16 v[104:119], a[64:67], a[128:131], v[104:119]
    buffer_load_dwordx4 v[144:147], v27, s[24:27], s80 offen offset:1024 sc1
    ds_read_b64_tr_b16 a[104:105], v15 offset:20480
    ds_read_b64_tr_b16 a[106:107], v15 offset:22528
    v_mfma_f32_32x32x16_bf16 v[104:119], a[68:71], a[132:135], v[104:119]
    buffer_load_dwordx4 v[152:155], v27, s[24:27], s80 offen offset:1280 sc1
    ds_read_b64_tr_b16 a[108:109], v15 offset:20992
    ds_read_b64_tr_b16 a[110:111], v15 offset:23040
    v_mfma_f32_32x32x16_bf16 v[104:119], a[72:75], a[136:139], v[104:119]
    ds_read_b64_tr_b16 a[112:113], v15 offset:24576
    ds_read_b64_tr_b16 a[114:115], v15 offset:26624
    v_add_u32 v14, s22, v10
    v_mfma_f32_32x32x16_bf16 v[104:119], a[76:79], a[140:143], v[104:119]
    s_waitcnt lgkmcnt(10)
    ds_read_b64_tr_b16 a[116:117], v15 offset:25088
    ds_read_b64_tr_b16 a[118:119], v15 offset:27136
    v_mfma_f32_32x32x16_bf16 v[104:119], a[80:83], a[144:147], v[104:119]
    buffer_load_dwordx4 v[160:163], v27, s[24:27], s80 offen offset:2048 sc1
    ds_read_b64_tr_b16 a[120:121], v15 offset:28672
    ds_read_b64_tr_b16 a[122:123], v15 offset:30720
    v_mfma_f32_32x32x16_bf16 v[104:119], a[84:87], a[148:151], v[104:119]
    s_mov_b32 m0, s16
    ds_read_b64_tr_b16 a[124:125], v15 offset:29184
    ds_read_b64_tr_b16 a[126:127], v15 offset:31232
    v_mfma_f32_32x32x16_bf16 v[104:119], a[88:91], a[152:155], v[104:119]
    s_waitcnt vmcnt(45)
    s_barrier
    ds_read_b64_tr_b16 a[64:65], v14 offset:0
    ds_read_b64_tr_b16 a[66:67], v14 offset:2048
    v_mfma_f32_32x32x16_bf16 v[104:119], a[92:95], a[156:159], v[104:119]
    s_waitcnt lgkmcnt(10)
    buffer_load_dwordx4 v[168:171], v27, s[24:27], s80 offen offset:2304 sc1
    ds_read_b64_tr_b16 a[68:69], v14 offset:512
    ds_read_b64_tr_b16 a[70:71], v14 offset:2560
    v_mfma_f32_32x32x16_bf16 v[104:119], a[96:99], a[160:163], v[104:119]
    ds_read_b64_tr_b16 a[72:73], v14 offset:4096
    ds_read_b64_tr_b16 a[74:75], v14 offset:6144
    v_mfma_f32_32x32x16_bf16 v[104:119], a[100:103], a[164:167], v[104:119]
    buffer_load_dwordx4 v6, s[4:7], s18 offen offset:0 sc1 lds
    ds_read_b64_tr_b16 a[76:77], v14 offset:4608
    ds_read_b64_tr_b16 a[78:79], v14 offset:6656
    v_mfma_f32_32x32x16_bf16 v[104:119], a[104:107], a[168:171], v[104:119]
    buffer_load_dwordx4 v7, s[4:7], s18 offen offset:1024 sc1 lds
    ds_read_b64_tr_b16 a[80:81], v14 offset:8192
    ds_read_b64_tr_b16 a[82:83], v14 offset:10240
    v_mfma_f32_32x32x16_bf16 v[104:119], a[108:111], a[172:175], v[104:119]
    s_waitcnt lgkmcnt(10)
    ds_read_b64_tr_b16 a[84:85], v14 offset:8704
    ds_read_b64_tr_b16 a[86:87], v14 offset:10752
    v_mfma_f32_32x32x16_bf16 v[104:119], a[112:115], a[176:179], v[104:119]
    buffer_load_dwordx4 v8, s[4:7], s18 offen offset:2048 sc1 lds
    ds_read_b64_tr_b16 a[88:89], v14 offset:12288
    ds_read_b64_tr_b16 a[90:91], v14 offset:14336
    v_mfma_f32_32x32x16_bf16 v[104:119], a[116:119], a[180:183], v[104:119]
    buffer_load_dwordx4 v9, s[4:7], s18 offen offset:3072 sc1 lds
    ds_read_b64_tr_b16 a[92:93], v14 offset:12800
    ds_read_b64_tr_b16 a[94:95], v14 offset:14848
    v_mfma_f32_32x32x16_bf16 v[104:119], a[120:123], a[184:187], v[104:119]
    s_add_u32 m0, s16, 16384
    s_add_u32 s89, s18, s20
    ds_read_b64_tr_b16 a[96:97], v14 offset:16384
    ds_read_b64_tr_b16 a[98:99], v14 offset:18432
    v_mfma_f32_32x32x16_bf16 v[104:119], a[124:127], a[188:191], v[104:119]
    s_waitcnt vmcnt(47)
    buffer_load_dwordx4 v[176:179], v27, s[24:27], s80 offen offset:3072 sc1
    ds_read_b64_tr_b16 a[100:101], v14 offset:16896
    ds_read_b64_tr_b16 a[102:103], v14 offset:18944
    v_add_u32 v15, s22, v11
    s_waitcnt lgkmcnt(12)
    v_mfma_f32_32x32x16_bf16 v[88:103], a[64:67], a[192:195], v[88:103]
    s_add_u32 s22, s22, 32768
    buffer_load_dwordx4 v[184:187], v27, s[24:27], s80 offen offset:3328 sc1
    s_add_u32 s80, s80, 4096
    buffer_load_dwordx4 v6, s[4:7], s89 offen offset:0 sc1 lds
    ds_read_b64_tr_b16 a[104:105], v14 offset:20480
    ds_read_b64_tr_b16 a[106:107], v14 offset:22528
    v_mfma_f32_32x32x16_bf16 v[88:103], a[68:71], a[196:199], v[88:103]
    s_cmp_eq_u32 s22, 163840
    s_cselect_b32 s22, 0, s22
    buffer_load_dwordx4 v7, s[4:7], s89 offen offset:1024 sc1 lds
    ds_read_b64_tr_b16 a[108:109], v14 offset:20992
    ds_read_b64_tr_b16 a[110:111], v14 offset:23040
    v_mfma_f32_32x32x16_bf16 v[88:103], a[72:75], a[200:203], v[88:103]
    buffer_load_dwordx4 v[192:195], v27, s[24:27], s80 offen offset:0 sc1
    ds_read_b64_tr_b16 a[112:113], v14 offset:24576
    ds_read_b64_tr_b16 a[114:115], v14 offset:26624
    v_mfma_f32_32x32x16_bf16 v[88:103], a[76:79], a[204:207], v[88:103]
    s_waitcnt lgkmcnt(10)
    ds_read_b64_tr_b16 a[116:117], v14 offset:25088
    ds_read_b64_tr_b16 a[118:119], v14 offset:27136
    v_mfma_f32_32x32x16_bf16 v[88:103], a[80:83], a[208:211], v[88:103]
    buffer_load_dwordx4 v[200:203], v27, s[24:27], s80 offen offset:256 sc1
    ds_read_b64_tr_b16 a[120:121], v14 offset:28672
    ds_read_b64_tr_b16 a[122:123], v14 offset:30720
    v_mfma_f32_32x32x16_bf16 v[88:103], a[84:87], a[212:215], v[88:103]
    buffer_load_dwordx4 v8, s[4:7], s89 offen offset:2048 sc1 lds
    ds_read_b64_tr_b16 a[124:125], v14 offset:29184
    ds_read_b64_tr_b16 a[126:127], v14 offset:31232
    v_mfma_f32_32x32x16_bf16 v[88:103], a[88:91], a[216:219], v[88:103]
    buffer_load_dwordx4 v[208:211], v27, s[24:27], s80 offen offset:1024 sc1
    ds_read_b64_tr_b16 a[64:65], v15 offset:0
    ds_read_b64_tr_b16 a[66:67], v15 offset:2048
    v_mfma_f32_32x32x16_bf16 v[88:103], a[92:95], a[220:223], v[88:103]
    s_waitcnt lgkmcnt(10)
    ds_read_b64_tr_b16 a[68:69], v15 offset:512
    ds_read_b64_tr_b16 a[70:71], v15 offset:2560
    v_mfma_f32_32x32x16_bf16 v[88:103], a[96:99], a[224:227], v[88:103]
    ds_read_b64_tr_b16 a[72:73], v15 offset:4096
    ds_read_b64_tr_b16 a[74:75], v15 offset:6144
    v_mfma_f32_32x32x16_bf16 v[88:103], a[100:103], a[228:231], v[88:103]
    buffer_load_dwordx4 v[216:219], v27, s[24:27], s80 offen offset:1280 sc1
    ds_read_b64_tr_b16 a[76:77], v15 offset:4608
    ds_read_b64_tr_b16 a[78:79], v15 offset:6656
    v_mfma_f32_32x32x16_bf16 v[88:103], a[104:107], a[232:235], v[88:103]
    buffer_load_dwordx4 v9, s[4:7], s89 offen offset:3072 sc1 lds
    ds_read_b64_tr_b16 a[80:81], v15 offset:8192
    ds_read_b64_tr_b16 a[82:83], v15 offset:10240
    v_mfma_f32_32x32x16_bf16 v[88:103], a[108:111], a[236:239], v[88:103]
    s_waitcnt lgkmcnt(10)
    ds_read_b64_tr_b16 a[84:85], v15 offset:8704
    ds_read_b64_tr_b16 a[86:87], v15 offset:10752
    v_mfma_f32_32x32x16_bf16 v[88:103], a[112:115], a[240:243], v[88:103]
    s_add_u32 s16, s16, 32768
    buffer_load_dwordx4 v[224:227], v27, s[24:27], s80 offen offset:2048 sc1
    ds_read_b64_tr_b16 a[88:89], v15 offset:12288
    ds_read_b64_tr_b16 a[90:91], v15 offset:14336
    v_mfma_f32_32x32x16_bf16 v[88:103], a[116:119], a[244:247], v[88:103]
    ds_read_b64_tr_b16 a[92:93], v15 offset:12800
    ds_read_b64_tr_b16 a[94:95], v15 offset:14848
    v_mfma_f32_32x32x16_bf16 v[88:103], a[120:123], a[248:251], v[88:103]
    s_cmp_eq_u32 s16, s17
    s_cselect_b32 s16, s67, s16
    ds_read_b64_tr_b16 a[96:97], v15 offset:16384
    ds_read_b64_tr_b16 a[98:99], v15 offset:18432
    v_mfma_f32_32x32x16_bf16 v[88:103], a[124:127], a[252:255], v[88:103]
    s_waitcnt lgkmcnt(10)
    s_add_u32 s18, s18, s19
    ds_read_b64_tr_b16 a[100:101], v15 offset:16896
    ds_read_b64_tr_b16 a[102:103], v15 offset:18944
    v_mfma_f32_32x32x16_bf16 v[104:119], a[64:67], a[192:195], v[104:119]
    buffer_load_dwordx4 v[232:235], v27, s[24:27], s80 offen offset:2304 sc1
    ds_read_b64_tr_b16 a[104:105], v15 offset:20480
    ds_read_b64_tr_b16 a[106:107], v15 offset:22528
    v_mfma_f32_32x32x16_bf16 v[104:119], a[68:71], a[196:199], v[104:119]
    buffer_load_dwordx4 v[240:243], v27, s[24:27], s80 offen offset:3072 sc1
    ds_read_b64_tr_b16 a[108:109], v15 offset:20992
    ds_read_b64_tr_b16 a[110:111], v15 offset:23040
    v_mfma_f32_32x32x16_bf16 v[104:119], a[72:75], a[200:203], v[104:119]
    ds_read_b64_tr_b16 a[112:113], v15 offset:24576
    ds_read_b64_tr_b16 a[114:115], v15 offset:26624
    v_add_u32 v14, s22, v10
    v_mfma_f32_32x32x16_bf16 v[104:119], a[76:79], a[204:207], v[104:119]
    s_waitcnt lgkmcnt(10)
    ds_read_b64_tr_b16 a[116:117], v15 offset:25088
    ds_read_b64_tr_b16 a[118:119], v15 offset:27136
    v_mfma_f32_32x32x16_bf16 v[104:119], a[80:83], a[208:211], v[104:119]
    buffer_load_dwordx4 v[248:251], v27, s[24:27], s80 offen offset:3328 sc1
    s_add_u32 s80, s80, 4096
    ds_read_b64_tr_b16 a[120:121], v15 offset:28672
    ds_read_b64_tr_b16 a[122:123], v15 offset:30720
    v_mfma_f32_32x32x16_bf16 v[104:119], a[84:87], a[212:215], v[104:119]
    s_mov_b32 m0, s16
    ds_read_b64_tr_b16 a[124:125], v15 offset:29184
    ds_read_b64_tr_b16 a[126:127], v15 offset:31232
    v_mfma_f32_32x32x16_bf16 v[104:119], a[88:91], a[216:219], v[104:119]
    s_waitcnt vmcnt(41)
    s_barrier
    buffer_store_dword v11, v3, s[24:27], s73 offen sc1
    ds_read_b64_tr_b16 a[64:65], v14 offset:0
    ds_read_b64_tr_b16 a[66:67], v14 offset:2048
    v_mfma_f32_32x32x16_bf16 v[104:119], a[92:95], a[220:223], v[104:119]
    s_waitcnt lgkmcnt(10)
    buffer_load_dwordx4 a[0:3], v27, s[24:27], s80 offen offset:0 sc1
    ds_read_b64_tr_b16 a[68:69], v14 offset:512
    ds_read_b64_tr_b16 a[70:71], v14 offset:2560
    v_mfma_f32_32x32x16_bf16 v[104:119], a[96:99], a[224:227], v[104:119]
    ds_read_b64_tr_b16 a[72:73], v14 offset:4096
    ds_read_b64_tr_b16 a[74:75], v14 offset:6144
    v_mfma_f32_32x32x16_bf16 v[104:119], a[100:103], a[228:231], v[104:119]
    buffer_load_dwordx4 v6, s[4:7], s18 offen offset:0 sc1 lds
    ds_read_b64_tr_b16 a[76:77], v14 offset:4608
    ds_read_b64_tr_b16 a[78:79], v14 offset:6656
    v_mfma_f32_32x32x16_bf16 v[104:119], a[104:107], a[232:235], v[104:119]
    buffer_load_dwordx4 v7, s[4:7], s18 offen offset:1024 sc1 lds
    ds_read_b64_tr_b16 a[80:81], v14 offset:8192
    ds_read_b64_tr_b16 a[82:83], v14 offset:10240
    v_mfma_f32_32x32x16_bf16 v[104:119], a[108:111], a[236:239], v[104:119]
    s_waitcnt lgkmcnt(10)
    ds_read_b64_tr_b16 a[84:85], v14 offset:8704
    ds_read_b64_tr_b16 a[86:87], v14 offset:10752
    v_mfma_f32_32x32x16_bf16 v[104:119], a[112:115], a[240:243], v[104:119]
    buffer_load_dwordx4 v8, s[4:7], s18 offen offset:2048 sc1 lds
    ds_read_b64_tr_b16 a[88:89], v14 offset:12288
    ds_read_b64_tr_b16 a[90:91], v14 offset:14336
    v_mfma_f32_32x32x16_bf16 v[104:119], a[116:119], a[244:247], v[104:119]
    buffer_load_dwordx4 v9, s[4:7], s18 offen offset:3072 sc1 lds
    ds_read_b64_tr_b16 a[92:93], v14 offset:12800
    ds_read_b64_tr_b16 a[94:95], v14 offset:14848
    v_mfma_f32_32x32x16_bf16 v[104:119], a[120:123], a[248:251], v[104:119]
    s_add_u32 m0, s16, 16384
    s_add_u32 s89, s18, s20
    ds_read_b64_tr_b16 a[96:97], v14 offset:16384
    ds_read_b64_tr_b16 a[98:99], v14 offset:18432
    v_mfma_f32_32x32x16_bf16 v[104:119], a[124:127], a[252:255], v[104:119]
    s_waitcnt vmcnt(31)
    buffer_load_dwordx4 a[4:7], v27, s[24:27], s80 offen offset:256 sc1
    ds_read_b64_tr_b16 a[100:101], v14 offset:16896
    ds_read_b64_tr_b16 a[102:103], v14 offset:18944
    v_add_u32 v15, s22, v11
    s_waitcnt lgkmcnt(12)
    v_mfma_f32_32x32x16_bf16 v[88:103], a[64:67], v[132:135], v[88:103]
    s_add_u32 s22, s22, 32768
    buffer_load_dwordx4 a[8:11], v27, s[24:27], s80 offen offset:1024 sc1
    buffer_load_dwordx4 v6, s[4:7], s89 offen offset:0 sc1 lds
    ds_read_b64_tr_b16 a[104:105], v14 offset:20480
    ds_read_b64_tr_b16 a[106:107], v14 offset:22528
    v_mfma_f32_32x32x16_bf16 v[88:103], a[68:71], v[140:143], v[88:103]
    s_cmp_eq_u32 s22, 163840
    s_cselect_b32 s22, 0, s22
    buffer_load_dwordx4 v7, s[4:7], s89 offen offset:1024 sc1 lds
    ds_read_b64_tr_b16 a[108:109], v14 offset:20992
    ds_read_b64_tr_b16 a[110:111], v14 offset:23040
    v_mfma_f32_32x32x16_bf16 v[88:103], a[72:75], v[148:151], v[88:103]
    buffer_load_dwordx4 a[12:15], v27, s[24:27], s80 offen offset:1280 sc1
    ds_read_b64_tr_b16 a[112:113], v14 offset:24576
    ds_read_b64_tr_b16 a[114:115], v14 offset:26624
    v_mfma_f32_32x32x16_bf16 v[88:103], a[76:79], v[156:159], v[88:103]
    s_waitcnt lgkmcnt(10)
    ds_read_b64_tr_b16 a[116:117], v14 offset:25088
    ds_read_b64_tr_b16 a[118:119], v14 offset:27136
    v_mfma_f32_32x32x16_bf16 v[88:103], a[80:83], v[164:167], v[88:103]
    buffer_load_dwordx4 a[16:19], v27, s[24:27], s80 offen offset:2048 sc1
    ds_read_b64_tr_b16 a[120:121], v14 offset:28672
    ds_read_b64_tr_b16 a[122:123], v14 offset:30720
    v_mfma_f32_32x32x16_bf16 v[88:103], a[84:87], v[172:175], v[88:103]
    buffer_load_dwordx4 v8, s[4:7], s89 offen offset:2048 sc1 lds
    ds_read_b64_tr_b16 a[124:125], v14 offset:29184
    ds_read_b64_tr_b16 a[126:127], v14 offset:31232
    v_mfma_f32_32x32x16_bf16 v[88:103], a[88:91], v[180:183], v[88:103]
    buffer_load_dwordx4 a[20:23], v27, s[24:27], s80 offen offset:2304 sc1
    ds_read_b64_tr_b16 a[64:65], v15 offset:0
    ds_read_b64_tr_b16 a[66:67], v15 offset:2048
    v_mfma_f32_32x32x16_bf16 v[88:103], a[92:95], v[188:191], v[88:103]
    s_waitcnt lgkmcnt(10)
    ds_read_b64_tr_b16 a[68:69], v15 offset:512
    ds_read_b64_tr_b16 a[70:71], v15 offset:2560
    v_mfma_f32_32x32x16_bf16 v[88:103], a[96:99], v[196:199], v[88:103]
    ds_read_b64_tr_b16 a[72:73], v15 offset:4096
    ds_read_b64_tr_b16 a[74:75], v15 offset:6144
    v_mfma_f32_32x32x16_bf16 v[88:103], a[100:103], v[204:207], v[88:103]
    buffer_load_dwordx4 a[24:27], v27, s[24:27], s80 offen offset:3072 sc1
    ds_read_b64_tr_b16 a[76:77], v15 offset:4608
    ds_read_b64_tr_b16 a[78:79], v15 offset:6656
    v_mfma_f32_32x32x16_bf16 v[88:103], a[104:107], v[212:215], v[88:103]
    buffer_load_dwordx4 v9, s[4:7], s89 offen offset:3072 sc1 lds
    ds_read_b64_tr_b16 a[80:81], v15 offset:8192
    ds_read_b64_tr_b16 a[82:83], v15 offset:10240
    v_mfma_f32_32x32x16_bf16 v[88:103], a[108:111], v[220:223], v[88:103]
    s_waitcnt lgkmcnt(10)
    ds_read_b64_tr_b16 a[84:85], v15 offset:8704
    ds_read_b64_tr_b16 a[86:87], v15 offset:10752
    v_mfma_f32_32x32x16_bf16 v[88:103], a[112:115], v[228:231], v[88:103]
    s_add_u32 s16, s16, 32768
    buffer_load_dwordx4 a[28:31], v27, s[24:27], s80 offen offset:3328 sc1
    s_add_u32 s80, s80, 4096
    ds_read_b64_tr_b16 a[88:89], v15 offset:12288
    ds_read_b64_tr_b16 a[90:91], v15 offset:14336
    v_mfma_f32_32x32x16_bf16 v[88:103], a[116:119], v[236:239], v[88:103]
    ds_read_b64_tr_b16 a[92:93], v15 offset:12800
    ds_read_b64_tr_b16 a[94:95], v15 offset:14848
    v_mfma_f32_32x32x16_bf16 v[88:103], a[120:123], v[244:247], v[88:103]
    s_cmp_eq_u32 s16, s17
    s_cselect_b32 s16, s67, s16
    buffer_load_dwordx4 a[32:35], v27, s[24:27], s80 offen offset:0 sc1
    ds_read_b64_tr_b16 a[96:97], v15 offset:16384
    ds_read_b64_tr_b16 a[98:99], v15 offset:18432
    v_mfma_f32_32x32x16_bf16 v[88:103], a[124:127], v[252:255], v[88:103]
    s_waitcnt lgkmcnt(10)
    s_add_u32 s18, s18, s19
    ds_read_b64_tr_b16 a[100:101], v15 offset:16896
    ds_read_b64_tr_b16 a[102:103], v15 offset:18944
    v_mfma_f32_32x32x16_bf16 v[104:119], a[64:67], v[132:135], v[104:119]
    buffer_load_dwordx4 a[36:39], v27, s[24:27], s80 offen offset:256 sc1
    ds_read_b64_tr_b16 a[104:105], v15 offset:20480
    ds_read_b64_tr_b16 a[106:107], v15 offset:22528
    v_mfma_f32_32x32x16_bf16 v[104:119], a[68:71], v[140:143], v[104:119]
    buffer_load_dwordx4 a[40:43], v27, s[24:27], s80 offen offset:1024 sc1
    ds_read_b64_tr_b16 a[108:109], v15 offset:20992
    ds_read_b64_tr_b16 a[110:111], v15 offset:23040
    v_mfma_f32_32x32x16_bf16 v[104:119], a[72:75], v[148:151], v[104:119]
    ds_read_b64_tr_b16 a[112:113], v15 offset:24576
    ds_read_b64_tr_b16 a[114:115], v15 offset:26624
    v_add_u32 v14, s22, v10
    v_mfma_f32_32x32x16_bf16 v[104:119], a[76:79], v[156:159], v[104:119]
    s_waitcnt lgkmcnt(10)
    ds_read_b64_tr_b16 a[116:117], v15 offset:25088
    ds_read_b64_tr_b16 a[118:119], v15 offset:27136
    v_mfma_f32_32x32x16_bf16 v[104:119], a[80:83], v[164:167], v[104:119]
    buffer_load_dwordx4 a[44:47], v27, s[24:27], s80 offen offset:1280 sc1
    ds_read_b64_tr_b16 a[120:121], v15 offset:28672
    ds_read_b64_tr_b16 a[122:123], v15 offset:30720
    v_mfma_f32_32x32x16_bf16 v[104:119], a[84:87], v[172:175], v[104:119]
    ds_read_b64_tr_b16 a[124:125], v15 offset:29184
    ds_read_b64_tr_b16 a[126:127], v15 offset:31232
    v_mfma_f32_32x32x16_bf16 v[104:119], a[88:91], v[180:183], v[104:119]
    s_waitcnt vmcnt(44)
    s_barrier
    ds_read_b64_tr_b16 a[64:65], v14 offset:0
    ds_read_b64_tr_b16 a[66:67], v14 offset:2048
    v_mfma_f32_32x32x16_bf16 v[104:119], a[92:95], v[188:191], v[104:119]
    s_waitcnt lgkmcnt(10)
    buffer_load_dwordx4 a[48:51], v27, s[24:27], s80 offen offset:2048 sc1
    ds_read_b64_tr_b16 a[68:69], v14 offset:512
    ds_read_b64_tr_b16 a[70:71], v14 offset:2560
    v_mfma_f32_32x32x16_bf16 v[104:119], a[96:99], v[196:199], v[104:119]
    buffer_load_dwordx4 a[52:55], v27, s[24:27], s80 offen offset:2304 sc1
    ds_read_b64_tr_b16 a[72:73], v14 offset:4096
    ds_read_b64_tr_b16 a[74:75], v14 offset:6144
    v_mfma_f32_32x32x16_bf16 v[104:119], a[100:103], v[204:207], v[104:119]
    ds_read_b64_tr_b16 a[76:77], v14 offset:4608
    ds_read_b64_tr_b16 a[78:79], v14 offset:6656
    v_mfma_f32_32x32x16_bf16 v[104:119], a[104:107], v[212:215], v[104:119]
    ds_read_b64_tr_b16 a[80:81], v14 offset:8192
    ds_read_b64_tr_b16 a[82:83], v14 offset:10240
    v_mfma_f32_32x32x16_bf16 v[104:119], a[108:111], v[220:223], v[104:119]
    s_waitcnt lgkmcnt(10)
    buffer_load_dwordx4 a[56:59], v27, s[24:27], s80 offen offset:3072 sc1
    ds_read_b64_tr_b16 a[84:85], v14 offset:8704
    ds_read_b64_tr_b16 a[86:87], v14 offset:10752
    v_mfma_f32_32x32x16_bf16 v[104:119], a[112:115], v[228:231], v[104:119]
    ds_read_b64_tr_b16 a[88:89], v14 offset:12288
    ds_read_b64_tr_b16 a[90:91], v14 offset:14336
    v_mfma_f32_32x32x16_bf16 v[104:119], a[116:119], v[236:239], v[104:119]
    buffer_load_dwordx4 a[60:63], v27, s[24:27], s80 offen offset:3328 sc1
    s_add_u32 s80, s80, 4096
    s_cmp_eq_u32 s69, 6
    s_cselect_b32 s80, 2147483648, s80
    ds_read_b64_tr_b16 a[92:93], v14 offset:12800
    ds_read_b64_tr_b16 a[94:95], v14 offset:14848
    v_mfma_f32_32x32x16_bf16 v[104:119], a[120:123], v[244:247], v[104:119]
    ds_read_b64_tr_b16 a[96:97], v14 offset:16384
    ds_read_b64_tr_b16 a[98:99], v14 offset:18432
    v_mfma_f32_32x32x16_bf16 v[104:119], a[124:127], v[252:255], v[104:119]
    s_waitcnt vmcnt(25)
    buffer_load_dwordx4 a[128:131], v27, s[24:27], s80 offen offset:0 sc1
    ds_read_b64_tr_b16 a[100:101], v14 offset:16896
    ds_read_b64_tr_b16 a[102:103], v14 offset:18944
    v_add_u32 v15, s22, v11
    s_waitcnt lgkmcnt(12)
    v_mfma_f32_32x32x16_bf16 v[88:103], a[64:67], v[128:131], v[88:103]
    s_add_u32 s22, s22, 32768
    buffer_load_dwordx4 a[132:135], v27, s[24:27], s80 offen offset:256 sc1
    ds_read_b64_tr_b16 a[104:105], v14 offset:20480
    ds_read_b64_tr_b16 a[106:107], v14 offset:22528
    v_mfma_f32_32x32x16_bf16 v[88:103], a[68:71], v[136:139], v[88:103]
    s_cmp_eq_u32 s22, 163840
    s_cselect_b32 s22, 0, s22
    ds_read_b64_tr_b16 a[108:109], v14 offset:20992
    ds_read_b64_tr_b16 a[110:111], v14 offset:23040
    v_mfma_f32_32x32x16_bf16 v[88:103], a[72:75], v[144:147], v[88:103]
    buffer_load_dwordx4 a[136:139], v27, s[24:27], s80 offen offset:1024 sc1
    ds_read_b64_tr_b16 a[112:113], v14 offset:24576
    ds_read_b64_tr_b16 a[114:115], v14 offset:26624
    v_mfma_f32_32x32x16_bf16 v[88:103], a[76:79], v[152:155], v[88:103]
    s_waitcnt lgkmcnt(10)
    ds_read_b64_tr_b16 a[116:117], v14 offset:25088
    ds_read_b64_tr_b16 a[118:119], v14 offset:27136
    v_mfma_f32_32x32x16_bf16 v[88:103], a[80:83], v[160:163], v[88:103]
    buffer_load_dwordx4 a[140:143], v27, s[24:27], s80 offen offset:1280 sc1
    ds_read_b64_tr_b16 a[120:121], v14 offset:28672
    ds_read_b64_tr_b16 a[122:123], v14 offset:30720
    v_mfma_f32_32x32x16_bf16 v[88:103], a[84:87], v[168:171], v[88:103]
    ds_read_b64_tr_b16 a[124:125], v14 offset:29184
    ds_read_b64_tr_b16 a[126:127], v14 offset:31232
    v_mfma_f32_32x32x16_bf16 v[88:103], a[88:91], v[176:179], v[88:103]
    buffer_load_dwordx4 a[144:147], v27, s[24:27], s80 offen offset:2048 sc1
    ds_read_b64_tr_b16 a[64:65], v15 offset:0
    ds_read_b64_tr_b16 a[66:67], v15 offset:2048
    v_mfma_f32_32x32x16_bf16 v[88:103], a[92:95], v[184:187], v[88:103]
    s_waitcnt lgkmcnt(10)
    ds_read_b64_tr_b16 a[68:69], v15 offset:512
    ds_read_b64_tr_b16 a[70:71], v15 offset:2560
    v_mfma_f32_32x32x16_bf16 v[88:103], a[96:99], v[192:195], v[88:103]
    ds_read_b64_tr_b16 a[72:73], v15 offset:4096
    ds_read_b64_tr_b16 a[74:75], v15 offset:6144
    v_mfma_f32_32x32x16_bf16 v[88:103], a[100:103], v[200:203], v[88:103]
    buffer_load_dwordx4 a[148:151], v27, s[24:27], s80 offen offset:2304 sc1
    ds_read_b64_tr_b16 a[76:77], v15 offset:4608
    ds_read_b64_tr_b16 a[78:79], v15 offset:6656
    v_mfma_f32_32x32x16_bf16 v[88:103], a[104:107], v[208:211], v[88:103]
    ds_read_b64_tr_b16 a[80:81], v15 offset:8192
    ds_read_b64_tr_b16 a[82:83], v15 offset:10240
    v_mfma_f32_32x32x16_bf16 v[88:103], a[108:111], v[216:219], v[88:103]
    s_waitcnt lgkmcnt(10)
    ds_read_b64_tr_b16 a[84:85], v15 offset:8704
    ds_read_b64_tr_b16 a[86:87], v15 offset:10752
    v_mfma_f32_32x32x16_bf16 v[88:103], a[112:115], v[224:227], v[88:103]
    buffer_load_dwordx4 a[152:155], v27, s[24:27], s80 offen offset:3072 sc1
    ds_read_b64_tr_b16 a[88:89], v15 offset:12288
    ds_read_b64_tr_b16 a[90:91], v15 offset:14336
    v_mfma_f32_32x32x16_bf16 v[88:103], a[116:119], v[232:235], v[88:103]
    ds_read_b64_tr_b16 a[92:93], v15 offset:12800
    ds_read_b64_tr_b16 a[94:95], v15 offset:14848
    v_mfma_f32_32x32x16_bf16 v[88:103], a[120:123], v[240:243], v[88:103]
    buffer_load_dwordx4 a[156:159], v27, s[24:27], s80 offen offset:3328 sc1
    s_add_u32 s80, s80, 4096
    ds_read_b64_tr_b16 a[96:97], v15 offset:16384
    ds_read_b64_tr_b16 a[98:99], v15 offset:18432
    v_mfma_f32_32x32x16_bf16 v[88:103], a[124:127], v[248:251], v[88:103]
    s_waitcnt lgkmcnt(10)
    ds_read_b64_tr_b16 a[100:101], v15 offset:16896
    ds_read_b64_tr_b16 a[102:103], v15 offset:18944
    v_mfma_f32_32x32x16_bf16 v[104:119], a[64:67], v[128:131], v[104:119]
    buffer_load_dwordx4 a[160:163], v27, s[24:27], s80 offen offset:0 sc1
    ds_read_b64_tr_b16 a[104:105], v15 offset:20480
    ds_read_b64_tr_b16 a[106:107], v15 offset:22528
    v_mfma_f32_32x32x16_bf16 v[104:119], a[68:71], v[136:139], v[104:119]
    buffer_load_dwordx4 a[164:167], v27, s[24:27], s80 offen offset:256 sc1
    ds_read_b64_tr_b16 a[108:109], v15 offset:20992
    ds_read_b64_tr_b16 a[110:111], v15 offset:23040
    v_mfma_f32_32x32x16_bf16 v[104:119], a[72:75], v[144:147], v[104:119]
    ds_read_b64_tr_b16 a[112:113], v15 offset:24576
    ds_read_b64_tr_b16 a[114:115], v15 offset:26624
    v_add_u32 v14, s22, v10
    v_mfma_f32_32x32x16_bf16 v[104:119], a[76:79], v[152:155], v[104:119]
    s_waitcnt lgkmcnt(10)
    ds_read_b64_tr_b16 a[116:117], v15 offset:25088
    ds_read_b64_tr_b16 a[118:119], v15 offset:27136
    v_mfma_f32_32x32x16_bf16 v[104:119], a[80:83], v[160:163], v[104:119]
    buffer_load_dwordx4 a[168:171], v27, s[24:27], s80 offen offset:1024 sc1
    ds_read_b64_tr_b16 a[120:121], v15 offset:28672
    ds_read_b64_tr_b16 a[122:123], v15 offset:30720
    v_mfma_f32_32x32x16_bf16 v[104:119], a[84:87], v[168:171], v[104:119]
    ds_read_b64_tr_b16 a[124:125], v15 offset:29184
    ds_read_b64_tr_b16 a[126:127], v15 offset:31232
    v_mfma_f32_32x32x16_bf16 v[104:119], a[88:91], v[176:179], v[104:119]
    s_waitcnt vmcnt(40)
    s_barrier
    ds_read_b64_tr_b16 a[64:65], v14 offset:0
    ds_read_b64_tr_b16 a[66:67], v14 offset:2048
    v_mfma_f32_32x32x16_bf16 v[104:119], a[92:95], v[184:187], v[104:119]
    s_waitcnt lgkmcnt(10)
    buffer_load_dwordx4 a[172:175], v27, s[24:27], s80 offen offset:1280 sc1
    ds_read_b64_tr_b16 a[68:69], v14 offset:512
    ds_read_b64_tr_b16 a[70:71], v14 offset:2560
    v_mfma_f32_32x32x16_bf16 v[104:119], a[96:99], v[192:195], v[104:119]
    buffer_load_dwordx4 a[176:179], v27, s[24:27], s80 offen offset:2048 sc1
    ds_read_b64_tr_b16 a[72:73], v14 offset:4096
    ds_read_b64_tr_b16 a[74:75], v14 offset:6144
    v_mfma_f32_32x32x16_bf16 v[104:119], a[100:103], v[200:203], v[104:119]
    ds_read_b64_tr_b16 a[76:77], v14 offset:4608
    ds_read_b64_tr_b16 a[78:79], v14 offset:6656
    v_mfma_f32_32x32x16_bf16 v[104:119], a[104:107], v[208:211], v[104:119]
    ds_read_b64_tr_b16 a[80:81], v14 offset:8192
    ds_read_b64_tr_b16 a[82:83], v14 offset:10240
    v_mfma_f32_32x32x16_bf16 v[104:119], a[108:111], v[216:219], v[104:119]
    s_waitcnt lgkmcnt(10)
    buffer_load_dwordx4 a[180:183], v27, s[24:27], s80 offen offset:2304 sc1
    ds_read_b64_tr_b16 a[84:85], v14 offset:8704
    ds_read_b64_tr_b16 a[86:87], v14 offset:10752
    v_mfma_f32_32x32x16_bf16 v[104:119], a[112:115], v[224:227], v[104:119]
    ds_read_b64_tr_b16 a[88:89], v14 offset:12288
    ds_read_b64_tr_b16 a[90:91], v14 offset:14336
    v_mfma_f32_32x32x16_bf16 v[104:119], a[116:119], v[232:235], v[104:119]
    buffer_load_dwordx4 a[184:187], v27, s[24:27], s80 offen offset:3072 sc1
    ds_read_b64_tr_b16 a[92:93], v14 offset:12800
    ds_read_b64_tr_b16 a[94:95], v14 offset:14848
    v_mfma_f32_32x32x16_bf16 v[104:119], a[120:123], v[240:243], v[104:119]
    ds_read_b64_tr_b16 a[96:97], v14 offset:16384
    ds_read_b64_tr_b16 a[98:99], v14 offset:18432
    v_mfma_f32_32x32x16_bf16 v[104:119], a[124:127], v[248:251], v[104:119]
    s_waitcnt vmcnt(15)
    buffer_load_dwordx4 a[188:191], v27, s[24:27], s80 offen offset:3328 sc1
    s_add_u32 s80, s80, 4096
    ds_read_b64_tr_b16 a[100:101], v14 offset:16896
    ds_read_b64_tr_b16 a[102:103], v14 offset:18944
    v_add_u32 v15, s22, v11
    s_waitcnt lgkmcnt(12)
    v_mfma_f32_32x32x16_bf16 v[88:103], a[64:67], a[0:3], v[88:103]
    s_add_u32 s22, s22, 32768
    ds_read_b64_tr_b16 a[104:105], v14 offset:20480
    ds_read_b64_tr_b16 a[106:107], v14 offset:22528
    v_mfma_f32_32x32x16_bf16 v[88:103], a[68:71], a[4:7], v[88:103]
    s_cmp_eq_u32 s22, 163840
    s_cselect_b32 s22, 0, s22
    ds_read_b64_tr_b16 a[108:109], v14 offset:20992
    ds_read_b64_tr_b16 a[110:111], v14 offset:23040
    v_mfma_f32_32x32x16_bf16 v[88:103], a[72:75], a[8:11], v[88:103]
    ds_read_b64_tr_b16 a[112:113], v14 offset:24576
    ds_read_b64_tr_b16 a[114:115], v14 offset:26624
    v_mfma_f32_32x32x16_bf16 v[88:103], a[76:79], a[12:15], v[88:103]
    s_waitcnt lgkmcnt(10)
    ds_read_b64_tr_b16 a[116:117], v14 offset:25088
    ds_read_b64_tr_b16 a[118:119], v14 offset:27136
    v_mfma_f32_32x32x16_bf16 v[88:103], a[80:83], a[16:19], v[88:103]
    ds_read_b64_tr_b16 a[120:121], v14 offset:28672
    ds_read_b64_tr_b16 a[122:123], v14 offset:30720
    v_mfma_f32_32x32x16_bf16 v[88:103], a[84:87], a[20:23], v[88:103]
    ds_read_b64_tr_b16 a[124:125], v14 offset:29184
    ds_read_b64_tr_b16 a[126:127], v14 offset:31232
    v_mfma_f32_32x32x16_bf16 v[88:103], a[88:91], a[24:27], v[88:103]
    ds_read_b64_tr_b16 a[64:65], v15 offset:0
    ds_read_b64_tr_b16 a[66:67], v15 offset:2048
    v_mfma_f32_32x32x16_bf16 v[88:103], a[92:95], a[28:31], v[88:103]
    s_waitcnt lgkmcnt(10)
    ds_read_b64_tr_b16 a[68:69], v15 offset:512
    ds_read_b64_tr_b16 a[70:71], v15 offset:2560
    v_mfma_f32_32x32x16_bf16 v[88:103], a[96:99], a[32:35], v[88:103]
    ds_read_b64_tr_b16 a[72:73], v15 offset:4096
    ds_read_b64_tr_b16 a[74:75], v15 offset:6144
    v_mfma_f32_32x32x16_bf16 v[88:103], a[100:103], a[36:39], v[88:103]
    ds_read_b64_tr_b16 a[76:77], v15 offset:4608
    ds_read_b64_tr_b16 a[78:79], v15 offset:6656
    v_mfma_f32_32x32x16_bf16 v[88:103], a[104:107], a[40:43], v[88:103]
    ds_read_b64_tr_b16 a[80:81], v15 offset:8192
    ds_read_b64_tr_b16 a[82:83], v15 offset:10240
    v_mfma_f32_32x32x16_bf16 v[88:103], a[108:111], a[44:47], v[88:103]
    s_waitcnt lgkmcnt(10)
    ds_read_b64_tr_b16 a[84:85], v15 offset:8704
    ds_read_b64_tr_b16 a[86:87], v15 offset:10752
    v_mfma_f32_32x32x16_bf16 v[88:103], a[112:115], a[48:51], v[88:103]
    ds_read_b64_tr_b16 a[88:89], v15 offset:12288
    ds_read_b64_tr_b16 a[90:91], v15 offset:14336
    v_mfma_f32_32x32x16_bf16 v[88:103], a[116:119], a[52:55], v[88:103]
    ds_read_b64_tr_b16 a[92:93], v15 offset:12800
    ds_read_b64_tr_b16 a[94:95], v15 offset:14848
    v_mfma_f32_32x32x16_bf16 v[88:103], a[120:123], a[56:59], v[88:103]
    ds_read_b64_tr_b16 a[96:97], v15 offset:16384
    ds_read_b64_tr_b16 a[98:99], v15 offset:18432
    v_mfma_f32_32x32x16_bf16 v[88:103], a[124:127], a[60:63], v[88:103]
    s_waitcnt lgkmcnt(10)
    ds_read_b64_tr_b16 a[100:101], v15 offset:16896
    ds_read_b64_tr_b16 a[102:103], v15 offset:18944
    v_mfma_f32_32x32x16_bf16 v[104:119], a[64:67], a[0:3], v[104:119]
    ds_read_b64_tr_b16 a[104:105], v15 offset:20480
    ds_read_b64_tr_b16 a[106:107], v15 offset:22528
    v_mfma_f32_32x32x16_bf16 v[104:119], a[68:71], a[4:7], v[104:119]
    ds_read_b64_tr_b16 a[108:109], v15 offset:20992
    ds_read_b64_tr_b16 a[110:111], v15 offset:23040
    v_mfma_f32_32x32x16_bf16 v[104:119], a[72:75], a[8:11], v[104:119]
    ds_read_b64_tr_b16 a[112:113], v15 offset:24576
    ds_read_b64_tr_b16 a[114:115], v15 offset:26624
    v_add_u32 v14, s22, v10
    v_mfma_f32_32x32x16_bf16 v[104:119], a[76:79], a[12:15], v[104:119]
    s_waitcnt lgkmcnt(10)
    ds_read_b64_tr_b16 a[116:117], v15 offset:25088
    ds_read_b64_tr_b16 a[118:119], v15 offset:27136
    v_mfma_f32_32x32x16_bf16 v[104:119], a[80:83], a[16:19], v[104:119]
    ds_read_b64_tr_b16 a[120:121], v15 offset:28672
    ds_read_b64_tr_b16 a[122:123], v15 offset:30720
    v_mfma_f32_32x32x16_bf16 v[104:119], a[84:87], a[20:23], v[104:119]
    ds_read_b64_tr_b16 a[124:125], v15 offset:29184
    ds_read_b64_tr_b16 a[126:127], v15 offset:31232
    v_mfma_f32_32x32x16_bf16 v[104:119], a[88:91], a[24:27], v[104:119]
    s_waitcnt vmcnt(25)
    s_barrier
    ds_read_b64_tr_b16 a[64:65], v14 offset:0
    ds_read_b64_tr_b16 a[66:67], v14 offset:2048
    v_mfma_f32_32x32x16_bf16 v[104:119], a[92:95], a[28:31], v[104:119]
    s_waitcnt lgkmcnt(10)
    ds_read_b64_tr_b16 a[68:69], v14 offset:512
    ds_read_b64_tr_b16 a[70:71], v14 offset:2560
    v_mfma_f32_32x32x16_bf16 v[104:119], a[96:99], a[32:35], v[104:119]
    ds_read_b64_tr_b16 a[72:73], v14 offset:4096
    ds_read_b64_tr_b16 a[74:75], v14 offset:6144
    v_mfma_f32_32x32x16_bf16 v[104:119], a[100:103], a[36:39], v[104:119]
    ds_read_b64_tr_b16 a[76:77], v14 offset:4608
    ds_read_b64_tr_b16 a[78:79], v14 offset:6656
    v_mfma_f32_32x32x16_bf16 v[104:119], a[104:107], a[40:43], v[104:119]
    ds_read_b64_tr_b16 a[80:81], v14 offset:8192
    ds_read_b64_tr_b16 a[82:83], v14 offset:10240
    v_mfma_f32_32x32x16_bf16 v[104:119], a[108:111], a[44:47], v[104:119]
    s_waitcnt lgkmcnt(10)
    ds_read_b64_tr_b16 a[84:85], v14 offset:8704
    ds_read_b64_tr_b16 a[86:87], v14 offset:10752
    v_mfma_f32_32x32x16_bf16 v[104:119], a[112:115], a[48:51], v[104:119]
    ds_read_b64_tr_b16 a[88:89], v14 offset:12288
    ds_read_b64_tr_b16 a[90:91], v14 offset:14336
    v_mfma_f32_32x32x16_bf16 v[104:119], a[116:119], a[52:55], v[104:119]
    ds_read_b64_tr_b16 a[92:93], v14 offset:12800
    ds_read_b64_tr_b16 a[94:95], v14 offset:14848
    v_mfma_f32_32x32x16_bf16 v[104:119], a[120:123], a[56:59], v[104:119]
    ds_read_b64_tr_b16 a[96:97], v14 offset:16384
    ds_read_b64_tr_b16 a[98:99], v14 offset:18432
    v_mfma_f32_32x32x16_bf16 v[104:119], a[124:127], a[60:63], v[104:119]
    s_waitcnt vmcnt(0)
    ds_read_b64_tr_b16 a[100:101], v14 offset:16896
    ds_read_b64_tr_b16 a[102:103], v14 offset:18944
    v_add_u32 v15, s22, v11
    s_cmp_eq_u32 s69, 6
    s_cbranch_scc1 fz_short
fz_x5:
    s_waitcnt lgkmcnt(12)
    v_mfma_f32_32x32x16_bf16 v[88:103], a[64:67], a[128:131], v[88:103]
    ds_read_b64_tr_b16 a[104:105], v14 offset:20480
    ds_read_b64_tr_b16 a[106:107], v14 offset:22528
    v_mfma_f32_32x32x16_bf16 v[88:103], a[68:71], a[132:135], v[88:103]
    ds_read_b64_tr_b16 a[108:109], v14 offset:20992
    ds_read_b64_tr_b16 a[110:111], v14 offset:23040
    v_mfma_f32_32x32x16_bf16 v[88:103], a[72:75], a[136:139], v[88:103]
    ds_read_b64_tr_b16 a[112:113], v14 offset:24576
    ds_read_b64_tr_b16 a[114:115], v14 offset:26624
    v_mfma_f32_32x32x16_bf16 v[88:103], a[76:79], a[140:143], v[88:103]
    s_waitcnt lgkmcnt(10)
    ds_read_b64_tr_b16 a[116:117], v14 offset:25088
    ds_read_b64_tr_b16 a[118:119], v14 offset:27136
    v_mfma_f32_32x32x16_bf16 v[88:103], a[80:83], a[144:147], v[88:103]
    ds_read_b64_tr_b16 a[120:121], v14 offset:28672
    ds_read_b64_tr_b16 a[122:123], v14 offset:30720
    v_mfma_f32_32x32x16_bf16 v[88:103], a[84:87], a[148:151], v[88:103]
    ds_read_b64_tr_b16 a[124:125], v14 offset:29184
    ds_read_b64_tr_b16 a[126:127], v14 offset:31232
    v_mfma_f32_32x32x16_bf16 v[88:103], a[88:91], a[152:155], v[88:103]
    ds_read_b64_tr_b16 a[64:65], v15 offset:0
    ds_read_b64_tr_b16 a[66:67], v15 offset:2048
    v_mfma_f32_32x32x16_bf16 v[88:103], a[92:95], a[156:159], v[88:103]
    s_waitcnt lgkmcnt(10)
    ds_read_b64_tr_b16 a[68:69], v15 offset:512
    ds_read_b64_tr_b16 a[70:71], v15 offset:2560
    v_mfma_f32_32x32x16_bf16 v[88:103], a[96:99], a[160:163], v[88:103]
    ds_read_b64_tr_b16 a[72:73], v15 offset:4096
    ds_read_b64_tr_b16 a[74:75], v15 offset:6144
    v_mfma_f32_32x32x16_bf16 v[88:103], a[100:103], a[164:167], v[88:103]
    ds_read_b64_tr_b16 a[76:77], v15 offset:4608
    ds_read_b64_tr_b16 a[78:79], v15 offset:6656
    v_mfma_f32_32x32x16_bf16 v[88:103], a[104:107], a[168:171], v[88:103]
    ds_read_b64_tr_b16 a[80:81], v15 offset:8192
    ds_read_b64_tr_b16 a[82:83], v15 offset:10240
    v_mfma_f32_32x32x16_bf16 v[88:103], a[108:111], a[172:175], v[88:103]
    s_waitcnt lgkmcnt(10)
    ds_read_b64_tr_b16 a[84:85], v15 offset:8704
    ds_read_b64_tr_b16 a[86:87], v15 offset:10752
    v_mfma_f32_32x32x16_bf16 v[88:103], a[112:115], a[176:179], v[88:103]
    ds_read_b64_tr_b16 a[88:89], v15 offset:12288
    ds_read_b64_tr_b16 a[90:91], v15 offset:14336
    v_mfma_f32_32x32x16_bf16 v[88:103], a[116:119], a[180:183], v[88:103]
    ds_read_b64_tr_b16 a[92:93], v15 offset:12800
    ds_read_b64_tr_b16 a[94:95], v15 offset:14848
    v_mfma_f32_32x32x16_bf16 v[88:103], a[120:123], a[184:187], v[88:103]
    ds_read_b64_tr_b16 a[96:97], v15 offset:16384
    ds_read_b64_tr_b16 a[98:99], v15 offset:18432
    v_mfma_f32_32x32x16_bf16 v[88:103], a[124:127], a[188:191], v[88:103]
    s_waitcnt lgkmcnt(10)
    ds_read_b64_tr_b16 a[100:101], v15 offset:16896
    ds_read_b64_tr_b16 a[102:103], v15 offset:18944
    v_mfma_f32_32x32x16_bf16 v[104:119], a[64:67], a[128:131], v[104:119]
    ds_read_b64_tr_b16 a[104:105], v15 offset:20480
    ds_read_b64_tr_b16 a[106:107], v15 offset:22528
    v_mfma_f32_32x32x16_bf16 v[104:119], a[68:71], a[132:135], v[104:119]
    ds_read_b64_tr_b16 a[108:109], v15 offset:20992
    ds_read_b64_tr_b16 a[110:111], v15 offset:23040
    v_mfma_f32_32x32x16_bf16 v[104:119], a[72:75], a[136:139], v[104:119]
    ds_read_b64_tr_b16 a[112:113], v15 offset:24576
    ds_read_b64_tr_b16 a[114:115], v15 offset:26624
    v_mul_f32 v88, v88, v20
    v_mul_f32 v89, v89, v20
    v_mfma_f32_32x32x16_bf16 v[104:119], a[76:79], a[140:143], v[104:119]
    s_waitcnt lgkmcnt(10)
    ds_read_b64_tr_b16 a[116:117], v15 offset:25088
    ds_read_b64_tr_b16 a[118:119], v15 offset:27136
    v_mul_f32 v90, v90, v20
    v_mul_f32 v91, v91, v20
    v_mfma_f32_32x32x16_bf16 v[104:119], a[80:83], a[144:147], v[104:119]
    ds_read_b64_tr_b16 a[120:121], v15 offset:28672
    ds_read_b64_tr_b16 a[122:123], v15 offset:30720
    v_mul_f32 v92, v92, v20
    v_mul_f32 v93, v93, v20
    v_mfma_f32_32x32x16_bf16 v[104:119], a[84:87], a[148:151], v[104:119]
    ds_read_b64_tr_b16 a[124:125], v15 offset:29184
    ds_read_b64_tr_b16 a[126:127], v15 offset:31232
    v_mul_f32 v94, v94, v20
    v_mul_f32 v95, v95, v20
    v_mfma_f32_32x32x16_bf16 v[104:119], a[88:91], a[152:155], v[104:119]
    v_cvt_pk_bf16_f32 v88, v88, v89
    v_cvt_pk_bf16_f32 v89, v90, v91
    v_mfma_f32_32x32x16_bf16 v[104:119], a[92:95], a[156:159], v[104:119]
    s_waitcnt lgkmcnt(8)
    v_cvt_pk_bf16_f32 v90, v92, v93
    v_cvt_pk_bf16_f32 v91, v94, v95
    v_mfma_f32_32x32x16_bf16 v[104:119], a[96:99], a[160:163], v[104:119]
    buffer_store_dwordx4 v[88:91], v18, s[24:27], s36 offen offset:0 sc1
    v_mul_f32 v96, v96, v20
    v_mul_f32 v97, v97, v20
    v_mfma_f32_32x32x16_bf16 v[104:119], a[100:103], a[164:167], v[104:119]
    v_mul_f32 v98, v98, v20
    v_mul_f32 v99, v99, v20
    v_mfma_f32_32x32x16_bf16 v[104:119], a[104:107], a[168:171], v[104:119]
    v_mul_f32 v100, v100, v20
    v_mul_f32 v101, v101, v20
    v_mfma_f32_32x32x16_bf16 v[104:119], a[108:111], a[172:175], v[104:119]
    s_waitcnt lgkmcnt(0)
    v_mul_f32 v102, v102, v20
    v_mul_f32 v103, v103, v20
    v_mfma_f32_32x32x16_bf16 v[104:119], a[112:115], a[176:179], v[104:119]
    v_cvt_pk_bf16_f32 v92, v96, v97
    v_cvt_pk_bf16_f32 v93, v98, v99
    v_mfma_f32_32x32x16_bf16 v[104:119], a[116:119], a[180:183], v[104:119]
    v_cvt_pk_bf16_f32 v94, v100, v101
    v_cvt_pk_bf16_f32 v95, v102, v103
    v_mfma_f32_32x32x16_bf16 v[104:119], a[120:123], a[184:187], v[104:119]
    buffer_store_dwordx4 v[92:95], v18, s[24:27], s36 offen offset:128 sc1
    v_mfma_f32_32x32x16_bf16 v[104:119], a[124:127], a[188:191], v[104:119]
    s_branch fz_oend
fz_short:
    v_mul_f32 v88, v88, v20
    v_mul_f32 v89, v89, v20
    v_mul_f32 v90, v90, v20
    v_mul_f32 v91, v91, v20
    v_mul_f32 v92, v92, v20
    v_mul_f32 v93, v93, v20
    v_mul_f32 v94, v94, v20
    v_mul_f32 v95, v95, v20
    v_cvt_pk_bf16_f32 v88, v88, v89
    v_cvt_pk_bf16_f32 v89, v90, v91
    v_cvt_pk_bf16_f32 v90, v92, v93
    v_cvt_pk_bf16_f32 v91, v94, v95
    buffer_store_dwordx4 v[88:91], v18, s[24:27], s36 offen offset:0 sc1
    v_mul_f32 v96, v96, v20
    v_mul_f32 v97, v97, v20
    v_mul_f32 v98, v98, v20
    v_mul_f32 v99, v99, v20
    v_mul_f32 v100, v100, v20
    v_mul_f32 v101, v101, v20
    v_mul_f32 v102, v102, v20
    v_mul_f32 v103, v103, v20
    v_cvt_pk_bf16_f32 v92, v96, v97
    v_cvt_pk_bf16_f32 v93, v98, v99
    v_cvt_pk_bf16_f32 v94, v100, v101
    v_cvt_pk_bf16_f32 v95, v102, v103
    buffer_store_dwordx4 v[92:95], v18, s[24:27], s36 offen offset:128 sc1
    s_branch fz_oend
fz_stash:
    ds_read_b128 a[64:67], v5 offset:16384
    ds_read_b128 a[68:71], v5 offset:17408
    ds_read_b128 a[72:75], v5 offset:18432
    ds_read_b128 a[76:79], v5 offset:19456
    ds_read_b128 a[80:83], v5 offset:20480
    ds_read_b128 a[84:87], v5 offset:21504
    ds_read_b128 a[88:91], v5 offset:22528
    ds_read_b128 a[92:95], v5 offset:23552
    ds_read_b128 a[96:99], v5 offset:24576
    ds_read_b128 a[100:103], v5 offset:25600
    v_mov_b32 v26, v20
    v_mov_b32 v27, v21
    s_nop 0
    v_permlane32_swap_b32 v20, v26
    v_permlane32_swap_b32 v21, v27
    v_add_f32 v20, v20, v26
    v_add_f32 v21, v21, v27
    v_mov_b32 v26, v20
    v_mov_b32 v27, v21
    s_nop 0
    v_permlane16_swap_b32 v20, v26
    v_permlane16_swap_b32 v21, v27
    v_add_f32 v20, v20, v26
    v_add_f32 v21, v21, v27
    v_rcp_f32 v124, v20
    v_rcp_f32 v125, v21
    v_mov_b32 v84, 0
    v_mov_b32 v85, 0
    v_mov_b32 v86, 0
    v_mov_b32 v87, 0
    v_cvt_pk_bf16_f32 v128, v128, v129
    v_cvt_pk_bf16_f32 v129, v130, v131
    v_cvt_pk_bf16_f32 v130, v132, v133
    v_cvt_pk_bf16_f32 v131, v134, v135
    v_accvgpr_write_b32 a192, v128
    v_accvgpr_write_b32 a193, v129
    v_accvgpr_write_b32 a194, v130
    v_accvgpr_write_b32 a195, v131
    v_cvt_pk_bf16_f32 v136, v136, v137
    v_cvt_pk_bf16_f32 v137, v138, v139
    v_cvt_pk_bf16_f32 v138, v140, v141
    v_cvt_pk_bf16_f32 v139, v142, v143
    v_accvgpr_write_b32 a196, v136
    v_accvgpr_write_b32 a197, v137
    v_accvgpr_write_b32 a198, v138
    v_accvgpr_write_b32 a199, v139
    v_mfma_f32_32x32x16_bf16 v[128:143], v[84:87], v[84:87], 0
    v_cvt_pk_bf16_f32 v144, v144, v145
    v_cvt_pk_bf16_f32 v145, v146, v147
    v_cvt_pk_bf16_f32 v146, v148, v149
    v_cvt_pk_bf16_f32 v147, v150, v151
    v_accvgpr_write_b32 a200, v144
    v_accvgpr_write_b32 a201, v145
    v_accvgpr_write_b32 a202, v146
    v_accvgpr_write_b32 a203, v147
    v_cvt_pk_bf16_f32 v152, v152, v153
    v_cvt_pk_bf16_f32 v153, v154, v155
    v_cvt_pk_bf16_f32 v154, v156, v157
    v_cvt_pk_bf16_f32 v155, v158, v159
    v_accvgpr_write_b32 a204, v152
    v_accvgpr_write_b32 a205, v153
    v_accvgpr_write_b32 a206, v154
    v_accvgpr_write_b32 a207, v155
    v_mfma_f32_32x32x16_bf16 v[144:159], v[84:87], v[84:87], 0
    v_cvt_pk_bf16_f32 v160, v160, v161
    v_cvt_pk_bf16_f32 v161, v162, v163
    v_cvt_pk_bf16_f32 v162, v164, v165
    v_cvt_pk_bf16_f32 v163, v166, v167
    v_accvgpr_write_b32 a208, v160
    v_accvgpr_write_b32 a209, v161
    v_accvgpr_write_b32 a210, v162
    v_accvgpr_write_b32 a211, v163
    v_cvt_pk_bf16_f32 v168, v168, v169
    v_cvt_pk_bf16_f32 v169, v170, v171
    v_cvt_pk_bf16_f32 v170, v172, v173
    v_cvt_pk_bf16_f32 v171, v174, v175
    v_accvgpr_write_b32 a212, v168
    v_accvgpr_write_b32 a213, v169
    v_accvgpr_write_b32 a214, v170
    v_accvgpr_write_b32 a215, v171
    v_mfma_f32_32x32x16_bf16 v[160:175], v[84:87], v[84:87], 0
    v_cvt_pk_bf16_f32 v176, v176, v177
    v_cvt_pk_bf16_f32 v177, v178, v179
    v_cvt_pk_bf16_f32 v178, v180, v181
    v_cvt_pk_bf16_f32 v179, v182, v183
    v_accvgpr_write_b32 a216, v176
    v_accvgpr_write_b32 a217, v177
    v_accvgpr_write_b32 a218, v178
    v_accvgpr_write_b32 a219, v179
    v_cvt_pk_bf16_f32 v184, v184, v185
    v_cvt_pk_bf16_f32 v185, v186, v187
    v_cvt_pk_bf16_f32 v186, v188, v189
    v_cvt_pk_bf16_f32 v187, v190, v191
    v_accvgpr_write_b32 a220, v184
    v_accvgpr_write_b32 a221, v185
    v_accvgpr_write_b32 a222, v186
    v_accvgpr_write_b32 a223, v187
    v_mfma_f32_32x32x16_bf16 v[176:191], v[84:87], v[84:87], 0
    v_cvt_pk_bf16_f32 v192, v192, v193
    v_cvt_pk_bf16_f32 v193, v194, v195
    v_cvt_pk_bf16_f32 v194, v196, v197
    v_cvt_pk_bf16_f32 v195, v198, v199
    v_accvgpr_write_b32 a224, v192
    v_accvgpr_write_b32 a225, v193
    v_accvgpr_write_b32 a226, v194
    v_accvgpr_write_b32 a227, v195
    v_cvt_pk_bf16_f32 v200, v200, v201
    v_cvt_pk_bf16_f32 v201, v202, v203
    v_cvt_pk_bf16_f32 v202, v204, v205
    v_cvt_pk_bf16_f32 v203, v206, v207
    v_accvgpr_write_b32 a228, v200
    v_accvgpr_write_b32 a229, v201
    v_accvgpr_write_b32 a230, v202
    v_accvgpr_write_b32 a231, v203
    v_mfma_f32_32x32x16_bf16 v[192:207], v[84:87], v[84:87], 0
    v_cvt_pk_bf16_f32 v208, v208, v209
    v_cvt_pk_bf16_f32 v209, v210, v211
    v_cvt_pk_bf16_f32 v210, v212, v213
    v_cvt_pk_bf16_f32 v211, v214, v215
    v_accvgpr_write_b32 a232, v208
    v_accvgpr_write_b32 a233, v209
    v_accvgpr_write_b32 a234, v210
    v_accvgpr_write_b32 a235, v211
    v_cvt_pk_bf16_f32 v216, v216, v217
    v_cvt_pk_bf16_f32 v217, v218, v219
    v_cvt_pk_bf16_f32 v218, v220, v221
    v_cvt_pk_bf16_f32 v219, v222, v223
    v_accvgpr_write_b32 a236, v216
    v_accvgpr_write_b32 a237, v217
    v_accvgpr_write_b32 a238, v218
    v_accvgpr_write_b32 a239, v219
    v_mfma_f32_32x32x16_bf16 v[208:223], v[84:87], v[84:87], 0
    v_cvt_pk_bf16_f32 v224, v224, v225
    v_cvt_pk_bf16_f32 v225, v226, v227
    v_cvt_pk_bf16_f32 v226, v228, v229
    v_cvt_pk_bf16_f32 v227, v230, v231
    v_accvgpr_write_b32 a240, v224
    v_accvgpr_write_b32 a241, v225
    v_accvgpr_write_b32 a242, v226
    v_accvgpr_write_b32 a243, v227
    v_cvt_pk_bf16_f32 v232, v232, v233
    v_cvt_pk_bf16_f32 v233, v234, v235
    v_cvt_pk_bf16_f32 v234, v236, v237
    v_cvt_pk_bf16_f32 v235, v238, v239
    v_accvgpr_write_b32 a244, v232
    v_accvgpr_write_b32 a245, v233
    v_accvgpr_write_b32 a246, v234
    v_accvgpr_write_b32 a247, v235
    v_mfma_f32_32x32x16_bf16 v[224:239], v[84:87], v[84:87], 0
    v_cvt_pk_bf16_f32 v240, v240, v241
    v_cvt_pk_bf16_f32 v241, v242, v243
    v_cvt_pk_bf16_f32 v242, v244, v245
    v_cvt_pk_bf16_f32 v243, v246, v247
    v_accvgpr_write_b32 a248, v240
    v_accvgpr_write_b32 a249, v241
    v_accvgpr_write_b32 a250, v242
    v_accvgpr_write_b32 a251, v243
    v_cvt_pk_bf16_f32 v248, v248, v249
    v_cvt_pk_bf16_f32 v249, v250, v251
    v_cvt_pk_bf16_f32 v250, v252, v253
    v_cvt_pk_bf16_f32 v251, v254, v255
    v_accvgpr_write_b32 a252, v248
    v_accvgpr_write_b32 a253, v249
    v_accvgpr_write_b32 a254, v250
    v_accvgpr_write_b32 a255, v251
    v_mfma_f32_32x32x16_bf16 v[240:255], v[84:87], v[84:87], 0
    s_waitcnt vmcnt(17)
    v_accvgpr_mov_b32 a0, a128
    v_accvgpr_mov_b32 a1, a129
    v_accvgpr_mov_b32 a2, a130
    v_accvgpr_mov_b32 a3, a131
    v_accvgpr_mov_b32 a4, a132
    v_accvgpr_mov_b32 a5, a133
    v_accvgpr_mov_b32 a6, a134
    v_accvgpr_mov_b32 a7, a135
    v_accvgpr_mov_b32 a8, a136
    v_accvgpr_mov_b32 a9, a137
    v_accvgpr_mov_b32 a10, a138
    v_accvgpr_mov_b32 a11, a139
    v_accvgpr_mov_b32 a12, a140
    v_accvgpr_mov_b32 a13, a141
    v_accvgpr_mov_b32 a14, a142
    v_accvgpr_mov_b32 a15, a143
    v_accvgpr_mov_b32 a16, a144
    v_accvgpr_mov_b32 a17, a145
    v_accvgpr_mov_b32 a18, a146
    v_accvgpr_mov_b32 a19, a147
    v_accvgpr_mov_b32 a20, a148
    v_accvgpr_mov_b32 a21, a149
    v_accvgpr_mov_b32 a22, a150
    v_accvgpr_mov_b32 a23, a151
    v_accvgpr_mov_b32 a24, a152
    v_accvgpr_mov_b32 a25, a153
    v_accvgpr_mov_b32 a26, a154
    v_accvgpr_mov_b32 a27, a155
    v_accvgpr_mov_b32 a28, a156
    v_accvgpr_mov_b32 a29, a157
    v_accvgpr_mov_b32 a30, a158
    v_accvgpr_mov_b32 a31, a159
    v_accvgpr_mov_b32 a32, a160
    v_accvgpr_mov_b32 a33, a161
    v_accvgpr_mov_b32 a34, a162
    v_accvgpr_mov_b32 a35, a163
    v_accvgpr_mov_b32 a36, a164
    v_accvgpr_mov_b32 a37, a165
    v_accvgpr_mov_b32 a38, a166
    v_accvgpr_mov_b32 a39, a167
    v_accvgpr_mov_b32 a40, a168
    v_accvgpr_mov_b32 a41, a169
    v_accvgpr_mov_b32 a42, a170
    v_accvgpr_mov_b32 a43, a171
    v_accvgpr_mov_b32 a44, a172
    v_accvgpr_mov_b32 a45, a173
    v_accvgpr_mov_b32 a46, a174
    v_accvgpr_mov_b32 a47, a175
    v_accvgpr_mov_b32 a48, a176
    v_accvgpr_mov_b32 a49, a177
    v_accvgpr_mov_b32 a50, a178
    v_accvgpr_mov_b32 a51, a179
    v_accvgpr_mov_b32 a52, a180
    v_accvgpr_mov_b32 a53, a181
    v_accvgpr_mov_b32 a54, a182
    v_accvgpr_mov_b32 a55, a183
    v_accvgpr_mov_b32 a56, a184
    v_accvgpr_mov_b32 a57, a185
    v_accvgpr_mov_b32 a58, a186
    v_accvgpr_mov_b32 a59, a187
    v_accvgpr_mov_b32 a60, a188
    v_accvgpr_mov_b32 a61, a189
    v_accvgpr_mov_b32 a62, a190
    v_accvgpr_mov_b32 a63, a191
    v_mov_b32 v48, 0
    v_mov_b32 v49, 0
    v_mov_b32 v50, 0
    v_mov_b32 v51, 0
    v_mov_b32 v52, 0
    v_mov_b32 v53, 0
    v_mov_b32 v54, 0
    v_mov_b32 v55, 0
    s_mov_b32 s28, 1
    s_mov_b32 s32, s35
    s_branch fz_pro
fz_stashe:
fz_crare:
    v_max_f32 v26, 0, v18
    v_max_f32 v27, 0, v19
    v_sub_f32 v18, v18, v26
    v_sub_f32 v19, v19, v27
    v_exp_f32 v26, -v26
    v_exp_f32 v27, -v27
    s_nop 0
    v_mul_f32 v20, v20, v26
    v_mul_f32 v128, v128, v26
    v_mul_f32 v129, v129, v26
    v_mul_f32 v130, v130, v26
    v_mul_f32 v131, v131, v26
    v_mul_f32 v132, v132, v26
    v_mul_f32 v133, v133, v26
    v_mul_f32 v134, v134, v26
    v_mul_f32 v135, v135, v26
    v_mul_f32 v144, v144, v26
    v_mul_f32 v145, v145, v26
    v_mul_f32 v146, v146, v26
    v_mul_f32 v147, v147, v26
    v_mul_f32 v148, v148, v26
    v_mul_f32 v149, v149, v26
    v_mul_f32 v150, v150, v26
    v_mul_f32 v151, v151, v26
    v_mul_f32 v160, v160, v26
    v_mul_f32 v161, v161, v26
    v_mul_f32 v162, v162, v26
    v_mul_f32 v163, v163, v26
    v_mul_f32 v164, v164, v26
    v_mul_f32 v165, v165, v26
    v_mul_f32 v166, v166, v26
    v_mul_f32 v167, v167, v26
    v_mul_f32 v176, v176, v26
    v_mul_f32 v177, v177, v26
    v_mul_f32 v178, v178, v26
    v_mul_f32 v179, v179, v26
    v_mul_f32 v180, v180, v26
    v_mul_f32 v181, v181, v26
    v_mul_f32 v182, v182, v26
    v_mul_f32 v183, v183, v26
    v_mul_f32 v192, v192, v26
    v_mul_f32 v193, v193, v26
    v_mul_f32 v194, v194, v26
    v_mul_f32 v195, v195, v26
    v_mul_f32 v196, v196, v26
    v_mul_f32 v197, v197, v26
    v_mul_f32 v198, v198, v26
    v_mul_f32 v199, v199, v26
    v_mul_f32 v208, v208, v26
    v_mul_f32 v209, v209, v26
    v_mul_f32 v210, v210, v26
    v_mul_f32 v211, v211, v26
    v_mul_f32 v212, v212, v26
    v_mul_f32 v213, v213, v26
    v_mul_f32 v214, v214, v26
    v_mul_f32 v215, v215, v26
    v_mul_f32 v224, v224, v26
    v_mul_f32 v225, v225, v26
    v_mul_f32 v226, v226, v26
    v_mul_f32 v227, v227, v26
    v_mul_f32 v228, v228, v26
    v_mul_f32 v229, v229, v26
    v_mul_f32 v230, v230, v26
    v_mul_f32 v231, v231, v26
    v_mul_f32 v240, v240, v26
    v_mul_f32 v241, v241, v26
    v_mul_f32 v242, v242, v26
    v_mul_f32 v243, v243, v26
    v_mul_f32 v244, v244, v26
    v_mul_f32 v245, v245, v26
    v_mul_f32 v246, v246, v26
    v_mul_f32 v247, v247, v26
    v_mul_f32 v21, v21, v27
    v_mul_f32 v136, v136, v27
    v_mul_f32 v137, v137, v27
    v_mul_f32 v138, v138, v27
    v_mul_f32 v139, v139, v27
    v_mul_f32 v140, v140, v27
    v_mul_f32 v141, v141, v27
    v_mul_f32 v142, v142, v27
    v_mul_f32 v143, v143, v27
    v_mul_f32 v152, v152, v27
    v_mul_f32 v153, v153, v27
    v_mul_f32 v154, v154, v27
    v_mul_f32 v155, v155, v27
    v_mul_f32 v156, v156, v27
    v_mul_f32 v157, v157, v27
    v_mul_f32 v158, v158, v27
    v_mul_f32 v159, v159, v27
    v_mul_f32 v168, v168, v27
    v_mul_f32 v169, v169, v27
    v_mul_f32 v170, v170, v27
    v_mul_f32 v171, v171, v27
    v_mul_f32 v172, v172, v27
    v_mul_f32 v173, v173, v27
    v_mul_f32 v174, v174, v27
    v_mul_f32 v175, v175, v27
    v_mul_f32 v184, v184, v27
    v_mul_f32 v185, v185, v27
    v_mul_f32 v186, v186, v27
    v_mul_f32 v187, v187, v27
    v_mul_f32 v188, v188, v27
    v_mul_f32 v189, v189, v27
    v_mul_f32 v190, v190, v27
    v_mul_f32 v191, v191, v27
    v_mul_f32 v200, v200, v27
    v_mul_f32 v201, v201, v27
    v_mul_f32 v202, v202, v27
    v_mul_f32 v203, v203, v27
    v_mul_f32 v204, v204, v27
    v_mul_f32 v205, v205, v27
    v_mul_f32 v206, v206, v27
    v_mul_f32 v207, v207, v27
    v_mul_f32 v216, v216, v27
    v_mul_f32 v217, v217, v27
    v_mul_f32 v218, v218, v27
    v_mul_f32 v219, v219, v27
    v_mul_f32 v220, v220, v27
    v_mul_f32 v221, v221, v27
    v_mul_f32 v222, v222, v27
    v_mul_f32 v223, v223, v27
    v_mul_f32 v232, v232, v27
    v_mul_f32 v233, v233, v27
    v_mul_f32 v234, v234, v27
    v_mul_f32 v235, v235, v27
    v_mul_f32 v236, v236, v27
    v_mul_f32 v237, v237, v27
    v_mul_f32 v238, v238, v27
    v_mul_f32 v239, v239, v27
    v_mul_f32 v248, v248, v27
    v_mul_f32 v249, v249, v27
    v_mul_f32 v250, v250, v27
    v_mul_f32 v251, v251, v27
    v_mul_f32 v252, v252, v27
    v_mul_f32 v253, v253, v27
    v_mul_f32 v254, v254, v27
    v_mul_f32 v255, v255, v27
    s_branch fz_cmb
fz_rare0:
    s_nop 7
    v_max3_f32 v18, v88, v89, v90
    v_max3_f32 v18, v18, v91, v96
    v_max3_f32 v18, v18, v97, v98
    v_max_f32 v18, v18, v99
    v_max3_f32 v19, v92, v93, v94
    v_max3_f32 v19, v19, v95, v100
    v_max3_f32 v19, v19, v101, v102
    v_max_f32 v19, v19, v103
    v_mov_b32 v26, v18
    v_mov_b32 v27, v19
    s_nop 0
    v_permlane32_swap_b32 v18, v26
    v_permlane32_swap_b32 v19, v27
    v_max_f32 v18, v18, v26
    v_max_f32 v19, v19, v27
    v_mov_b32 v26, v18
    v_mov_b32 v27, v19
    s_nop 0
    v_permlane16_swap_b32 v18, v26
    v_permlane16_swap_b32 v19, v27
    v_max_f32 v18, v18, v26
    v_max_f32 v19, v19, v27
    v_max_f32 v18, 0, v18
    v_max_f32 v19, 0, v19
    v_exp_f32 v26, -v18
    v_exp_f32 v27, -v19
    v_sub_f32 v88, v88, v18
    v_sub_f32 v89, v89, v18
    v_sub_f32 v90, v90, v18
    v_sub_f32 v91, v91, v18
    v_sub_f32 v96, v96, v18
    v_sub_f32 v97, v97, v18
    v_sub_f32 v98, v98, v18
    v_sub_f32 v99, v99, v18
    v_sub_f32 v104, v104, v18
    v_sub_f32 v105, v105, v18
    v_sub_f32 v106, v106, v18
    v_sub_f32 v107, v107, v18
    v_sub_f32 v112, v112, v18
    v_sub_f32 v113, v113, v18
    v_sub_f32 v114, v114, v18
    v_sub_f32 v115, v115, v18
    v_sub_f32 v40, v40, v18
    v_sub_f32 v41, v41, v18
    v_sub_f32 v42, v42, v18
    v_sub_f32 v43, v43, v18
    v_mul_f32 v20, v20, v26
    v_mul_f32 v128, v128, v26
    v_mul_f32 v129, v129, v26
    v_mul_f32 v130, v130, v26
    v_mul_f32 v131, v131, v26
    v_mul_f32 v132, v132, v26
    v_mul_f32 v133, v133, v26
    v_mul_f32 v134, v134, v26
    v_mul_f32 v135, v135, v26
    v_mul_f32 v144, v144, v26
    v_mul_f32 v145, v145, v26
    v_mul_f32 v146, v146, v26
    v_mul_f32 v147, v147, v26
    v_mul_f32 v148, v148, v26
    v_mul_f32 v149, v149, v26
    v_mul_f32 v150, v150, v26
    v_mul_f32 v151, v151, v26
    v_mul_f32 v160, v160, v26
    v_mul_f32 v161, v161, v26
    v_mul_f32 v162, v162, v26
    v_mul_f32 v163, v163, v26
    v_mul_f32 v164, v164, v26
    v_mul_f32 v165, v165, v26
    v_mul_f32 v166, v166, v26
    v_mul_f32 v167, v167, v26
    v_mul_f32 v176, v176, v26
    v_mul_f32 v177, v177, v26
    v_mul_f32 v178, v178, v26
    v_mul_f32 v179, v179, v26
    v_mul_f32 v180, v180, v26
    v_mul_f32 v181, v181, v26
    v_mul_f32 v182, v182, v26
    v_mul_f32 v183, v183, v26
    v_mul_f32 v192, v192, v26
    v_mul_f32 v193, v193, v26
    v_mul_f32 v194, v194, v26
    v_mul_f32 v195, v195, v26
    v_mul_f32 v196, v196, v26
    v_mul_f32 v197, v197, v26
    v_mul_f32 v198, v198, v26
    v_mul_f32 v199, v199, v26
    v_mul_f32 v208, v208, v26
    v_mul_f32 v209, v209, v26
    v_mul_f32 v210, v210, v26
    v_mul_f32 v211, v211, v26
    v_mul_f32 v212, v212, v26
    v_mul_f32 v213, v213, v26
    v_mul_f32 v214, v214, v26
    v_mul_f32 v215, v215, v26
    v_mul_f32 v224, v224, v26
    v_mul_f32 v225, v225, v26
    v_mul_f32 v226, v226, v26
    v_mul_f32 v227, v227, v26
    v_mul_f32 v228, v228, v26
    v_mul_f32 v229, v229, v26
    v_mul_f32 v230, v230, v26
    v_mul_f32 v231, v231, v26
    v_mul_f32 v240, v240, v26
    v_mul_f32 v241, v241, v26
    v_mul_f32 v242, v242, v26
    v_mul_f32 v243, v243, v26
    v_mul_f32 v244, v244, v26
    v_mul_f32 v245, v245, v26
    v_mul_f32 v246, v246, v26
    v_mul_f32 v247, v247, v26
    v_exp_f32 v32, v88
    v_exp_f32 v33, v89
    v_exp_f32 v34, v90
    v_exp_f32 v35, v91
    v_exp_f32 v36, v96
    v_exp_f32 v37, v97
    v_exp_f32 v38, v98
    v_exp_f32 v39, v99
    s_nop 0
    v_add_f32 v24, v32, v33
    v_add_f32 v24, v24, v34
    v_add_f32 v24, v24, v35
    v_add_f32 v24, v24, v36
    v_add_f32 v24, v24, v37
    v_add_f32 v24, v24, v38
    v_add_f32 v24, v24, v39
    v_cvt_pk_bf16_f32 v72, v32, v33
    v_cvt_pk_bf16_f32 v73, v34, v35
    v_cvt_pk_bf16_f32 v74, v36, v37
    v_cvt_pk_bf16_f32 v75, v38, v39
    v_sub_f32 v92, v92, v19
    v_sub_f32 v93, v93, v19
    v_sub_f32 v94, v94, v19
    v_sub_f32 v95, v95, v19
    v_sub_f32 v100, v100, v19
    v_sub_f32 v101, v101, v19
    v_sub_f32 v102, v102, v19
    v_sub_f32 v103, v103, v19
    v_sub_f32 v108, v108, v19
    v_sub_f32 v109, v109, v19
    v_sub_f32 v110, v110, v19
    v_sub_f32 v111, v111, v19
    v_sub_f32 v116, v116, v19
    v_sub_f32 v117, v117, v19
    v_sub_f32 v118, v118, v19
    v_sub_f32 v119, v119, v19
    v_sub_f32 v44, v44, v19
    v_sub_f32 v45, v45, v19
    v_sub_f32 v46, v46, v19
    v_sub_f32 v47, v47, v19
    v_mul_f32 v21, v21, v27
    v_mul_f32 v136, v136, v27
    v_mul_f32 v137, v137, v27
    v_mul_f32 v138, v138, v27
    v_mul_f32 v139, v139, v27
    v_mul_f32 v140, v140, v27
    v_mul_f32 v141, v141, v27
    v_mul_f32 v142, v142, v27
    v_mul_f32 v143, v143, v27
    v_mul_f32 v152, v152, v27
    v_mul_f32 v153, v153, v27
    v_mul_f32 v154, v154, v27
    v_mul_f32 v155, v155, v27
    v_mul_f32 v156, v156, v27
    v_mul_f32 v157, v157, v27
    v_mul_f32 v158, v158, v27
    v_mul_f32 v159, v159, v27
    v_mul_f32 v168, v168, v27
    v_mul_f32 v169, v169, v27
    v_mul_f32 v170, v170, v27
    v_mul_f32 v171, v171, v27
    v_mul_f32 v172, v172, v27
    v_mul_f32 v173, v173, v27
    v_mul_f32 v174, v174, v27
    v_mul_f32 v175, v175, v27
    v_mul_f32 v184, v184, v27
    v_mul_f32 v185, v185, v27
    v_mul_f32 v186, v186, v27
    v_mul_f32 v187, v187, v27
    v_mul_f32 v188, v188, v27
    v_mul_f32 v189, v189, v27
    v_mul_f32 v190, v190, v27
    v_mul_f32 v191, v191, v27
    v_mul_f32 v200, v200, v27
    v_mul_f32 v201, v201, v27
    v_mul_f32 v202, v202, v27
    v_mul_f32 v203, v203, v27
    v_mul_f32 v204, v204, v27
    v_mul_f32 v205, v205, v27
    v_mul_f32 v206, v206, v27
    v_mul_f32 v207, v207, v27
    v_mul_f32 v216, v216, v27
    v_mul_f32 v217, v217, v27
    v_mul_f32 v218, v218, v27
    v_mul_f32 v219, v219, v27
    v_mul_f32 v220, v220, v27
    v_mul_f32 v221, v221, v27
    v_mul_f32 v222, v222, v27
    v_mul_f32 v223, v223, v27
    v_mul_f32 v232, v232, v27
    v_mul_f32 v233, v233, v27
    v_mul_f32 v234, v234, v27
    v_mul_f32 v235, v235, v27
    v_mul_f32 v236, v236, v27
    v_mul_f32 v237, v237, v27
    v_mul_f32 v238, v238, v27
    v_mul_f32 v239, v239, v27
    v_mul_f32 v248, v248, v27
    v_mul_f32 v249, v249, v27
    v_mul_f32 v250, v250, v27
    v_mul_f32 v251, v251, v27
    v_mul_f32 v252, v252, v27
    v_mul_f32 v253, v253, v27
    v_mul_f32 v254, v254, v27
    v_mul_f32 v255, v255, v27
    v_exp_f32 v32, v92
    v_exp_f32 v33, v93
    v_exp_f32 v34, v94
    v_exp_f32 v35, v95
    v_exp_f32 v36, v100
    v_exp_f32 v37, v101
    v_exp_f32 v38, v102
    v_exp_f32 v39, v103
    s_nop 0
    v_add_f32 v25, v32, v33
    v_add_f32 v25, v25, v34
    v_add_f32 v25, v25, v35
    v_add_f32 v25, v25, v36
    v_add_f32 v25, v25, v37
    v_add_f32 v25, v25, v38
    v_add_f32 v25, v25, v39
    v_cvt_pk_bf16_f32 v76, v32, v33
    v_cvt_pk_bf16_f32 v77, v34, v35
    v_cvt_pk_bf16_f32 v78, v36, v37
    v_cvt_pk_bf16_f32 v79, v38, v39
    s_cmp_eq_u32 s30, 0
    s_cbranch_scc1 fz_ret_le
    s_cmp_eq_u32 s30, 1
    s_cbranch_scc1 fz_ret_T1
    s_branch fz_ret_T3
fz_rare1:
    s_nop 7
    v_max3_f32 v18, v104, v105, v106
    v_max3_f32 v18, v18, v107, v112
    v_max3_f32 v18, v18, v113, v114
    v_max_f32 v18, v18, v115
    v_max3_f32 v19, v108, v109, v110
    v_max3_f32 v19, v19, v111, v116
    v_max3_f32 v19, v19, v117, v118
    v_max_f32 v19, v19, v119
    v_mov_b32 v26, v18
    v_mov_b32 v27, v19
    s_nop 0
    v_permlane32_swap_b32 v18, v26
    v_permlane32_swap_b32 v19, v27
    v_max_f32 v18, v18, v26
    v_max_f32 v19, v19, v27
    v_mov_b32 v26, v18
    v_mov_b32 v27, v19
    s_nop 0
    v_permlane16_swap_b32 v18, v26
    v_permlane16_swap_b32 v19, v27
    v_max_f32 v18, v18, v26
    v_max_f32 v19, v19, v27
    v_max_f32 v18, 0, v18
    v_max_f32 v19, 0, v19
    v_exp_f32 v26, -v18
    v_exp_f32 v27, -v19
    v_sub_f32 v88, v88, v18
    v_sub_f32 v89, v89, v18
    v_sub_f32 v90, v90, v18
    v_sub_f32 v91, v91, v18
    v_sub_f32 v96, v96, v18
    v_sub_f32 v97, v97, v18
    v_sub_f32 v98, v98, v18
    v_sub_f32 v99, v99, v18
    v_sub_f32 v104, v104, v18
    v_sub_f32 v105, v105, v18
    v_sub_f32 v106, v106, v18
    v_sub_f32 v107, v107, v18
    v_sub_f32 v112, v112, v18
    v_sub_f32 v113, v113, v18
    v_sub_f32 v114, v114, v18
    v_sub_f32 v115, v115, v18
    v_sub_f32 v40, v40, v18
    v_sub_f32 v41, v41, v18
    v_sub_f32 v42, v42, v18
    v_sub_f32 v43, v43, v18
    v_mul_f32 v20, v20, v26
    v_mul_f32 v128, v128, v26
    v_mul_f32 v129, v129, v26
    v_mul_f32 v130, v130, v26
    v_mul_f32 v131, v131, v26
    v_mul_f32 v132, v132, v26
    v_mul_f32 v133, v133, v26
    v_mul_f32 v134, v134, v26
    v_mul_f32 v135, v135, v26
    v_mul_f32 v144, v144, v26
    v_mul_f32 v145, v145, v26
    v_mul_f32 v146, v146, v26
    v_mul_f32 v147, v147, v26
    v_mul_f32 v148, v148, v26
    v_mul_f32 v149, v149, v26
    v_mul_f32 v150, v150, v26
    v_mul_f32 v151, v151, v26
    v_mul_f32 v160, v160, v26
    v_mul_f32 v161, v161, v26
    v_mul_f32 v162, v162, v26
    v_mul_f32 v163, v163, v26
    v_mul_f32 v164, v164, v26
    v_mul_f32 v165, v165, v26
    v_mul_f32 v166, v166, v26
    v_mul_f32 v167, v167, v26
    v_mul_f32 v176, v176, v26
    v_mul_f32 v177, v177, v26
    v_mul_f32 v178, v178, v26
    v_mul_f32 v179, v179, v26
    v_mul_f32 v180, v180, v26
    v_mul_f32 v181, v181, v26
    v_mul_f32 v182, v182, v26
    v_mul_f32 v183, v183, v26
    v_mul_f32 v192, v192, v26
    v_mul_f32 v193, v193, v26
    v_mul_f32 v194, v194, v26
    v_mul_f32 v195, v195, v26
    v_mul_f32 v196, v196, v26
    v_mul_f32 v197, v197, v26
    v_mul_f32 v198, v198, v26
    v_mul_f32 v199, v199, v26
    v_mul_f32 v208, v208, v26
    v_mul_f32 v209, v209, v26
    v_mul_f32 v210, v210, v26
    v_mul_f32 v211, v211, v26
    v_mul_f32 v212, v212, v26
    v_mul_f32 v213, v213, v26
    v_mul_f32 v214, v214, v26
    v_mul_f32 v215, v215, v26
    v_mul_f32 v224, v224, v26
    v_mul_f32 v225, v225, v26
    v_mul_f32 v226, v226, v26
    v_mul_f32 v227, v227, v26
    v_mul_f32 v228, v228, v26
    v_mul_f32 v229, v229, v26
    v_mul_f32 v230, v230, v26
    v_mul_f32 v231, v231, v26
    v_mul_f32 v240, v240, v26
    v_mul_f32 v241, v241, v26
    v_mul_f32 v242, v242, v26
    v_mul_f32 v243, v243, v26
    v_mul_f32 v244, v244, v26
    v_mul_f32 v245, v245, v26
    v_mul_f32 v246, v246, v26
    v_mul_f32 v247, v247, v26
    v_exp_f32 v32, v104
    v_exp_f32 v33, v105
    v_exp_f32 v34, v106
    v_exp_f32 v35, v107
    v_exp_f32 v36, v112
    v_exp_f32 v37, v113
    v_exp_f32 v38, v114
    v_exp_f32 v39, v115
    s_nop 0
    v_add_f32 v24, v32, v33
    v_add_f32 v24, v24, v34
    v_add_f32 v24, v24, v35
    v_add_f32 v24, v24, v36
    v_add_f32 v24, v24, v37
    v_add_f32 v24, v24, v38
    v_add_f32 v24, v24, v39
    v_cvt_pk_bf16_f32 v80, v32, v33
    v_cvt_pk_bf16_f32 v81, v34, v35
    v_cvt_pk_bf16_f32 v82, v36, v37
    v_cvt_pk_bf16_f32 v83, v38, v39
    v_sub_f32 v92, v92, v19
    v_sub_f32 v93, v93, v19
    v_sub_f32 v94, v94, v19
    v_sub_f32 v95, v95, v19
    v_sub_f32 v100, v100, v19
    v_sub_f32 v101, v101, v19
    v_sub_f32 v102, v102, v19
    v_sub_f32 v103, v103, v19
    v_sub_f32 v108, v108, v19
    v_sub_f32 v109, v109, v19
    v_sub_f32 v110, v110, v19
    v_sub_f32 v111, v111, v19
    v_sub_f32 v116, v116, v19
    v_sub_f32 v117, v117, v19
    v_sub_f32 v118, v118, v19
    v_sub_f32 v119, v119, v19
    v_sub_f32 v44, v44, v19
    v_sub_f32 v45, v45, v19
    v_sub_f32 v46, v46, v19
    v_sub_f32 v47, v47, v19
    v_mul_f32 v21, v21, v27
    v_mul_f32 v136, v136, v27
    v_mul_f32 v137, v137, v27
    v_mul_f32 v138, v138, v27
    v_mul_f32 v139, v139, v27
    v_mul_f32 v140, v140, v27
    v_mul_f32 v141, v141, v27
    v_mul_f32 v142, v142, v27
    v_mul_f32 v143, v143, v27
    v_mul_f32 v152, v152, v27
    v_mul_f32 v153, v153, v27
    v_mul_f32 v154, v154, v27
    v_mul_f32 v155, v155, v27
    v_mul_f32 v156, v156, v27
    v_mul_f32 v157, v157, v27
    v_mul_f32 v158, v158, v27
    v_mul_f32 v159, v159, v27
    v_mul_f32 v168, v168, v27
    v_mul_f32 v169, v169, v27
    v_mul_f32 v170, v170, v27
    v_mul_f32 v171, v171, v27
    v_mul_f32 v172, v172, v27
    v_mul_f32 v173, v173, v27
    v_mul_f32 v174, v174, v27
    v_mul_f32 v175, v175, v27
    v_mul_f32 v184, v184, v27
    v_mul_f32 v185, v185, v27
    v_mul_f32 v186, v186, v27
    v_mul_f32 v187, v187, v27
    v_mul_f32 v188, v188, v27
    v_mul_f32 v189, v189, v27
    v_mul_f32 v190, v190, v27
    v_mul_f32 v191, v191, v27
    v_mul_f32 v200, v200, v27
    v_mul_f32 v201, v201, v27
    v_mul_f32 v202, v202, v27
    v_mul_f32 v203, v203, v27
    v_mul_f32 v204, v204, v27
    v_mul_f32 v205, v205, v27
    v_mul_f32 v206, v206, v27
    v_mul_f32 v207, v207, v27
    v_mul_f32 v216, v216, v27
    v_mul_f32 v217, v217, v27
    v_mul_f32 v218, v218, v27
    v_mul_f32 v219, v219, v27
    v_mul_f32 v220, v220, v27
    v_mul_f32 v221, v221, v27
    v_mul_f32 v222, v222, v27
    v_mul_f32 v223, v223, v27
    v_mul_f32 v232, v232, v27
    v_mul_f32 v233, v233, v27
    v_mul_f32 v234, v234, v27
    v_mul_f32 v235, v235, v27
    v_mul_f32 v236, v236, v27
    v_mul_f32 v237, v237, v27
    v_mul_f32 v238, v238, v27
    v_mul_f32 v239, v239, v27
    v_mul_f32 v248, v248, v27
    v_mul_f32 v249, v249, v27
    v_mul_f32 v250, v250, v27
    v_mul_f32 v251, v251, v27
    v_mul_f32 v252, v252, v27
    v_mul_f32 v253, v253, v27
    v_mul_f32 v254, v254, v27
    v_mul_f32 v255, v255, v27
    v_exp_f32 v32, v108
    v_exp_f32 v33, v109
    v_exp_f32 v34, v110
    v_exp_f32 v35, v111
    v_exp_f32 v36, v116
    v_exp_f32 v37, v117
    v_exp_f32 v38, v118
    v_exp_f32 v39, v119
    s_nop 0
    v_add_f32 v25, v32, v33
    v_add_f32 v25, v25, v34
    v_add_f32 v25, v25, v35
    v_add_f32 v25, v25, v36
    v_add_f32 v25, v25, v37
    v_add_f32 v25, v25, v38
    v_add_f32 v25, v25, v39
    v_cvt_pk_bf16_f32 v84, v32, v33
    v_cvt_pk_bf16_f32 v85, v34, v35
    v_cvt_pk_bf16_f32 v86, v36, v37
    v_cvt_pk_bf16_f32 v87, v38, v39
    s_cmp_eq_u32 s30, 0
    s_cbranch_scc1 fz_ret_lo
    s_cmp_eq_u32 s30, 1
    s_cbranch_scc1 fz_ret_L1
    s_cmp_eq_u32 s30, 2
    s_cbranch_scc1 fz_ret_T0
    s_cmp_eq_u32 s30, 3
    s_cbranch_scc1 fz_ret_T2
    s_branch fz_ret_T4
fz_fin:
    buffer_load_dwordx2 v[30:31], v26, s[24:27], 0 offen sc1
    v_bfe_u32 v80, v4, 5, 3
    v_and_b32 v81, 16, v4
    v_mov_b32 v82, 0x3f80
    v_lshlrev_b32 v81, v81, v82
    s_mov_b32 s12, s60
    s_mov_b32 s13, s61
    s_mov_b32 s14, 1835008
    s_mov_b32 s15, 0x20000
    v_cmp_eq_u32 vcc, 0, v80
    s_add_u32 s16, s3, 0
    v_mov_b32 v40, 0
    v_mov_b32 v41, 0
    v_lshlrev_b32 v200, 16, v32
    v_and_b32 v201, s38, v32
    v_cndmask_b32 v72, 0, v81, vcc
    v_cmp_eq_u32 vcc, 1, v80
    s_add_u32 s17, s3, 4096
    v_mov_b32 v42, 0
    v_mov_b32 v43, 0
    v_lshlrev_b32 v202, 16, v33
    v_and_b32 v203, s38, v33
    v_cndmask_b32 v73, 0, v81, vcc
    v_cmp_eq_u32 vcc, 2, v80
    s_add_u32 s18, s3, 8192
    v_mov_b32 v44, 0
    v_mov_b32 v45, 0
    v_lshlrev_b32 v208, 16, v34
    v_and_b32 v209, s38, v34
    v_cndmask_b32 v74, 0, v81, vcc
    v_cmp_eq_u32 vcc, 3, v80
    s_add_u32 s19, s3, 12288
    v_mov_b32 v46, 0
    v_mov_b32 v47, 0
    v_lshlrev_b32 v210, 16, v35
    v_and_b32 v211, s38, v35
    v_cndmask_b32 v75, 0, v81, vcc
    v_cmp_eq_u32 vcc, 4, v80
    s_add_u32 s20, s3, 16384
    v_mov_b32 v48, 0
    v_mov_b32 v49, 0
    v_lshlrev_b32 v216, 16, v36
    v_and_b32 v217, s38, v36
    v_cndmask_b32 v76, 0, v81, vcc
    v_cmp_eq_u32 vcc, 5, v80
    s_add_u32 s21, s3, 20480
    v_mov_b32 v50, 0
    v_mov_b32 v51, 0
    v_lshlrev_b32 v218, 16, v37
    v_and_b32 v219, s38, v37
    v_cndmask_b32 v77, 0, v81, vcc
    v_cmp_eq_u32 vcc, 6, v80
    s_add_u32 s22, s3, 24576
    v_mov_b32 v52, 0
    v_mov_b32 v53, 0
    v_lshlrev_b32 v224, 16, v38
    v_and_b32 v225, s38, v38
    v_cndmask_b32 v78, 0, v81, vcc
    v_cmp_eq_u32 vcc, 7, v80
    s_add_u32 s3, s3, 28672
    v_mov_b32 v54, 0
    v_mov_b32 v55, 0
    v_lshlrev_b32 v226, 16, v39
    v_and_b32 v227, s38, v39
    v_cndmask_b32 v79, 0, v81, vcc
    v_lshrrev_b32 v80, 9, v4
    v_and_b32 v27, 0xf0, v4
    v_lshl_add_u32 v27, v80, 8, v27
    v_bfe_u32 v80, v4, 8, 1
    s_movk_i32 s36, 0x1ff
    s_mov_b32 s37, 0
    s_mov_b32 s23, 0
    v_lshl_add_u32 v27, v80, 3, v27
    s_mov_b32 s82, 100000
    s_waitcnt vmcnt(1)
    buffer_store_dword v11, v3, s[24:27], s79 offen offset:4 sc1
    s_cmp_eq_u32 s69, 7
    s_cselect_b32 s73, s73, 2147483648
    buffer_store_dword v11, v3, s[24:27], s73 offen sc1
    s_waitcnt vmcnt(2)
fz_rnd:
    v_cmp_eq_u64 vcc, 0, v[30:31]
    v_cmp_eq_u32 s[4:5], 0, v31
    s_mov_b32 s31, s23
    s_mov_b32 s23, s37
    s_sub_u32 s82, s82, 1
    s_cselect_b32 s88, 0, 0x1ff
    s_quadmask_b32 s86, vcc_lo
    s_quadmask_b32 s87, s4
    s_and_b32 s86, s86, 15
    s_lshl4_add_u32 s86, s87, s86
    s_lshr_b32 s87, s87, 4
    s_cselect_b32 s87, 256, 0
    s_or_b32 s86, s86, s87
    s_and_b32 s86, s86, s88
    s_andn2_b32 s37, s36, s86
    s_and_b32 s36, s36, s86
    s_cbranch_scc0 fz_nofp
    buffer_load_dwordx2 v[30:31], v26, s[24:27], 0 offen sc1
fz_nofp:
    s_mov_b32 s32, 0
    s_cmp_eq_u32 s37, 0
    s_cbranch_scc1 fz_nold
    s_bitcmp1_b32 s37, 8
    s_cbranch_scc0 fz_r8
    s_mov_b32 s32, 4
    buffer_load_dwordx2 v[240:241], v27, s[24:27], s3 offen offset:0 sc1
    buffer_load_dwordx2 v[242:243], v27, s[24:27], s3 offen offset:512 sc1
    buffer_load_dwordx2 v[244:245], v27, s[24:27], s3 offen offset:1024 sc1
    buffer_load_dwordx2 v[246:247], v27, s[24:27], s3 offen offset:1536 sc1
fz_r8:
    s_bitcmp1_b32 s37, 0
    s_cbranch_scc0 fz_r0
    s_add_u32 s32, s32, 4
    buffer_load_dwordx4 v[88:91], v4, s[24:27], s16 offen offset:0 sc1
    buffer_load_dwordx4 v[104:107], v4, s[24:27], s17 offen offset:0 sc1
    buffer_load_dwordx4 v[120:123], v4, s[24:27], s18 offen offset:0 sc1
    buffer_load_dwordx4 v[136:139], v4, s[24:27], s19 offen offset:0 sc1
fz_r0:
    s_bitcmp1_b32 s37, 1
    s_cbranch_scc0 fz_r1
    s_add_u32 s32, s32, 4
    buffer_load_dwordx4 v[92:95], v4, s[24:27], s16 offen offset:1024 sc1
    buffer_load_dwordx4 v[108:111], v4, s[24:27], s17 offen offset:1024 sc1
    buffer_load_dwordx4 v[124:127], v4, s[24:27], s18 offen offset:1024 sc1
    buffer_load_dwordx4 v[140:143], v4, s[24:27], s19 offen offset:1024 sc1
fz_r1:
    s_bitcmp1_b32 s37, 2
    s_cbranch_scc0 fz_r2
    s_add_u32 s32, s32, 4
    buffer_load_dwordx4 v[96:99], v4, s[24:27], s16 offen offset:2048 sc1
    buffer_load_dwordx4 v[112:115], v4, s[24:27], s17 offen offset:2048 sc1
    buffer_load_dwordx4 v[128:131], v4, s[24:27], s18 offen offset:2048 sc1
    buffer_load_dwordx4 v[144:147], v4, s[24:27], s19 offen offset:2048 sc1
fz_r2:
    s_bitcmp1_b32 s37, 3
    s_cbranch_scc0 fz_r3
    s_add_u32 s32, s32, 4
    buffer_load_dwordx4 v[100:103], v4, s[24:27], s16 offen offset:3072 sc1
    buffer_load_dwordx4 v[116:119], v4, s[24:27], s17 offen offset:3072 sc1
    buffer_load_dwordx4 v[132:135], v4, s[24:27], s18 offen offset:3072 sc1
    buffer_load_dwordx4 v[148:151], v4, s[24:27], s19 offen offset:3072 sc1
fz_r3:
    s_bitcmp1_b32 s37, 4
    s_cbranch_scc0 fz_r4
    s_add_u32 s32, s32, 3
    buffer_load_dwordx4 v[152:155], v4, s[24:27], s20 offen offset:0 sc1
    buffer_load_dwordx4 v[168:171], v4, s[24:27], s21 offen offset:0 sc1
    buffer_load_dwordx4 v[184:187], v4, s[24:27], s22 offen offset:0 sc1
fz_r4:
    s_bitcmp1_b32 s37, 5
    s_cbranch_scc0 fz_r5
    s_add_u32 s32, s32, 3
    buffer_load_dwordx4 v[156:159], v4, s[24:27], s20 offen offset:1024 sc1
    buffer_load_dwordx4 v[172:175], v4, s[24:27], s21 offen offset:1024 sc1
    buffer_load_dwordx4 v[188:191], v4, s[24:27], s22 offen offset:1024 sc1
fz_r5:
    s_bitcmp1_b32 s37, 6
    s_cbranch_scc0 fz_r6
    s_add_u32 s32, s32, 3
    buffer_load_dwordx4 v[160:163], v4, s[24:27], s20 offen offset:2048 sc1
    buffer_load_dwordx4 v[176:179], v4, s[24:27], s21 offen offset:2048 sc1
    buffer_load_dwordx4 v[192:195], v4, s[24:27], s22 offen offset:2048 sc1
fz_r6:
    s_bitcmp1_b32 s37, 7
    s_cbranch_scc0 fz_r7
    s_add_u32 s32, s32, 3
    buffer_load_dwordx4 v[164:167], v4, s[24:27], s20 offen offset:3072 sc1
    buffer_load_dwordx4 v[180:183], v4, s[24:27], s21 offen offset:3072 sc1
    buffer_load_dwordx4 v[196:199], v4, s[24:27], s22 offen offset:3072 sc1
fz_r7:
fz_nold:
    s_cmp_eq_u32 s31, 0
    s_cbranch_scc1 fz_nosum
    s_bitcmp1_b32 s31, 0
    s_cbranch_scc0 fz_c0
    v_mfma_f32_16x16x32_bf16 v[40:43], v[72:75], v[88:91], v[40:43]
    v_mfma_f32_16x16x32_bf16 v[44:47], v[72:75], v[120:123], v[44:47]
    v_mfma_f32_16x16x32_bf16 v[40:43], v[76:79], v[104:107], v[40:43]
    v_mfma_f32_16x16x32_bf16 v[44:47], v[76:79], v[136:139], v[44:47]
fz_c0:
    s_bitcmp1_b32 s31, 1
    s_cbranch_scc0 fz_c1
    v_mfma_f32_16x16x32_bf16 v[40:43], v[72:75], v[92:95], v[40:43]
    v_mfma_f32_16x16x32_bf16 v[44:47], v[72:75], v[124:127], v[44:47]
    v_mfma_f32_16x16x32_bf16 v[40:43], v[76:79], v[108:111], v[40:43]
    v_mfma_f32_16x16x32_bf16 v[44:47], v[76:79], v[140:143], v[44:47]
fz_c1:
    s_bitcmp1_b32 s31, 2
    s_cbranch_scc0 fz_c2
    v_mfma_f32_16x16x32_bf16 v[40:43], v[72:75], v[96:99], v[40:43]
    v_mfma_f32_16x16x32_bf16 v[44:47], v[72:75], v[128:131], v[44:47]
    v_mfma_f32_16x16x32_bf16 v[40:43], v[76:79], v[112:115], v[40:43]
    v_mfma_f32_16x16x32_bf16 v[44:47], v[76:79], v[144:147], v[44:47]
fz_c2:
    s_bitcmp1_b32 s31, 3
    s_cbranch_scc0 fz_c3
    v_mfma_f32_16x16x32_bf16 v[40:43], v[72:75], v[100:103], v[40:43]
    v_mfma_f32_16x16x32_bf16 v[44:47], v[72:75], v[132:135], v[44:47]
    v_mfma_f32_16x16x32_bf16 v[40:43], v[76:79], v[116:119], v[40:43]
    v_mfma_f32_16x16x32_bf16 v[44:47], v[76:79], v[148:151], v[44:47]
fz_c3:
    s_bitcmp1_b32 s31, 4
    s_cbranch_scc0 fz_c4
    v_mfma_f32_16x16x32_bf16 v[48:51], v[72:75], v[152:155], v[48:51]
    v_mfma_f32_16x16x32_bf16 v[52:55], v[72:75], v[184:187], v[52:55]
    v_mfma_f32_16x16x32_bf16 v[48:51], v[76:79], v[168:171], v[48:51]
fz_c4:
    s_bitcmp1_b32 s31, 5
    s_cbranch_scc0 fz_c5
    v_mfma_f32_16x16x32_bf16 v[48:51], v[72:75], v[156:159], v[48:51]
    v_mfma_f32_16x16x32_bf16 v[52:55], v[72:75], v[188:191], v[52:55]
    v_mfma_f32_16x16x32_bf16 v[48:51], v[76:79], v[172:175], v[48:51]
fz_c5:
    s_bitcmp1_b32 s31, 6
    s_cbranch_scc0 fz_c6
    v_mfma_f32_16x16x32_bf16 v[48:51], v[72:75], v[160:163], v[48:51]
    v_mfma_f32_16x16x32_bf16 v[52:55], v[72:75], v[192:195], v[52:55]
    v_mfma_f32_16x16x32_bf16 v[48:51], v[76:79], v[176:179], v[48:51]
fz_c6:
    s_bitcmp1_b32 s31, 7
    s_cbranch_scc0 fz_c7
    v_mfma_f32_16x16x32_bf16 v[48:51], v[72:75], v[164:167], v[48:51]
    v_mfma_f32_16x16x32_bf16 v[52:55], v[72:75], v[196:199], v[52:55]
    v_mfma_f32_16x16x32_bf16 v[48:51], v[76:79], v[180:183], v[48:51]
fz_c7:
    s_bitcmp1_b32 s31, 8
    s_cbranch_scc0 fz_nosum
    v_lshlrev_b32 v56, 16, v240
    v_and_b32 v57, s38, v240
    v_lshlrev_b32 v58, 16, v241
    v_and_b32 v59, s38, v241
    v_lshlrev_b32 v60, 16, v242
    v_and_b32 v61, s38, v242
    v_lshlrev_b32 v62, 16, v243
    v_and_b32 v63, s38, v243
    v_lshlrev_b32 v64, 16, v244
    v_and_b32 v65, s38, v244
    v_lshlrev_b32 v66, 16, v245
    v_and_b32 v67, s38, v245
    v_lshlrev_b32 v68, 16, v246
    v_and_b32 v69, s38, v246
    v_lshlrev_b32 v70, 16, v247
    v_and_b32 v71, s38, v247
    v_mov_b32 v80, v68
    v_mov_b32 v81, v69
    v_mov_b32 v82, v70
    v_mov_b32 v83, v71
    s_nop 1
    v_permlane32_swap_b32 v68, v80
    v_permlane32_swap_b32 v69, v81
    v_permlane32_swap_b32 v70, v82
    v_permlane32_swap_b32 v71, v83
    s_nop 1
    v_add_f32 v68, v68, v80
    v_add_f32 v69, v69, v81
    v_add_f32 v70, v70, v82
    v_add_f32 v71, v71, v83
    v_mul_f32 v80, 0xbfb8aa3b, v56
    v_mul_f32 v81, 0xbfb8aa3b, v57
    v_mul_f32 v82, 0xbfb8aa3b, v58
    v_mul_f32 v83, 0xbfb8aa3b, v59
    v_mul_f32 v84, 0xbfb8aa3b, v60
    v_mul_f32 v85, 0xbfb8aa3b, v61
    v_mul_f32 v86, 0xbfb8aa3b, v62
    v_mul_f32 v87, 0xbfb8aa3b, v63
    v_exp_f32 v80, v80
    v_exp_f32 v81, v81
    v_exp_f32 v82, v82
    v_exp_f32 v83, v83
    v_exp_f32 v84, v84
    v_exp_f32 v85, v85
    v_exp_f32 v86, v86
    v_exp_f32 v87, v87
    v_add_f32 v80, 1.0, v80
    v_add_f32 v81, 1.0, v81
    v_add_f32 v82, 1.0, v82
    v_add_f32 v83, 1.0, v83
    v_add_f32 v84, 1.0, v84
    v_add_f32 v85, 1.0, v85
    v_add_f32 v86, 1.0, v86
    v_add_f32 v87, 1.0, v87
    v_rcp_f32 v80, v80
    v_rcp_f32 v81, v81
    v_rcp_f32 v82, v82
    v_rcp_f32 v83, v83
    v_rcp_f32 v84, v84
    v_rcp_f32 v85, v85
    v_rcp_f32 v86, v86
    v_rcp_f32 v87, v87
    v_mul_f32 v56, v56, v80
    v_mul_f32 v57, v57, v81
    v_mul_f32 v58, v58, v82
    v_mul_f32 v59, v59, v83
    v_mul_f32 v60, v60, v84
    v_mul_f32 v61, v61, v85
    v_mul_f32 v62, v62, v86
    v_mul_f32 v63, v63, v87
    v_mul_f32 v80, 0xbfb8aa3b, v64
    v_mul_f32 v81, 0xbfb8aa3b, v65
    v_mul_f32 v82, 0xbfb8aa3b, v66
    v_mul_f32 v83, 0xbfb8aa3b, v67
    v_mul_f32 v84, 0xbfb8aa3b, v68
    v_mul_f32 v85, 0xbfb8aa3b, v69
    v_mul_f32 v86, 0xbfb8aa3b, v70
    v_mul_f32 v87, 0xbfb8aa3b, v71
    v_exp_f32 v80, v80
    v_exp_f32 v81, v81
    v_exp_f32 v82, v82
    v_exp_f32 v83, v83
    v_exp_f32 v84, v84
    v_exp_f32 v85, v85
    v_exp_f32 v86, v86
    v_exp_f32 v87, v87
    v_add_f32 v80, 1.0, v80
    v_add_f32 v81, 1.0, v81
    v_add_f32 v82, 1.0, v82
    v_add_f32 v83, 1.0, v83
    v_add_f32 v84, 1.0, v84
    v_add_f32 v85, 1.0, v85
    v_add_f32 v86, 1.0, v86
    v_add_f32 v87, 1.0, v87
    v_rcp_f32 v80, v80
    v_rcp_f32 v81, v81
    v_rcp_f32 v82, v82
    v_rcp_f32 v83, v83
    v_rcp_f32 v84, v84
    v_rcp_f32 v85, v85
    v_rcp_f32 v86, v86
    v_rcp_f32 v87, v87
    v_mul_f32 v64, v64, v80
    v_mul_f32 v65, v65, v81
    v_mul_f32 v66, v66, v82
    v_mul_f32 v67, v67, v83
    v_mul_f32 v68, v68, v84
    v_mul_f32 v69, v69, v85
    v_mul_f32 v70, v70, v86
    v_mul_f32 v71, v71, v87
fz_nosum:
    s_or_b32 s86, s37, s23
    s_or_b32 s86, s86, s36
    s_cbranch_scc0 fz_out
    s_cmp_lt_u32 s32, 3
    s_cbranch_scc1 fz_w0
    s_cmp_lt_u32 s32, 4
    s_cbranch_scc1 fz_w1
    s_cmp_lt_u32 s32, 6
    s_cbranch_scc1 fz_w2
    s_cmp_lt_u32 s32, 8
    s_cbranch_scc1 fz_w3
    s_cmp_lt_u32 s32, 11
    s_cbranch_scc1 fz_w4
    s_cmp_lt_u32 s32, 14
    s_cbranch_scc1 fz_w5
    s_cmp_lt_u32 s32, 18
    s_cbranch_scc1 fz_w6
    s_cmp_lt_u32 s32, 24
    s_cbranch_scc1 fz_w7
    s_waitcnt vmcnt(24)
    s_branch fz_rnd
fz_w0:
    s_waitcnt vmcnt(0)
    s_branch fz_rnd
fz_w1:
    s_waitcnt vmcnt(3)
    s_branch fz_rnd
fz_w2:
    s_waitcnt vmcnt(4)
    s_branch fz_rnd
fz_w3:
    s_waitcnt vmcnt(6)
    s_branch fz_rnd
fz_w4:
    s_waitcnt vmcnt(8)
    s_branch fz_rnd
fz_w5:
    s_waitcnt vmcnt(11)
    s_branch fz_rnd
fz_w6:
    s_waitcnt vmcnt(14)
    s_branch fz_rnd
fz_w7:
    s_waitcnt vmcnt(18)
    s_branch fz_rnd
fz_out:
    s_nop 4
    v_fmac_f32 v200, v56, v40
    v_fmac_f32 v201, v57, v41
    v_fmac_f32 v202, v58, v42
    v_fmac_f32 v203, v59, v43
    v_cvt_pk_bf16_f32 v32, v200, v201
    v_cvt_pk_bf16_f32 v33, v202, v203
    buffer_store_dwordx2 v[32:33], v28, s[12:15], s78 offen offset:0
    v_fmac_f32 v208, v60, v44
    v_fmac_f32 v209, v61, v45
    v_fmac_f32 v210, v62, v46
    v_fmac_f32 v211, v63, v47
    v_cvt_pk_bf16_f32 v34, v208, v209
    v_cvt_pk_bf16_f32 v35, v210, v211
    buffer_store_dwordx2 v[34:35], v28, s[12:15], s78 offen offset:256
    v_fmac_f32 v216, v64, v48
    v_fmac_f32 v217, v65, v49
    v_fmac_f32 v218, v66, v50
    v_fmac_f32 v219, v67, v51
    v_cvt_pk_bf16_f32 v36, v216, v217
    v_cvt_pk_bf16_f32 v37, v218, v219
    buffer_store_dwordx2 v[36:37], v28, s[12:15], s78 offen offset:512
    v_fmac_f32 v224, v68, v52
    v_fmac_f32 v225, v69, v53
    v_fmac_f32 v226, v70, v54
    v_fmac_f32 v227, v71, v55
    v_cvt_pk_bf16_f32 v38, v224, v225
    v_cvt_pk_bf16_f32 v39, v226, v227
    buffer_store_dwordx2 v[38:39], v29, s[12:15], s78 offen offset:768
fz_fine:
    s_endpgm
fz_pfo:
    s_lshl_b32 s87, s68, 2
    s_add_u32 s87, s87, s66
    s_mul_i32 s88, s87, 25088
    s_mul_i32 s87, s87, 57344
    s_mul_i32 s10, s86, 40960
    s_lshl_b32 s86, s86, 14
    s_add_u32 s10, s10, 16384
    s_add_u32 s10, s10, s87
    s_add_u32 s87, s87, s86
    s_add_u32 s86, s88, 25088
    s_cmp_eq_u32 s69, 8
    s_cselect_b32 s8, s58, s50
    s_cselect_b32 s9, s59, s51
    s_cselect_b32 s10, s86, s10
    s_cselect_b32 s87, s88, s87
    s_mov_b32 s11, 0x20000
    v_lshlrev_b32 v125, 7, v1
    buffer_load_dword v124, v125, s[8:11], s87 offen
    s_add_u32 s87, s87, 8192
    buffer_load_dword v124, v125, s[8:11], s87 offen
    s_add_u32 s87, s87, 8192
    buffer_load_dword v124, v125, s[8:11], s87 offen
    s_add_u32 s87, s87, 8192
    buffer_load_dword v124, v125, s[8:11], s87 offen
    s_add_u32 s87, s87, 8192
    buffer_load_dword v124, v125, s[8:11], s87 offen
    s_add_u32 s87, s87, 8192
    s_branch fz_pfr
fz_kslow:
    s_mov_b32 s82, 100000
fz_spk:
    s_sub_u32 s82, s82, 1
    s_cbranch_scc1 fz_spxk
    buffer_load_dword v21, v22, s[24:27], s86 offen sc1
    s_waitcnt vmcnt(0)
    v_cmp_eq_u32 vcc, 0, v21
    s_cmp_eq_u64 vcc, 0
    s_cbranch_scc0 fz_spk
fz_spxk:
    s_mov_b32 s6, 268435456
    s_sub_u32 s18, s18, 98304
    s_add_u32 s16, s67, 131072
    s_add_u32 m0, s16, 16384
    s_add_u32 s89, s18, s20
    s_nop 0
    buffer_load_dwordx4 v2, s[4:7], s89 offen offset:0 sc1 lds
    buffer_load_dwordx4 v2, s[4:7], s89 offen offset:1024 sc1 lds
    buffer_load_dwordx4 v2, s[4:7], s89 offen offset:2048 sc1 lds
    buffer_load_dwordx4 v2, s[4:7], s89 offen offset:3072 sc1 lds
    s_add_u32 s16, s16, 32768
    s_cmp_eq_u32 s16, s17
    s_cselect_b32 s16, s67, s16
    s_add_u32 s18, s18, s19
    s_mov_b32 m0, s16
    s_nop 0
    buffer_load_dwordx4 v2, s[4:7], s18 offen offset:0 sc1 lds
    buffer_load_dwordx4 v2, s[4:7], s18 offen offset:1024 sc1 lds
    buffer_load_dwordx4 v2, s[4:7], s18 offen offset:2048 sc1 lds
    buffer_load_dwordx4 v2, s[4:7], s18 offen offset:3072 sc1 lds
    s_add_u32 m0, s16, 16384
    s_add_u32 s89, s18, s20
    s_nop 0
    buffer_load_dwordx4 v2, s[4:7], s89 offen offset:0 sc1 lds
    buffer_load_dwordx4 v2, s[4:7], s89 offen offset:1024 sc1 lds
    buffer_load_dwordx4 v2, s[4:7], s89 offen offset:2048 sc1 lds
    buffer_load_dwordx4 v2, s[4:7], s89 offen offset:3072 sc1 lds
    s_add_u32 s16, s16, 32768
    s_cmp_eq_u32 s16, s17
    s_cselect_b32 s16, s67, s16
    s_add_u32 s18, s18, s19
    s_mov_b32 m0, s16
    s_nop 0
    buffer_load_dwordx4 v2, s[4:7], s18 offen offset:0 sc1 lds
    buffer_load_dwordx4 v2, s[4:7], s18 offen offset:1024 sc1 lds
    buffer_load_dwordx4 v2, s[4:7], s18 offen offset:2048 sc1 lds
    buffer_load_dwordx4 v2, s[4:7], s18 offen offset:3072 sc1 lds
    s_add_u32 m0, s16, 16384
    s_add_u32 s89, s18, s20
    s_nop 0
    buffer_load_dwordx4 v2, s[4:7], s89 offen offset:0 sc1 lds
    buffer_load_dwordx4 v2, s[4:7], s89 offen offset:1024 sc1 lds
    buffer_load_dwordx4 v2, s[4:7], s89 offen offset:2048 sc1 lds
    buffer_load_dwordx4 v2, s[4:7], s89 offen offset:3072 sc1 lds
    s_add_u32 s16, s16, 32768
    s_cmp_eq_u32 s16, s17
    s_cselect_b32 s16, s67, s16
    s_add_u32 s18, s18, s19
    s_waitcnt vmcnt(16)
    s_branch fz_kok
fz_zend:
    s_endpgm
.section .rodata,"a"
.p2align 6
.amdhsa_kernel recurrent_scan__compressed_kv_cla__swiglu_ffn__prompt_kernel
  .amdhsa_next_free_vgpr 512
  .amdhsa_next_free_sgpr 102
  .amdhsa_accum_offset 256
  .amdhsa_group_segment_fixed_size 0
  .amdhsa_kernarg_size 104
  .amdhsa_user_sgpr_count 2
  .amdhsa_user_sgpr_kernarg_segment_ptr 1
  .amdhsa_system_sgpr_workgroup_id_x 1
  .amdhsa_float_denorm_mode_32 3
  .amdhsa_float_denorm_mode_16_64 3
.end_amdhsa_kernel
```
